```python
import torch

def _softmax(x, axis=-1):
    return torch.softmax(x, dim=axis)
def _gelu(x):
    return torch.nn.functional.gelu(x, approximate="tanh")
def _silu(x):
    return torch.nn.functional.silu(x)
def _sigmoid(x):
    return torch.sigmoid(x)
def _layernorm(x, axis=-1, eps=1e-5):
    m = x.mean(dim=axis, keepdim=True)
    v = x.var(dim=axis, keepdim=True, unbiased=False)
    return (x - m) / torch.sqrt(v + eps)
def _scatter_add(tgt, idx, src, axis=0):
    return tgt.clone().index_add_(axis, idx, src)
def _segment_sum(src, seg, n):
    out = torch.zeros((n,) + src.shape[1:], dtype=src.dtype)
    return out.index_add_(0, seg, src)
def _pad(x, pw):
    flat = tuple(v for pair in reversed(pw) for v in pair)
    return torch.nn.functional.pad(x, flat)

kernel_name = 'interleave_layers__sliding_local_dilated__swiglu_ffn__prompt'

def setup_inputs():

    _w = (lambda a: (lambda t: t.to(torch.bfloat16) if t.is_floating_point() else t)(torch.as_tensor(a)))
    def _A_setup():
        B, S, D = 1, 2048, 512
        return {
            "x": _w((lambda *s: torch.randn(*s, dtype=torch.bfloat16) * 0.05)(B, S, D)),
            "wqkv": _w((lambda *s: torch.randn(*s, dtype=torch.bfloat16) * 0.05)(D, 3 * D)),
            "wo": _w((lambda *s: torch.randn(*s, dtype=torch.bfloat16) * 0.05)(D, D)),
        }
    _A_in = _A_setup()

    def _B_setup():
        B, S, D, F = 1, 2048, 512, 1792
        return {
            "x": _w((lambda *s: torch.randn(*s, dtype=torch.bfloat16) * 0.05)(B, S, D)),
            "w_gate": _w((lambda *s: torch.randn(*s, dtype=torch.bfloat16) * 0.05)(D, F)),
            "w_up": _w((lambda *s: torch.randn(*s, dtype=torch.bfloat16) * 0.05)(D, F)),
            "w_down": _w((lambda *s: torch.randn(*s, dtype=torch.bfloat16) * 0.05)(F, D)),
        }
    _B_in = _B_setup()

    return {
        "A_x": _A_in["x"],
        "A_wqkv": _A_in["wqkv"],
        "A_wo": _A_in["wo"],
        "B_x": _B_in["x"],
        "B_w_gate": _B_in["w_gate"],
        "B_w_up": _B_in["w_up"],
        "B_w_down": _B_in["w_down"],
    }

def reference(A_x, A_wqkv, A_wo, B_x, B_w_gate, B_w_up, B_w_down):
    def _A_ref(x, wqkv, wo):
        B, S, D = x.shape
        H = 32; Dh = D // H
        W, dil = 8, 2
        qkv = (lambda x, *d: x.permute(*d))((x @ wqkv).reshape(B, S, 3, H, Dh), 2, 0, 3, 1, 4)
        q, k, v = qkv[0], qkv[1], qkv[2]
        scale = Dh ** -0.5
        pos = torch.arange(S)
        off = torch.arange(W) * dil
        idx = pos[:, None] - off[None, :]
        mask = idx >= 0
        idx_c = torch.where(mask, idx, 0).reshape(-1)
        kg = k[:, :, idx_c, :].reshape(B, H, S, W, Dh)
        vg = v[:, :, idx_c, :].reshape(B, H, S, W, Dh)
        logits = torch.einsum("bhsd,bhswd->bhsw", q, kg) * scale
        logits = torch.where(mask[None, None, :, :], logits, -1e9)
        attn = _softmax(logits, axis=-1)
        o = torch.einsum("bhsw,bhswd->bhsd", attn, vg)
        return (lambda x, *d: x.permute(*d))(o, 0, 2, 1, 3).reshape(B, S, D) @ wo

    def _B_ref(x, w_gate, w_up, w_down):
        g = _silu(x @ w_gate)
        u = x @ w_up
        return (g * u) @ w_down

    x = A_x
    x = x + _A_ref(_layernorm(x, axis=-1), A_wqkv, A_wo)
    x = x + _B_ref(_layernorm(x, axis=-1), B_w_gate, B_w_up, B_w_down)
    x = x + _A_ref(_layernorm(x, axis=-1), A_wqkv, A_wo)
    x = x + _B_ref(_layernorm(x, axis=-1), B_w_gate, B_w_up, B_w_down)
    return x
```

```asm
; @launch grid=(256,1,1) block=(256,1,1) lds=163840
.amdgcn_target "amdgcn-amd-amdhsa--gfx950"
.text
.globl interleave_layers__sliding_local_dilated__swiglu_ffn__prompt_kernel
.p2align 8
.type interleave_layers__sliding_local_dilated__swiglu_ffn__prompt_kernel,@function
interleave_layers__sliding_local_dilated__swiglu_ffn__prompt_kernel:
Lm_start:
s_cmp_ge_u32 s2, 256
s_cbranch_scc1 Lm_exit
s_load_dwordx4 s[68:71], s[0:1], 0
s_load_dwordx2 s[72:73], s[0:1], 16
s_load_dwordx2 s[74:75], s[0:1], 32
s_load_dwordx4 s[76:79], s[0:1], 40
s_load_dwordx2 s[4:5], s[0:1], 72
s_getpc_b64 s[80:81]
Lf_pc:
s_lshr_b32 s48, s2, 3
s_lshl_b32 s96, s48, 11
v_lshl_add_u32 v248, v0, 3, s96
global_load_dwordx2 v[124:125], v248, s[80:81]
v_lshrrev_b32 v245, 6, v0
v_and_b32 v240, 63, v0
v_readfirstlane_b32 s14, v245
v_and_b32 v243, 15, v240
v_lshrrev_b32 v244, 4, v240
s_and_b32 s13, s48, 15
s_lshr_b32 s48, s48, 4
s_and_b32 s12, s2, 7
s_lshl_b32 s12, s12, 1
s_add_u32 s12, s12, s48
s_and_b32 s15, s14, 1
s_lshl_b32 s93, s2, 1
s_add_u32 s93, s93, s15
s_lshl_b32 s21, s14, 12
s_cmp_ge_u32 s14, 2
s_cbranch_scc1 Lf_iS
s_lshl_b32 s92, s12, 4
s_add_u32 s92, s92, s13
s_lshl_b32 s92, s92, 1
s_add_u32 s92, s92, s14
v_lshlrev_b32 v248, 11, v244
v_lshl_add_u32 v248, v243, 4, v248
s_add_u32 s94, s21, 139264
s_bfe_u32 s96, s92, 0x60002
s_lshl_b32 s95, s96, 15
s_bfe_u32 s96, s92, 0x10008
s_lshl_b32 s96, s96, 10
s_add_u32 s95, s95, s96
s_and_b32 s96, s92, 3
s_lshl_b32 s96, s96, 8
s_add_u32 s95, s95, s96
s_and_b32 s96, s93, 15
s_mul_i32 s96, s96, 98304
s_lshr_b32 s97, s93, 4
s_min_u32 s97, s97, 23
s_lshl_b32 s97, s97, 7
s_add_u32 s96, s96, s97
v_and_b32 v241, 31, v240
v_mul_u32_u24 v249, 3072, v241
s_waitcnt lgkmcnt(0)
s_mov_b32 s8, s68
s_and_b32 s9, s69, 0xffff
s_mov_b32 s10, 2097152
s_mov_b32 s11, 0x20000
s_mov_b32 s68, s70
s_and_b32 s69, s71, 0xffff
s_mov_b32 s70, 1572864
s_mov_b32 s71, 0x20000
buffer_load_dword v128, v249, s[68:71], s96 offen
s_add_u32 m0, s94, 0
s_nop 0
buffer_load_dwordx4 v248, s[8:11], s95 offen lds
s_add_u32 s95, s95, 8192
s_add_u32 m0, s94, 1024
s_nop 0
buffer_load_dwordx4 v248, s[8:11], s95 offen lds
s_add_u32 s95, s95, 8192
s_add_u32 m0, s94, 2048
s_nop 0
buffer_load_dwordx4 v248, s[8:11], s95 offen lds
s_add_u32 s95, s95, 8192
s_add_u32 m0, s94, 3072
s_nop 0
buffer_load_dwordx4 v248, s[8:11], s95 offen lds
s_branch Lf_raw
Lf_iS:
s_and_b32 s96, s93, 7
s_bfe_u32 s97, s93, 0x30003
s_lshl_b32 s97, s97, 9
s_add_u32 s96, s96, s97
s_and_b32 s97, s93, 15
s_mul_i32 s97, s97, 896
s_lshr_b32 s98, s93, 4
s_add_u32 s97, s97, s98
s_cmp_lt_u32 s93, 448
s_cselect_b32 s95, s97, s96
s_cselect_b32 s96, 7, 2
s_cselect_b32 s97, 0, 0x8000
s_lshl_b32 s95, s95, 7
s_lshl_b32 s86, s96, 18
s_lshl_b32 s96, s96, 9
s_mov_b32 s87, 0x20000
s_mov_b32 s90, s86
s_mov_b32 s91, 0x20000
v_lshrrev_b32 v248, 3, v240
v_mul_u32_u24 v248, s96, v248
v_and_b32 v249, 7, v240
v_lshl_add_u32 v248, v249, 4, v248
s_lshl_b32 s96, s96, 3
s_add_u32 s97, s97, s95
s_lshl_b32 s94, s14, 13
s_add_u32 s94, s94, 131072
s_cmp_lt_u32 s93, 448
s_waitcnt lgkmcnt(0)
s_cselect_b32 s84, s74, s72
s_cselect_b32 s85, s75, s73
s_cselect_b32 s88, s76, s72
s_cselect_b32 s89, s77, s73
s_and_b32 s85, s85, 0xffff
s_and_b32 s89, s89, 0xffff
s_add_u32 m0, s94, 0
s_nop 0
buffer_load_dwordx4 v248, s[84:87], s95 offen nt lds
s_add_u32 s95, s95, s96
s_add_u32 m0, s94, 1024
s_nop 0
buffer_load_dwordx4 v248, s[84:87], s95 offen nt lds
s_add_u32 s95, s95, s96
s_add_u32 m0, s94, 2048
s_nop 0
buffer_load_dwordx4 v248, s[84:87], s95 offen nt lds
s_add_u32 s95, s95, s96
s_add_u32 m0, s94, 3072
s_nop 0
buffer_load_dwordx4 v248, s[84:87], s95 offen nt lds
s_add_u32 m0, s94, 4096
s_nop 0
buffer_load_dwordx4 v248, s[88:91], s97 offen nt lds
s_add_u32 s97, s97, s96
s_add_u32 m0, s94, 5120
s_nop 0
buffer_load_dwordx4 v248, s[88:91], s97 offen nt lds
s_add_u32 s97, s97, s96
s_add_u32 m0, s94, 6144
s_nop 0
buffer_load_dwordx4 v248, s[88:91], s97 offen nt lds
s_add_u32 s97, s97, s96
s_add_u32 m0, s94, 7168
s_nop 0
buffer_load_dwordx4 v248, s[88:91], s97 offen nt lds
v_and_b32 v241, 31, v240
s_mov_b32 s8, s68
s_and_b32 s9, s69, 0xffff
s_mov_b32 s10, 2097152
s_mov_b32 s11, 0x20000
s_mov_b32 s68, s70
s_and_b32 s69, s71, 0xffff
s_mov_b32 s70, 1572864
s_mov_b32 s71, 0x20000
Lf_raw:
v_lshlrev_b32 v1, 4, v240
v_lshrrev_b32 v242, 5, v240
s_lshr_b32 s16, s14, 1
s_and_b32 s5, s5, 0xffff
s_mov_b32 s6, 0x10000000
s_mov_b32 s7, 0x20000
v_xor_b32 v248, v243, v244
v_lshlrev_b32 v248, 4, v248
v_lshl_add_u32 v249, v244, 11, v248
v_xor_b32 v248, v242, v243
v_lshlrev_b32 v248, 4, v248
v_lshl_add_u32 v250, v243, 8, v248
v_and_b32 v248, 1, v244
v_lshl_add_u32 v250, v248, 3, v250
s_lshl_b32 s48, s15, 13
s_lshl_b32 s49, s14, 6
v_xor_b32 v220, s49, v249
v_xor_b32 v208, 0, v249
v_add_u32 v208, 0, v208
v_xor_b32 v216, 0, v250
v_add_u32 v212, s48, v216
v_add_u32 v216, 131072, v216
v_xor_b32 v160, 32, v212
v_xor_b32 v188, 32, v216
v_xor_b32 v209, 64, v249
v_add_u32 v209, 7168, v209
v_xor_b32 v217, 64, v250
v_add_u32 v213, s48, v217
v_add_u32 v217, 131072, v217
v_xor_b32 v161, 32, v213
v_xor_b32 v189, 32, v217
v_xor_b32 v210, 128, v249
v_add_u32 v210, 14336, v210
v_xor_b32 v218, 128, v250
v_add_u32 v214, s48, v218
v_add_u32 v218, 131072, v218
v_xor_b32 v162, 32, v214
v_xor_b32 v190, 32, v218
v_xor_b32 v211, 192, v249
v_add_u32 v211, 21504, v211
v_xor_b32 v219, 192, v250
v_add_u32 v215, s48, v219
v_add_u32 v219, 131072, v219
v_xor_b32 v163, 32, v215
v_xor_b32 v191, 32, v219
v_lshrrev_b32 v249, 3, v240
v_mul_u32_u24 v249, 3072, v249
v_lshlrev_b32 v250, 1, v244
v_and_b32 v245, 7, v240
v_xor_b32 v250, v250, v245
v_lshl_add_u32 v221, v250, 4, v249
v_lshrrev_b32 v249, 2, v243
v_lshl_add_u32 v249, v248, 2, v249
v_lshrrev_b32 v250, 1, v249
v_lshlrev_b32 v249, 7, v249
v_lshl_add_u32 v249, v250, 5, v249
v_and_b32 v250, 3, v240
v_lshl_add_u32 v249, v250, 3, v249
v_mul_u32_u24 v250, 3072, v242
v_add_u32 v249, v249, v250
v_add_u32 v249, 32768, v249
s_lshl_b32 s48, s16, 6
v_xor_b32 v222, s48, v249
v_xor_b32 v223, 32, v222
s_lshl_b32 s48, s15, 5
v_xor_b32 v192, s48, v222
s_and_b32 s49, s13, 1
s_lshl_b32 s48, s49, 6
v_xor_b32 v193, s48, v249
s_mul_i32 s48, s14, 12288
v_add_u32 v193, s48, v193
v_xor_b32 v194, 32, v193
s_lshl_b32 s48, s12, 1
s_add_u32 s48, s48, s49
s_lshl_b32 s48, s48, 2
s_add_u32 s50, s48, s14
s_and_b32 s49, s50, 63
s_lshl_b32 s49, s49, 15
s_lshr_b32 s50, s50, 6
s_lshl_b32 s50, s50, 10
s_add_u32 s80, s50, s49
s_add_u32 s48, s48, 127
s_and_b32 s49, s48, 63
s_lshl_b32 s49, s49, 15
s_bfe_u32 s48, s48, 0x10006
s_lshl_b32 s48, s48, 10
s_add_u32 s48, s48, s49
s_lshl_b32 s49, s14, 13
s_add_u32 s81, s48, s49
s_mul_i32 s48, s14, 49152
s_lshr_b32 s49, s13, 1
s_lshl_b32 s49, s49, 7
s_add_u32 s82, s48, s49
s_mul_i32 s3, s14, 6144
s_add_u32 s3, s3, 32768
s_lshl_b32 s57, s14, 10
s_add_u32 s57, s57, 131072
s_mul_i32 s17, s13, 98304
s_add_u32 s17, s17, s21
s_and_b32 s98, s13, 7
s_lshr_b32 s99, s13, 3
s_mov_b32 s66, 1
s_mov_b32 s52, 0
s_lshl_b32 s18, s98, 16
s_add_u32 s18, s18, s21
s_add_u32 s18, s18, 1572864
s_mul_i32 s19, s13, 229376
s_add_u32 s19, s19, s21
s_add_u32 s19, s19, 2097152
s_mul_i32 s20, s98, 229376
s_add_u32 s20, s20, s21
s_add_u32 s20, s20, 5767168
s_lshl_b32 s48, s12, 2
s_lshl_b32 s49, s99, 1
s_add_u32 s49, s49, s15
s_add_u32 s49, s49, s48
s_add_u32 s48, s48, s14
s_lshl_b32 s50, s48, 15
s_add_u32 s22, s50, 8388608
s_add_u32 s30, s50, 12582912
s_lshl_b32 s50, s48, 12
s_add_u32 s31, s50, 14942208
s_and_b32 s50, s13, 1
s_lshl_b32 s50, s50, 1
s_lshl_b32 s51, s12, 2
s_add_u32 s51, s51, s50
s_add_u32 s25, s51, 63
s_and_b32 s25, s25, 63
s_lshl_b32 s25, s25, 12
s_add_u32 s25, s25, 14680064
s_add_u32 s51, s51, s15
s_lshl_b32 s23, s51, 12
s_add_u32 s23, s23, 14680064
s_lshl_b32 s26, s51, 5
s_and_b32 s51, s13, 14
s_add_u32 s51, s51, s16
s_add_u32 s26, s26, s51
s_lshl_b32 s26, s26, 10
s_add_u32 s26, s26, 10485760
s_add_u32 s50, s50, s15
s_lshl_b32 s50, s50, 4
s_add_u32 s50, s50, s51
s_lshl_b32 s36, s50, 3
s_mul_i32 s32, s48, 114688
s_mul_i32 s50, s13, 7
s_add_u32 s50, s50, 1
s_lshr_b32 s50, s50, 1
s_lshl_b32 s50, s50, 10
s_add_u32 s32, s32, s50
s_add_u32 s32, s32, 15728640
s_mul_i32 s33, s49, 114688
s_mul_i32 s50, s16, 28672
s_add_u32 s33, s33, s50
s_add_u32 s33, s33, 15728640
s_lshl_b32 s50, s49, 15
s_lshl_b32 s51, s16, 13
s_add_u32 s27, s50, s51
s_add_u32 s27, s27, 10485760
s_lshl_b32 s51, s98, 1
s_add_u32 s51, s51, s16
s_lshl_b32 s51, s51, 10
s_add_u32 s50, s50, s51
s_add_u32 s28, s50, 12582912
s_add_u32 s34, s50, 25165824
s_add_u32 s50, s12, 1
s_and_b32 s50, s50, 15
s_lshl_b32 s44, s50, 14
s_lshr_b32 s51, s51, 7
s_add_u32 s44, s44, s51
s_add_u32 s44, s44, 7866880
s_lshl_b32 s51, s98, 9
s_lshl_b32 s50, s16, 3
s_add_u32 s51, s51, s50
s_lshl_b32 s50, s49, 12
s_add_u32 s50, s50, s51
s_add_u32 s29, s50, 14942208
s_add_u32 s35, s50, 31457280
s_add_u32 s50, s12, 15
s_and_b32 s50, s50, 15
s_lshl_b32 s24, s50, 17
s_add_u32 s24, s24, s21
s_add_u32 s24, s24, 8503296
s_lshl_b32 s50, s12, 14
s_add_u32 s50, s50, 7864320
s_add_u32 s45, s50, 2560
s_add_u32 s46, s50, 2688
s_lshl_b32 s51, s14, 7
s_add_u32 s51, s51, s50
s_add_u32 s39, s51, 1024
s_add_u32 s43, s51, 2048
s_lshl_b32 s48, s13, 3
s_add_u32 s51, s51, s48
s_add_u32 s36, s36, s50
s_add_u32 s40, s51, 4096
s_getreg_b32 s55, hwreg(HW_REG_XCC_ID, 0, 4)
s_add_u32 s55, s55, 1
v_min_u32 v26, 1, v1
v_lshlrev_b32 v26, 30, v26
s_and_b32 s51, s49, 3
s_cmp_eq_u32 s51, 3
s_cselect_b32 s53, 1, 0
s_lshl_b32 s51, s51, 7
s_add_u32 s51, s51, s50
s_lshl_b32 s48, s16, 6
s_add_u32 s48, s48, s51
s_add_u32 s37, s48, 0
s_add_u32 s41, s48, 4096
s_lshl_b32 s48, s98, 1
s_add_u32 s48, s48, s16
s_lshl_b32 s48, s48, 3
s_add_u32 s48, s48, s51
s_add_u32 s38, s48, 1024
s_add_u32 s42, s48, 2048
s_and_b32 s48, s49, 31
s_lshl_b32 s48, s48, 16
s_lshr_b32 s54, s49, 5
s_lshl_b32 s54, s54, 10
s_add_u32 s54, s54, s48
s_lshl_b32 s48, s98, 7
s_add_u32 s54, s54, s48
s_lshl_b32 s48, s16, 6
s_add_u32 s54, s54, s48
v_add_u32 v2, 0x10000, v1
v_add_u32 v3, 0x20000, v1
v_add_u32 v4, 16384, v1
v_add_u32 v5, 4096, v1
v_lshlrev_b32 v245, 4, v241
v_lshl_add_u32 v6, v242, 9, v245
v_lshl_add_u32 v7, v242, 2, v245
s_lshl_b32 s48, s16, 13
v_add_u32 v8, s48, v1
v_add_u32 v11, s21, v1
v_add_u32 v9, s48, v2
v_add_u32 v12, s21, v2
v_add_u32 v10, s48, v3
v_add_u32 v13, s21, v3
v_lshlrev_b32 v16, 3, v243
v_and_b32 v17, 56, v16
s_add_u32 s48, s21, 147456
v_add_u32 v18, s48, v1
s_xor_b32 s48, s21, 8192
s_add_u32 s48, s48, 147456
v_add_u32 v19, s48, v1
s_lshl_b32 s48, s14, 11
s_add_u32 s48, s48, 147456
v_add_u32 v22, s48, v1
s_add_u32 s48, s48, 2048
s_cmp_eq_u32 s15, 0
s_cselect_b32 s48, s48, 155648
v_add_u32 v20, s48, v1
s_lshl_b32 s48, s16, 12
s_lshl_b32 s50, s15, 10
s_add_u32 s48, s48, s50
s_add_u32 s48, s48, 147456
v_add_u32 v21, s48, v1
s_lshl_b32 s48, s14, 9
s_add_u32 s48, s48, 157696
v_lshl_add_u32 v23, v240, 2, s48
v_lshl_add_u32 v24, v243, 2, s48
v_lshl_add_u32 v25, v244, 4, s48
s_lshl_b32 s56, s15, 2
s_cmp_lg_u32 s15, 0
s_cselect_b64 vcc, -1, 0
v_cndmask_b32 v30, v24, v25, vcc
v_add_u32 v30, 320, v30
s_mov_b32 s62, 0
s_mov_b32 s63, -1
v_mov_b32 v164, 0x3f803f80
v_mov_b32 v165, 0x3f803f80
v_mov_b32 v166, 0x3f803f80
v_mov_b32 v167, 0x3f803f80
v_lshlrev_b32 v245, 2, v244
v_sub_u32 v245, v243, v245
v_mov_b32 v249, 0xf149f2ca
s_and_b32 s48, s12, 7
s_or_b32 s48, s48, s15
s_and_b32 s50, s13, 1
s_or_b32 s48, s48, s50
v_subrev_u32 v248, 0, v245
v_cmp_le_u32 vcc, 8, v248
s_nop 1
v_cndmask_b32 v132, 0, v249, vcc
v_add_u32 v248, 16, v248
v_cmp_le_u32 vcc, 8, v248
s_nop 1
v_cndmask_b32 v136, 0, v249, vcc
v_subrev_u32 v248, 1, v245
v_cmp_le_u32 vcc, 8, v248
s_nop 1
v_cndmask_b32 v133, 0, v249, vcc
v_add_u32 v248, 16, v248
v_cmp_le_u32 vcc, 8, v248
s_nop 1
v_cndmask_b32 v137, 0, v249, vcc
v_subrev_u32 v248, 2, v245
v_cmp_le_u32 vcc, 8, v248
s_nop 1
v_cndmask_b32 v134, 0, v249, vcc
v_add_u32 v248, 16, v248
v_cmp_le_u32 vcc, 8, v248
s_nop 1
v_cndmask_b32 v138, 0, v249, vcc
v_subrev_u32 v248, 3, v245
v_cmp_le_u32 vcc, 8, v248
s_nop 1
v_cndmask_b32 v135, 0, v249, vcc
v_add_u32 v248, 16, v248
v_cmp_le_u32 vcc, 8, v248
s_nop 1
v_cndmask_b32 v139, 0, v249, vcc
s_cmp_eq_u32 s48, 0
s_cselect_b64 vcc, -1, 0
v_cndmask_b32 v140, v136, v249, vcc
v_cndmask_b32 v141, v137, v249, vcc
v_cndmask_b32 v142, v138, v249, vcc
v_cndmask_b32 v143, v139, v249, vcc
s_lshl_b32 s48, s13, 2
s_add_u32 s48, s48, s14
s_add_u32 s49, s48, 10
s_cmp_lt_u32 s48, 22
s_cselect_b32 s48, s48, s49
s_lshl_b32 s48, s48, 7
s_add_u32 s48, s48, s46
s_sub_u32 s48, s48, 2688
buffer_load_dword v126, v26, s[4:7], s48 offen sc1
s_lshl_b32 s48, s2, 3
s_lshl_b32 s49, s15, 12
s_add_u32 s48, s48, s49
s_add_u32 s48, s48, 8126464
buffer_load_dword v127, v26, s[4:7], s48 offen sc1
v_mov_b32 v36, 8134656
buffer_load_dword v37, v36, s[4:7], 0 offen sc1
s_mov_b32 s99, 268435456
s_mov_b32 s72, 268435456
s_mov_b32 s73, 268435456
s_mov_b32 s74, 268435456
s_mov_b32 s75, 268435456
s_mov_b32 s76, 268435456
s_mov_b32 s77, 268435456
s_mov_b32 s78, 268435456
s_mov_b32 s79, 268435456
s_mov_b32 s84, 268435456
s_mov_b32 s85, 268435456
s_mov_b32 s86, 268435456
s_mov_b32 s87, 268435456
v_mov_b32 v176, 0
s_cmp_ge_u32 s14, 2
s_cbranch_scc1 Lf_a2
v_lshlrev_b32 v248, 8, v243
v_lshl_add_u32 v248, v244, 3, v248
v_add_u32 v177, s94, v248
v_lshlrev_b32 v250, 9, v242
v_and_b32 v249, 1, v244
v_lshlrev_b32 v249, 3, v249
v_add_u32 v250, v250, v249
v_lshl_add_u32 v176, v243, 4, v250
s_lshl_b32 s96, s92, 12
s_add_u32 s72, s96, 8388608
s_add_u32 s73, s96, 8389632
s_add_u32 s74, s96, 8390656
s_add_u32 s75, s96, 8391680
s_lshr_b32 s97, s92, 3
s_lshl_b32 s97, s97, 12
s_and_b32 s50, s92, 4
s_lshl_b32 s50, s50, 6
s_add_u32 s97, s97, s50
s_and_b32 s50, s92, 3
s_lshl_b32 s50, s50, 10
s_add_u32 s97, s97, s50
s_add_u32 s99, s97, 14680064
v_mov_b32 v172, 0
v_mov_b32 v173, 0
v_mov_b32 v174, 0
v_mov_b32 v175, 0
s_branch Lf_g0
Lf_a2:
s_cmp_ge_u32 s93, 448
s_cbranch_scc1 Lf_aO
v_lshrrev_b32 v248, 2, v243
v_lshl_add_u32 v248, v244, 2, v248
v_lshlrev_b32 v248, 7, v248
v_and_b32 v249, 3, v243
v_lshlrev_b32 v249, 3, v249
v_add3_u32 v248, v248, v249, s94
v_mov_b32 v177, v248
v_lshlrev_b32 v250, 2, v241
v_lshl_add_u32 v250, v242, 30, v250
s_lshr_b32 s96, s93, 4
s_lshl_b32 s96, s96, 2
s_add_u32 s96, s96, 0
s_mul_i32 s97, s96, 147
s_lshr_b32 s97, s97, 10
s_mul_i32 s88, s97, 7
s_sub_u32 s96, s96, s88
s_and_b32 s88, s97, 1
s_sub_u32 s96, s96, s88
s_cselect_b32 s96, 6, s96
s_and_b32 s88, s93, 15
s_lshl_b32 s48, s88, 1
s_add_u32 s48, s48, s96
s_lshl_b32 s49, s96, 4
s_add_u32 s49, s49, s88
s_cmp_lt_u32 s96, 2
s_cselect_b32 s48, s48, s49
s_mul_i32 s50, s97, 112
s_add_u32 s48, s48, s50
s_lshl_b32 s48, s48, 11
s_add_u32 s72, s48, 2097152
s_add_u32 s73, s48, 2098176
s_lshl_b32 s97, s97, 4
s_add_u32 s97, s97, s88
s_mul_i32 s97, s97, 896
s_lshl_b32 s96, s96, 7
s_add_u32 s97, s97, s96
s_add_u32 s84, s97, 7602176
s_lshr_b32 s96, s93, 4
s_lshl_b32 s96, s96, 2
s_add_u32 s96, s96, 1
s_mul_i32 s97, s96, 147
s_lshr_b32 s97, s97, 10
s_mul_i32 s88, s97, 7
s_sub_u32 s96, s96, s88
s_and_b32 s88, s97, 1
s_sub_u32 s96, s96, s88
s_cselect_b32 s96, 6, s96
s_and_b32 s88, s93, 15
s_lshl_b32 s48, s88, 1
s_add_u32 s48, s48, s96
s_lshl_b32 s49, s96, 4
s_add_u32 s49, s49, s88
s_cmp_lt_u32 s96, 2
s_cselect_b32 s48, s48, s49
s_mul_i32 s50, s97, 112
s_add_u32 s48, s48, s50
s_lshl_b32 s48, s48, 11
s_add_u32 s74, s48, 2097152
s_add_u32 s75, s48, 2098176
s_lshl_b32 s97, s97, 4
s_add_u32 s97, s97, s88
s_mul_i32 s97, s97, 896
s_lshl_b32 s96, s96, 7
s_add_u32 s97, s97, s96
s_add_u32 s85, s97, 7602176
s_lshr_b32 s96, s93, 4
s_lshl_b32 s96, s96, 2
s_add_u32 s96, s96, 2
s_mul_i32 s97, s96, 147
s_lshr_b32 s97, s97, 10
s_mul_i32 s88, s97, 7
s_sub_u32 s96, s96, s88
s_and_b32 s88, s97, 1
s_sub_u32 s96, s96, s88
s_cselect_b32 s96, 6, s96
s_and_b32 s88, s93, 15
s_lshl_b32 s48, s88, 1
s_add_u32 s48, s48, s96
s_lshl_b32 s49, s96, 4
s_add_u32 s49, s49, s88
s_cmp_lt_u32 s96, 2
s_cselect_b32 s48, s48, s49
s_mul_i32 s50, s97, 112
s_add_u32 s48, s48, s50
s_lshl_b32 s48, s48, 11
s_add_u32 s76, s48, 2097152
s_add_u32 s77, s48, 2098176
s_lshl_b32 s97, s97, 4
s_add_u32 s97, s97, s88
s_mul_i32 s97, s97, 896
s_lshl_b32 s96, s96, 7
s_add_u32 s97, s97, s96
s_add_u32 s86, s97, 7602176
s_lshr_b32 s96, s93, 4
s_lshl_b32 s96, s96, 2
s_add_u32 s96, s96, 3
s_mul_i32 s97, s96, 147
s_lshr_b32 s97, s97, 10
s_mul_i32 s88, s97, 7
s_sub_u32 s96, s96, s88
s_and_b32 s88, s97, 1
s_sub_u32 s96, s96, s88
s_cselect_b32 s96, 6, s96
s_and_b32 s88, s93, 15
s_lshl_b32 s48, s88, 1
s_add_u32 s48, s48, s96
s_lshl_b32 s49, s96, 4
s_add_u32 s49, s49, s88
s_cmp_lt_u32 s96, 2
s_cselect_b32 s48, s48, s49
s_mul_i32 s50, s97, 112
s_add_u32 s48, s48, s50
s_lshl_b32 s48, s48, 11
s_add_u32 s78, s48, 2097152
s_add_u32 s79, s48, 2098176
s_lshl_b32 s97, s97, 4
s_add_u32 s97, s97, s88
s_mul_i32 s97, s97, 896
s_lshl_b32 s96, s96, 7
s_add_u32 s97, s97, s96
s_add_u32 s87, s97, 7602176
s_branch Lf_g0
Lf_aO:
v_lshrrev_b32 v248, 2, v243
v_lshl_add_u32 v248, v244, 2, v248
v_lshlrev_b32 v248, 7, v248
v_and_b32 v249, 3, v243
v_lshlrev_b32 v249, 3, v249
v_add3_u32 v248, v248, v249, s94
v_mov_b32 v177, v248
s_sub_u32 s96, s93, 448
s_and_b32 s97, s96, 7
s_lshl_b32 s97, s97, 6
s_lshr_b32 s96, s96, 3
s_and_b32 s88, s96, 3
s_lshl_b32 s88, s88, 4
s_add_u32 s97, s97, s88
s_lshr_b32 s96, s96, 2
s_lshl_b32 s88, s96, 3
s_add_u32 s97, s97, s88
s_lshl_b32 s97, s97, 10
s_add_u32 s97, s97, 1572864
s_lshl_b32 s96, s96, 11
s_add_u32 s48, s97, s96
s_xor_b32 s96, s96, 2048
s_add_u32 s49, s97, s96
s_add_u32 s72, s48, 0
s_add_u32 s73, s48, 1024
s_add_u32 s74, s49, 0
s_add_u32 s75, s49, 1024
s_add_u32 s76, s48, 4096
s_add_u32 s77, s48, 5120
s_add_u32 s78, s49, 4096
s_add_u32 s79, s49, 5120
Lf_g0:
s_lshr_b32 s96, s93, 3
s_and_b32 s50, s93, 7
s_lshl_b32 s95, s96, 8
s_add_u32 s95, s95, s50
s_lshl_b32 s95, s95, 7
s_lshl_b32 s97, s16, 14
s_add_u32 s95, s95, s97
s_mul_i32 s97, s96, 147
s_lshr_b32 s97, s97, 10
s_mul_i32 s51, s97, 7
s_sub_u32 s96, s96, s51
s_and_b32 s51, s96, 3
s_lshl_b32 s51, s51, 3
s_lshr_b32 s58, s96, 2
s_add_u32 s51, s51, s58
s_and_b32 s58, s97, 3
s_cmp_eq_u32 s96, 3
s_cselect_b32 s48, 0, s58
s_cselect_b32 s92, 1, 0
s_add_u32 s58, s58, s48
s_add_u32 s51, s51, s58
s_lshr_b32 s96, s51, 1
s_lshl_b32 s96, s96, 4
s_and_b32 s51, s51, 1
s_lshl_b32 s51, s51, 2
s_add_u32 s51, s51, s96
s_and_b32 s97, s97, 4
s_lshl_b32 s96, s97, 1
s_add_u32 s51, s51, s96
s_mul_i32 s50, s50, 224
s_add_u32 s51, s51, s50
s_lshl_b32 s51, s51, 10
s_add_u32 s51, s51, 5767168
s_cmp_lt_u32 s93, 448
s_cselect_b32 s51, s51, 268435456
s_lshl_b32 s97, s97, 9
s_lshl_b32 s96, s16, 11
s_xor_b32 s97, s97, s96
s_add_u32 s58, s51, s97
s_lshl_b32 s94, s15, 12
s_add_u32 s94, s94, 139264
v_lshrrev_b32 v248, 2, v243
v_lshl_add_u32 v248, v244, 2, v248
v_lshlrev_b32 v248, 7, v248
v_and_b32 v249, 3, v243
v_lshlrev_b32 v249, 3, v249
v_add3_u32 v248, v248, v249, s94
s_lshl_b32 s96, s92, 9
v_mul_u32_u24 v249, s96, v244
s_lshl_b32 s96, s16, 6
v_add3_u32 v27, v248, v249, s96
s_mul_i32 s96, s92, 1536
s_sub_u32 s96, 2048, s96
v_add_u32 v14, s96, v27
s_lshl_b32 s96, s16, 11
s_add_u32 s94, s94, s96
v_lshrrev_b32 v248, 3, v240
v_mul_u32_u24 v248, 1024, v248
v_and_b32 v249, 7, v240
v_lshl_add_u32 v248, v249, 4, v248
s_add_u32 m0, s21, 0
s_add_u32 s47, s80, 0
buffer_load_dwordx4 v208, s[8:11], s47 offen offset:0 lds
buffer_load_dwordx4 v209, s[8:11], s47 offen offset:1024 lds
buffer_load_dwordx4 v210, s[8:11], s47 offen offset:2048 lds
buffer_load_dwordx4 v211, s[8:11], s47 offen offset:3072 lds
s_add_u32 m0, s57, 0
s_add_u32 s47, s81, 0
buffer_load_dwordx4 v220, s[8:11], s47 offen lds
s_add_u32 m0, s3, 0
s_add_u32 s47, s82, 0
buffer_load_dwordx4 v221, s[68:71], s47 offen offset:0 lds
buffer_load_dwordx4 v221, s[68:71], s47 offen offset:1024 lds
buffer_load_dwordx4 v221, s[68:71], s47 offen offset:2048 lds
s_add_u32 m0, s3, 3072
s_add_u32 s47, s82, 24576
buffer_load_dwordx4 v221, s[68:71], s47 offen offset:0 lds
buffer_load_dwordx4 v221, s[68:71], s47 offen offset:1024 lds
buffer_load_dwordx4 v221, s[68:71], s47 offen offset:2048 lds
s_add_u32 m0, s3, 24576
s_add_u32 s47, s82, 196608
buffer_load_dwordx4 v221, s[68:71], s47 offen offset:0 lds
buffer_load_dwordx4 v221, s[68:71], s47 offen offset:1024 lds
buffer_load_dwordx4 v221, s[68:71], s47 offen offset:2048 lds
s_add_u32 m0, s3, 27648
s_add_u32 s47, s82, 221184
buffer_load_dwordx4 v221, s[68:71], s47 offen offset:0 lds
buffer_load_dwordx4 v221, s[68:71], s47 offen offset:1024 lds
buffer_load_dwordx4 v221, s[68:71], s47 offen offset:2048 lds
s_waitcnt vmcnt(20)
s_cmp_ge_u32 s14, 2
s_cbranch_scc1 Lf_p2
ds_read2_b64 v[40:43], v177 offset0:0 offset1:4
ds_read2_b64 v[44:47], v177 offset0:8 offset1:12
ds_read2_b64 v[48:51], v177 offset0:16 offset1:20
ds_read2_b64 v[52:55], v177 offset0:24 offset1:28
s_waitcnt lgkmcnt(3)
buffer_store_dwordx4 v[40:43], v1, s[4:7], s72 offen sc1
s_waitcnt lgkmcnt(2)
buffer_store_dwordx4 v[44:47], v1, s[4:7], s73 offen sc1
s_waitcnt lgkmcnt(1)
buffer_store_dwordx4 v[48:51], v1, s[4:7], s74 offen sc1
s_waitcnt lgkmcnt(0)
buffer_store_dwordx4 v[52:55], v1, s[4:7], s75 offen sc1
v_dot2_f32_bf16 v172, v40, v164, v172
v_dot2_f32_bf16 v173, v40, v40, v173
v_dot2_f32_bf16 v174, v41, v164, v174
v_dot2_f32_bf16 v175, v41, v41, v175
v_dot2_f32_bf16 v172, v42, v164, v172
v_dot2_f32_bf16 v173, v42, v42, v173
v_dot2_f32_bf16 v174, v43, v164, v174
v_dot2_f32_bf16 v175, v43, v43, v175
v_dot2_f32_bf16 v172, v44, v164, v172
v_dot2_f32_bf16 v173, v44, v44, v173
v_dot2_f32_bf16 v174, v45, v164, v174
v_dot2_f32_bf16 v175, v45, v45, v175
v_dot2_f32_bf16 v172, v46, v164, v172
v_dot2_f32_bf16 v173, v46, v46, v173
v_dot2_f32_bf16 v174, v47, v164, v174
v_dot2_f32_bf16 v175, v47, v47, v175
v_dot2_f32_bf16 v172, v48, v164, v172
v_dot2_f32_bf16 v173, v48, v48, v173
v_dot2_f32_bf16 v174, v49, v164, v174
v_dot2_f32_bf16 v175, v49, v49, v175
v_dot2_f32_bf16 v172, v50, v164, v172
v_dot2_f32_bf16 v173, v50, v50, v173
v_dot2_f32_bf16 v174, v51, v164, v174
v_dot2_f32_bf16 v175, v51, v51, v175
v_dot2_f32_bf16 v172, v52, v164, v172
v_dot2_f32_bf16 v173, v52, v52, v173
v_dot2_f32_bf16 v174, v53, v164, v174
v_dot2_f32_bf16 v175, v53, v53, v175
v_dot2_f32_bf16 v172, v54, v164, v172
v_dot2_f32_bf16 v173, v54, v54, v173
v_dot2_f32_bf16 v174, v55, v164, v174
v_dot2_f32_bf16 v175, v55, v55, v175
s_nop 3
v_add_f32 v172, v172, v174
v_add_f32 v173, v173, v175
buffer_store_dwordx2 v[172:173], v176, s[4:7], s99 offen sc1
buffer_store_dword v224, v1, s[4:7], s84 offen
buffer_store_dword v224, v1, s[4:7], s84 offen
buffer_store_dword v224, v1, s[4:7], s84 offen
buffer_store_dword v224, v1, s[4:7], s84 offen
buffer_store_dword v224, v1, s[4:7], s84 offen
buffer_store_dword v224, v1, s[4:7], s84 offen
buffer_store_dword v224, v1, s[4:7], s84 offen
s_branch Lf_go
Lf_p2:
s_cmp_ge_u32 s93, 448
s_cbranch_scc1 Lf_sO
ds_read_b64_tr_b16 v[40:41], v177 offset:0
ds_read_b64_tr_b16 v[42:43], v177 offset:2048
ds_read_b64_tr_b16 v[44:45], v177 offset:4096
ds_read_b64_tr_b16 v[46:47], v177 offset:6144
ds_read_b64_tr_b16 v[48:49], v177 offset:32
ds_read_b64_tr_b16 v[50:51], v177 offset:2080
ds_read_b64_tr_b16 v[52:53], v177 offset:4128
ds_read_b64_tr_b16 v[54:55], v177 offset:6176
ds_read_b64_tr_b16 v[56:57], v177 offset:64
ds_read_b64_tr_b16 v[58:59], v177 offset:2112
ds_read_b64_tr_b16 v[60:61], v177 offset:4160
ds_read_b64_tr_b16 v[62:63], v177 offset:6208
ds_read_b64_tr_b16 v[64:65], v177 offset:96
ds_read_b64_tr_b16 v[66:67], v177 offset:2144
ds_read_b64_tr_b16 v[68:69], v177 offset:4192
ds_read_b64_tr_b16 v[70:71], v177 offset:6240
s_waitcnt lgkmcnt(14)
v_mfma_f32_16x16x32_bf16 v[72:75], v[164:167], v[40:43], 0
s_waitcnt lgkmcnt(12)
v_mfma_f32_16x16x32_bf16 v[76:79], v[164:167], v[44:47], 0
s_waitcnt lgkmcnt(10)
v_mfma_f32_16x16x32_bf16 v[80:83], v[164:167], v[48:51], 0
s_waitcnt lgkmcnt(8)
v_mfma_f32_16x16x32_bf16 v[84:87], v[164:167], v[52:55], 0
s_waitcnt lgkmcnt(6)
v_mfma_f32_16x16x32_bf16 v[88:91], v[164:167], v[56:59], 0
s_waitcnt lgkmcnt(4)
v_mfma_f32_16x16x32_bf16 v[92:95], v[164:167], v[60:63], 0
s_waitcnt lgkmcnt(2)
v_mfma_f32_16x16x32_bf16 v[96:99], v[164:167], v[64:67], 0
s_waitcnt lgkmcnt(0)
v_mfma_f32_16x16x32_bf16 v[100:103], v[164:167], v[68:71], 0
buffer_store_dwordx4 v[40:43], v1, s[4:7], s72 offen sc1
buffer_store_dwordx4 v[44:47], v1, s[4:7], s73 offen sc1
buffer_store_dwordx4 v[48:51], v1, s[4:7], s74 offen sc1
buffer_store_dwordx4 v[52:55], v1, s[4:7], s75 offen sc1
buffer_store_dwordx4 v[56:59], v1, s[4:7], s76 offen sc1
buffer_store_dwordx4 v[60:63], v1, s[4:7], s77 offen sc1
buffer_store_dwordx4 v[64:67], v1, s[4:7], s78 offen sc1
buffer_store_dwordx4 v[68:71], v1, s[4:7], s79 offen sc1
s_mov_b32 vcc_lo, 0xffff0000
s_mov_b32 vcc_hi, 0xffff0000
v_cndmask_b32 v224, v72, v76, vcc
v_cndmask_b32 v225, v80, v84, vcc
v_cndmask_b32 v226, v88, v92, vcc
v_cndmask_b32 v227, v96, v100, vcc
buffer_store_dword v224, v250, s[4:7], s84 offen sc1
buffer_store_dword v225, v250, s[4:7], s85 offen sc1
buffer_store_dword v226, v250, s[4:7], s86 offen sc1
buffer_store_dword v227, v250, s[4:7], s87 offen sc1
s_branch Lf_go
Lf_sO:
ds_read_b64_tr_b16 v[40:41], v177 offset:0
ds_read_b64_tr_b16 v[42:43], v177 offset:2048
ds_read_b64_tr_b16 v[44:45], v177 offset:32
ds_read_b64_tr_b16 v[46:47], v177 offset:2080
ds_read_b64_tr_b16 v[48:49], v177 offset:64
ds_read_b64_tr_b16 v[50:51], v177 offset:2112
ds_read_b64_tr_b16 v[52:53], v177 offset:96
ds_read_b64_tr_b16 v[54:55], v177 offset:2144
ds_read_b64_tr_b16 v[56:57], v177 offset:4096
ds_read_b64_tr_b16 v[58:59], v177 offset:6144
ds_read_b64_tr_b16 v[60:61], v177 offset:4128
ds_read_b64_tr_b16 v[62:63], v177 offset:6176
ds_read_b64_tr_b16 v[64:65], v177 offset:4160
ds_read_b64_tr_b16 v[66:67], v177 offset:6208
ds_read_b64_tr_b16 v[68:69], v177 offset:4192
ds_read_b64_tr_b16 v[70:71], v177 offset:6240
s_waitcnt lgkmcnt(14)
buffer_store_dwordx4 v[40:43], v1, s[4:7], s72 offen sc1
s_waitcnt lgkmcnt(12)
buffer_store_dwordx4 v[44:47], v1, s[4:7], s73 offen sc1
s_waitcnt lgkmcnt(10)
buffer_store_dwordx4 v[48:51], v1, s[4:7], s74 offen sc1
s_waitcnt lgkmcnt(8)
buffer_store_dwordx4 v[52:55], v1, s[4:7], s75 offen sc1
s_waitcnt lgkmcnt(6)
buffer_store_dwordx4 v[56:59], v1, s[4:7], s76 offen sc1
s_waitcnt lgkmcnt(4)
buffer_store_dwordx4 v[60:63], v1, s[4:7], s77 offen sc1
s_waitcnt lgkmcnt(2)
buffer_store_dwordx4 v[64:67], v1, s[4:7], s78 offen sc1
s_waitcnt lgkmcnt(0)
buffer_store_dwordx4 v[68:71], v1, s[4:7], s79 offen sc1
buffer_store_dword v224, v1, s[4:7], s84 offen
buffer_store_dword v224, v1, s[4:7], s84 offen
buffer_store_dword v224, v1, s[4:7], s84 offen
buffer_store_dword v224, v1, s[4:7], s84 offen
Lf_go:
s_waitcnt vmcnt(29)
v_add_u32 v37, 1, v37
s_nop 0
v_readfirstlane_b32 s67, v37
v_mov_b32 v36, s55
v_lshlrev_b32 v168, 3, v0
v_add_u32 v168, 8130560, v168
s_add_u32 s96, s12, 15
s_and_b32 s96, s96, 15
s_lshl_b32 s96, s96, 14
s_add_u32 s96, s96, 7867008
v_add_u32 v169, s46, v16
v_add_u32 v170, s96, v16
v_cndmask_b32 v169, v169, v170, s[62:63]
s_waitcnt vmcnt(18)
s_barrier
ds_read_b64 a[24:25], v212 offset:0
ds_read_b64 a[26:27], v160 offset:0
ds_read_b64 a[28:29], v212 offset:4096
ds_read_b64 a[30:31], v160 offset:4096
ds_read_b64_tr_b16 a[0:1], v222 offset:0
ds_read_b64_tr_b16 a[2:3], v222 offset:6144
ds_read_b64_tr_b16 a[4:5], v223 offset:0
ds_read_b64_tr_b16 a[6:7], v223 offset:6144
ds_read_b64_tr_b16 a[8:9], v222 offset:1024
ds_read_b64_tr_b16 a[10:11], v222 offset:7168
ds_read_b64_tr_b16 a[12:13], v222 offset:2048
ds_read_b64_tr_b16 a[14:15], v222 offset:8192
ds_read_b64_tr_b16 a[16:17], v223 offset:1024
ds_read_b64_tr_b16 a[18:19], v223 offset:7168
ds_read_b64_tr_b16 a[20:21], v223 offset:2048
ds_read_b64_tr_b16 a[22:23], v223 offset:8192
ds_read_b64_tr_b16 a[32:33], v192 offset:1024
ds_read_b64_tr_b16 a[34:35], v192 offset:7168
ds_read_b64_tr_b16 a[36:37], v192 offset:2048
ds_read_b64_tr_b16 a[38:39], v192 offset:8192
ds_read_b64 a[40:41], v216 offset:0
ds_read_b64 a[42:43], v188 offset:0
s_waitcnt lgkmcnt(12)
v_mfma_f32_16x16x32_bf16 v[72:75], a[0:3], a[24:27], 0
ds_read_b64 a[68:69], v213 offset:0
ds_read_b64 a[70:71], v161 offset:0
s_add_u32 m0, s21, 16384
s_add_u32 s47, s80, 256
buffer_load_dwordx4 v208, s[8:11], s47 offen offset:0 lds
v_mfma_f32_16x16x32_bf16 v[76:79], a[0:3], a[28:31], 0
ds_read_b64 a[72:73], v213 offset:4096
ds_read_b64 a[74:75], v161 offset:4096
v_mfma_f32_16x16x32_bf16 v[80:83], a[4:7], a[24:27], 0
ds_read_b64_tr_b16 a[44:45], v222 offset:12288
ds_read_b64_tr_b16 a[46:47], v222 offset:18432
buffer_load_dwordx4 v209, s[8:11], s47 offen offset:1024 lds
v_mfma_f32_16x16x32_bf16 v[84:87], a[4:7], a[28:31], 0
ds_read_b64_tr_b16 a[48:49], v223 offset:12288
ds_read_b64_tr_b16 a[50:51], v223 offset:18432
v_mfma_f32_16x16x32_bf16 v[88:91], a[8:11], a[24:27], 0
ds_read_b64_tr_b16 a[52:53], v222 offset:13312
ds_read_b64_tr_b16 a[54:55], v222 offset:19456
buffer_load_dwordx4 v210, s[8:11], s47 offen offset:2048 lds
v_mfma_f32_16x16x32_bf16 v[92:95], a[8:11], a[28:31], 0
ds_read_b64_tr_b16 a[56:57], v222 offset:14336
ds_read_b64_tr_b16 a[58:59], v222 offset:20480
s_waitcnt lgkmcnt(12)
v_mfma_f32_16x16x32_bf16 v[96:99], a[24:27], a[12:15], 0
ds_read_b64_tr_b16 a[60:61], v223 offset:13312
ds_read_b64_tr_b16 a[62:63], v223 offset:19456
buffer_load_dwordx4 v211, s[8:11], s47 offen offset:3072 lds
v_mfma_f32_16x16x32_bf16 v[100:103], a[28:31], a[12:15], 0
ds_read_b64_tr_b16 a[64:65], v223 offset:14336
ds_read_b64_tr_b16 a[66:67], v223 offset:20480
v_mfma_f32_16x16x32_bf16 v[104:107], a[16:19], a[24:27], 0
ds_read_b64_tr_b16 a[76:77], v192 offset:13312
s_add_u32 m0, s57, 4096
s_add_u32 s47, s81, 256
buffer_load_dwordx4 v220, s[8:11], s47 offen lds
v_mfma_f32_16x16x32_bf16 v[108:111], a[16:19], a[28:31], 0
ds_read_b64_tr_b16 a[78:79], v192 offset:19456
v_mfma_f32_16x16x32_bf16 v[112:115], a[24:27], a[20:23], 0
ds_read_b64_tr_b16 a[80:81], v192 offset:14336
s_add_u32 m0, s3, 49152
s_add_u32 s47, s82, 393216
buffer_load_dwordx4 v221, s[68:71], s47 offen offset:0 lds
v_mfma_f32_16x16x32_bf16 v[116:119], a[28:31], a[20:23], 0
ds_read_b64_tr_b16 a[82:83], v192 offset:20480
v_mfma_f32_16x16x32_bf16 v[120:123], a[32:35], a[40:43], 0
ds_read_b64 a[84:85], v217 offset:0
buffer_load_dwordx4 v221, s[68:71], s47 offen offset:1024 lds
v_mfma_f32_16x16x32_bf16 v[196:199], a[40:43], a[36:39], 0
ds_read_b64 a[86:87], v189 offset:0
s_cmp_lg_u32 s15, 0
s_cbranch_scc1 LZ_c1
v_mfma_f32_16x16x32_bf16 v[144:147], a[0:3], v[164:167], 0
v_mfma_f32_16x16x32_bf16 v[148:151], a[4:7], v[164:167], 0
v_mfma_f32_16x16x32_bf16 v[152:155], a[8:11], v[164:167], 0
v_mfma_f32_16x16x32_bf16 v[180:183], v[164:167], a[12:15], 0
v_mfma_f32_16x16x32_bf16 v[156:159], a[16:19], v[164:167], 0
v_mfma_f32_16x16x32_bf16 v[184:187], v[164:167], a[20:23], 0
LZ_c1:
s_waitcnt lgkmcnt(12)
s_waitcnt vmcnt(19)
s_barrier
v_mfma_f32_16x16x32_bf16 v[72:75], a[44:47], a[68:71], v[72:75]
ds_read_b64 a[24:25], v214 offset:0
ds_read_b64 a[26:27], v162 offset:0
buffer_load_dwordx4 v221, s[68:71], s47 offen offset:2048 lds
v_mfma_f32_16x16x32_bf16 v[76:79], a[44:47], a[72:75], v[76:79]
ds_read_b64 a[28:29], v214 offset:4096
ds_read_b64 a[30:31], v162 offset:4096
v_mfma_f32_16x16x32_bf16 v[80:83], a[48:51], a[68:71], v[80:83]
ds_read_b64_tr_b16 a[0:1], v222 offset:24576
ds_read_b64_tr_b16 a[2:3], v222 offset:30720
s_add_u32 m0, s3, 52224
s_add_u32 s47, s82, 417792
buffer_load_dwordx4 v221, s[68:71], s47 offen offset:0 lds
v_mfma_f32_16x16x32_bf16 v[84:87], a[48:51], a[72:75], v[84:87]
ds_read_b64_tr_b16 a[4:5], v223 offset:24576
ds_read_b64_tr_b16 a[6:7], v223 offset:30720
v_mfma_f32_16x16x32_bf16 v[88:91], a[52:55], a[68:71], v[88:91]
ds_read_b64_tr_b16 a[8:9], v222 offset:25600
ds_read_b64_tr_b16 a[10:11], v222 offset:31744
buffer_load_dwordx4 v221, s[68:71], s47 offen offset:1024 lds
v_mfma_f32_16x16x32_bf16 v[92:95], a[52:55], a[72:75], v[92:95]
ds_read_b64_tr_b16 a[12:13], v222 offset:26624
ds_read_b64_tr_b16 a[14:15], v222 offset:32768
s_waitcnt lgkmcnt(12)
v_mfma_f32_16x16x32_bf16 v[96:99], a[68:71], a[56:59], v[96:99]
ds_read_b64_tr_b16 a[16:17], v223 offset:25600
ds_read_b64_tr_b16 a[18:19], v223 offset:31744
buffer_load_dwordx4 v221, s[68:71], s47 offen offset:2048 lds
v_mfma_f32_16x16x32_bf16 v[100:103], a[72:75], a[56:59], v[100:103]
ds_read_b64_tr_b16 a[20:21], v223 offset:26624
ds_read_b64_tr_b16 a[22:23], v223 offset:32768
v_mfma_f32_16x16x32_bf16 v[104:107], a[60:63], a[68:71], v[104:107]
ds_read_b64_tr_b16 a[32:33], v192 offset:25600
s_add_u32 m0, s3, 73728
s_add_u32 s47, s82, 589824
buffer_load_dwordx4 v221, s[68:71], s47 offen offset:0 lds
v_mfma_f32_16x16x32_bf16 v[108:111], a[60:63], a[72:75], v[108:111]
ds_read_b64_tr_b16 a[34:35], v192 offset:31744
v_mfma_f32_16x16x32_bf16 v[112:115], a[68:71], a[64:67], v[112:115]
ds_read_b64_tr_b16 a[36:37], v192 offset:26624
buffer_load_dwordx4 v221, s[68:71], s47 offen offset:1024 lds
v_mfma_f32_16x16x32_bf16 v[116:119], a[72:75], a[64:67], v[116:119]
ds_read_b64_tr_b16 a[38:39], v192 offset:32768
v_mfma_f32_16x16x32_bf16 v[120:123], a[76:79], a[84:87], v[120:123]
ds_read_b64 a[40:41], v218 offset:0
buffer_load_dwordx4 v221, s[68:71], s47 offen offset:2048 lds
v_mfma_f32_16x16x32_bf16 v[196:199], a[84:87], a[80:83], v[196:199]
ds_read_b64 a[42:43], v190 offset:0
s_cmp_lg_u32 s15, 1
s_cbranch_scc1 LZ_c2
v_mfma_f32_16x16x32_bf16 v[144:147], a[44:47], v[164:167], 0
v_mfma_f32_16x16x32_bf16 v[148:151], a[48:51], v[164:167], 0
v_mfma_f32_16x16x32_bf16 v[152:155], a[52:55], v[164:167], 0
v_mfma_f32_16x16x32_bf16 v[180:183], v[164:167], a[56:59], 0
v_mfma_f32_16x16x32_bf16 v[156:159], a[60:63], v[164:167], 0
v_mfma_f32_16x16x32_bf16 v[184:187], v[164:167], a[64:67], 0
LZ_c2:
s_waitcnt lgkmcnt(12)
v_mfma_f32_16x16x32_bf16 v[72:75], a[0:3], a[24:27], v[72:75]
ds_read_b64 a[68:69], v215 offset:0
ds_read_b64 a[70:71], v163 offset:0
s_add_u32 m0, s3, 76800
s_add_u32 s47, s82, 614400
buffer_load_dwordx4 v221, s[68:71], s47 offen offset:0 lds
v_mfma_f32_16x16x32_bf16 v[76:79], a[0:3], a[28:31], v[76:79]
ds_read_b64 a[72:73], v215 offset:4096
ds_read_b64 a[74:75], v163 offset:4096
v_mfma_f32_16x16x32_bf16 v[80:83], a[4:7], a[24:27], v[80:83]
ds_read_b64_tr_b16 a[44:45], v222 offset:36864
ds_read_b64_tr_b16 a[46:47], v222 offset:43008
buffer_load_dwordx4 v221, s[68:71], s47 offen offset:1024 lds
v_mfma_f32_16x16x32_bf16 v[84:87], a[4:7], a[28:31], v[84:87]
ds_read_b64_tr_b16 a[48:49], v223 offset:36864
ds_read_b64_tr_b16 a[50:51], v223 offset:43008
ds_read_b64_tr_b16 a[128:129], v193 offset:0
ds_read_b64_tr_b16 a[130:131], v193 offset:6144
ds_read_b64_tr_b16 a[144:145], v194 offset:0
v_mfma_f32_16x16x32_bf16 v[88:91], a[8:11], a[24:27], v[88:91]
ds_read_b64_tr_b16 a[52:53], v222 offset:37888
ds_read_b64_tr_b16 a[54:55], v222 offset:44032
buffer_load_dwordx4 v221, s[68:71], s47 offen offset:2048 lds
v_mfma_f32_16x16x32_bf16 v[92:95], a[8:11], a[28:31], v[92:95]
ds_read_b64_tr_b16 a[56:57], v222 offset:38912
ds_read_b64_tr_b16 a[58:59], v222 offset:45056
ds_read_b64_tr_b16 a[146:147], v194 offset:6144
s_waitcnt lgkmcnt(15)
v_mfma_f32_16x16x32_bf16 v[96:99], a[24:27], a[12:15], v[96:99]
ds_read_b64_tr_b16 a[60:61], v223 offset:37888
ds_read_b64_tr_b16 a[62:63], v223 offset:44032
ds_read_b64_tr_b16 a[160:161], v193 offset:1024
v_mfma_f32_16x16x32_bf16 v[100:103], a[28:31], a[12:15], v[100:103]
ds_read_b64_tr_b16 a[64:65], v223 offset:38912
ds_read_b64_tr_b16 a[66:67], v223 offset:45056
ds_read_b64_tr_b16 a[162:163], v193 offset:7168
v_mfma_f32_16x16x32_bf16 v[104:107], a[16:19], a[24:27], v[104:107]
ds_read_b64_tr_b16 a[76:77], v192 offset:37888
ds_read_b64_tr_b16 a[176:177], v193 offset:2048
v_mfma_f32_16x16x32_bf16 v[108:111], a[16:19], a[28:31], v[108:111]
ds_read_b64_tr_b16 a[78:79], v192 offset:44032
ds_read_b64_tr_b16 a[178:179], v193 offset:8192
v_mfma_f32_16x16x32_bf16 v[112:115], a[24:27], a[20:23], v[112:115]
ds_read_b64_tr_b16 a[80:81], v192 offset:38912
ds_read_b64_tr_b16 a[192:193], v194 offset:1024
v_mfma_f32_16x16x32_bf16 v[116:119], a[28:31], a[20:23], v[116:119]
ds_read_b64_tr_b16 a[82:83], v192 offset:45056
ds_read_b64_tr_b16 a[194:195], v194 offset:7168
v_mfma_f32_16x16x32_bf16 v[120:123], a[32:35], a[40:43], v[120:123]
ds_read_b64 a[84:85], v219 offset:0
ds_read_b64_tr_b16 a[208:209], v194 offset:2048
ds_read_b64_tr_b16 a[210:211], v194 offset:8192
v_mfma_f32_16x16x32_bf16 v[196:199], a[40:43], a[36:39], v[196:199]
ds_read_b64 a[86:87], v191 offset:0
s_cmp_lg_u32 s15, 0
s_cbranch_scc1 LZ_c3
v_mfma_f32_16x16x32_bf16 v[144:147], a[0:3], v[164:167], v[144:147]
v_mfma_f32_16x16x32_bf16 v[148:151], a[4:7], v[164:167], v[148:151]
v_mfma_f32_16x16x32_bf16 v[152:155], a[8:11], v[164:167], v[152:155]
v_mfma_f32_16x16x32_bf16 v[180:183], v[164:167], a[12:15], v[180:183]
v_mfma_f32_16x16x32_bf16 v[156:159], a[16:19], v[164:167], v[156:159]
v_mfma_f32_16x16x32_bf16 v[184:187], v[164:167], a[20:23], v[184:187]
LZ_c3:
s_waitcnt vmcnt(6) lgkmcnt(0)
s_barrier
v_add_u32 v222, 49152, v222
v_add_u32 v223, 49152, v223
v_add_u32 v192, 49152, v192
v_add_u32 v193, 49152, v193
v_add_u32 v194, 49152, v194
s_cmp_lg_u32 s14, 0
s_cbranch_scc1 LZ_c4
s_lshl_b32 s96, s13, 3
s_add_u32 s96, s96, s46
s_lshl_b32 s97, s2, 3
s_add_u32 s97, s97, 8130560
buffer_store_dwordx2 v[36:37], v26, s[4:7], s96 offen offset:0 sc1
buffer_store_dwordx2 v[36:37], v26, s[4:7], s97 offen offset:0 sc1
LZ_c4:
v_mov_b32 v36, 1
v_mfma_f32_16x16x32_bf16 v[72:75], a[44:47], a[68:71], v[72:75]
ds_read_b64 a[24:25], v212 offset:16384
ds_read_b64 a[26:27], v160 offset:16384
v_mfma_f32_16x16x32_bf16 v[76:79], a[44:47], a[72:75], v[76:79]
ds_read_b64 a[28:29], v212 offset:20480
ds_read_b64 a[30:31], v160 offset:20480
s_add_u32 m0, s21, 0
s_add_u32 s47, s80, 512
buffer_load_dwordx4 v208, s[8:11], s47 offen offset:0 lds
v_mfma_f32_16x16x32_bf16 v[80:83], a[48:51], a[68:71], v[80:83]
ds_read_b64_tr_b16 a[0:1], v222 offset:0
ds_read_b64_tr_b16 a[2:3], v222 offset:6144
v_mfma_f32_16x16x32_bf16 v[84:87], a[48:51], a[72:75], v[84:87]
ds_read_b64_tr_b16 a[4:5], v223 offset:0
ds_read_b64_tr_b16 a[6:7], v223 offset:6144
buffer_load_dwordx4 v209, s[8:11], s47 offen offset:1024 lds
v_mfma_f32_16x16x32_bf16 v[88:91], a[52:55], a[68:71], v[88:91]
ds_read_b64_tr_b16 a[8:9], v222 offset:1024
ds_read_b64_tr_b16 a[10:11], v222 offset:7168
v_mfma_f32_16x16x32_bf16 v[92:95], a[52:55], a[72:75], v[92:95]
ds_read_b64_tr_b16 a[12:13], v222 offset:2048
ds_read_b64_tr_b16 a[14:15], v222 offset:8192
buffer_load_dwordx4 v210, s[8:11], s47 offen offset:2048 lds
v_mfma_f32_16x16x32_bf16 v[96:99], a[68:71], a[56:59], v[96:99]
ds_read_b64_tr_b16 a[16:17], v223 offset:1024
ds_read_b64_tr_b16 a[18:19], v223 offset:7168
v_mfma_f32_16x16x32_bf16 v[100:103], a[72:75], a[56:59], v[100:103]
ds_read_b64_tr_b16 a[20:21], v223 offset:2048
ds_read_b64_tr_b16 a[22:23], v223 offset:8192
v_mfma_f32_16x16x32_bf16 v[104:107], a[60:63], a[68:71], v[104:107]
ds_read_b64_tr_b16 a[32:33], v192 offset:1024
buffer_load_dwordx4 v211, s[8:11], s47 offen offset:3072 lds
v_mfma_f32_16x16x32_bf16 v[108:111], a[60:63], a[72:75], v[108:111]
ds_read_b64_tr_b16 a[34:35], v192 offset:7168
v_mfma_f32_16x16x32_bf16 v[112:115], a[68:71], a[64:67], v[112:115]
ds_read_b64_tr_b16 a[36:37], v192 offset:2048
s_add_u32 m0, s57, 0
s_add_u32 s47, s81, 512
buffer_load_dwordx4 v220, s[8:11], s47 offen lds
v_mfma_f32_16x16x32_bf16 v[116:119], a[72:75], a[64:67], v[116:119]
ds_read_b64_tr_b16 a[38:39], v192 offset:8192
v_mfma_f32_16x16x32_bf16 v[120:123], a[76:79], a[84:87], v[120:123]
ds_read_b64 a[40:41], v216 offset:4096
s_add_u32 m0, s3, 0
s_add_u32 s47, s82, 786432
buffer_load_dwordx4 v221, s[68:71], s47 offen offset:0 lds
v_mfma_f32_16x16x32_bf16 v[196:199], a[84:87], a[80:83], v[196:199]
ds_read_b64 a[42:43], v188 offset:4096
s_cmp_lg_u32 s15, 1
s_cbranch_scc1 LZ_c5
v_mfma_f32_16x16x32_bf16 v[144:147], a[44:47], v[164:167], v[144:147]
v_mfma_f32_16x16x32_bf16 v[148:151], a[48:51], v[164:167], v[148:151]
v_mfma_f32_16x16x32_bf16 v[152:155], a[52:55], v[164:167], v[152:155]
v_mfma_f32_16x16x32_bf16 v[180:183], v[164:167], a[56:59], v[180:183]
v_mfma_f32_16x16x32_bf16 v[156:159], a[60:63], v[164:167], v[156:159]
v_mfma_f32_16x16x32_bf16 v[184:187], v[164:167], a[64:67], v[184:187]
LZ_c5:
s_waitcnt lgkmcnt(12)
v_mfma_f32_16x16x32_bf16 v[72:75], a[0:3], a[24:27], v[72:75]
ds_read_b64 a[68:69], v213 offset:16384
ds_read_b64 a[70:71], v161 offset:16384
v_mfma_f32_16x16x32_bf16 v[76:79], a[0:3], a[28:31], v[76:79]
ds_read_b64 a[72:73], v213 offset:20480
ds_read_b64 a[74:75], v161 offset:20480
buffer_load_dwordx4 v221, s[68:71], s47 offen offset:1024 lds
v_mfma_f32_16x16x32_bf16 v[80:83], a[4:7], a[24:27], v[80:83]
ds_read_b64_tr_b16 a[44:45], v222 offset:12288
ds_read_b64_tr_b16 a[46:47], v222 offset:18432
v_mfma_f32_16x16x32_bf16 v[84:87], a[4:7], a[28:31], v[84:87]
ds_read_b64_tr_b16 a[48:49], v223 offset:12288
ds_read_b64_tr_b16 a[50:51], v223 offset:18432
buffer_load_dwordx4 v221, s[68:71], s47 offen offset:2048 lds
v_mfma_f32_16x16x32_bf16 v[88:91], a[8:11], a[24:27], v[88:91]
ds_read_b64_tr_b16 a[52:53], v222 offset:13312
ds_read_b64_tr_b16 a[54:55], v222 offset:19456
v_mfma_f32_16x16x32_bf16 v[92:95], a[8:11], a[28:31], v[92:95]
ds_read_b64_tr_b16 a[56:57], v222 offset:14336
ds_read_b64_tr_b16 a[58:59], v222 offset:20480
s_add_u32 m0, s3, 3072
s_add_u32 s47, s82, 811008
buffer_load_dwordx4 v221, s[68:71], s47 offen offset:0 lds
s_waitcnt lgkmcnt(12)
v_mfma_f32_16x16x32_bf16 v[96:99], a[24:27], a[12:15], v[96:99]
ds_read_b64_tr_b16 a[60:61], v223 offset:13312
ds_read_b64_tr_b16 a[62:63], v223 offset:19456
v_mfma_f32_16x16x32_bf16 v[100:103], a[28:31], a[12:15], v[100:103]
ds_read_b64_tr_b16 a[64:65], v223 offset:14336
ds_read_b64_tr_b16 a[66:67], v223 offset:20480
v_mfma_f32_16x16x32_bf16 v[104:107], a[16:19], a[24:27], v[104:107]
ds_read_b64_tr_b16 a[76:77], v192 offset:13312
buffer_load_dwordx4 v221, s[68:71], s47 offen offset:1024 lds
v_mfma_f32_16x16x32_bf16 v[108:111], a[16:19], a[28:31], v[108:111]
ds_read_b64_tr_b16 a[78:79], v192 offset:19456
v_mfma_f32_16x16x32_bf16 v[112:115], a[24:27], a[20:23], v[112:115]
ds_read_b64_tr_b16 a[80:81], v192 offset:14336
buffer_load_dwordx4 v221, s[68:71], s47 offen offset:2048 lds
v_mfma_f32_16x16x32_bf16 v[116:119], a[28:31], a[20:23], v[116:119]
ds_read_b64_tr_b16 a[82:83], v192 offset:20480
v_mfma_f32_16x16x32_bf16 v[120:123], a[32:35], a[40:43], v[120:123]
ds_read_b64 a[84:85], v217 offset:4096
s_add_u32 m0, s3, 24576
s_add_u32 s47, s82, 983040
buffer_load_dwordx4 v221, s[68:71], s47 offen offset:0 lds
v_mfma_f32_16x16x32_bf16 v[196:199], a[40:43], a[36:39], v[196:199]
ds_read_b64 a[86:87], v189 offset:4096
s_cmp_lg_u32 s15, 0
s_cbranch_scc1 LZ_c6
v_mfma_f32_16x16x32_bf16 v[144:147], a[0:3], v[164:167], v[144:147]
v_mfma_f32_16x16x32_bf16 v[148:151], a[4:7], v[164:167], v[148:151]
v_mfma_f32_16x16x32_bf16 v[152:155], a[8:11], v[164:167], v[152:155]
v_mfma_f32_16x16x32_bf16 v[180:183], v[164:167], a[12:15], v[180:183]
v_mfma_f32_16x16x32_bf16 v[156:159], a[16:19], v[164:167], v[156:159]
v_mfma_f32_16x16x32_bf16 v[184:187], v[164:167], a[20:23], v[184:187]
LZ_c6:
s_waitcnt lgkmcnt(12)
s_waitcnt vmcnt(12)
s_barrier
v_mfma_f32_16x16x32_bf16 v[72:75], a[44:47], a[68:71], v[72:75]
ds_read_b64 a[24:25], v214 offset:16384
ds_read_b64 a[26:27], v162 offset:16384
v_mfma_f32_16x16x32_bf16 v[76:79], a[44:47], a[72:75], v[76:79]
ds_read_b64 a[28:29], v214 offset:20480
ds_read_b64 a[30:31], v162 offset:20480
buffer_load_dwordx4 v221, s[68:71], s47 offen offset:1024 lds
v_mfma_f32_16x16x32_bf16 v[80:83], a[48:51], a[68:71], v[80:83]
ds_read_b64_tr_b16 a[0:1], v222 offset:24576
ds_read_b64_tr_b16 a[2:3], v222 offset:30720
ds_read_b64_tr_b16 a[132:133], v193 offset:0
v_mfma_f32_16x16x32_bf16 v[84:87], a[48:51], a[72:75], v[84:87]
ds_read_b64_tr_b16 a[4:5], v223 offset:24576
ds_read_b64_tr_b16 a[6:7], v223 offset:30720
buffer_load_dwordx4 v221, s[68:71], s47 offen offset:2048 lds
v_mfma_f32_16x16x32_bf16 v[88:91], a[52:55], a[68:71], v[88:91]
ds_read_b64_tr_b16 a[8:9], v222 offset:25600
ds_read_b64_tr_b16 a[10:11], v222 offset:31744
ds_read_b64_tr_b16 a[134:135], v193 offset:6144
v_mfma_f32_16x16x32_bf16 v[92:95], a[52:55], a[72:75], v[92:95]
ds_read_b64_tr_b16 a[12:13], v222 offset:26624
ds_read_b64_tr_b16 a[14:15], v222 offset:32768
s_add_u32 m0, s3, 27648
s_add_u32 s47, s82, 1007616
buffer_load_dwordx4 v221, s[68:71], s47 offen offset:0 lds
s_waitcnt lgkmcnt(14)
v_mfma_f32_16x16x32_bf16 v[96:99], a[68:71], a[56:59], v[96:99]
ds_read_b64_tr_b16 a[16:17], v223 offset:25600
ds_read_b64_tr_b16 a[18:19], v223 offset:31744
ds_read_b64_tr_b16 a[148:149], v194 offset:0
v_mfma_f32_16x16x32_bf16 v[100:103], a[72:75], a[56:59], v[100:103]
ds_read_b64_tr_b16 a[20:21], v223 offset:26624
ds_read_b64_tr_b16 a[22:23], v223 offset:32768
v_mfma_f32_16x16x32_bf16 v[104:107], a[60:63], a[68:71], v[104:107]
ds_read_b64_tr_b16 a[32:33], v192 offset:25600
buffer_load_dwordx4 v221, s[68:71], s47 offen offset:1024 lds
v_mfma_f32_16x16x32_bf16 v[108:111], a[60:63], a[72:75], v[108:111]
ds_read_b64_tr_b16 a[34:35], v192 offset:31744
ds_read_b64_tr_b16 a[150:151], v194 offset:6144
v_mfma_f32_16x16x32_bf16 v[112:115], a[68:71], a[64:67], v[112:115]
ds_read_b64_tr_b16 a[36:37], v192 offset:26624
buffer_load_dwordx4 v221, s[68:71], s47 offen offset:2048 lds
v_mfma_f32_16x16x32_bf16 v[116:119], a[72:75], a[64:67], v[116:119]
ds_read_b64_tr_b16 a[38:39], v192 offset:32768
ds_read_b64_tr_b16 a[164:165], v193 offset:1024
v_mfma_f32_16x16x32_bf16 v[120:123], a[76:79], a[84:87], v[120:123]
ds_read_b64 a[40:41], v218 offset:4096
ds_read_b64_tr_b16 a[166:167], v193 offset:7168
v_mfma_f32_16x16x32_bf16 v[196:199], a[84:87], a[80:83], v[196:199]
ds_read_b64 a[42:43], v190 offset:4096
s_cmp_lg_u32 s15, 1
s_cbranch_scc1 LZ_c7
v_mfma_f32_16x16x32_bf16 v[144:147], a[44:47], v[164:167], v[144:147]
v_mfma_f32_16x16x32_bf16 v[148:151], a[48:51], v[164:167], v[148:151]
v_mfma_f32_16x16x32_bf16 v[152:155], a[52:55], v[164:167], v[152:155]
v_mfma_f32_16x16x32_bf16 v[180:183], v[164:167], a[56:59], v[180:183]
v_mfma_f32_16x16x32_bf16 v[156:159], a[60:63], v[164:167], v[156:159]
v_mfma_f32_16x16x32_bf16 v[184:187], v[164:167], a[64:67], v[184:187]
LZ_c7:
s_waitcnt lgkmcnt(15)
v_mfma_f32_16x16x32_bf16 v[72:75], a[0:3], a[24:27], v[72:75]
ds_read_b64 a[68:69], v215 offset:16384
ds_read_b64 a[70:71], v163 offset:16384
ds_read_b64_tr_b16 a[180:181], v193 offset:2048
v_mfma_f32_16x16x32_bf16 v[76:79], a[0:3], a[28:31], v[76:79]
ds_read_b64 a[72:73], v215 offset:20480
ds_read_b64 a[74:75], v163 offset:20480
v_mfma_f32_16x16x32_bf16 v[80:83], a[4:7], a[24:27], v[80:83]
ds_read_b64_tr_b16 a[44:45], v222 offset:36864
ds_read_b64_tr_b16 a[46:47], v222 offset:43008
ds_read_b64_tr_b16 a[182:183], v193 offset:8192
v_mfma_f32_16x16x32_bf16 v[84:87], a[4:7], a[28:31], v[84:87]
ds_read_b64_tr_b16 a[48:49], v223 offset:36864
ds_read_b64_tr_b16 a[50:51], v223 offset:43008
v_mfma_f32_16x16x32_bf16 v[88:91], a[8:11], a[24:27], v[88:91]
ds_read_b64_tr_b16 a[52:53], v222 offset:37888
ds_read_b64_tr_b16 a[54:55], v222 offset:44032
ds_read_b64_tr_b16 a[196:197], v194 offset:1024
v_mfma_f32_16x16x32_bf16 v[92:95], a[8:11], a[28:31], v[92:95]
ds_read_b64_tr_b16 a[56:57], v222 offset:38912
ds_read_b64_tr_b16 a[58:59], v222 offset:45056
s_waitcnt lgkmcnt(15)
v_mfma_f32_16x16x32_bf16 v[96:99], a[24:27], a[12:15], v[96:99]
ds_read_b64_tr_b16 a[60:61], v223 offset:37888
ds_read_b64_tr_b16 a[62:63], v223 offset:44032
ds_read_b64_tr_b16 a[198:199], v194 offset:7168
v_mfma_f32_16x16x32_bf16 v[100:103], a[28:31], a[12:15], v[100:103]
ds_read_b64_tr_b16 a[64:65], v223 offset:38912
ds_read_b64_tr_b16 a[66:67], v223 offset:45056
v_mfma_f32_16x16x32_bf16 v[104:107], a[16:19], a[24:27], v[104:107]
ds_read_b64_tr_b16 a[76:77], v192 offset:37888
ds_read_b64_tr_b16 a[212:213], v194 offset:2048
v_mfma_f32_16x16x32_bf16 v[108:111], a[16:19], a[28:31], v[108:111]
ds_read_b64_tr_b16 a[78:79], v192 offset:44032
v_mfma_f32_16x16x32_bf16 v[112:115], a[24:27], a[20:23], v[112:115]
ds_read_b64_tr_b16 a[80:81], v192 offset:38912
ds_read_b64_tr_b16 a[214:215], v194 offset:8192
v_mfma_f32_16x16x32_bf16 v[116:119], a[28:31], a[20:23], v[116:119]
ds_read_b64_tr_b16 a[82:83], v192 offset:45056
v_mfma_f32_16x16x32_bf16 v[120:123], a[32:35], a[40:43], v[120:123]
ds_read_b64 a[84:85], v219 offset:4096
v_mfma_f32_16x16x32_bf16 v[196:199], a[40:43], a[36:39], v[196:199]
ds_read_b64 a[86:87], v191 offset:4096
s_cmp_lg_u32 s15, 0
s_cbranch_scc1 LZ_c8
v_mfma_f32_16x16x32_bf16 v[144:147], a[0:3], v[164:167], v[144:147]
v_mfma_f32_16x16x32_bf16 v[148:151], a[4:7], v[164:167], v[148:151]
v_mfma_f32_16x16x32_bf16 v[152:155], a[8:11], v[164:167], v[152:155]
v_mfma_f32_16x16x32_bf16 v[180:183], v[164:167], a[12:15], v[180:183]
v_mfma_f32_16x16x32_bf16 v[156:159], a[16:19], v[164:167], v[156:159]
v_mfma_f32_16x16x32_bf16 v[184:187], v[164:167], a[20:23], v[184:187]
LZ_c8:
s_waitcnt vmcnt(6) lgkmcnt(0)
s_barrier
v_subrev_u32 v222, 49152, v222
v_subrev_u32 v223, 49152, v223
v_subrev_u32 v192, 49152, v192
v_subrev_u32 v193, 49152, v193
v_subrev_u32 v194, 49152, v194
v_mfma_f32_16x16x32_bf16 v[72:75], a[44:47], a[68:71], v[72:75]
ds_read_b64 a[24:25], v212 offset:0
ds_read_b64 a[26:27], v160 offset:0
v_mfma_f32_16x16x32_bf16 v[76:79], a[44:47], a[72:75], v[76:79]
ds_read_b64 a[28:29], v212 offset:4096
ds_read_b64 a[30:31], v160 offset:4096
s_add_u32 m0, s21, 16384
s_add_u32 s47, s80, 768
buffer_load_dwordx4 v208, s[8:11], s47 offen offset:0 lds
v_mfma_f32_16x16x32_bf16 v[80:83], a[48:51], a[68:71], v[80:83]
ds_read_b64_tr_b16 a[0:1], v222 offset:0
ds_read_b64_tr_b16 a[2:3], v222 offset:6144
v_mfma_f32_16x16x32_bf16 v[84:87], a[48:51], a[72:75], v[84:87]
ds_read_b64_tr_b16 a[4:5], v223 offset:0
ds_read_b64_tr_b16 a[6:7], v223 offset:6144
buffer_load_dwordx4 v209, s[8:11], s47 offen offset:1024 lds
v_mfma_f32_16x16x32_bf16 v[88:91], a[52:55], a[68:71], v[88:91]
ds_read_b64_tr_b16 a[8:9], v222 offset:1024
ds_read_b64_tr_b16 a[10:11], v222 offset:7168
s_load_dwordx2 s[88:89], s[0:1], 48
v_mfma_f32_16x16x32_bf16 v[92:95], a[52:55], a[72:75], v[92:95]
ds_read_b64_tr_b16 a[12:13], v222 offset:2048
ds_read_b64_tr_b16 a[14:15], v222 offset:8192
buffer_load_dwordx4 v210, s[8:11], s47 offen offset:2048 lds
v_mfma_f32_16x16x32_bf16 v[96:99], a[68:71], a[56:59], v[96:99]
ds_read_b64_tr_b16 a[16:17], v223 offset:1024
ds_read_b64_tr_b16 a[18:19], v223 offset:7168
v_mfma_f32_16x16x32_bf16 v[100:103], a[72:75], a[56:59], v[100:103]
ds_read_b64_tr_b16 a[20:21], v223 offset:2048
ds_read_b64_tr_b16 a[22:23], v223 offset:8192
v_mfma_f32_16x16x32_bf16 v[104:107], a[60:63], a[68:71], v[104:107]
ds_read_b64_tr_b16 a[32:33], v192 offset:1024
buffer_load_dwordx4 v211, s[8:11], s47 offen offset:3072 lds
v_mfma_f32_16x16x32_bf16 v[108:111], a[60:63], a[72:75], v[108:111]
ds_read_b64_tr_b16 a[34:35], v192 offset:7168
v_mfma_f32_16x16x32_bf16 v[112:115], a[68:71], a[64:67], v[112:115]
ds_read_b64_tr_b16 a[36:37], v192 offset:2048
s_add_u32 m0, s57, 4096
s_add_u32 s47, s81, 768
buffer_load_dwordx4 v220, s[8:11], s47 offen lds
v_mfma_f32_16x16x32_bf16 v[116:119], a[72:75], a[64:67], v[116:119]
ds_read_b64_tr_b16 a[38:39], v192 offset:8192
v_mfma_f32_16x16x32_bf16 v[120:123], a[76:79], a[84:87], v[120:123]
ds_read_b64 a[40:41], v216 offset:0
s_add_u32 m0, s3, 49152
s_add_u32 s47, s82, 1179648
buffer_load_dwordx4 v221, s[68:71], s47 offen offset:0 lds
v_mfma_f32_16x16x32_bf16 v[196:199], a[84:87], a[80:83], v[196:199]
ds_read_b64 a[42:43], v188 offset:0
s_cmp_lg_u32 s15, 1
s_cbranch_scc1 LZ_c9
v_mfma_f32_16x16x32_bf16 v[144:147], a[44:47], v[164:167], v[144:147]
v_mfma_f32_16x16x32_bf16 v[148:151], a[48:51], v[164:167], v[148:151]
v_mfma_f32_16x16x32_bf16 v[152:155], a[52:55], v[164:167], v[152:155]
v_mfma_f32_16x16x32_bf16 v[180:183], v[164:167], a[56:59], v[180:183]
v_mfma_f32_16x16x32_bf16 v[156:159], a[60:63], v[164:167], v[156:159]
v_mfma_f32_16x16x32_bf16 v[184:187], v[164:167], a[64:67], v[184:187]
LZ_c9:
s_waitcnt lgkmcnt(12)
v_mfma_f32_16x16x32_bf16 v[72:75], a[0:3], a[24:27], v[72:75]
ds_read_b64 a[68:69], v213 offset:0
ds_read_b64 a[70:71], v161 offset:0
v_mfma_f32_16x16x32_bf16 v[76:79], a[0:3], a[28:31], v[76:79]
ds_read_b64 a[72:73], v213 offset:4096
ds_read_b64 a[74:75], v161 offset:4096
buffer_load_dwordx4 v221, s[68:71], s47 offen offset:1024 lds
v_mfma_f32_16x16x32_bf16 v[80:83], a[4:7], a[24:27], v[80:83]
ds_read_b64_tr_b16 a[44:45], v222 offset:12288
ds_read_b64_tr_b16 a[46:47], v222 offset:18432
s_mov_b32 s90, 1835008
v_mfma_f32_16x16x32_bf16 v[84:87], a[4:7], a[28:31], v[84:87]
ds_read_b64_tr_b16 a[48:49], v223 offset:12288
ds_read_b64_tr_b16 a[50:51], v223 offset:18432
buffer_load_dwordx4 v221, s[68:71], s47 offen offset:2048 lds
v_mfma_f32_16x16x32_bf16 v[88:91], a[8:11], a[24:27], v[88:91]
ds_read_b64_tr_b16 a[52:53], v222 offset:13312
ds_read_b64_tr_b16 a[54:55], v222 offset:19456
v_mfma_f32_16x16x32_bf16 v[92:95], a[8:11], a[28:31], v[92:95]
ds_read_b64_tr_b16 a[56:57], v222 offset:14336
ds_read_b64_tr_b16 a[58:59], v222 offset:20480
s_add_u32 m0, s3, 52224
s_add_u32 s47, s82, 1204224
buffer_load_dwordx4 v221, s[68:71], s47 offen offset:0 lds
s_waitcnt lgkmcnt(12)
v_mfma_f32_16x16x32_bf16 v[96:99], a[24:27], a[12:15], v[96:99]
ds_read_b64_tr_b16 a[60:61], v223 offset:13312
ds_read_b64_tr_b16 a[62:63], v223 offset:19456
v_mfma_f32_16x16x32_bf16 v[100:103], a[28:31], a[12:15], v[100:103]
ds_read_b64_tr_b16 a[64:65], v223 offset:14336
ds_read_b64_tr_b16 a[66:67], v223 offset:20480
v_mfma_f32_16x16x32_bf16 v[104:107], a[16:19], a[24:27], v[104:107]
ds_read_b64_tr_b16 a[76:77], v192 offset:13312
buffer_load_dwordx4 v221, s[68:71], s47 offen offset:1024 lds
v_mfma_f32_16x16x32_bf16 v[108:111], a[16:19], a[28:31], v[108:111]
ds_read_b64_tr_b16 a[78:79], v192 offset:19456
v_mfma_f32_16x16x32_bf16 v[112:115], a[24:27], a[20:23], v[112:115]
ds_read_b64_tr_b16 a[80:81], v192 offset:14336
buffer_load_dwordx4 v221, s[68:71], s47 offen offset:2048 lds
v_mfma_f32_16x16x32_bf16 v[116:119], a[28:31], a[20:23], v[116:119]
ds_read_b64_tr_b16 a[82:83], v192 offset:20480
v_mfma_f32_16x16x32_bf16 v[120:123], a[32:35], a[40:43], v[120:123]
ds_read_b64 a[84:85], v217 offset:0
s_add_u32 m0, s3, 73728
s_add_u32 s47, s82, 1376256
buffer_load_dwordx4 v221, s[68:71], s47 offen offset:0 lds
v_mfma_f32_16x16x32_bf16 v[196:199], a[40:43], a[36:39], v[196:199]
ds_read_b64 a[86:87], v189 offset:0
s_mov_b32 s91, 0x20000
s_cmp_lg_u32 s15, 0
s_cbranch_scc1 LZ_c10
v_mfma_f32_16x16x32_bf16 v[144:147], a[0:3], v[164:167], v[144:147]
v_mfma_f32_16x16x32_bf16 v[148:151], a[4:7], v[164:167], v[148:151]
v_mfma_f32_16x16x32_bf16 v[152:155], a[8:11], v[164:167], v[152:155]
v_mfma_f32_16x16x32_bf16 v[180:183], v[164:167], a[12:15], v[180:183]
v_mfma_f32_16x16x32_bf16 v[156:159], a[16:19], v[164:167], v[156:159]
v_mfma_f32_16x16x32_bf16 v[184:187], v[164:167], a[20:23], v[184:187]
LZ_c10:
s_waitcnt lgkmcnt(12)
s_waitcnt vmcnt(12)
s_barrier
v_mfma_f32_16x16x32_bf16 v[72:75], a[44:47], a[68:71], v[72:75]
ds_read_b64 a[24:25], v214 offset:0
ds_read_b64 a[26:27], v162 offset:0
v_mfma_f32_16x16x32_bf16 v[76:79], a[44:47], a[72:75], v[76:79]
ds_read_b64 a[28:29], v214 offset:4096
ds_read_b64 a[30:31], v162 offset:4096
buffer_load_dwordx4 v221, s[68:71], s47 offen offset:1024 lds
v_mfma_f32_16x16x32_bf16 v[80:83], a[48:51], a[68:71], v[80:83]
ds_read_b64_tr_b16 a[0:1], v222 offset:24576
ds_read_b64_tr_b16 a[2:3], v222 offset:30720
ds_read_b64_tr_b16 a[136:137], v193 offset:0
buffer_load_dwordx2 v[170:171], v169, s[4:7], 0 offen offset:0 sc1
v_mfma_f32_16x16x32_bf16 v[84:87], a[48:51], a[72:75], v[84:87]
ds_read_b64_tr_b16 a[4:5], v223 offset:24576
ds_read_b64_tr_b16 a[6:7], v223 offset:30720
buffer_load_dwordx4 v221, s[68:71], s47 offen offset:2048 lds
v_mfma_f32_16x16x32_bf16 v[88:91], a[52:55], a[68:71], v[88:91]
ds_read_b64_tr_b16 a[8:9], v222 offset:25600
ds_read_b64_tr_b16 a[10:11], v222 offset:31744
ds_read_b64_tr_b16 a[138:139], v193 offset:6144
v_mfma_f32_16x16x32_bf16 v[92:95], a[52:55], a[72:75], v[92:95]
ds_read_b64_tr_b16 a[12:13], v222 offset:26624
ds_read_b64_tr_b16 a[14:15], v222 offset:32768
s_add_u32 m0, s3, 76800
s_add_u32 s47, s82, 1400832
buffer_load_dwordx4 v221, s[68:71], s47 offen offset:0 lds
s_waitcnt lgkmcnt(14)
v_mfma_f32_16x16x32_bf16 v[96:99], a[68:71], a[56:59], v[96:99]
ds_read_b64_tr_b16 a[16:17], v223 offset:25600
ds_read_b64_tr_b16 a[18:19], v223 offset:31744
ds_read_b64_tr_b16 a[152:153], v194 offset:0
v_mfma_f32_16x16x32_bf16 v[100:103], a[72:75], a[56:59], v[100:103]
ds_read_b64_tr_b16 a[20:21], v223 offset:26624
ds_read_b64_tr_b16 a[22:23], v223 offset:32768
v_mfma_f32_16x16x32_bf16 v[104:107], a[60:63], a[68:71], v[104:107]
ds_read_b64_tr_b16 a[32:33], v192 offset:25600
buffer_load_dwordx4 v221, s[68:71], s47 offen offset:1024 lds
v_mfma_f32_16x16x32_bf16 v[108:111], a[60:63], a[72:75], v[108:111]
ds_read_b64_tr_b16 a[34:35], v192 offset:31744
ds_read_b64_tr_b16 a[154:155], v194 offset:6144
v_mfma_f32_16x16x32_bf16 v[112:115], a[68:71], a[64:67], v[112:115]
ds_read_b64_tr_b16 a[36:37], v192 offset:26624
buffer_load_dwordx4 v221, s[68:71], s47 offen offset:2048 lds
v_mfma_f32_16x16x32_bf16 v[116:119], a[72:75], a[64:67], v[116:119]
ds_read_b64_tr_b16 a[38:39], v192 offset:32768
ds_read_b64_tr_b16 a[168:169], v193 offset:1024
s_waitcnt lgkmcnt(0)
s_and_b32 s89, s89, 0xffff
v_mfma_f32_16x16x32_bf16 v[120:123], a[76:79], a[84:87], v[120:123]
ds_read_b64 a[40:41], v218 offset:0
ds_read_b64_tr_b16 a[170:171], v193 offset:7168
v_mfma_f32_16x16x32_bf16 v[196:199], a[84:87], a[80:83], v[196:199]
ds_read_b64 a[42:43], v190 offset:0
s_cmp_lg_u32 s15, 1
s_cbranch_scc1 LZ_c11
v_mfma_f32_16x16x32_bf16 v[144:147], a[44:47], v[164:167], v[144:147]
v_mfma_f32_16x16x32_bf16 v[148:151], a[48:51], v[164:167], v[148:151]
v_mfma_f32_16x16x32_bf16 v[152:155], a[52:55], v[164:167], v[152:155]
v_mfma_f32_16x16x32_bf16 v[180:183], v[164:167], a[56:59], v[180:183]
v_mfma_f32_16x16x32_bf16 v[156:159], a[60:63], v[164:167], v[156:159]
v_mfma_f32_16x16x32_bf16 v[184:187], v[164:167], a[64:67], v[184:187]
LZ_c11:
v_mfma_f32_16x16x32_bf16 v[72:75], a[0:3], a[24:27], v[72:75]
ds_read_b64 a[68:69], v215 offset:0
ds_read_b64 a[70:71], v163 offset:0
ds_read_b64_tr_b16 a[184:185], v193 offset:2048
v_mfma_f32_16x16x32_bf16 v[76:79], a[0:3], a[28:31], v[76:79]
ds_read_b64 a[72:73], v215 offset:4096
ds_read_b64 a[74:75], v163 offset:4096
v_mfma_f32_16x16x32_bf16 v[80:83], a[4:7], a[24:27], v[80:83]
ds_read_b64_tr_b16 a[44:45], v222 offset:36864
ds_read_b64_tr_b16 a[46:47], v222 offset:43008
ds_read_b64_tr_b16 a[186:187], v193 offset:8192
v_mfma_f32_16x16x32_bf16 v[84:87], a[4:7], a[28:31], v[84:87]
ds_read_b64_tr_b16 a[48:49], v223 offset:36864
ds_read_b64_tr_b16 a[50:51], v223 offset:43008
v_mfma_f32_16x16x32_bf16 v[88:91], a[8:11], a[24:27], v[88:91]
ds_read_b64_tr_b16 a[52:53], v222 offset:37888
ds_read_b64_tr_b16 a[54:55], v222 offset:44032
ds_read_b64_tr_b16 a[200:201], v194 offset:1024
v_mfma_f32_16x16x32_bf16 v[92:95], a[8:11], a[28:31], v[92:95]
ds_read_b64_tr_b16 a[56:57], v222 offset:38912
ds_read_b64_tr_b16 a[58:59], v222 offset:45056
s_waitcnt lgkmcnt(15)
v_mfma_f32_16x16x32_bf16 v[96:99], a[24:27], a[12:15], v[96:99]
ds_read_b64_tr_b16 a[60:61], v223 offset:37888
ds_read_b64_tr_b16 a[62:63], v223 offset:44032
ds_read_b64_tr_b16 a[202:203], v194 offset:7168
v_mfma_f32_16x16x32_bf16 v[100:103], a[28:31], a[12:15], v[100:103]
ds_read_b64_tr_b16 a[64:65], v223 offset:38912
ds_read_b64_tr_b16 a[66:67], v223 offset:45056
v_mfma_f32_16x16x32_bf16 v[104:107], a[16:19], a[24:27], v[104:107]
ds_read_b64_tr_b16 a[76:77], v192 offset:37888
ds_read_b64_tr_b16 a[216:217], v194 offset:2048
v_mfma_f32_16x16x32_bf16 v[108:111], a[16:19], a[28:31], v[108:111]
ds_read_b64_tr_b16 a[78:79], v192 offset:44032
s_waitcnt vmcnt(4)
v_cmp_ne_u32 vcc, s67, v171
s_nop 0
s_cbranch_vccnz LZ_sp19
LZ_ok18:
v_mfma_f32_16x16x32_bf16 v[112:115], a[24:27], a[20:23], v[112:115]
ds_read_b64_tr_b16 a[80:81], v192 offset:38912
ds_read_b64_tr_b16 a[218:219], v194 offset:8192
v_mfma_f32_16x16x32_bf16 v[116:119], a[28:31], a[20:23], v[116:119]
ds_read_b64_tr_b16 a[82:83], v192 offset:45056
buffer_load_dwordx4 v[224:227], v6, s[4:7], s23 offen offset:0 sc1
v_mfma_f32_16x16x32_bf16 v[120:123], a[32:35], a[40:43], v[120:123]
ds_read_b64 a[84:85], v219 offset:0
buffer_load_dwordx4 v[228:231], v6, s[4:7], s23 offen offset:1024 sc1
v_mfma_f32_16x16x32_bf16 v[196:199], a[40:43], a[36:39], v[196:199]
ds_read_b64 a[86:87], v191 offset:0
s_cmp_lg_u32 s15, 0
s_cbranch_scc1 LZ_c12
v_mfma_f32_16x16x32_bf16 v[144:147], a[0:3], v[164:167], v[144:147]
v_mfma_f32_16x16x32_bf16 v[148:151], a[4:7], v[164:167], v[148:151]
v_mfma_f32_16x16x32_bf16 v[152:155], a[8:11], v[164:167], v[152:155]
v_mfma_f32_16x16x32_bf16 v[180:183], v[164:167], a[12:15], v[180:183]
v_mfma_f32_16x16x32_bf16 v[156:159], a[16:19], v[164:167], v[156:159]
v_mfma_f32_16x16x32_bf16 v[184:187], v[164:167], a[20:23], v[184:187]
LZ_c12:
s_waitcnt lgkmcnt(0)
s_barrier
v_add_u32 v222, 49152, v222
v_add_u32 v223, 49152, v223
v_add_u32 v192, 49152, v192
v_add_u32 v193, 49152, v193
v_add_u32 v194, 49152, v194
v_mfma_f32_16x16x32_bf16 v[72:75], a[44:47], a[68:71], v[72:75]
ds_read_b64 a[24:25], v212 offset:16384
ds_read_b64 a[26:27], v160 offset:16384
buffer_load_dwordx4 v[232:235], v6, s[4:7], s23 offen offset:2048 sc1
v_mfma_f32_16x16x32_bf16 v[76:79], a[44:47], a[72:75], v[76:79]
ds_read_b64 a[28:29], v212 offset:20480
ds_read_b64 a[30:31], v160 offset:20480
v_mfma_f32_16x16x32_bf16 v[80:83], a[48:51], a[68:71], v[80:83]
ds_read_b64_tr_b16 a[0:1], v222 offset:0
ds_read_b64_tr_b16 a[2:3], v222 offset:6144
v_mfma_f32_16x16x32_bf16 v[84:87], a[48:51], a[72:75], v[84:87]
ds_read_b64_tr_b16 a[4:5], v223 offset:0
ds_read_b64_tr_b16 a[6:7], v223 offset:6144
buffer_load_dwordx4 v[236:239], v6, s[4:7], s23 offen offset:3072 sc1
v_mfma_f32_16x16x32_bf16 v[88:91], a[52:55], a[68:71], v[88:91]
ds_read_b64_tr_b16 a[8:9], v222 offset:1024
ds_read_b64_tr_b16 a[10:11], v222 offset:7168
v_mfma_f32_16x16x32_bf16 v[92:95], a[52:55], a[72:75], v[92:95]
ds_read_b64_tr_b16 a[12:13], v222 offset:2048
ds_read_b64_tr_b16 a[14:15], v222 offset:8192
buffer_load_dwordx4 v[40:43], v6, s[4:7], s25 offen offset:0 sc1
v_mfma_f32_16x16x32_bf16 v[96:99], a[68:71], a[56:59], v[96:99]
ds_read_b64_tr_b16 a[16:17], v223 offset:1024
ds_read_b64_tr_b16 a[18:19], v223 offset:7168
v_mfma_f32_16x16x32_bf16 v[100:103], a[72:75], a[56:59], v[100:103]
ds_read_b64_tr_b16 a[20:21], v223 offset:2048
ds_read_b64_tr_b16 a[22:23], v223 offset:8192
v_mfma_f32_16x16x32_bf16 v[104:107], a[60:63], a[68:71], v[104:107]
ds_read_b64_tr_b16 a[32:33], v192 offset:1024
buffer_load_dwordx4 v[44:47], v6, s[4:7], s25 offen offset:1024 sc1
v_mfma_f32_16x16x32_bf16 v[108:111], a[60:63], a[72:75], v[108:111]
ds_read_b64_tr_b16 a[34:35], v192 offset:7168
v_mfma_f32_16x16x32_bf16 v[112:115], a[68:71], a[64:67], v[112:115]
ds_read_b64_tr_b16 a[36:37], v192 offset:2048
buffer_load_dwordx4 v[48:51], v6, s[4:7], s25 offen offset:2048 sc1
v_mfma_f32_16x16x32_bf16 v[116:119], a[72:75], a[64:67], v[116:119]
ds_read_b64_tr_b16 a[38:39], v192 offset:8192
v_mfma_f32_16x16x32_bf16 v[120:123], a[76:79], a[84:87], v[120:123]
ds_read_b64 a[40:41], v216 offset:4096
buffer_load_dwordx4 v[52:55], v6, s[4:7], s25 offen offset:3072 sc1
v_mfma_f32_16x16x32_bf16 v[196:199], a[84:87], a[80:83], v[196:199]
ds_read_b64 a[42:43], v188 offset:4096
s_cmp_lg_u32 s15, 1
s_cbranch_scc1 LZ_c13
v_mfma_f32_16x16x32_bf16 v[144:147], a[44:47], v[164:167], v[144:147]
v_mfma_f32_16x16x32_bf16 v[148:151], a[48:51], v[164:167], v[148:151]
v_mfma_f32_16x16x32_bf16 v[152:155], a[52:55], v[164:167], v[152:155]
v_mfma_f32_16x16x32_bf16 v[180:183], v[164:167], a[56:59], v[180:183]
v_mfma_f32_16x16x32_bf16 v[156:159], a[60:63], v[164:167], v[156:159]
v_mfma_f32_16x16x32_bf16 v[184:187], v[164:167], a[64:67], v[184:187]
LZ_c13:
s_waitcnt lgkmcnt(12)
v_mfma_f32_16x16x32_bf16 v[72:75], a[0:3], a[24:27], v[72:75]
ds_read_b64 a[68:69], v213 offset:16384
ds_read_b64 a[70:71], v161 offset:16384
s_sub_u32 s50, s34, 16777216
v_mfma_f32_16x16x32_bf16 v[76:79], a[0:3], a[28:31], v[76:79]
ds_read_b64 a[72:73], v213 offset:20480
ds_read_b64 a[74:75], v161 offset:20480
v_mfma_f32_16x16x32_bf16 v[80:83], a[4:7], a[24:27], v[80:83]
ds_read_b64_tr_b16 a[44:45], v222 offset:12288
ds_read_b64_tr_b16 a[46:47], v222 offset:18432
v_mfma_f32_16x16x32_bf16 v[84:87], a[4:7], a[28:31], v[84:87]
ds_read_b64_tr_b16 a[48:49], v223 offset:12288
ds_read_b64_tr_b16 a[50:51], v223 offset:18432
buffer_load_dwordx4 v[124:127], v1, s[4:7], s50 offen sc1
v_mfma_f32_16x16x32_bf16 v[88:91], a[8:11], a[24:27], v[88:91]
ds_read_b64_tr_b16 a[52:53], v222 offset:13312
ds_read_b64_tr_b16 a[54:55], v222 offset:19456
v_mfma_f32_16x16x32_bf16 v[92:95], a[8:11], a[28:31], v[92:95]
ds_read_b64_tr_b16 a[56:57], v222 offset:14336
ds_read_b64_tr_b16 a[58:59], v222 offset:20480
buffer_load_dwordx4 v[128:131], v4, s[4:7], s50 offen sc1
s_waitcnt lgkmcnt(12)
v_mfma_f32_16x16x32_bf16 v[96:99], a[24:27], a[12:15], v[96:99]
ds_read_b64_tr_b16 a[60:61], v223 offset:13312
ds_read_b64_tr_b16 a[62:63], v223 offset:19456
v_mfma_f32_16x16x32_bf16 v[100:103], a[28:31], a[12:15], v[100:103]
ds_read_b64_tr_b16 a[64:65], v223 offset:14336
ds_read_b64_tr_b16 a[66:67], v223 offset:20480
v_mfma_f32_16x16x32_bf16 v[104:107], a[16:19], a[24:27], v[104:107]
ds_read_b64_tr_b16 a[76:77], v192 offset:13312
buffer_load_dwordx2 v[38:39], v168, s[4:7], 0 offen offset:0 sc1
v_mfma_f32_16x16x32_bf16 v[108:111], a[16:19], a[28:31], v[108:111]
ds_read_b64_tr_b16 a[78:79], v192 offset:19456
v_mfma_f32_16x16x32_bf16 v[112:115], a[24:27], a[20:23], v[112:115]
ds_read_b64_tr_b16 a[80:81], v192 offset:14336
v_mfma_f32_16x16x32_bf16 v[116:119], a[28:31], a[20:23], v[116:119]
ds_read_b64_tr_b16 a[82:83], v192 offset:20480
v_mfma_f32_16x16x32_bf16 v[120:123], a[32:35], a[40:43], v[120:123]
ds_read_b64 a[84:85], v217 offset:4096
v_mfma_f32_16x16x32_bf16 v[196:199], a[40:43], a[36:39], v[196:199]
ds_read_b64 a[86:87], v189 offset:4096
s_cmp_lg_u32 s15, 0
s_cbranch_scc1 LZ_c14
v_mfma_f32_16x16x32_bf16 v[144:147], a[0:3], v[164:167], v[144:147]
v_mfma_f32_16x16x32_bf16 v[148:151], a[4:7], v[164:167], v[148:151]
v_mfma_f32_16x16x32_bf16 v[152:155], a[8:11], v[164:167], v[152:155]
v_mfma_f32_16x16x32_bf16 v[180:183], v[164:167], a[12:15], v[180:183]
v_mfma_f32_16x16x32_bf16 v[156:159], a[16:19], v[164:167], v[156:159]
v_mfma_f32_16x16x32_bf16 v[184:187], v[164:167], a[20:23], v[184:187]
LZ_c14:
s_waitcnt lgkmcnt(12)
s_waitcnt vmcnt(11)
s_barrier
v_mfma_f32_16x16x32_bf16 v[72:75], a[44:47], a[68:71], v[72:75]
ds_read_b64 a[24:25], v214 offset:16384
ds_read_b64 a[26:27], v162 offset:16384
v_mfma_f32_16x16x32_bf16 v[76:79], a[44:47], a[72:75], v[76:79]
ds_read_b64 a[28:29], v214 offset:20480
ds_read_b64 a[30:31], v162 offset:20480
v_mfma_f32_16x16x32_bf16 v[80:83], a[48:51], a[68:71], v[80:83]
ds_read_b64_tr_b16 a[0:1], v222 offset:24576
ds_read_b64_tr_b16 a[2:3], v222 offset:30720
ds_read_b64_tr_b16 a[140:141], v193 offset:0
v_mfma_f32_16x16x32_bf16 v[84:87], a[48:51], a[72:75], v[84:87]
ds_read_b64_tr_b16 a[4:5], v223 offset:24576
ds_read_b64_tr_b16 a[6:7], v223 offset:30720
v_mfma_f32_16x16x32_bf16 v[88:91], a[52:55], a[68:71], v[88:91]
ds_read_b64_tr_b16 a[8:9], v222 offset:25600
ds_read_b64_tr_b16 a[10:11], v222 offset:31744
ds_read_b64_tr_b16 a[142:143], v193 offset:6144
v_mfma_f32_16x16x32_bf16 v[92:95], a[52:55], a[72:75], v[92:95]
ds_read_b64_tr_b16 a[12:13], v222 offset:26624
ds_read_b64_tr_b16 a[14:15], v222 offset:32768
s_waitcnt lgkmcnt(14)
v_mfma_f32_16x16x32_bf16 v[96:99], a[68:71], a[56:59], v[96:99]
ds_read_b64_tr_b16 a[16:17], v223 offset:25600
ds_read_b64_tr_b16 a[18:19], v223 offset:31744
ds_read_b64_tr_b16 a[156:157], v194 offset:0
v_mfma_f32_16x16x32_bf16 v[100:103], a[72:75], a[56:59], v[100:103]
ds_read_b64_tr_b16 a[20:21], v223 offset:26624
ds_read_b64_tr_b16 a[22:23], v223 offset:32768
v_mfma_f32_16x16x32_bf16 v[104:107], a[60:63], a[68:71], v[104:107]
ds_read_b64_tr_b16 a[32:33], v192 offset:25600
ds_read_b64_tr_b16 a[158:159], v194 offset:6144
v_mfma_f32_16x16x32_bf16 v[108:111], a[60:63], a[72:75], v[108:111]
ds_read_b64_tr_b16 a[34:35], v192 offset:31744
v_mfma_f32_16x16x32_bf16 v[112:115], a[68:71], a[64:67], v[112:115]
ds_read_b64_tr_b16 a[36:37], v192 offset:26624
ds_read_b64_tr_b16 a[172:173], v193 offset:1024
v_mfma_f32_16x16x32_bf16 v[116:119], a[72:75], a[64:67], v[116:119]
ds_read_b64_tr_b16 a[38:39], v192 offset:32768
v_mfma_f32_16x16x32_bf16 v[120:123], a[76:79], a[84:87], v[120:123]
ds_read_b64 a[40:41], v218 offset:4096
ds_read_b64_tr_b16 a[174:175], v193 offset:7168
v_mfma_f32_16x16x32_bf16 v[196:199], a[84:87], a[80:83], v[196:199]
ds_read_b64 a[42:43], v190 offset:4096
s_cmp_lg_u32 s15, 1
s_cbranch_scc1 LZ_c15
v_mfma_f32_16x16x32_bf16 v[144:147], a[44:47], v[164:167], v[144:147]
v_mfma_f32_16x16x32_bf16 v[148:151], a[48:51], v[164:167], v[148:151]
v_mfma_f32_16x16x32_bf16 v[152:155], a[52:55], v[164:167], v[152:155]
v_mfma_f32_16x16x32_bf16 v[180:183], v[164:167], a[56:59], v[180:183]
v_mfma_f32_16x16x32_bf16 v[156:159], a[60:63], v[164:167], v[156:159]
v_mfma_f32_16x16x32_bf16 v[184:187], v[164:167], a[64:67], v[184:187]
LZ_c15:
s_waitcnt lgkmcnt(15)
v_mfma_f32_16x16x32_bf16 v[72:75], a[0:3], a[24:27], v[72:75]
ds_read_b64 a[68:69], v215 offset:16384
ds_read_b64 a[70:71], v163 offset:16384
ds_read_b64_tr_b16 a[188:189], v193 offset:2048
v_mfma_f32_16x16x32_bf16 v[76:79], a[0:3], a[28:31], v[76:79]
ds_read_b64 a[72:73], v215 offset:20480
ds_read_b64 a[74:75], v163 offset:20480
v_mfma_f32_16x16x32_bf16 v[80:83], a[4:7], a[24:27], v[80:83]
ds_read_b64_tr_b16 a[44:45], v222 offset:36864
ds_read_b64_tr_b16 a[46:47], v222 offset:43008
ds_read_b64_tr_b16 a[190:191], v193 offset:8192
v_mfma_f32_16x16x32_bf16 v[84:87], a[4:7], a[28:31], v[84:87]
ds_read_b64_tr_b16 a[48:49], v223 offset:36864
ds_read_b64_tr_b16 a[50:51], v223 offset:43008
v_mfma_f32_16x16x32_bf16 v[88:91], a[8:11], a[24:27], v[88:91]
ds_read_b64_tr_b16 a[52:53], v222 offset:37888
ds_read_b64_tr_b16 a[54:55], v222 offset:44032
ds_read_b64_tr_b16 a[204:205], v194 offset:1024
v_mfma_f32_16x16x32_bf16 v[92:95], a[8:11], a[28:31], v[92:95]
ds_read_b64_tr_b16 a[56:57], v222 offset:38912
ds_read_b64_tr_b16 a[58:59], v222 offset:45056
buffer_load_dword v29, v1, s[4:7], s28 offen offset:0 sc1
s_waitcnt lgkmcnt(15)
v_mfma_f32_16x16x32_bf16 v[96:99], a[24:27], a[12:15], v[96:99]
ds_read_b64_tr_b16 a[60:61], v223 offset:37888
ds_read_b64_tr_b16 a[62:63], v223 offset:44032
ds_read_b64_tr_b16 a[206:207], v194 offset:7168
v_mfma_f32_16x16x32_bf16 v[100:103], a[28:31], a[12:15], v[100:103]
ds_read_b64_tr_b16 a[64:65], v223 offset:38912
ds_read_b64_tr_b16 a[66:67], v223 offset:45056
buffer_load_dword v29, v4, s[4:7], s28 offen offset:0 sc1
v_mfma_f32_16x16x32_bf16 v[104:107], a[16:19], a[24:27], v[104:107]
ds_read_b64_tr_b16 a[76:77], v192 offset:37888
ds_read_b64_tr_b16 a[220:221], v194 offset:2048
v_mfma_f32_16x16x32_bf16 v[108:111], a[16:19], a[28:31], v[108:111]
ds_read_b64_tr_b16 a[78:79], v192 offset:44032
buffer_load_dword v29, v7, s[4:7], s29 offen offset:0 sc1
v_mfma_f32_16x16x32_bf16 v[112:115], a[24:27], a[20:23], v[112:115]
ds_read_b64_tr_b16 a[80:81], v192 offset:38912
ds_read_b64_tr_b16 a[222:223], v194 offset:8192
v_mfma_f32_16x16x32_bf16 v[116:119], a[28:31], a[20:23], v[116:119]
ds_read_b64_tr_b16 a[82:83], v192 offset:45056
v_mfma_f32_16x16x32_bf16 v[120:123], a[32:35], a[40:43], v[120:123]
ds_read_b64 a[84:85], v219 offset:4096
buffer_load_dword v29, v7, s[4:7], s35 offen offset:0 sc1
v_mfma_f32_16x16x32_bf16 v[196:199], a[40:43], a[36:39], v[196:199]
ds_read_b64 a[86:87], v191 offset:4096
s_cmp_lg_u32 s15, 0
s_cbranch_scc1 LZ_c16
v_mfma_f32_16x16x32_bf16 v[144:147], a[0:3], v[164:167], v[144:147]
v_mfma_f32_16x16x32_bf16 v[148:151], a[4:7], v[164:167], v[148:151]
v_mfma_f32_16x16x32_bf16 v[152:155], a[8:11], v[164:167], v[152:155]
v_mfma_f32_16x16x32_bf16 v[180:183], v[164:167], a[12:15], v[180:183]
v_mfma_f32_16x16x32_bf16 v[156:159], a[16:19], v[164:167], v[156:159]
v_mfma_f32_16x16x32_bf16 v[184:187], v[164:167], a[20:23], v[184:187]
LZ_c16:
s_waitcnt lgkmcnt(15)
v_mfma_f32_16x16x32_bf16 v[72:75], a[44:47], a[68:71], v[72:75]
s_add_u32 m0, s94, 0
s_add_u32 s47, s95, 0
buffer_load_dwordx4 v248, s[88:91], s47 offen nt lds
v_mfma_f32_16x16x32_bf16 v[76:79], a[44:47], a[72:75], v[76:79]
v_mfma_f32_16x16x32_bf16 v[80:83], a[48:51], a[68:71], v[80:83]
v_mfma_f32_16x16x32_bf16 v[84:87], a[48:51], a[72:75], v[84:87]
s_add_u32 m0, s94, 1024
s_add_u32 s47, s95, 8192
buffer_load_dwordx4 v248, s[88:91], s47 offen nt lds
v_mfma_f32_16x16x32_bf16 v[88:91], a[52:55], a[68:71], v[88:91]
v_mfma_f32_16x16x32_bf16 v[92:95], a[52:55], a[72:75], v[92:95]
s_waitcnt lgkmcnt(0)
v_mfma_f32_16x16x32_bf16 v[96:99], a[68:71], a[56:59], v[96:99]
v_mfma_f32_16x16x32_bf16 v[100:103], a[72:75], a[56:59], v[100:103]
v_mfma_f32_16x16x32_bf16 v[104:107], a[60:63], a[68:71], v[104:107]
v_mfma_f32_16x16x32_bf16 v[108:111], a[60:63], a[72:75], v[108:111]
v_mfma_f32_16x16x32_bf16 v[112:115], a[68:71], a[64:67], v[112:115]
v_mfma_f32_16x16x32_bf16 v[116:119], a[72:75], a[64:67], v[116:119]
v_mfma_f32_16x16x32_bf16 v[120:123], a[76:79], a[84:87], v[120:123]
v_mfma_f32_16x16x32_bf16 v[196:199], a[84:87], a[80:83], v[196:199]
s_cmp_lg_u32 s15, 1
s_cbranch_scc1 LZ_c17
v_mfma_f32_16x16x32_bf16 v[144:147], a[44:47], v[164:167], v[144:147]
v_mfma_f32_16x16x32_bf16 v[148:151], a[48:51], v[164:167], v[148:151]
v_mfma_f32_16x16x32_bf16 v[152:155], a[52:55], v[164:167], v[152:155]
v_mfma_f32_16x16x32_bf16 v[180:183], v[164:167], a[56:59], v[180:183]
v_mfma_f32_16x16x32_bf16 v[156:159], a[60:63], v[164:167], v[156:159]
v_mfma_f32_16x16x32_bf16 v[184:187], v[164:167], a[64:67], v[184:187]
LZ_c17:
v_cmp_ne_u32 vcc, s55, v170
s_nop 0
s_cmp_lg_u32 vcc_lo, 0
s_cselect_b32 s99, 1, 0
s_nop 1
v_mov_b32 v34, v180
s_nop 0
v_mov_b32 v35, v184
v_add_u32 v208, 2048, v25
v_add_u32 v209, 2048, v24
ds_write_b128 v208, v[144:147] offset:0
ds_write_b128 v208, v[148:151] offset:64
ds_write_b128 v208, v[152:155] offset:128
ds_write_b128 v208, v[156:159] offset:192
ds_write2_b32 v209, v34, v35 offset0:64 offset1:80
v_xor_b32 v208, 512, v208
v_xor_b32 v209, 512, v209
s_waitcnt vmcnt(6)
v_cmp_ne_u32 vcc, s67, v39
s_nop 0
s_cbranch_vccnz LZ_sp21
LZ_ok20:
s_waitcnt lgkmcnt(0)
s_barrier
ds_read_b128 v[240:243], v208 offset:0
ds_read_b128 v[244:247], v208 offset:64
ds_read_b128 v[248:251], v208 offset:128
ds_read_b128 v[252:255], v208 offset:192
ds_read2_b32 v[168:169], v209 offset0:64 offset1:80
s_waitcnt lgkmcnt(4)
v_pk_add_f32 v[144:145], v[144:145], v[240:241]
v_pk_add_f32 v[146:147], v[146:147], v[242:243]
s_waitcnt lgkmcnt(3)
v_pk_add_f32 v[148:149], v[148:149], v[244:245]
v_pk_add_f32 v[150:151], v[150:151], v[246:247]
s_waitcnt lgkmcnt(2)
v_pk_add_f32 v[152:153], v[152:153], v[248:249]
v_pk_add_f32 v[154:155], v[154:155], v[250:251]
s_waitcnt lgkmcnt(1)
v_pk_add_f32 v[156:157], v[156:157], v[252:253]
v_pk_add_f32 v[158:159], v[158:159], v[254:255]
s_waitcnt lgkmcnt(0)
v_pk_add_f32 v[34:35], v[34:35], v[168:169]
s_cmp_lg_u32 s99, 0
s_cbranch_scc1 LS0_tail
LF0_tail:
v_pk_add_f32 v[224:225], v[224:225], v[226:227]
s_getpc_b64 s[64:65]
LF0_pc1:
s_lshr_b32 s51, s2, 3
s_lshl_b32 s51, s51, 2
s_add_u32 s51, s51, s14
s_lshl_b32 s51, s51, 8
s_add_u32 s51, s51, 0
v_lshrrev_b32 v255, 2, v1
v_add_u32 v255, s51, v255
global_load_dword v29, v255, s[64:65]
v_pk_add_f32 v[228:229], v[228:229], v[230:231]
v_pk_add_f32 v[232:233], v[232:233], v[234:235]
v_pk_add_f32 v[236:237], v[236:237], v[238:239]
v_pk_add_f32 v[224:225], v[224:225], v[228:229]
v_pk_add_f32 v[232:233], v[232:233], v[236:237]
v_pk_add_f32 v[224:225], v[224:225], v[232:233]
v_mov_b32 v226, v224
v_mov_b32 v227, v225
s_nop 0
v_permlane32_swap_b32 v224, v226
v_permlane32_swap_b32 v225, v227
v_add_f32 v224, v224, v226
v_add_f32 v225, v225, v227
buffer_load_dword v29, v26, s[4:7], s37 offen offset:0 sc1
v_mul_f32 v224, 0xbb000000, v224
v_mul_f32 v225, 0x3b000000, v225
v_fma_f32 v225, -v224, v224, v225
v_max_f32 v225, 0, v225
v_add_f32 v225, 0x3727c5ac, v225
v_rsq_f32 v226, v225
s_nop 0
v_cndmask_b32 v227, v224, v226, s[62:63]
ds_write_b32 v23, v227
ds_read2_b32 v[200:201], v24 offset0:0 offset1:32
ds_read2_b32 v[202:203], v24 offset0:16 offset1:48
ds_read_b128 v[208:211], v25 offset:0
ds_read_b128 v[212:215], v25 offset:128
buffer_load_dword v29, v26, s[4:7], s39 offen offset:0 sc1
ds_read_b128 v[216:219], v25 offset:64
ds_read_b128 v[220:223], v25 offset:192
s_waitcnt lgkmcnt(5)
v_mul_f32 v204, 0x3eb8aa3b, v201
s_waitcnt lgkmcnt(4)
v_mul_f32 v205, 0x3eb8aa3b, v203
v_pk_add_f32 v[40:41], v[40:41], v[42:43]
v_pk_add_f32 v[44:45], v[44:45], v[46:47]
v_pk_add_f32 v[48:49], v[48:49], v[50:51]
v_pk_add_f32 v[52:53], v[52:53], v[54:55]
v_pk_add_f32 v[40:41], v[40:41], v[44:45]
v_pk_add_f32 v[48:49], v[48:49], v[52:53]
v_pk_add_f32 v[40:41], v[40:41], v[48:49]
v_mov_b32 v42, v40
v_mov_b32 v43, v41
s_add_u32 m0, s21, 98304
s_add_u32 s47, s19, 0
buffer_load_dwordx4 v1, s[4:7], s47 offen offset:0 sc1 lds
v_permlane32_swap_b32 v40, v42
v_permlane32_swap_b32 v41, v43
v_add_f32 v40, v40, v42
v_add_f32 v41, v41, v43
v_mul_f32 v40, 0xbb000000, v40
v_mul_f32 v41, 0x3b000000, v41
v_fma_f32 v41, -v40, v40, v41
v_max_f32 v41, 0, v41
v_add_f32 v41, 0x3727c5ac, v41
v_rsq_f32 v42, v41
s_nop 0
v_cndmask_b32 v43, v40, v42, s[62:63]
ds_write_b32 v23, v43 offset:256
buffer_load_dwordx4 v1, s[4:7], s47 offen offset:1024 sc1 lds
ds_read2_b32 v[40:41], v24 offset0:80 offset1:112
ds_read_b128 v[44:47], v25 offset:320
ds_read_b128 v[48:51], v25 offset:448
s_cmp_lg_u32 s15, 0
s_cselect_b64 vcc, -1, 0
v_cndmask_b32 v52, v34, v35, vcc
v_cndmask_b32 v160, v152, v156, vcc
v_cndmask_b32 v161, v153, v157, vcc
v_cndmask_b32 v162, v154, v158, vcc
v_cndmask_b32 v163, v155, v159, vcc
v_pk_fma_f32 v[92:93], v[202:203], v[152:153], v[92:93] op_sel:[0,0,0] op_sel_hi:[0,1,1]
v_pk_fma_f32 v[94:95], v[202:203], v[154:155], v[94:95] op_sel:[0,0,0] op_sel_hi:[0,1,1]
v_pk_mul_f32 v[92:93], v[202:203], v[92:93] op_sel:[1,0] op_sel_hi:[1,1]
buffer_load_dwordx4 v1, s[4:7], s47 offen offset:2048 sc1 lds
v_pk_mul_f32 v[94:95], v[202:203], v[94:95] op_sel:[1,0] op_sel_hi:[1,1]
v_cvt_pk_bf16_f32 v172, v92, v93
v_cvt_pk_bf16_f32 v173, v94, v95
s_waitcnt lgkmcnt(5)
v_pk_fma_f32 v[100:101], v[216:217], v[34:35], v[100:101] op_sel:[0,0,0] op_sel_hi:[1,0,1]
v_pk_fma_f32 v[102:103], v[218:219], v[34:35], v[102:103] op_sel:[0,0,0] op_sel_hi:[1,0,1]
s_waitcnt lgkmcnt(4)
v_pk_mul_f32 v[100:101], v[220:221], v[100:101] op_sel:[0,0] op_sel_hi:[1,1]
v_pk_mul_f32 v[102:103], v[222:223], v[102:103] op_sel:[0,0] op_sel_hi:[1,1]
v_cvt_pk_bf16_f32 v184, v100, v101
v_cvt_pk_bf16_f32 v185, v102, v103
ds_write_b64 v20, v[172:173] offset:0
ds_write_b64 v20, v[184:185] offset:8
v_pk_fma_f32 v[108:109], v[202:203], v[156:157], v[108:109] op_sel:[0,0,0] op_sel_hi:[0,1,1]
v_pk_fma_f32 v[110:111], v[202:203], v[158:159], v[110:111] op_sel:[0,0,0] op_sel_hi:[0,1,1]
buffer_load_dwordx4 v1, s[4:7], s47 offen offset:3072 sc1 lds
v_pk_mul_f32 v[108:109], v[202:203], v[108:109] op_sel:[1,0] op_sel_hi:[1,1]
v_pk_mul_f32 v[110:111], v[202:203], v[110:111] op_sel:[1,0] op_sel_hi:[1,1]
v_cvt_pk_bf16_f32 v178, v108, v109
v_cvt_pk_bf16_f32 v179, v110, v111
v_pk_fma_f32 v[116:117], v[216:217], v[34:35], v[116:117] op_sel:[0,1,0] op_sel_hi:[1,1,1]
v_pk_fma_f32 v[118:119], v[218:219], v[34:35], v[118:119] op_sel:[0,1,0] op_sel_hi:[1,1,1]
v_pk_mul_f32 v[116:117], v[220:221], v[116:117] op_sel:[0,0] op_sel_hi:[1,1]
v_pk_mul_f32 v[118:119], v[222:223], v[118:119] op_sel:[0,0] op_sel_hi:[1,1]
v_cvt_pk_bf16_f32 v190, v116, v117
v_cvt_pk_bf16_f32 v191, v118, v119
ds_write_b64 v20, v[178:179] offset:1024
ds_write_b64 v20, v[190:191] offset:1032
s_add_u32 m0, s21, 114688
s_add_u32 s47, s19, 16384
buffer_load_dwordx4 v1, s[4:7], s47 offen offset:0 sc1 lds
s_waitcnt lgkmcnt(6)
v_pk_fma_f32 v[120:121], v[40:41], v[160:161], v[120:121] op_sel:[0,0,0] op_sel_hi:[0,1,1]
v_pk_fma_f32 v[122:123], v[40:41], v[162:163], v[122:123] op_sel:[0,0,0] op_sel_hi:[0,1,1]
v_pk_mul_f32 v[120:121], v[40:41], v[120:121] op_sel:[1,0] op_sel_hi:[1,1]
v_pk_mul_f32 v[122:123], v[40:41], v[122:123] op_sel:[1,0] op_sel_hi:[1,1]
v_cvt_pk_bf16_f32 v120, v120, v121
v_cvt_pk_bf16_f32 v121, v122, v123
s_waitcnt lgkmcnt(5)
v_pk_fma_f32 v[196:197], v[44:45], v[52:53], v[196:197] op_sel:[0,0,0] op_sel_hi:[1,0,1]
v_pk_fma_f32 v[198:199], v[46:47], v[52:53], v[198:199] op_sel:[0,0,0] op_sel_hi:[1,0,1]
s_waitcnt lgkmcnt(4)
v_pk_mul_f32 v[196:197], v[48:49], v[196:197] op_sel:[0,0] op_sel_hi:[1,1]
v_pk_mul_f32 v[198:199], v[50:51], v[198:199] op_sel:[0,0] op_sel_hi:[1,1]
v_cvt_pk_bf16_f32 v122, v196, v197
v_cvt_pk_bf16_f32 v123, v198, v199
buffer_load_dwordx4 v1, s[4:7], s47 offen offset:1024 sc1 lds
ds_write_b128 v21, v[120:123]
v_pk_fma_f32 v[88:89], v[200:201], v[152:153], v[88:89] op_sel:[0,0,0] op_sel_hi:[0,1,1]
v_pk_fma_f32 v[90:91], v[200:201], v[154:155], v[90:91] op_sel:[0,0,0] op_sel_hi:[0,1,1]
v_pk_mul_f32 v[88:89], v[200:201], v[88:89] op_sel:[1,0] op_sel_hi:[1,1]
v_pk_mul_f32 v[90:91], v[200:201], v[90:91] op_sel:[1,0] op_sel_hi:[1,1]
v_cvt_pk_bf16_f32 v170, v88, v89
v_cvt_pk_bf16_f32 v171, v90, v91
v_pk_fma_f32 v[96:97], v[208:209], v[34:35], v[96:97] op_sel:[0,0,0] op_sel_hi:[1,0,1]
v_pk_fma_f32 v[98:99], v[210:211], v[34:35], v[98:99] op_sel:[0,0,0] op_sel_hi:[1,0,1]
v_pk_mul_f32 v[96:97], v[212:213], v[96:97] op_sel:[0,0] op_sel_hi:[1,1]
v_pk_mul_f32 v[98:99], v[214:215], v[98:99] op_sel:[0,0] op_sel_hi:[1,1]
v_cvt_pk_bf16_f32 v182, v96, v97
v_cvt_pk_bf16_f32 v183, v98, v99
buffer_load_dwordx4 v1, s[4:7], s47 offen offset:2048 sc1 lds
v_pk_fma_f32 v[76:77], v[202:203], v[144:145], v[76:77] op_sel:[0,0,0] op_sel_hi:[0,1,1]
v_pk_fma_f32 v[78:79], v[202:203], v[146:147], v[78:79] op_sel:[0,0,0] op_sel_hi:[0,1,1]
v_cvt_pk_bf16_f32 v76, v76, v77
v_cvt_pk_bf16_f32 v77, v78, v79
v_pk_fma_f32 v[72:73], v[200:201], v[144:145], v[72:73] op_sel:[0,0,0] op_sel_hi:[0,1,1]
v_pk_fma_f32 v[74:75], v[200:201], v[146:147], v[74:75] op_sel:[0,0,0] op_sel_hi:[0,1,1]
v_cvt_pk_bf16_f32 v72, v72, v73
v_cvt_pk_bf16_f32 v73, v74, v75
v_pk_fma_f32 v[104:105], v[200:201], v[156:157], v[104:105] op_sel:[0,0,0] op_sel_hi:[0,1,1]
v_pk_fma_f32 v[106:107], v[200:201], v[158:159], v[106:107] op_sel:[0,0,0] op_sel_hi:[0,1,1]
v_pk_mul_f32 v[104:105], v[200:201], v[104:105] op_sel:[1,0] op_sel_hi:[1,1]
v_pk_mul_f32 v[106:107], v[200:201], v[106:107] op_sel:[1,0] op_sel_hi:[1,1]
buffer_load_dwordx4 v1, s[4:7], s47 offen offset:3072 sc1 lds
v_cvt_pk_bf16_f32 v176, v104, v105
v_cvt_pk_bf16_f32 v177, v106, v107
v_pk_fma_f32 v[112:113], v[208:209], v[34:35], v[112:113] op_sel:[0,1,0] op_sel_hi:[1,1,1]
v_pk_fma_f32 v[114:115], v[210:211], v[34:35], v[114:115] op_sel:[0,1,0] op_sel_hi:[1,1,1]
v_pk_mul_f32 v[112:113], v[212:213], v[112:113] op_sel:[0,0] op_sel_hi:[1,1]
v_pk_mul_f32 v[114:115], v[214:215], v[114:115] op_sel:[0,0] op_sel_hi:[1,1]
v_cvt_pk_bf16_f32 v188, v112, v113
v_cvt_pk_bf16_f32 v189, v114, v115
v_pk_fma_f32 v[84:85], v[202:203], v[148:149], v[84:85] op_sel:[0,0,0] op_sel_hi:[0,1,1]
v_pk_fma_f32 v[86:87], v[202:203], v[150:151], v[86:87] op_sel:[0,0,0] op_sel_hi:[0,1,1]
v_cvt_pk_bf16_f32 v84, v84, v85
v_cvt_pk_bf16_f32 v85, v86, v87
v_pk_fma_f32 v[80:81], v[200:201], v[148:149], v[80:81] op_sel:[0,0,0] op_sel_hi:[0,1,1]
v_pk_fma_f32 v[82:83], v[200:201], v[150:151], v[82:83] op_sel:[0,0,0] op_sel_hi:[0,1,1]
v_cvt_pk_bf16_f32 v80, v80, v81
v_cvt_pk_bf16_f32 v81, v82, v83
s_lshl_b32 s51, s14, 9
s_sub_u32 s51, s51, 4096
v_subrev_u32 v208, s51, v25
v_subrev_u32 v209, s51, v24
s_and_b32 s51, s13, 1
s_cmp_lg_u32 s51, s16
s_cbranch_scc1 LF0_c2
ds_write_b128 v208, v[144:147] offset:0
ds_write_b128 v208, v[148:151] offset:64
ds_write_b128 v208, v[152:155] offset:128
ds_write_b128 v208, v[156:159] offset:192
ds_write2_b32 v209, v34, v35 offset0:64 offset1:80
LF0_c2:
s_waitcnt vmcnt(11)
s_waitcnt lgkmcnt(0)
s_barrier
ds_read_b64 v[168:169], v22 offset:0
ds_read_b64 v[180:181], v22 offset:8
ds_read_b64 v[174:175], v22 offset:1024
ds_read_b64 v[186:187], v22 offset:1032
ds_read_b128 v[144:147], v208 offset:0
ds_read_b128 v[148:151], v208 offset:64
ds_read_b128 v[152:155], v208 offset:128
ds_read_b128 v[156:159], v208 offset:192
ds_read2_b32 v[34:35], v209 offset0:64 offset1:80
v_mfma_f32_16x16x16_bf16 v[224:227], v[170:171], v[76:77], v[136:139]
s_add_u32 m0, s21, 0
s_add_u32 s47, s18, 0
buffer_load_dwordx4 v1, s[4:7], s47 offen offset:0 sc1 lds
v_mfma_f32_16x16x16_bf16 v[228:231], v[172:173], v[76:77], v[132:135]
v_mfma_f32_16x16x16_bf16 v[240:243], v[176:177], v[84:85], v[136:139]
v_mfma_f32_16x16x16_bf16 v[244:247], v[178:179], v[84:85], v[132:135]
s_waitcnt lgkmcnt(8)
v_mfma_f32_16x16x16_bf16 v[40:43], v[168:169], v[72:73], v[140:143]
v_mfma_f32_16x16x16_bf16 v[44:47], v[170:171], v[72:73], v[132:135]
s_waitcnt lgkmcnt(6)
v_mfma_f32_16x16x16_bf16 v[56:59], v[174:175], v[80:81], v[140:143]
buffer_load_dwordx4 v1, s[4:7], s47 offen offset:1024 sc1 lds
v_mfma_f32_16x16x16_bf16 v[60:63], v[176:177], v[80:81], v[132:135]
v_max3_f32 v232, v224, v225, v226
v_max3_f32 v233, v227, v228, v229
v_max3_f32 v232, v232, v230, v231
v_max_f32 v232, v232, v233
v_mov_b32 v233, v232
buffer_load_dwordx4 v1, s[4:7], s47 offen offset:2048 sc1 lds
v_max3_f32 v248, v240, v241, v242
v_max3_f32 v249, v243, v244, v245
v_max3_f32 v248, v248, v246, v247
v_max_f32 v248, v248, v249
v_mov_b32 v249, v248
v_max3_f32 v48, v40, v41, v42
buffer_load_dwordx4 v1, s[4:7], s47 offen offset:3072 sc1 lds
v_max3_f32 v49, v43, v44, v45
v_max3_f32 v48, v48, v46, v47
v_max_f32 v48, v48, v49
v_mov_b32 v49, v48
v_max3_f32 v64, v56, v57, v58
v_max3_f32 v65, v59, v60, v61
v_max3_f32 v64, v64, v62, v63
s_add_u32 m0, s21, 16384
s_add_u32 s47, s18, 16384
buffer_load_dwordx4 v1, s[4:7], s47 offen offset:0 sc1 lds
v_max_f32 v64, v64, v65
v_mov_b32 v65, v64
v_permlane32_swap_b32 v232, v233
v_max_f32 v232, v232, v233
v_mov_b32 v233, v232
v_permlane32_swap_b32 v248, v249
buffer_load_dwordx4 v1, s[4:7], s47 offen offset:1024 sc1 lds
v_max_f32 v248, v248, v249
v_mov_b32 v249, v248
v_permlane32_swap_b32 v48, v49
v_max_f32 v48, v48, v49
v_mov_b32 v49, v48
v_permlane32_swap_b32 v64, v65
buffer_load_dwordx4 v1, s[4:7], s47 offen offset:2048 sc1 lds
v_max_f32 v64, v64, v65
v_mov_b32 v65, v64
v_permlane16_swap_b32 v232, v233
v_max_f32 v232, v232, v233
v_mul_f32 v232, v205, v232
v_permlane16_swap_b32 v248, v249
buffer_load_dwordx4 v1, s[4:7], s47 offen offset:3072 sc1 lds
v_max_f32 v248, v248, v249
v_mul_f32 v248, v205, v248
v_permlane16_swap_b32 v48, v49
v_max_f32 v48, v48, v49
v_mul_f32 v48, v204, v48
v_permlane16_swap_b32 v64, v65
v_max_f32 v64, v64, v65
s_add_u32 m0, s21, 32768
s_add_u32 s47, s18, 32768
buffer_load_dwordx4 v1, s[4:7], s47 offen offset:0 sc1 lds
v_mul_f32 v64, v204, v64
v_pk_fma_f32 v[224:225], v[224:225], v[204:205], v[232:233] op_sel:[0,1,0] op_sel_hi:[1,1,0] neg_lo:[0,0,1] neg_hi:[0,0,1]
v_pk_fma_f32 v[226:227], v[226:227], v[204:205], v[232:233] op_sel:[0,1,0] op_sel_hi:[1,1,0] neg_lo:[0,0,1] neg_hi:[0,0,1]
v_pk_fma_f32 v[228:229], v[228:229], v[204:205], v[232:233] op_sel:[0,1,0] op_sel_hi:[1,1,0] neg_lo:[0,0,1] neg_hi:[0,0,1]
v_pk_fma_f32 v[230:231], v[230:231], v[204:205], v[232:233] op_sel:[0,1,0] op_sel_hi:[1,1,0] neg_lo:[0,0,1] neg_hi:[0,0,1]
v_pk_fma_f32 v[240:241], v[240:241], v[204:205], v[248:249] op_sel:[0,1,0] op_sel_hi:[1,1,0] neg_lo:[0,0,1] neg_hi:[0,0,1]
buffer_load_dwordx4 v1, s[4:7], s47 offen offset:1024 sc1 lds
v_pk_fma_f32 v[242:243], v[242:243], v[204:205], v[248:249] op_sel:[0,1,0] op_sel_hi:[1,1,0] neg_lo:[0,0,1] neg_hi:[0,0,1]
v_pk_fma_f32 v[244:245], v[244:245], v[204:205], v[248:249] op_sel:[0,1,0] op_sel_hi:[1,1,0] neg_lo:[0,0,1] neg_hi:[0,0,1]
v_pk_fma_f32 v[246:247], v[246:247], v[204:205], v[248:249] op_sel:[0,1,0] op_sel_hi:[1,1,0] neg_lo:[0,0,1] neg_hi:[0,0,1]
v_pk_fma_f32 v[40:41], v[40:41], v[204:205], v[48:49] op_sel:[0,0,0] op_sel_hi:[1,0,0] neg_lo:[0,0,1] neg_hi:[0,0,1]
v_pk_fma_f32 v[42:43], v[42:43], v[204:205], v[48:49] op_sel:[0,0,0] op_sel_hi:[1,0,0] neg_lo:[0,0,1] neg_hi:[0,0,1]
v_pk_fma_f32 v[44:45], v[44:45], v[204:205], v[48:49] op_sel:[0,0,0] op_sel_hi:[1,0,0] neg_lo:[0,0,1] neg_hi:[0,0,1]
buffer_load_dwordx4 v1, s[4:7], s47 offen offset:2048 sc1 lds
v_pk_fma_f32 v[46:47], v[46:47], v[204:205], v[48:49] op_sel:[0,0,0] op_sel_hi:[1,0,0] neg_lo:[0,0,1] neg_hi:[0,0,1]
v_pk_fma_f32 v[56:57], v[56:57], v[204:205], v[64:65] op_sel:[0,0,0] op_sel_hi:[1,0,0] neg_lo:[0,0,1] neg_hi:[0,0,1]
v_pk_fma_f32 v[58:59], v[58:59], v[204:205], v[64:65] op_sel:[0,0,0] op_sel_hi:[1,0,0] neg_lo:[0,0,1] neg_hi:[0,0,1]
v_pk_fma_f32 v[60:61], v[60:61], v[204:205], v[64:65] op_sel:[0,0,0] op_sel_hi:[1,0,0] neg_lo:[0,0,1] neg_hi:[0,0,1]
v_pk_fma_f32 v[62:63], v[62:63], v[204:205], v[64:65] op_sel:[0,0,0] op_sel_hi:[1,0,0] neg_lo:[0,0,1] neg_hi:[0,0,1]
v_exp_f32 v224, v224
buffer_load_dwordx4 v1, s[4:7], s47 offen offset:3072 sc1 lds
v_exp_f32 v225, v225
v_exp_f32 v226, v226
v_exp_f32 v227, v227
v_exp_f32 v228, v228
v_exp_f32 v229, v229
v_exp_f32 v230, v230
v_exp_f32 v231, v231
s_add_u32 m0, s21, 49152
s_add_u32 s47, s18, 49152
buffer_load_dwordx4 v1, s[4:7], s47 offen offset:0 sc1 lds
v_exp_f32 v240, v240
v_exp_f32 v241, v241
v_exp_f32 v242, v242
v_exp_f32 v243, v243
v_exp_f32 v244, v244
v_exp_f32 v245, v245
buffer_load_dwordx4 v1, s[4:7], s47 offen offset:1024 sc1 lds
v_exp_f32 v246, v246
v_exp_f32 v247, v247
v_exp_f32 v40, v40
v_exp_f32 v41, v41
v_exp_f32 v42, v42
v_exp_f32 v43, v43
buffer_load_dwordx4 v1, s[4:7], s47 offen offset:2048 sc1 lds
v_exp_f32 v44, v44
v_exp_f32 v45, v45
v_exp_f32 v46, v46
v_exp_f32 v47, v47
v_exp_f32 v56, v56
v_exp_f32 v57, v57
buffer_load_dwordx4 v1, s[4:7], s47 offen offset:3072 sc1 lds
v_exp_f32 v58, v58
v_exp_f32 v59, v59
v_exp_f32 v60, v60
v_exp_f32 v61, v61
v_exp_f32 v62, v62
v_exp_f32 v63, v63
v_cvt_pk_bf16_f32 v234, v224, v225
v_cvt_pk_bf16_f32 v235, v226, v227
v_cvt_pk_bf16_f32 v236, v228, v229
v_cvt_pk_bf16_f32 v237, v230, v231
v_cvt_pk_bf16_f32 v250, v240, v241
v_cvt_pk_bf16_f32 v251, v242, v243
v_cvt_pk_bf16_f32 v252, v244, v245
v_cvt_pk_bf16_f32 v253, v246, v247
v_cvt_pk_bf16_f32 v50, v40, v41
v_cvt_pk_bf16_f32 v51, v42, v43
v_cvt_pk_bf16_f32 v52, v44, v45
v_cvt_pk_bf16_f32 v53, v46, v47
v_cvt_pk_bf16_f32 v66, v56, v57
v_cvt_pk_bf16_f32 v67, v58, v59
v_cvt_pk_bf16_f32 v68, v60, v61
v_cvt_pk_bf16_f32 v69, v62, v63
v_mfma_f32_16x16x32_bf16 v[228:231], v[164:167], v[234:237], 0
v_mfma_f32_16x16x32_bf16 v[224:227], v[182:185], v[234:237], 0
v_mfma_f32_16x16x32_bf16 v[244:247], v[164:167], v[250:253], 0
v_mfma_f32_16x16x32_bf16 v[240:243], v[188:191], v[250:253], 0
v_mfma_f32_16x16x32_bf16 v[44:47], v[164:167], v[50:53], 0
v_mfma_f32_16x16x32_bf16 v[40:43], v[180:183], v[50:53], 0
v_mfma_f32_16x16x32_bf16 v[60:63], v[164:167], v[66:69], 0
s_waitcnt lgkmcnt(5)
v_mfma_f32_16x16x32_bf16 v[56:59], v[186:189], v[66:69], 0
v_rcp_f32 v228, v228
s_nop 0
v_rcp_f32 v244, v244
s_nop 0
v_rcp_f32 v44, v44
s_nop 0
v_rcp_f32 v60, v60
v_pk_mul_f32 v[224:225], v[228:229], v[224:225] op_sel_hi:[0,1]
v_pk_mul_f32 v[226:227], v[228:229], v[226:227] op_sel_hi:[0,1]
v_pk_mul_f32 v[240:241], v[244:245], v[240:241] op_sel_hi:[0,1]
v_pk_mul_f32 v[242:243], v[244:245], v[242:243] op_sel_hi:[0,1]
v_pk_mul_f32 v[40:41], v[44:45], v[40:41] op_sel_hi:[0,1]
v_pk_mul_f32 v[42:43], v[44:45], v[42:43] op_sel_hi:[0,1]
v_pk_mul_f32 v[56:57], v[60:61], v[56:57] op_sel_hi:[0,1]
v_pk_mul_f32 v[58:59], v[60:61], v[58:59] op_sel_hi:[0,1]
v_cvt_pk_bf16_f32 v196, v224, v225
v_cvt_pk_bf16_f32 v197, v226, v227
v_cvt_pk_bf16_f32 v198, v240, v241
v_cvt_pk_bf16_f32 v199, v242, v243
v_cvt_pk_bf16_f32 v192, v40, v41
v_cvt_pk_bf16_f32 v193, v42, v43
v_cvt_pk_bf16_f32 v194, v56, v57
v_cvt_pk_bf16_f32 v195, v58, v59
s_add_u32 s48, s26, 16384
buffer_store_dwordx4 v[192:195], v1, s[4:7], s26 offen sc1
buffer_store_dwordx4 v[196:199], v1, s[4:7], s48 offen sc1
s_waitcnt vmcnt(0)
buffer_store_dwordx2 v[36:37], v26, s[4:7], s36 offen offset:0
v_lshlrev_b32 v168, 16, v124
v_and_b32 v169, 0xffff0000, v124
v_lshlrev_b32 v170, 16, v125
v_and_b32 v171, 0xffff0000, v125
v_lshlrev_b32 v172, 16, v126
v_and_b32 v173, 0xffff0000, v126
v_lshlrev_b32 v174, 16, v127
v_and_b32 v175, 0xffff0000, v127
v_lshlrev_b32 v176, 16, v128
v_and_b32 v177, 0xffff0000, v128
v_lshlrev_b32 v178, 16, v129
v_and_b32 v179, 0xffff0000, v129
v_lshlrev_b32 v180, 16, v130
v_and_b32 v181, 0xffff0000, v130
v_lshlrev_b32 v182, 16, v131
v_and_b32 v183, 0xffff0000, v131
buffer_load_dwordx2 v[38:39], v17, s[4:7], s37 offen offset:0 sc1
buffer_load_dwordx2 v[252:253], v17, s[4:7], s37 offen offset:0 sc1
s_waitcnt vmcnt(1)
v_cmp_ne_u64 vcc, s[66:67], v[38:39]
s_nop 0
s_cbranch_vccnz LF0_sp4
LF0_ok3:
s_add_u32 s48, s27, 0
buffer_load_dwordx4 a[0:3], v1, s[4:7], s48 offen offset:0 sc1
buffer_load_dwordx4 a[4:7], v4, s[4:7], s48 offen offset:0 sc1
buffer_load_dwordx4 a[8:11], v1, s[4:7], s48 offen offset:1024 sc1
buffer_load_dwordx4 a[12:15], v4, s[4:7], s48 offen offset:1024 sc1
buffer_load_dwordx4 a[16:19], v1, s[4:7], s48 offen offset:2048 sc1
buffer_load_dwordx4 a[20:23], v4, s[4:7], s48 offen offset:2048 sc1
buffer_load_dwordx4 a[24:27], v1, s[4:7], s48 offen offset:3072 sc1
buffer_load_dwordx4 a[28:31], v4, s[4:7], s48 offen offset:3072 sc1
s_add_u32 s48, s27, 4096
buffer_load_dwordx4 a[32:35], v1, s[4:7], s48 offen offset:0 sc1
buffer_load_dwordx4 a[36:39], v4, s[4:7], s48 offen offset:0 sc1
s_waitcnt lgkmcnt(0)
ds_read_b64_tr_b16 v[232:233], v27 offset:0
ds_read_b64_tr_b16 v[234:235], v14 offset:0
ds_read_b64_tr_b16 v[236:237], v27 offset:32
ds_read_b64_tr_b16 v[238:239], v14 offset:32
s_waitcnt lgkmcnt(0)
s_barrier
ds_read_b128 v[40:43], v8 offset:0
ds_read_b128 v[44:47], v8 offset:1024
ds_read_b128 v[48:51], v8 offset:2048
ds_read_b128 v[52:55], v8 offset:3072
s_waitcnt vmcnt(8) lgkmcnt(2)
v_mfma_f32_16x16x32_bf16 v[168:171], v[40:43], a[0:3], v[168:171]
ds_read_b128 v[56:59], v8 offset:4096
v_mfma_f32_16x16x32_bf16 v[176:179], v[40:43], a[4:7], v[176:179]
buffer_load_dwordx4 a[40:43], v1, s[4:7], s48 offen offset:1024 sc1
v_mfma_f32_16x16x32_bf16 v[172:175], v[44:47], a[0:3], v[172:175]
ds_read_b128 v[60:63], v8 offset:5120
v_mfma_f32_16x16x32_bf16 v[180:183], v[44:47], a[4:7], v[180:183]
s_waitcnt lgkmcnt(2)
v_mfma_f32_16x16x32_bf16 v[184:187], v[48:51], a[0:3], 0
ds_read_b128 v[64:67], v8 offset:6144
v_mfma_f32_16x16x32_bf16 v[192:195], v[48:51], a[4:7], 0
buffer_load_dwordx4 a[44:47], v4, s[4:7], s48 offen offset:1024 sc1
v_mfma_f32_16x16x32_bf16 v[188:191], v[52:55], a[0:3], 0
ds_read_b128 v[68:71], v8 offset:7168
v_mfma_f32_16x16x32_bf16 v[196:199], v[52:55], a[4:7], 0
s_waitcnt vmcnt(8) lgkmcnt(2)
v_mfma_f32_16x16x32_bf16 v[168:171], v[56:59], a[8:11], v[168:171]
ds_read_b128 v[40:43], v8 offset:16384
v_mfma_f32_16x16x32_bf16 v[176:179], v[56:59], a[12:15], v[176:179]
buffer_load_dwordx4 a[48:51], v1, s[4:7], s48 offen offset:2048 sc1
v_mfma_f32_16x16x32_bf16 v[172:175], v[60:63], a[8:11], v[172:175]
ds_read_b128 v[44:47], v8 offset:17408
v_mfma_f32_16x16x32_bf16 v[180:183], v[60:63], a[12:15], v[180:183]
s_waitcnt lgkmcnt(2)
v_mfma_f32_16x16x32_bf16 v[184:187], v[64:67], a[8:11], v[184:187]
ds_read_b128 v[48:51], v8 offset:18432
v_mfma_f32_16x16x32_bf16 v[192:195], v[64:67], a[12:15], v[192:195]
buffer_load_dwordx4 a[52:55], v4, s[4:7], s48 offen offset:2048 sc1
v_mfma_f32_16x16x32_bf16 v[188:191], v[68:71], a[8:11], v[188:191]
ds_read_b128 v[52:55], v8 offset:19456
v_mfma_f32_16x16x32_bf16 v[196:199], v[68:71], a[12:15], v[196:199]
s_waitcnt vmcnt(8) lgkmcnt(2)
v_mfma_f32_16x16x32_bf16 v[168:171], v[40:43], a[16:19], v[168:171]
ds_read_b128 v[56:59], v8 offset:20480
v_mfma_f32_16x16x32_bf16 v[176:179], v[40:43], a[20:23], v[176:179]
buffer_load_dwordx4 a[56:59], v1, s[4:7], s48 offen offset:3072 sc1
v_mfma_f32_16x16x32_bf16 v[172:175], v[44:47], a[16:19], v[172:175]
ds_read_b128 v[60:63], v8 offset:21504
v_mfma_f32_16x16x32_bf16 v[180:183], v[44:47], a[20:23], v[180:183]
s_waitcnt lgkmcnt(2)
v_mfma_f32_16x16x32_bf16 v[184:187], v[48:51], a[16:19], v[184:187]
ds_read_b128 v[64:67], v8 offset:22528
v_mfma_f32_16x16x32_bf16 v[192:195], v[48:51], a[20:23], v[192:195]
buffer_load_dwordx4 a[60:63], v4, s[4:7], s48 offen offset:3072 sc1
v_mfma_f32_16x16x32_bf16 v[188:191], v[52:55], a[16:19], v[188:191]
ds_read_b128 v[68:71], v8 offset:23552
v_mfma_f32_16x16x32_bf16 v[196:199], v[52:55], a[20:23], v[196:199]
s_waitcnt vmcnt(8) lgkmcnt(2)
v_mfma_f32_16x16x32_bf16 v[168:171], v[56:59], a[24:27], v[168:171]
ds_read_b128 v[40:43], v8 offset:32768
s_mul_i32 s49, s13, 14336
v_mfma_f32_16x16x32_bf16 v[176:179], v[56:59], a[28:31], v[176:179]
s_add_u32 s49, s49, 7602176
v_lshlrev_b32 v255, 2, v0
v_mfma_f32_16x16x32_bf16 v[172:175], v[60:63], a[24:27], v[172:175]
ds_read_b128 v[44:47], v8 offset:33792
v_mfma_f32_16x16x32_bf16 v[180:183], v[60:63], a[28:31], v[180:183]
buffer_store_dwordx4 v[232:235], v1, s[4:7], s58 offen offset:0 sc1
s_waitcnt lgkmcnt(2)
v_mfma_f32_16x16x32_bf16 v[184:187], v[64:67], a[24:27], v[184:187]
ds_read_b128 v[48:51], v8 offset:34816
s_add_u32 s50, s49, 0
buffer_load_dword a64, v255, s[4:7], s50 offen offset:0 sc1
buffer_load_dword a65, v255, s[4:7], s50 offen offset:896 sc1
v_mfma_f32_16x16x32_bf16 v[192:195], v[64:67], a[28:31], v[192:195]
buffer_load_dword a66, v255, s[4:7], s50 offen offset:1792 sc1
buffer_load_dword a67, v255, s[4:7], s50 offen offset:2688 sc1
v_mfma_f32_16x16x32_bf16 v[188:191], v[68:71], a[24:27], v[188:191]
ds_read_b128 v[52:55], v8 offset:35840
v_mfma_f32_16x16x32_bf16 v[196:199], v[68:71], a[28:31], v[196:199]
buffer_store_dwordx4 v[236:239], v1, s[4:7], s58 offen offset:1024 sc1
s_waitcnt vmcnt(12) lgkmcnt(2)
v_mfma_f32_16x16x32_bf16 v[168:171], v[40:43], a[32:35], v[168:171]
ds_read_b128 v[56:59], v8 offset:36864
s_add_u32 s50, s49, 3584
buffer_load_dword a68, v255, s[4:7], s50 offen offset:0 sc1
buffer_load_dword a69, v255, s[4:7], s50 offen offset:896 sc1
v_mfma_f32_16x16x32_bf16 v[176:179], v[40:43], a[36:39], v[176:179]
buffer_load_dword a70, v255, s[4:7], s50 offen offset:1792 sc1
buffer_load_dword a71, v255, s[4:7], s50 offen offset:2688 sc1
v_mfma_f32_16x16x32_bf16 v[172:175], v[44:47], a[32:35], v[172:175]
ds_read_b128 v[60:63], v8 offset:37888
s_add_u32 s50, s49, 7168
buffer_load_dword a72, v255, s[4:7], s50 offen offset:0 sc1
buffer_load_dword a73, v255, s[4:7], s50 offen offset:896 sc1
v_mfma_f32_16x16x32_bf16 v[180:183], v[44:47], a[36:39], v[180:183]
buffer_load_dword a74, v255, s[4:7], s50 offen offset:1792 sc1
buffer_load_dword a75, v255, s[4:7], s50 offen offset:2688 sc1
s_waitcnt lgkmcnt(2)
v_mfma_f32_16x16x32_bf16 v[184:187], v[48:51], a[32:35], v[184:187]
ds_read_b128 v[64:67], v8 offset:38912
s_add_u32 s50, s49, 10752
buffer_load_dword a76, v255, s[4:7], s50 offen offset:0 sc1
buffer_load_dword a77, v255, s[4:7], s50 offen offset:896 sc1
v_mfma_f32_16x16x32_bf16 v[192:195], v[48:51], a[36:39], v[192:195]
buffer_load_dword a78, v255, s[4:7], s50 offen offset:1792 sc1
buffer_load_dword a79, v255, s[4:7], s50 offen offset:2688 sc1
v_mfma_f32_16x16x32_bf16 v[188:191], v[52:55], a[32:35], v[188:191]
ds_read_b128 v[68:71], v8 offset:39936
s_add_u32 m0, s21, 131072
s_add_u32 s47, s19, 32768
v_mfma_f32_16x16x32_bf16 v[196:199], v[52:55], a[36:39], v[196:199]
buffer_load_dwordx4 v1, s[4:7], s47 offen offset:0 sc1 lds
s_waitcnt vmcnt(23) lgkmcnt(2)
v_mfma_f32_16x16x32_bf16 v[168:171], v[56:59], a[40:43], v[168:171]
ds_read_b128 v[40:43], v8 offset:49152
v_mfma_f32_16x16x32_bf16 v[176:179], v[56:59], a[44:47], v[176:179]
v_mfma_f32_16x16x32_bf16 v[172:175], v[60:63], a[40:43], v[172:175]
ds_read_b128 v[44:47], v8 offset:50176
v_mfma_f32_16x16x32_bf16 v[180:183], v[60:63], a[44:47], v[180:183]
buffer_load_dwordx4 v1, s[4:7], s47 offen offset:1024 sc1 lds
s_waitcnt lgkmcnt(2)
v_mfma_f32_16x16x32_bf16 v[184:187], v[64:67], a[40:43], v[184:187]
ds_read_b128 v[48:51], v8 offset:51200
v_mfma_f32_16x16x32_bf16 v[192:195], v[64:67], a[44:47], v[192:195]
buffer_load_dwordx4 v1, s[4:7], s47 offen offset:2048 sc1 lds
v_mfma_f32_16x16x32_bf16 v[188:191], v[68:71], a[40:43], v[188:191]
ds_read_b128 v[52:55], v8 offset:52224
v_mfma_f32_16x16x32_bf16 v[196:199], v[68:71], a[44:47], v[196:199]
s_waitcnt vmcnt(23) lgkmcnt(2)
ds_read_b128 v[56:59], v8 offset:53248
buffer_load_dwordx4 v1, s[4:7], s47 offen offset:3072 sc1 lds
ds_read_b128 v[60:63], v8 offset:54272
s_add_u32 m0, s21, 65536
s_add_u32 s47, s19, 49152
buffer_load_dwordx4 v1, s[4:7], s47 offen offset:0 sc1 lds
ds_read_b128 v[64:67], v8 offset:55296
ds_read_b128 v[68:71], v8 offset:56320
buffer_load_dwordx4 v1, s[4:7], s47 offen offset:1024 sc1 lds
buffer_load_dwordx4 v1, s[4:7], s47 offen offset:2048 sc1 lds
buffer_load_dwordx4 v1, s[4:7], s47 offen offset:3072 sc1 lds
s_waitcnt lgkmcnt(5)
v_mfma_f32_16x16x32_bf16 v[184:187], v[48:51], a[48:51], v[184:187]
v_mfma_f32_16x16x32_bf16 v[192:195], v[48:51], a[52:55], v[192:195]
s_waitcnt lgkmcnt(4)
v_mfma_f32_16x16x32_bf16 v[188:191], v[52:55], a[48:51], v[188:191]
v_mfma_f32_16x16x32_bf16 v[196:199], v[52:55], a[52:55], v[196:199]
s_waitcnt vmcnt(27) lgkmcnt(1)
v_mfma_f32_16x16x32_bf16 v[184:187], v[64:67], a[56:59], v[184:187]
s_waitcnt vmcnt(26)
v_mfma_f32_16x16x32_bf16 v[192:195], v[64:67], a[60:63], v[192:195]
s_waitcnt lgkmcnt(0)
v_mfma_f32_16x16x32_bf16 v[188:191], v[68:71], a[56:59], v[188:191]
v_mfma_f32_16x16x32_bf16 v[196:199], v[68:71], a[60:63], v[196:199]
v_mfma_f32_16x16x32_bf16 v[168:171], v[40:43], a[48:51], v[168:171]
v_mfma_f32_16x16x32_bf16 v[176:179], v[40:43], a[52:55], v[176:179]
v_mfma_f32_16x16x32_bf16 v[172:175], v[44:47], a[48:51], v[172:175]
v_mfma_f32_16x16x32_bf16 v[180:183], v[44:47], a[52:55], v[180:183]
ds_write_b128 v18, v[184:187] offset:0
v_mfma_f32_16x16x32_bf16 v[168:171], v[56:59], a[56:59], v[168:171]
s_nop 0
ds_write_b128 v18, v[188:191] offset:1024
v_mfma_f32_16x16x32_bf16 v[176:179], v[56:59], a[60:63], v[176:179]
ds_write_b128 v18, v[192:195] offset:2048
v_mfma_f32_16x16x32_bf16 v[172:175], v[60:63], a[56:59], v[172:175]
ds_write_b128 v18, v[196:199] offset:3072
v_mfma_f32_16x16x32_bf16 v[180:183], v[60:63], a[60:63], v[180:183]
s_waitcnt vmcnt(20)
s_waitcnt lgkmcnt(0)
s_barrier
ds_read_b128 v[224:227], v19 offset:0
ds_read_b128 v[228:231], v19 offset:1024
ds_read_b128 v[232:235], v19 offset:2048
ds_read_b128 v[236:239], v19 offset:3072
s_waitcnt lgkmcnt(3)
v_pk_add_f32 v[168:169], v[168:169], v[224:225]
v_pk_add_f32 v[170:171], v[170:171], v[226:227]
s_waitcnt lgkmcnt(2)
v_pk_add_f32 v[172:173], v[172:173], v[228:229]
v_pk_add_f32 v[174:175], v[174:175], v[230:231]
s_waitcnt lgkmcnt(1)
v_pk_add_f32 v[176:177], v[176:177], v[232:233]
v_pk_add_f32 v[178:179], v[178:179], v[234:235]
s_waitcnt lgkmcnt(0)
v_pk_add_f32 v[180:181], v[180:181], v[236:237]
v_pk_add_f32 v[182:183], v[182:183], v[238:239]
v_cvt_pk_bf16_f32 v124, v168, v169
v_cvt_pk_bf16_f32 v125, v170, v171
v_cvt_pk_bf16_f32 v126, v172, v173
v_cvt_pk_bf16_f32 v127, v174, v175
v_cvt_pk_bf16_f32 v128, v176, v177
v_cvt_pk_bf16_f32 v129, v178, v179
v_cvt_pk_bf16_f32 v130, v180, v181
v_cvt_pk_bf16_f32 v131, v182, v183
buffer_store_dwordx4 v[124:127], v1, s[4:7], s28 offen
buffer_store_dwordx4 v[128:131], v4, s[4:7], s28 offen
v_pk_mul_f32 v[226:227], v[168:169], v[168:169]
v_pk_add_f32 v[224:225], v[168:169], v[170:171]
v_pk_mul_f32 v[230:231], v[176:177], v[176:177]
v_pk_add_f32 v[228:229], v[176:177], v[178:179]
v_pk_fma_f32 v[226:227], v[170:171], v[170:171], v[226:227]
v_pk_fma_f32 v[230:231], v[178:179], v[178:179], v[230:231]
v_pk_fma_f32 v[226:227], v[172:173], v[172:173], v[226:227]
v_pk_add_f32 v[224:225], v[224:225], v[172:173]
v_pk_fma_f32 v[230:231], v[180:181], v[180:181], v[230:231]
v_pk_add_f32 v[228:229], v[228:229], v[180:181]
v_pk_fma_f32 v[226:227], v[174:175], v[174:175], v[226:227]
v_pk_add_f32 v[224:225], v[224:225], v[174:175]
v_pk_fma_f32 v[230:231], v[182:183], v[182:183], v[230:231]
v_pk_add_f32 v[228:229], v[228:229], v[182:183]
v_add_f32 v224, v224, v225
v_add_f32 v226, v226, v227
v_add_f32 v228, v228, v229
v_add_f32 v230, v230, v231
v_permlane32_swap_b32 v224, v226
s_nop 0
v_permlane32_swap_b32 v228, v230
v_add_f32 v224, v224, v226
v_add_f32 v228, v228, v230
s_nop 1
v_permlane16_swap_b32 v224, v228
v_add_f32 v224, v224, v228
buffer_store_dword v224, v7, s[4:7], s29 offen
s_waitcnt vmcnt(0)
buffer_store_dwordx2 v[36:37], v26, s[4:7], s38 offen offset:0
s_add_u32 m0, s21, 81920
s_add_u32 s47, s19, 65536
buffer_load_dwordx4 v1, s[4:7], s47 offen offset:0 sc1 lds
buffer_load_dwordx4 v1, s[4:7], s47 offen offset:1024 sc1 lds
buffer_load_dwordx4 v1, s[4:7], s47 offen offset:2048 sc1 lds
buffer_load_dwordx4 v1, s[4:7], s47 offen offset:3072 sc1 lds
s_cmp_lg_u32 s14, 0
s_cbranch_scc1 LF0_c5
s_lshl_b32 s51, s2, 3
s_add_u32 s51, s51, 8126464
buffer_store_dwordx2 v[36:37], v26, s[4:7], s51 offen offset:0 sc1
LF0_c5:
s_load_dwordx2 s[8:9], s[0:1], 56
v_accvgpr_read_b32 v40, a64
v_accvgpr_read_b32 v41, a65
v_accvgpr_read_b32 v42, a66
v_accvgpr_read_b32 v43, a67
v_accvgpr_read_b32 v44, a68
v_accvgpr_read_b32 v45, a69
v_accvgpr_read_b32 v46, a70
v_accvgpr_read_b32 v47, a71
v_accvgpr_read_b32 v48, a72
v_accvgpr_read_b32 v49, a73
v_accvgpr_read_b32 v50, a74
v_accvgpr_read_b32 v51, a75
v_accvgpr_read_b32 v52, a76
v_accvgpr_read_b32 v53, a77
v_accvgpr_read_b32 v54, a78
v_accvgpr_read_b32 v55, a79
v_pk_add_f32 v[40:41], v[40:41], v[48:49]
v_pk_add_f32 v[42:43], v[42:43], v[50:51]
v_pk_add_f32 v[44:45], v[44:45], v[52:53]
v_pk_add_f32 v[46:47], v[46:47], v[54:55]
v_pk_add_f32 v[40:41], v[40:41], v[44:45]
v_pk_add_f32 v[42:43], v[42:43], v[46:47]
v_pk_add_f32 v[40:41], v[40:41], v[42:43]
v_add_f32 v40, v40, v41
v_cvt_pk_bf16_f32 v33, v40, 0
v_lshlrev_b32 v41, 16, v33
v_sub_f32 v41, v40, v41
v_cvt_pk_bf16_f32 v32, v40, v41
s_waitcnt lgkmcnt(0)
s_and_b32 s9, s9, 0xffff
s_mov_b32 s10, 0x200000
s_mov_b32 s11, 0x20000
buffer_load_dwordx2 v[38:39], v16, s[4:7], s39 offen offset:0 sc1
buffer_load_dwordx2 v[252:253], v16, s[4:7], s39 offen offset:0 sc1
s_waitcnt vmcnt(1)
v_cmp_ne_u64 vcc, s[66:67], v[38:39]
s_nop 0
s_cbranch_vccnz LF0_sp7
LF0_ok6:
s_add_u32 s48, s30, 0
buffer_load_dwordx4 a[0:3], v1, s[4:7], s48 offen offset:0 sc1
buffer_load_dwordx4 a[4:7], v4, s[4:7], s48 offen offset:0 sc1
buffer_load_dwordx4 a[8:11], v1, s[4:7], s48 offen offset:1024 sc1
buffer_load_dwordx4 a[12:15], v4, s[4:7], s48 offen offset:1024 sc1
buffer_load_dwordx4 a[16:19], v1, s[4:7], s48 offen offset:2048 sc1
buffer_load_dwordx4 a[20:23], v4, s[4:7], s48 offen offset:2048 sc1
buffer_load_dwordx4 a[24:27], v1, s[4:7], s48 offen offset:3072 sc1
buffer_load_dwordx4 a[28:31], v4, s[4:7], s48 offen offset:3072 sc1
s_add_u32 s48, s30, 4096
buffer_load_dwordx4 a[32:35], v1, s[4:7], s48 offen offset:0 sc1
buffer_load_dwordx4 a[36:39], v4, s[4:7], s48 offen offset:0 sc1
s_barrier
v_lshlrev_b32 v240, 3, v0
v_add_u32 v240, 147456, v240
ds_write_b64 v240, v[32:33]
v_and_b32 v25, 15, v0
v_lshlrev_b32 v25, 3, v25
v_add_u32 v25, 147456, v25
ds_read_b128 v[40:43], v2 offset:32768
ds_read_b128 v[44:47], v2 offset:33792
ds_read_b128 v[48:51], v2 offset:34816
ds_read_b128 v[52:55], v2 offset:35840
ds_read_b128 v[56:59], v2 offset:36864
ds_read_b128 v[60:63], v2 offset:37888
s_waitcnt vmcnt(8) lgkmcnt(2)
v_mfma_f32_16x16x32_bf16 v[72:75], v[40:43], a[0:3], 0
ds_read_b128 v[64:67], v2 offset:38912
v_mfma_f32_16x16x32_bf16 v[76:79], v[40:43], a[4:7], 0
buffer_load_dwordx4 a[40:43], v1, s[4:7], s48 offen offset:1024 sc1
v_mfma_f32_16x16x32_bf16 v[80:83], v[44:47], a[0:3], 0
ds_read_b128 v[68:71], v2 offset:39936
v_mfma_f32_16x16x32_bf16 v[84:87], v[44:47], a[4:7], 0
buffer_load_dwordx4 v[224:227], v6, s[4:7], s31 offen offset:0 sc1
v_mfma_f32_16x16x32_bf16 v[88:91], v[48:51], a[0:3], 0
ds_read_b128 v[40:43], v2 offset:40960
v_mfma_f32_16x16x32_bf16 v[92:95], v[48:51], a[4:7], 0
buffer_load_dwordx4 a[44:47], v4, s[4:7], s48 offen offset:1024 sc1
v_mfma_f32_16x16x32_bf16 v[96:99], v[52:55], a[0:3], 0
ds_read_b128 v[44:47], v2 offset:41984
v_mfma_f32_16x16x32_bf16 v[100:103], v[52:55], a[4:7], 0
buffer_load_dwordx4 v[228:231], v6, s[4:7], s31 offen offset:1024 sc1
s_waitcnt vmcnt(10) lgkmcnt(2)
v_mfma_f32_16x16x32_bf16 v[72:75], v[56:59], a[8:11], v[72:75]
ds_read_b128 v[48:51], v2 offset:43008
v_mfma_f32_16x16x32_bf16 v[76:79], v[56:59], a[12:15], v[76:79]
buffer_load_dwordx4 a[48:51], v1, s[4:7], s48 offen offset:2048 sc1
v_mfma_f32_16x16x32_bf16 v[80:83], v[60:63], a[8:11], v[80:83]
ds_read_b128 v[52:55], v2 offset:44032
v_mfma_f32_16x16x32_bf16 v[84:87], v[60:63], a[12:15], v[84:87]
buffer_load_dwordx4 v[232:235], v6, s[4:7], s31 offen offset:2048 sc1
v_mfma_f32_16x16x32_bf16 v[88:91], v[64:67], a[8:11], v[88:91]
ds_read_b128 v[56:59], v2 offset:45056
v_mfma_f32_16x16x32_bf16 v[92:95], v[64:67], a[12:15], v[92:95]
buffer_load_dwordx4 a[52:55], v4, s[4:7], s48 offen offset:2048 sc1
v_mfma_f32_16x16x32_bf16 v[96:99], v[68:71], a[8:11], v[96:99]
ds_read_b128 v[60:63], v2 offset:46080
v_mfma_f32_16x16x32_bf16 v[100:103], v[68:71], a[12:15], v[100:103]
buffer_load_dwordx4 v[236:239], v6, s[4:7], s31 offen offset:3072 sc1
s_waitcnt vmcnt(12) lgkmcnt(2)
v_mfma_f32_16x16x32_bf16 v[72:75], v[40:43], a[16:19], v[72:75]
ds_read_b128 v[64:67], v2 offset:47104
v_mfma_f32_16x16x32_bf16 v[76:79], v[40:43], a[20:23], v[76:79]
buffer_load_dwordx4 a[56:59], v1, s[4:7], s48 offen offset:3072 sc1
v_mfma_f32_16x16x32_bf16 v[80:83], v[44:47], a[16:19], v[80:83]
ds_read_b128 v[68:71], v2 offset:48128
v_mfma_f32_16x16x32_bf16 v[84:87], v[44:47], a[20:23], v[84:87]
v_mfma_f32_16x16x32_bf16 v[88:91], v[48:51], a[16:19], v[88:91]
ds_read_b128 v[40:43], v2 offset:49152
v_mfma_f32_16x16x32_bf16 v[92:95], v[48:51], a[20:23], v[92:95]
buffer_load_dwordx4 a[60:63], v4, s[4:7], s48 offen offset:3072 sc1
v_mfma_f32_16x16x32_bf16 v[96:99], v[52:55], a[16:19], v[96:99]
ds_read_b128 v[44:47], v2 offset:50176
v_mfma_f32_16x16x32_bf16 v[100:103], v[52:55], a[20:23], v[100:103]
s_waitcnt vmcnt(12) lgkmcnt(2)
v_mfma_f32_16x16x32_bf16 v[72:75], v[56:59], a[24:27], v[72:75]
ds_read_b128 v[48:51], v2 offset:51200
s_add_u32 s48, s30, 8192
v_mfma_f32_16x16x32_bf16 v[76:79], v[56:59], a[28:31], v[76:79]
buffer_load_dwordx4 a[64:67], v1, s[4:7], s48 offen offset:0 sc1
v_mfma_f32_16x16x32_bf16 v[80:83], v[60:63], a[24:27], v[80:83]
ds_read_b128 v[52:55], v2 offset:52224
v_mfma_f32_16x16x32_bf16 v[84:87], v[60:63], a[28:31], v[84:87]
v_mfma_f32_16x16x32_bf16 v[88:91], v[64:67], a[24:27], v[88:91]
ds_read_b128 v[56:59], v2 offset:53248
v_mfma_f32_16x16x32_bf16 v[92:95], v[64:67], a[28:31], v[92:95]
buffer_load_dwordx4 a[68:71], v4, s[4:7], s48 offen offset:0 sc1
v_mfma_f32_16x16x32_bf16 v[96:99], v[68:71], a[24:27], v[96:99]
ds_read_b128 v[60:63], v2 offset:54272
v_mfma_f32_16x16x32_bf16 v[100:103], v[68:71], a[28:31], v[100:103]
s_waitcnt vmcnt(12) lgkmcnt(2)
v_mfma_f32_16x16x32_bf16 v[72:75], v[40:43], a[32:35], v[72:75]
ds_read_b128 v[64:67], v2 offset:55296
v_mfma_f32_16x16x32_bf16 v[76:79], v[40:43], a[36:39], v[76:79]
buffer_load_dwordx4 a[72:75], v1, s[4:7], s48 offen offset:1024 sc1
v_mfma_f32_16x16x32_bf16 v[80:83], v[44:47], a[32:35], v[80:83]
ds_read_b128 v[68:71], v2 offset:56320
v_mfma_f32_16x16x32_bf16 v[84:87], v[44:47], a[36:39], v[84:87]
v_mfma_f32_16x16x32_bf16 v[88:91], v[48:51], a[32:35], v[88:91]
ds_read_b128 v[40:43], v2 offset:57344
v_mfma_f32_16x16x32_bf16 v[92:95], v[48:51], a[36:39], v[92:95]
buffer_load_dwordx4 a[76:79], v4, s[4:7], s48 offen offset:1024 sc1
v_mfma_f32_16x16x32_bf16 v[96:99], v[52:55], a[32:35], v[96:99]
ds_read_b128 v[44:47], v2 offset:58368
v_mfma_f32_16x16x32_bf16 v[100:103], v[52:55], a[36:39], v[100:103]
s_waitcnt vmcnt(11) lgkmcnt(2)
v_mfma_f32_16x16x32_bf16 v[72:75], v[56:59], a[40:43], v[72:75]
ds_read_b128 v[48:51], v2 offset:59392
v_mfma_f32_16x16x32_bf16 v[76:79], v[56:59], a[44:47], v[76:79]
buffer_load_dwordx4 a[80:83], v1, s[4:7], s48 offen offset:2048 sc1
v_mfma_f32_16x16x32_bf16 v[80:83], v[60:63], a[40:43], v[80:83]
ds_read_b128 v[52:55], v2 offset:60416
v_mfma_f32_16x16x32_bf16 v[84:87], v[60:63], a[44:47], v[84:87]
v_mfma_f32_16x16x32_bf16 v[88:91], v[64:67], a[40:43], v[88:91]
ds_read_b128 v[56:59], v2 offset:61440
v_mfma_f32_16x16x32_bf16 v[92:95], v[64:67], a[44:47], v[92:95]
buffer_load_dwordx4 a[84:87], v4, s[4:7], s48 offen offset:2048 sc1
v_mfma_f32_16x16x32_bf16 v[96:99], v[68:71], a[40:43], v[96:99]
ds_read_b128 v[60:63], v2 offset:62464
v_lshlrev_b32 v254, 3, v0
v_mfma_f32_16x16x32_bf16 v[100:103], v[68:71], a[44:47], v[100:103]
v_add_u32 v254, 8126464, v254
s_waitcnt vmcnt(9) lgkmcnt(2)
v_mfma_f32_16x16x32_bf16 v[72:75], v[40:43], a[48:51], v[72:75]
ds_read_b128 v[64:67], v2 offset:63488
buffer_load_dwordx4 a[88:91], v1, s[4:7], s48 offen offset:3072 sc1
v_mfma_f32_16x16x32_bf16 v[76:79], v[40:43], a[52:55], v[76:79]
v_add_f32 v224, v224, v226
v_mfma_f32_16x16x32_bf16 v[80:83], v[44:47], a[48:51], v[80:83]
ds_read_b128 v[68:71], v2 offset:64512
v_add_f32 v225, v225, v227
v_mfma_f32_16x16x32_bf16 v[84:87], v[44:47], a[52:55], v[84:87]
v_add_f32 v228, v228, v230
v_mfma_f32_16x16x32_bf16 v[88:91], v[48:51], a[48:51], v[88:91]
ds_read_b128 v[40:43], v3 offset:0
buffer_load_dwordx4 a[92:95], v4, s[4:7], s48 offen offset:3072 sc1
v_mfma_f32_16x16x32_bf16 v[92:95], v[48:51], a[52:55], v[92:95]
v_add_f32 v229, v229, v231
v_mfma_f32_16x16x32_bf16 v[96:99], v[52:55], a[48:51], v[96:99]
ds_read_b128 v[44:47], v3 offset:1024
v_add_f32 v232, v232, v234
v_mfma_f32_16x16x32_bf16 v[100:103], v[52:55], a[52:55], v[100:103]
v_add_f32 v233, v233, v235
s_waitcnt vmcnt(10)
v_add_f32 v236, v236, v238
s_waitcnt vmcnt(8) lgkmcnt(2)
v_mfma_f32_16x16x32_bf16 v[72:75], v[56:59], a[56:59], v[72:75]
ds_read_b128 v[48:51], v3 offset:2048
s_add_u32 s48, s30, 12288
v_mfma_f32_16x16x32_bf16 v[76:79], v[56:59], a[60:63], v[76:79]
buffer_load_dwordx4 a[96:99], v1, s[4:7], s48 offen offset:0 sc1
v_mfma_f32_16x16x32_bf16 v[80:83], v[60:63], a[56:59], v[80:83]
ds_read_b128 v[52:55], v3 offset:3072
v_add_f32 v237, v237, v239
v_mfma_f32_16x16x32_bf16 v[84:87], v[60:63], a[60:63], v[84:87]
v_add_f32 v224, v224, v228
v_mfma_f32_16x16x32_bf16 v[88:91], v[64:67], a[56:59], v[88:91]
ds_read_b128 v[56:59], v3 offset:4096
v_mfma_f32_16x16x32_bf16 v[92:95], v[64:67], a[60:63], v[92:95]
buffer_load_dwordx4 a[100:103], v4, s[4:7], s48 offen offset:0 sc1
v_mfma_f32_16x16x32_bf16 v[96:99], v[68:71], a[56:59], v[96:99]
ds_read_b128 v[60:63], v3 offset:5120
v_add_f32 v225, v225, v229
v_mfma_f32_16x16x32_bf16 v[100:103], v[68:71], a[60:63], v[100:103]
v_add_f32 v232, v232, v236
v_add_f32 v233, v233, v237
s_waitcnt vmcnt(8) lgkmcnt(2)
v_mfma_f32_16x16x32_bf16 v[72:75], v[40:43], a[64:67], v[72:75]
ds_read_b128 v[64:67], v3 offset:6144
buffer_load_dwordx4 a[104:107], v1, s[4:7], s48 offen offset:1024 sc1
v_mfma_f32_16x16x32_bf16 v[76:79], v[40:43], a[68:71], v[76:79]
v_add_f32 v224, v224, v232
v_mfma_f32_16x16x32_bf16 v[80:83], v[44:47], a[64:67], v[80:83]
ds_read_b128 v[68:71], v3 offset:7168
v_add_f32 v225, v225, v233
v_mfma_f32_16x16x32_bf16 v[84:87], v[44:47], a[68:71], v[84:87]
v_mov_b32 v226, v224
v_mfma_f32_16x16x32_bf16 v[88:91], v[48:51], a[64:67], v[88:91]
ds_read_b128 v[40:43], v3 offset:8192
buffer_load_dwordx4 a[108:111], v4, s[4:7], s48 offen offset:1024 sc1
v_mfma_f32_16x16x32_bf16 v[92:95], v[48:51], a[68:71], v[92:95]
v_mov_b32 v227, v225
v_mfma_f32_16x16x32_bf16 v[96:99], v[52:55], a[64:67], v[96:99]
ds_read_b128 v[44:47], v3 offset:9216
v_permlane32_swap_b32 v224, v226
v_mfma_f32_16x16x32_bf16 v[100:103], v[52:55], a[68:71], v[100:103]
v_permlane32_swap_b32 v225, v227
v_add_f32 v224, v224, v226
s_waitcnt vmcnt(8) lgkmcnt(2)
v_mfma_f32_16x16x32_bf16 v[72:75], v[56:59], a[72:75], v[72:75]
ds_read_b128 v[48:51], v3 offset:10240
v_mfma_f32_16x16x32_bf16 v[76:79], v[56:59], a[76:79], v[76:79]
buffer_load_dwordx4 a[112:115], v1, s[4:7], s48 offen offset:2048 sc1
v_mfma_f32_16x16x32_bf16 v[80:83], v[60:63], a[72:75], v[80:83]
ds_read_b128 v[52:55], v3 offset:11264
v_add_f32 v225, v225, v227
v_mfma_f32_16x16x32_bf16 v[84:87], v[60:63], a[76:79], v[84:87]
v_mul_f32 v224, 0xbb000000, v224
v_mul_f32 v225, 0x3b000000, v225
v_mfma_f32_16x16x32_bf16 v[88:91], v[64:67], a[72:75], v[88:91]
ds_read_b128 v[56:59], v3 offset:12288
v_mfma_f32_16x16x32_bf16 v[92:95], v[64:67], a[76:79], v[92:95]
buffer_load_dwordx4 a[116:119], v4, s[4:7], s48 offen offset:2048 sc1
v_mfma_f32_16x16x32_bf16 v[96:99], v[68:71], a[72:75], v[96:99]
ds_read_b128 v[60:63], v3 offset:13312
v_fma_f32 v225, -v224, v224, v225
v_mfma_f32_16x16x32_bf16 v[100:103], v[68:71], a[76:79], v[100:103]
v_max_f32 v225, 0, v225
v_add_f32 v225, 0x3727c5ac, v225
s_waitcnt vmcnt(8) lgkmcnt(2)
v_mfma_f32_16x16x32_bf16 v[72:75], v[40:43], a[80:83], v[72:75]
ds_read_b128 v[64:67], v3 offset:14336
v_mfma_f32_16x16x32_bf16 v[76:79], v[40:43], a[84:87], v[76:79]
buffer_load_dwordx4 a[120:123], v1, s[4:7], s48 offen offset:3072 sc1
v_mfma_f32_16x16x32_bf16 v[80:83], v[44:47], a[80:83], v[80:83]
ds_read_b128 v[68:71], v3 offset:15360
v_rsq_f32 v226, v225
v_mfma_f32_16x16x32_bf16 v[84:87], v[44:47], a[84:87], v[84:87]
v_mul_f32 v200, 0xbfb8aa3b, v226
buffer_load_dwordx2 v[38:39], v254, s[4:7], 0 offen offset:0 sc1
v_mfma_f32_16x16x32_bf16 v[88:91], v[48:51], a[80:83], v[88:91]
ds_read_b128 v[40:43], v2 offset:0
buffer_load_dwordx4 a[124:127], v4, s[4:7], s48 offen offset:3072 sc1
v_mfma_f32_16x16x32_bf16 v[92:95], v[48:51], a[84:87], v[92:95]
v_mov_b32 v202, v225
v_mfma_f32_16x16x32_bf16 v[96:99], v[52:55], a[80:83], v[96:99]
ds_read_b128 v[44:47], v2 offset:1024
v_mov_b32 v203, v225
v_mfma_f32_16x16x32_bf16 v[100:103], v[52:55], a[84:87], v[100:103]
v_mov_b32 v201, v200
v_mov_b32 v225, v224
s_waitcnt vmcnt(9) lgkmcnt(2)
v_mfma_f32_16x16x32_bf16 v[72:75], v[56:59], a[88:91], v[72:75]
ds_read_b128 v[48:51], v2 offset:2048
v_permlane16_swap_b32 v202, v203
v_permlane16_swap_b32 v200, v201
s_add_u32 m0, s21, 0
v_mfma_f32_16x16x32_bf16 v[76:79], v[56:59], a[92:95], v[76:79]
s_add_u32 s47, s19, 81920
buffer_load_dwordx4 v1, s[4:7], s47 offen offset:0 sc1 lds
v_mfma_f32_16x16x32_bf16 v[80:83], v[60:63], a[88:91], v[80:83]
ds_read_b128 v[52:55], v2 offset:3072
v_permlane16_swap_b32 v224, v225
v_mfma_f32_16x16x32_bf16 v[84:87], v[60:63], a[92:95], v[84:87]
s_mov_b64 vcc, 0xffff
v_cndmask_b32 v224, 0, v224, vcc
v_cndmask_b32 v225, 0, v225, vcc
v_mfma_f32_16x16x32_bf16 v[88:91], v[64:67], a[88:91], v[88:91]
ds_read_b128 v[56:59], v2 offset:4096
v_cvt_pk_bf16_f32 v232, v224, v224
v_mfma_f32_16x16x32_bf16 v[92:95], v[64:67], a[92:95], v[92:95]
buffer_load_dwordx4 v1, s[4:7], s47 offen offset:1024 sc1 lds
v_mfma_f32_16x16x32_bf16 v[96:99], v[68:71], a[88:91], v[96:99]
ds_read_b128 v[60:63], v2 offset:5120
v_lshlrev_b32 v226, 16, v232
v_mfma_f32_16x16x32_bf16 v[100:103], v[68:71], a[92:95], v[100:103]
v_sub_f32 v226, v224, v226
v_cvt_pk_bf16_f32 v233, v226, 0
s_waitcnt vmcnt(9) lgkmcnt(2)
v_mfma_f32_16x16x32_bf16 v[72:75], v[40:43], a[96:99], v[72:75]
ds_read_b128 v[64:67], v2 offset:6144
v_cvt_pk_bf16_f32 v236, v225, v225
v_lshlrev_b32 v226, 16, v236
v_mfma_f32_16x16x32_bf16 v[76:79], v[40:43], a[100:103], v[76:79]
v_sub_f32 v226, v225, v226
buffer_load_dwordx4 v1, s[4:7], s47 offen offset:2048 sc1 lds
v_mfma_f32_16x16x32_bf16 v[80:83], v[44:47], a[96:99], v[80:83]
ds_read_b128 v[68:71], v2 offset:7168
v_cvt_pk_bf16_f32 v237, v226, 0
v_mfma_f32_16x16x32_bf16 v[84:87], v[44:47], a[100:103], v[84:87]
v_mov_b32 v226, 0
v_mfma_f32_16x16x32_bf16 v[88:91], v[48:51], a[96:99], v[88:91]
ds_read_b128 v[40:43], v2 offset:8192
v_mov_b32 v227, 0
v_mfma_f32_16x16x32_bf16 v[92:95], v[48:51], a[100:103], v[92:95]
v_mov_b32 v230, 0
v_mov_b32 v231, 0
v_mfma_f32_16x16x32_bf16 v[96:99], v[52:55], a[96:99], v[96:99]
ds_read_b128 v[44:47], v2 offset:9216
v_mov_b32 v234, 0
v_mov_b32 v235, 0
v_mfma_f32_16x16x32_bf16 v[100:103], v[52:55], a[100:103], v[100:103]
v_mov_b32 v238, 0
buffer_load_dwordx4 v1, s[4:7], s47 offen offset:3072 sc1 lds
s_waitcnt vmcnt(9) lgkmcnt(2)
v_mfma_f32_16x16x32_bf16 v[72:75], v[56:59], a[104:107], v[72:75]
ds_read_b128 v[48:51], v2 offset:10240
v_mov_b32 v239, 0
v_mfma_f32_16x16x32_bf16 v[76:79], v[56:59], a[108:111], v[76:79]
s_add_u32 s76, s33, 0
v_mfma_f32_16x16x32_bf16 v[80:83], v[60:63], a[104:107], v[80:83]
ds_read_b128 v[52:55], v2 offset:11264
s_add_u32 s77, s33, 7168
v_mfma_f32_16x16x32_bf16 v[84:87], v[60:63], a[108:111], v[84:87]
s_add_u32 s78, s33, 14336
s_add_u32 s79, s33, 21504
v_mfma_f32_16x16x32_bf16 v[88:91], v[64:67], a[104:107], v[88:91]
ds_read_b128 v[56:59], v2 offset:12288
s_add_u32 s80, s33, 57344
v_mfma_f32_16x16x32_bf16 v[92:95], v[64:67], a[108:111], v[92:95]
s_add_u32 s81, s33, 64512
v_mfma_f32_16x16x32_bf16 v[96:99], v[68:71], a[104:107], v[96:99]
ds_read_b128 v[60:63], v2 offset:13312
s_add_u32 s82, s33, 71680
v_mfma_f32_16x16x32_bf16 v[100:103], v[68:71], a[108:111], v[100:103]
s_add_u32 s83, s33, 78848
s_add_u32 s58, s32, 57344
s_waitcnt vmcnt(7) lgkmcnt(2)
v_mfma_f32_16x16x32_bf16 v[72:75], v[40:43], a[112:115], v[72:75]
ds_read_b128 v[64:67], v2 offset:14336
v_mfma_f32_16x16x32_bf16 v[76:79], v[40:43], a[116:119], v[76:79]
s_waitcnt vmcnt(5)
v_cmp_ne_u64 vcc, s[66:67], v[38:39]
s_nop 0
s_cbranch_vccnz LF0_sp9
LF0_ok8:
v_mfma_f32_16x16x32_bf16 v[80:83], v[44:47], a[112:115], v[80:83]
s_barrier
v_mfma_f32_16x16x32_bf16 v[84:87], v[44:47], a[116:119], v[84:87]
ds_read_b128 v[68:71], v2 offset:15360
v_mfma_f32_16x16x32_bf16 v[88:91], v[48:51], a[112:115], v[88:91]
ds_read_b128 v[40:43], v2 offset:16384
s_add_u32 m0, s21, 98304
s_add_u32 s47, s19, 98304
v_mfma_f32_16x16x32_bf16 v[92:95], v[48:51], a[116:119], v[92:95]
buffer_load_dwordx4 v1, s[4:7], s47 offen offset:0 sc1 lds
v_mfma_f32_16x16x32_bf16 v[96:99], v[52:55], a[112:115], v[96:99]
ds_read_b128 v[44:47], v2 offset:17408
v_mfma_f32_16x16x32_bf16 v[100:103], v[52:55], a[116:119], v[100:103]
s_waitcnt vmcnt(5) lgkmcnt(2)
v_mfma_f32_16x16x32_bf16 v[72:75], v[56:59], a[120:123], v[72:75]
ds_read_b128 v[48:51], v2 offset:18432
ds_read_b64 v[224:225], v25 offset:0
ds_read_b64 v[228:229], v25 offset:128
v_mfma_f32_16x16x32_bf16 v[76:79], v[56:59], a[124:127], v[76:79]
buffer_load_dwordx4 v1, s[4:7], s47 offen offset:1024 sc1 lds
v_mfma_f32_16x16x32_bf16 v[80:83], v[60:63], a[120:123], v[80:83]
ds_read_b128 v[52:55], v2 offset:19456
v_mfma_f32_16x16x32_bf16 v[84:87], v[60:63], a[124:127], v[84:87]
v_mfma_f32_16x16x32_bf16 v[88:91], v[64:67], a[120:123], v[88:91]
ds_read_b128 v[56:59], v2 offset:20480
v_mfma_f32_16x16x32_bf16 v[92:95], v[64:67], a[124:127], v[92:95]
buffer_load_dwordx4 v1, s[4:7], s47 offen offset:2048 sc1 lds
v_mfma_f32_16x16x32_bf16 v[96:99], v[68:71], a[120:123], v[96:99]
ds_read_b128 v[60:63], v2 offset:21504
v_mfma_f32_16x16x32_bf16 v[100:103], v[68:71], a[124:127], v[100:103]
buffer_load_dword v29, v26, s[4:7], s41 offen offset:0 sc1
s_waitcnt lgkmcnt(4)
v_mfma_f32_16x16x32_bf16 v[72:75], v[224:227], v[232:235], v[72:75]
v_mfma_f32_16x16x32_bf16 v[76:79], v[224:227], v[236:239], v[76:79]
s_waitcnt lgkmcnt(3)
v_mfma_f32_16x16x32_bf16 v[80:83], v[228:231], v[232:235], v[80:83]
v_mfma_f32_16x16x32_bf16 v[84:87], v[228:231], v[236:239], v[84:87]
s_waitcnt lgkmcnt(2)
v_mfma_f32_16x16x32_bf16 v[104:107], v[40:43], a[0:3], 0
ds_read_b128 v[64:67], v2 offset:22528
ds_read_b64 v[224:225], v25 offset:256
v_mfma_f32_16x16x32_bf16 v[108:111], v[40:43], a[4:7], 0
ds_read_b64 v[228:229], v25 offset:384
v_mfma_f32_16x16x32_bf16 v[112:115], v[44:47], a[0:3], 0
ds_read_b128 v[68:71], v2 offset:23552
v_mfma_f32_16x16x32_bf16 v[116:119], v[44:47], a[4:7], 0
buffer_load_dwordx4 v1, s[4:7], s47 offen offset:3072 sc1 lds
v_mfma_f32_16x16x32_bf16 v[104:107], v[48:51], a[8:11], v[104:107]
ds_read_b128 v[40:43], v2 offset:24576
v_mul_f32 v240, v200, v72
v_mul_f32 v241, v200, v73
v_mfma_f32_16x16x32_bf16 v[108:111], v[48:51], a[12:15], v[108:111]
v_mul_f32 v242, v200, v74
v_mul_f32 v243, v200, v75
v_mfma_f32_16x16x32_bf16 v[112:115], v[52:55], a[8:11], v[112:115]
ds_read_b128 v[44:47], v2 offset:25600
s_add_u32 m0, s21, 16384
s_add_u32 s47, s20, 0
v_mfma_f32_16x16x32_bf16 v[116:119], v[52:55], a[12:15], v[116:119]
buffer_load_dwordx4 v1, s[4:7], s47 offen offset:0 sc1 lds
s_waitcnt lgkmcnt(4)
v_mfma_f32_16x16x32_bf16 v[88:91], v[224:227], v[232:235], v[88:91]
v_mfma_f32_16x16x32_bf16 v[92:95], v[224:227], v[236:239], v[92:95]
s_waitcnt lgkmcnt(3)
v_mfma_f32_16x16x32_bf16 v[96:99], v[228:231], v[232:235], v[96:99]
v_mfma_f32_16x16x32_bf16 v[100:103], v[228:231], v[236:239], v[100:103]
s_waitcnt lgkmcnt(2)
v_mfma_f32_16x16x32_bf16 v[104:107], v[56:59], a[16:19], v[104:107]
ds_read_b128 v[48:51], v2 offset:26624
v_mul_f32 v244, v201, v76
v_mul_f32 v245, v201, v77
v_mfma_f32_16x16x32_bf16 v[108:111], v[56:59], a[20:23], v[108:111]
v_mul_f32 v246, v201, v78
v_mul_f32 v247, v201, v79
v_mfma_f32_16x16x32_bf16 v[112:115], v[60:63], a[16:19], v[112:115]
ds_read_b128 v[52:55], v2 offset:27648
buffer_load_dwordx4 v1, s[4:7], s47 offen offset:1024 sc1 lds
v_mfma_f32_16x16x32_bf16 v[116:119], v[60:63], a[20:23], v[116:119]
v_exp_f32 v240, v240
v_mfma_f32_16x16x32_bf16 v[104:107], v[64:67], a[24:27], v[104:107]
ds_read_b128 v[56:59], v2 offset:28672
v_mul_f32 v72, v72, v80
v_mfma_f32_16x16x32_bf16 v[108:111], v[64:67], a[28:31], v[108:111]
v_exp_f32 v241, v241
v_mul_f32 v73, v73, v81
v_mfma_f32_16x16x32_bf16 v[112:115], v[68:71], a[24:27], v[112:115]
ds_read_b128 v[60:63], v2 offset:29696
v_exp_f32 v242, v242
v_mfma_f32_16x16x32_bf16 v[116:119], v[68:71], a[28:31], v[116:119]
v_mul_f32 v74, v74, v82
v_exp_f32 v243, v243
s_waitcnt lgkmcnt(2)
v_mfma_f32_16x16x32_bf16 v[104:107], v[40:43], a[32:35], v[104:107]
ds_read_b128 v[64:67], v2 offset:30720
buffer_load_dwordx4 v1, s[4:7], s47 offen offset:2048 sc1 lds
v_mfma_f32_16x16x32_bf16 v[108:111], v[40:43], a[36:39], v[108:111]
v_mul_f32 v75, v75, v83
v_mfma_f32_16x16x32_bf16 v[112:115], v[44:47], a[32:35], v[112:115]
s_waitcnt vmcnt(8)
s_barrier
ds_read_b128 v[68:71], v2 offset:31744
v_mfma_f32_16x16x32_bf16 v[116:119], v[44:47], a[36:39], v[116:119]
v_exp_f32 v244, v244
v_mfma_f32_16x16x32_bf16 v[104:107], v[48:51], a[40:43], v[104:107]
ds_read_b128 v[40:43], v1 offset:0
buffer_load_dwordx4 v1, s[4:7], s47 offen offset:3072 sc1 lds
v_mfma_f32_16x16x32_bf16 v[108:111], v[48:51], a[44:47], v[108:111]
v_mul_f32 v76, v76, v84
v_exp_f32 v245, v245
v_mfma_f32_16x16x32_bf16 v[112:115], v[52:55], a[40:43], v[112:115]
ds_read_b128 v[44:47], v1 offset:1024
v_mul_f32 v77, v77, v85
v_mfma_f32_16x16x32_bf16 v[116:119], v[52:55], a[44:47], v[116:119]
v_exp_f32 v246, v246
s_waitcnt lgkmcnt(2)
v_mfma_f32_16x16x32_bf16 v[104:107], v[56:59], a[48:51], v[104:107]
ds_read_b128 v[48:51], v1 offset:2048
s_add_u32 m0, s21, 65536
s_add_u32 s47, s19, 114688
v_mfma_f32_16x16x32_bf16 v[108:111], v[56:59], a[52:55], v[108:111]
buffer_load_dwordx4 v1, s[4:7], s47 offen offset:0 sc1 lds
v_mfma_f32_16x16x32_bf16 v[112:115], v[60:63], a[48:51], v[112:115]
ds_read_b128 v[52:55], v1 offset:3072
buffer_load_dword v29, v26, s[4:7], s41 offen offset:512 sc1
v_mfma_f32_16x16x32_bf16 v[116:119], v[60:63], a[52:55], v[116:119]
v_mul_f32 v78, v78, v86
v_exp_f32 v247, v247
v_mfma_f32_16x16x32_bf16 v[104:107], v[64:67], a[56:59], v[104:107]
ds_read_b128 v[56:59], v1 offset:4096
v_mul_f32 v79, v79, v87
v_fma_f32 v240, v240, v202, v202
v_mfma_f32_16x16x32_bf16 v[108:111], v[64:67], a[60:63], v[108:111]
v_fma_f32 v241, v241, v202, v202
v_fma_f32 v242, v242, v202, v202
v_mfma_f32_16x16x32_bf16 v[112:115], v[68:71], a[56:59], v[112:115]
ds_read_b128 v[60:63], v1 offset:5120
buffer_load_dwordx4 v1, s[4:7], s47 offen offset:1024 sc1 lds
v_mfma_f32_16x16x32_bf16 v[116:119], v[68:71], a[60:63], v[116:119]
v_fma_f32 v243, v243, v202, v202
v_fma_f32 v244, v244, v203, v203
s_waitcnt lgkmcnt(2)
v_mfma_f32_16x16x32_bf16 v[104:107], v[40:43], a[64:67], v[104:107]
ds_read_b128 v[64:67], v1 offset:6144
v_fma_f32 v245, v245, v203, v203
v_mfma_f32_16x16x32_bf16 v[108:111], v[40:43], a[68:71], v[108:111]
v_fma_f32 v246, v246, v203, v203
v_fma_f32 v247, v247, v203, v203
v_mfma_f32_16x16x32_bf16 v[112:115], v[44:47], a[64:67], v[112:115]
ds_read_b128 v[68:71], v1 offset:7168
buffer_load_dwordx4 v1, s[4:7], s47 offen offset:2048 sc1 lds
v_mfma_f32_16x16x32_bf16 v[116:119], v[44:47], a[68:71], v[116:119]
v_rcp_f32 v240, v240
v_mfma_f32_16x16x32_bf16 v[104:107], v[48:51], a[72:75], v[104:107]
ds_read_b128 v[40:43], v1 offset:8192
v_rcp_f32 v241, v241
v_mfma_f32_16x16x32_bf16 v[108:111], v[48:51], a[76:79], v[108:111]
v_rcp_f32 v242, v242
v_mfma_f32_16x16x32_bf16 v[112:115], v[52:55], a[72:75], v[112:115]
ds_read_b128 v[44:47], v1 offset:9216
buffer_load_dwordx4 v1, s[4:7], s47 offen offset:3072 sc1 lds
v_mfma_f32_16x16x32_bf16 v[116:119], v[52:55], a[76:79], v[116:119]
v_rcp_f32 v243, v243
s_waitcnt lgkmcnt(2)
v_mfma_f32_16x16x32_bf16 v[104:107], v[56:59], a[80:83], v[104:107]
ds_read_b128 v[48:51], v1 offset:10240
v_rcp_f32 v244, v244
v_mfma_f32_16x16x32_bf16 v[108:111], v[56:59], a[84:87], v[108:111]
v_rcp_f32 v245, v245
v_mfma_f32_16x16x32_bf16 v[112:115], v[60:63], a[80:83], v[112:115]
ds_read_b128 v[52:55], v1 offset:11264
v_rcp_f32 v246, v246
v_mfma_f32_16x16x32_bf16 v[116:119], v[60:63], a[84:87], v[116:119]
v_rcp_f32 v247, v247
v_mul_f32 v72, v72, v240
v_mfma_f32_16x16x32_bf16 v[104:107], v[64:67], a[88:91], v[104:107]
ds_read_b128 v[56:59], v1 offset:12288
s_add_u32 s57, s20, 98304
v_mfma_f32_16x16x32_bf16 v[108:111], v[64:67], a[92:95], v[108:111]
buffer_load_dwordx4 a[224:227], v1, s[4:7], s57 offen offset:0 sc1
v_mul_f32 v73, v73, v241
v_mfma_f32_16x16x32_bf16 v[112:115], v[68:71], a[88:91], v[112:115]
ds_read_b128 v[60:63], v1 offset:13312
v_mul_f32 v74, v74, v242
v_mul_f32 v75, v75, v243
v_mfma_f32_16x16x32_bf16 v[116:119], v[68:71], a[92:95], v[116:119]
v_mul_f32 v76, v76, v244
v_mul_f32 v77, v77, v245
s_waitcnt lgkmcnt(2)
v_mfma_f32_16x16x32_bf16 v[104:107], v[40:43], a[96:99], v[104:107]
ds_read_b128 v[64:67], v1 offset:14336
buffer_load_dwordx4 a[228:231], v1, s[4:7], s57 offen offset:1024 sc1
v_mfma_f32_16x16x32_bf16 v[108:111], v[40:43], a[100:103], v[108:111]
v_mul_f32 v78, v78, v246
v_mul_f32 v79, v79, v247
v_mfma_f32_16x16x32_bf16 v[112:115], v[44:47], a[96:99], v[112:115]
s_waitcnt vmcnt(11)
s_barrier
ds_read_b128 v[68:71], v1 offset:15360
v_mfma_f32_16x16x32_bf16 v[116:119], v[44:47], a[100:103], v[116:119]
v_cvt_pk_bf16_f32 v248, v72, v73
v_cvt_pk_bf16_f32 v249, v74, v75
v_mfma_f32_16x16x32_bf16 v[104:107], v[48:51], a[104:107], v[104:107]
ds_read_b128 v[40:43], v2 offset:32768
s_add_u32 m0, s21, 81920
s_add_u32 s47, s19, 131072
v_mfma_f32_16x16x32_bf16 v[108:111], v[48:51], a[108:111], v[108:111]
buffer_load_dwordx4 v1, s[4:7], s47 offen offset:0 sc1 lds
v_mfma_f32_16x16x32_bf16 v[112:115], v[52:55], a[104:107], v[112:115]
ds_read_b128 v[44:47], v2 offset:33792
ds_read_b64 v[224:225], v25 offset:512
ds_read_b64 v[228:229], v25 offset:640
v_mfma_f32_16x16x32_bf16 v[116:119], v[52:55], a[108:111], v[116:119]
v_cvt_pk_bf16_f32 v252, v76, v77
v_cvt_pk_bf16_f32 v253, v78, v79
s_waitcnt lgkmcnt(4)
v_mfma_f32_16x16x32_bf16 v[104:107], v[56:59], a[112:115], v[104:107]
ds_read_b128 v[48:51], v2 offset:34816
buffer_load_dword v29, v26, s[4:7], s41 offen offset:1024 sc1
v_mfma_f32_16x16x32_bf16 v[108:111], v[56:59], a[116:119], v[108:111]
v_mul_f32 v240, v200, v88
v_mul_f32 v241, v200, v89
v_mfma_f32_16x16x32_bf16 v[112:115], v[60:63], a[112:115], v[112:115]
ds_read_b128 v[52:55], v2 offset:35840
buffer_load_dwordx4 v1, s[4:7], s47 offen offset:1024 sc1 lds
v_mfma_f32_16x16x32_bf16 v[116:119], v[60:63], a[116:119], v[116:119]
v_mul_f32 v242, v200, v90
v_mul_f32 v243, v200, v91
v_mfma_f32_16x16x32_bf16 v[104:107], v[64:67], a[120:123], v[104:107]
ds_read_b128 v[56:59], v2 offset:36864
v_mul_f32 v244, v201, v92
v_mul_f32 v245, v201, v93
v_mfma_f32_16x16x32_bf16 v[108:111], v[64:67], a[124:127], v[108:111]
v_mul_f32 v246, v201, v94
v_mul_f32 v247, v201, v95
v_mfma_f32_16x16x32_bf16 v[112:115], v[68:71], a[120:123], v[112:115]
ds_read_b128 v[60:63], v2 offset:37888
buffer_load_dwordx4 v1, s[4:7], s47 offen offset:2048 sc1 lds
v_mfma_f32_16x16x32_bf16 v[116:119], v[68:71], a[124:127], v[116:119]
v_exp_f32 v240, v240
s_waitcnt lgkmcnt(5)
v_mfma_f32_16x16x32_bf16 v[104:107], v[224:227], v[232:235], v[104:107]
v_mfma_f32_16x16x32_bf16 v[108:111], v[224:227], v[236:239], v[108:111]
s_waitcnt lgkmcnt(4)
v_mfma_f32_16x16x32_bf16 v[112:115], v[228:231], v[232:235], v[112:115]
v_mfma_f32_16x16x32_bf16 v[116:119], v[228:231], v[236:239], v[116:119]
s_waitcnt lgkmcnt(2)
v_mfma_f32_16x16x32_bf16 v[72:75], v[40:43], a[0:3], 0
ds_read_b128 v[64:67], v2 offset:38912
v_mul_f32 v88, v88, v96
v_mfma_f32_16x16x32_bf16 v[76:79], v[40:43], a[4:7], 0
v_exp_f32 v241, v241
v_mul_f32 v89, v89, v97
v_mfma_f32_16x16x32_bf16 v[80:83], v[44:47], a[0:3], 0
ds_read_b128 v[68:71], v2 offset:39936
buffer_load_dwordx4 v1, s[4:7], s47 offen offset:3072 sc1 lds
v_mfma_f32_16x16x32_bf16 v[84:87], v[44:47], a[4:7], 0
v_exp_f32 v242, v242
v_mfma_f32_16x16x32_bf16 v[72:75], v[48:51], a[8:11], v[72:75]
ds_read_b128 v[40:43], v2 offset:40960
v_mul_f32 v90, v90, v98
v_mfma_f32_16x16x32_bf16 v[76:79], v[48:51], a[12:15], v[76:79]
v_exp_f32 v243, v243
v_mul_f32 v91, v91, v99
v_mfma_f32_16x16x32_bf16 v[80:83], v[52:55], a[8:11], v[80:83]
ds_read_b128 v[44:47], v2 offset:41984
v_exp_f32 v244, v244
v_mfma_f32_16x16x32_bf16 v[84:87], v[52:55], a[12:15], v[84:87]
v_mul_f32 v92, v92, v100
v_exp_f32 v245, v245
s_waitcnt lgkmcnt(2)
v_mfma_f32_16x16x32_bf16 v[72:75], v[56:59], a[16:19], v[72:75]
ds_read_b128 v[48:51], v2 offset:43008
s_add_u32 m0, s21, 32768
s_add_u32 s47, s20, 16384
v_mfma_f32_16x16x32_bf16 v[76:79], v[56:59], a[20:23], v[76:79]
buffer_load_dwordx4 v1, s[4:7], s47 offen offset:0 sc1 lds
v_mfma_f32_16x16x32_bf16 v[80:83], v[60:63], a[16:19], v[80:83]
ds_read_b128 v[52:55], v2 offset:44032
v_mul_f32 v93, v93, v101
v_mfma_f32_16x16x32_bf16 v[84:87], v[60:63], a[20:23], v[84:87]
v_exp_f32 v246, v246
v_mfma_f32_16x16x32_bf16 v[72:75], v[64:67], a[24:27], v[72:75]
ds_read_b128 v[56:59], v2 offset:45056
buffer_load_dwordx4 v1, s[4:7], s47 offen offset:1024 sc1 lds
v_mfma_f32_16x16x32_bf16 v[76:79], v[64:67], a[28:31], v[76:79]
v_mul_f32 v94, v94, v102
v_exp_f32 v247, v247
v_mfma_f32_16x16x32_bf16 v[80:83], v[68:71], a[24:27], v[80:83]
ds_read_b128 v[60:63], v2 offset:46080
v_mul_f32 v95, v95, v103
v_mfma_f32_16x16x32_bf16 v[84:87], v[68:71], a[28:31], v[84:87]
v_fma_f32 v240, v240, v202, v202
v_fma_f32 v241, v241, v202, v202
s_waitcnt lgkmcnt(2)
v_mfma_f32_16x16x32_bf16 v[72:75], v[40:43], a[32:35], v[72:75]
ds_read_b128 v[64:67], v2 offset:47104
buffer_load_dwordx4 v1, s[4:7], s47 offen offset:2048 sc1 lds
v_mfma_f32_16x16x32_bf16 v[76:79], v[40:43], a[36:39], v[76:79]
v_fma_f32 v242, v242, v202, v202
v_fma_f32 v243, v243, v202, v202
v_mfma_f32_16x16x32_bf16 v[80:83], v[44:47], a[32:35], v[80:83]
s_waitcnt vmcnt(10)
s_barrier
ds_read_b128 v[68:71], v2 offset:48128
v_mfma_f32_16x16x32_bf16 v[84:87], v[44:47], a[36:39], v[84:87]
v_fma_f32 v244, v244, v203, v203
v_fma_f32 v245, v245, v203, v203
v_mfma_f32_16x16x32_bf16 v[72:75], v[48:51], a[40:43], v[72:75]
ds_read_b128 v[40:43], v2 offset:0
v_fma_f32 v246, v246, v203, v203
v_fma_f32 v247, v247, v203, v203
v_mfma_f32_16x16x32_bf16 v[76:79], v[48:51], a[44:47], v[76:79]
v_rcp_f32 v240, v240
v_mfma_f32_16x16x32_bf16 v[80:83], v[52:55], a[40:43], v[80:83]
ds_read_b128 v[44:47], v2 offset:1024
buffer_load_dwordx4 v1, s[4:7], s47 offen offset:3072 sc1 lds
v_mfma_f32_16x16x32_bf16 v[84:87], v[52:55], a[44:47], v[84:87]
v_rcp_f32 v241, v241
s_waitcnt lgkmcnt(2)
v_mfma_f32_16x16x32_bf16 v[72:75], v[56:59], a[48:51], v[72:75]
ds_read_b128 v[48:51], v2 offset:2048
buffer_load_dword v29, v26, s[4:7], s41 offen offset:1536 sc1
v_mfma_f32_16x16x32_bf16 v[76:79], v[56:59], a[52:55], v[76:79]
v_rcp_f32 v242, v242
v_mfma_f32_16x16x32_bf16 v[80:83], v[60:63], a[48:51], v[80:83]
ds_read_b128 v[52:55], v2 offset:3072
s_add_u32 m0, s21, 0
s_add_u32 s47, s19, 147456
v_mfma_f32_16x16x32_bf16 v[84:87], v[60:63], a[52:55], v[84:87]
buffer_load_dwordx4 v1, s[4:7], s47 offen offset:0 sc1 lds
v_mfma_f32_16x16x32_bf16 v[72:75], v[64:67], a[56:59], v[72:75]
ds_read_b128 v[56:59], v2 offset:4096
v_rcp_f32 v243, v243
v_mfma_f32_16x16x32_bf16 v[76:79], v[64:67], a[60:63], v[76:79]
v_rcp_f32 v244, v244
v_mfma_f32_16x16x32_bf16 v[80:83], v[68:71], a[56:59], v[80:83]
ds_read_b128 v[60:63], v2 offset:5120
buffer_load_dwordx4 v1, s[4:7], s47 offen offset:1024 sc1 lds
v_mfma_f32_16x16x32_bf16 v[84:87], v[68:71], a[60:63], v[84:87]
v_rcp_f32 v245, v245
s_waitcnt lgkmcnt(2)
v_mfma_f32_16x16x32_bf16 v[72:75], v[40:43], a[64:67], v[72:75]
ds_read_b128 v[64:67], v2 offset:6144
v_rcp_f32 v246, v246
v_mfma_f32_16x16x32_bf16 v[76:79], v[40:43], a[68:71], v[76:79]
v_rcp_f32 v247, v247
v_mfma_f32_16x16x32_bf16 v[80:83], v[44:47], a[64:67], v[80:83]
ds_read_b128 v[68:71], v2 offset:7168
v_mul_f32 v88, v88, v240
v_mul_f32 v89, v89, v241
v_mfma_f32_16x16x32_bf16 v[84:87], v[44:47], a[68:71], v[84:87]
v_mul_f32 v90, v90, v242
v_mul_f32 v91, v91, v243
v_mfma_f32_16x16x32_bf16 v[72:75], v[48:51], a[72:75], v[72:75]
ds_read_b128 v[40:43], v2 offset:8192
buffer_load_dwordx4 v1, s[4:7], s47 offen offset:2048 sc1 lds
v_mfma_f32_16x16x32_bf16 v[76:79], v[48:51], a[76:79], v[76:79]
v_mul_f32 v92, v92, v244
v_mul_f32 v93, v93, v245
v_mfma_f32_16x16x32_bf16 v[80:83], v[52:55], a[72:75], v[80:83]
ds_read_b128 v[44:47], v2 offset:9216
v_mul_f32 v94, v94, v246
v_mul_f32 v95, v95, v247
v_mfma_f32_16x16x32_bf16 v[84:87], v[52:55], a[76:79], v[84:87]
v_cvt_pk_bf16_f32 v250, v88, v89
v_cvt_pk_bf16_f32 v251, v90, v91
s_waitcnt lgkmcnt(2)
v_mfma_f32_16x16x32_bf16 v[72:75], v[56:59], a[80:83], v[72:75]
ds_read_b128 v[48:51], v2 offset:10240
buffer_load_dwordx4 v1, s[4:7], s47 offen offset:3072 sc1 lds
v_mfma_f32_16x16x32_bf16 v[76:79], v[56:59], a[84:87], v[76:79]
v_cvt_pk_bf16_f32 v254, v92, v93
v_cvt_pk_bf16_f32 v255, v94, v95
v_mfma_f32_16x16x32_bf16 v[80:83], v[60:63], a[80:83], v[80:83]
ds_read_b128 v[52:55], v2 offset:11264
buffer_store_dwordx4 v[248:251], v1, s[4:7], s32 offen offset:0 sc1
v_mfma_f32_16x16x32_bf16 v[84:87], v[60:63], a[84:87], v[84:87]
buffer_store_dwordx4 v[252:255], v1, s[4:7], s58 offen offset:0 sc1
v_mfma_f32_16x16x32_bf16 v[72:75], v[64:67], a[88:91], v[72:75]
ds_read_b128 v[56:59], v2 offset:12288
buffer_load_dwordx4 a[232:235], v1, s[4:7], s57 offen offset:2048 sc1
v_mfma_f32_16x16x32_bf16 v[76:79], v[64:67], a[92:95], v[76:79]
v_mul_f32 v240, v200, v104
v_mul_f32 v241, v200, v105
v_mfma_f32_16x16x32_bf16 v[80:83], v[68:71], a[88:91], v[80:83]
ds_read_b128 v[60:63], v2 offset:13312
v_mul_f32 v242, v200, v106
v_mul_f32 v243, v200, v107
v_mfma_f32_16x16x32_bf16 v[84:87], v[68:71], a[92:95], v[84:87]
v_mul_f32 v244, v201, v108
v_mul_f32 v245, v201, v109
v_mul_f32 v246, v201, v110
s_waitcnt lgkmcnt(2)
v_mfma_f32_16x16x32_bf16 v[72:75], v[40:43], a[96:99], v[72:75]
ds_read_b128 v[64:67], v2 offset:14336
v_mul_f32 v247, v201, v111
v_mfma_f32_16x16x32_bf16 v[76:79], v[40:43], a[100:103], v[76:79]
v_exp_f32 v240, v240
v_mul_f32 v104, v104, v112
v_mfma_f32_16x16x32_bf16 v[80:83], v[44:47], a[96:99], v[80:83]
s_waitcnt vmcnt(12)
s_barrier
ds_read_b128 v[68:71], v2 offset:15360
v_mfma_f32_16x16x32_bf16 v[84:87], v[44:47], a[100:103], v[84:87]
buffer_load_dwordx4 a[236:239], v1, s[4:7], s57 offen offset:3072 sc1
v_mfma_f32_16x16x32_bf16 v[72:75], v[48:51], a[104:107], v[72:75]
ds_read_b128 v[40:43], v2 offset:16384
v_exp_f32 v241, v241
v_mfma_f32_16x16x32_bf16 v[76:79], v[48:51], a[108:111], v[76:79]
v_mul_f32 v105, v105, v113
v_exp_f32 v242, v242
v_mfma_f32_16x16x32_bf16 v[80:83], v[52:55], a[104:107], v[80:83]
ds_read_b128 v[44:47], v2 offset:17408
ds_read_b64 v[224:225], v25 offset:768
ds_read_b64 v[228:229], v25 offset:896
s_add_u32 m0, s21, 98304
v_mfma_f32_16x16x32_bf16 v[84:87], v[52:55], a[108:111], v[84:87]
s_add_u32 s47, s19, 163840
buffer_load_dwordx4 v1, s[4:7], s47 offen offset:0 sc1 lds
s_waitcnt lgkmcnt(4)
v_mfma_f32_16x16x32_bf16 v[72:75], v[56:59], a[112:115], v[72:75]
ds_read_b128 v[48:51], v2 offset:18432
v_mul_f32 v106, v106, v114
v_mfma_f32_16x16x32_bf16 v[76:79], v[56:59], a[116:119], v[76:79]
v_exp_f32 v243, v243
v_mfma_f32_16x16x32_bf16 v[80:83], v[60:63], a[112:115], v[80:83]
ds_read_b128 v[52:55], v2 offset:19456
buffer_load_dwordx4 v1, s[4:7], s47 offen offset:1024 sc1 lds
v_mfma_f32_16x16x32_bf16 v[84:87], v[60:63], a[116:119], v[84:87]
v_mul_f32 v107, v107, v115
v_exp_f32 v244, v244
v_mfma_f32_16x16x32_bf16 v[72:75], v[64:67], a[120:123], v[72:75]
ds_read_b128 v[56:59], v2 offset:20480
s_getpc_b64 s[64:65]
LF0_pc18:
s_lshr_b32 s51, s2, 3
s_lshl_b32 s51, s51, 2
s_add_u32 s51, s51, s14
s_lshl_b32 s51, s51, 8
v_mfma_f32_16x16x32_bf16 v[76:79], v[64:67], a[124:127], v[76:79]
s_add_u32 s51, s51, 0
v_lshrrev_b32 v212, 2, v1
v_add_u32 v212, s51, v212
global_load_dword v29, v212, s[64:65]
v_mfma_f32_16x16x32_bf16 v[80:83], v[68:71], a[120:123], v[80:83]
ds_read_b128 v[60:63], v2 offset:21504
v_mfma_f32_16x16x32_bf16 v[84:87], v[68:71], a[124:127], v[84:87]
s_waitcnt lgkmcnt(5)
v_mfma_f32_16x16x32_bf16 v[72:75], v[224:227], v[232:235], v[72:75]
v_mfma_f32_16x16x32_bf16 v[76:79], v[224:227], v[236:239], v[76:79]
s_waitcnt lgkmcnt(4)
v_mfma_f32_16x16x32_bf16 v[80:83], v[228:231], v[232:235], v[80:83]
v_mfma_f32_16x16x32_bf16 v[84:87], v[228:231], v[236:239], v[84:87]
s_waitcnt lgkmcnt(2)
v_mfma_f32_16x16x32_bf16 v[88:91], v[40:43], a[0:3], 0
ds_read_b128 v[64:67], v2 offset:22528
buffer_load_dwordx4 v1, s[4:7], s47 offen offset:2048 sc1 lds
v_mfma_f32_16x16x32_bf16 v[92:95], v[40:43], a[4:7], 0
v_mul_f32 v108, v108, v116
v_mfma_f32_16x16x32_bf16 v[96:99], v[44:47], a[0:3], 0
ds_read_b128 v[68:71], v2 offset:23552
v_exp_f32 v245, v245
v_mfma_f32_16x16x32_bf16 v[100:103], v[44:47], a[4:7], 0
v_mul_f32 v109, v109, v117
v_exp_f32 v246, v246
v_mfma_f32_16x16x32_bf16 v[88:91], v[48:51], a[8:11], v[88:91]
ds_read_b128 v[40:43], v2 offset:24576
buffer_load_dwordx4 v1, s[4:7], s47 offen offset:3072 sc1 lds
v_mfma_f32_16x16x32_bf16 v[92:95], v[48:51], a[12:15], v[92:95]
v_mul_f32 v110, v110, v118
v_mfma_f32_16x16x32_bf16 v[96:99], v[52:55], a[8:11], v[96:99]
ds_read_b128 v[44:47], v2 offset:25600
v_exp_f32 v247, v247
v_mfma_f32_16x16x32_bf16 v[100:103], v[52:55], a[12:15], v[100:103]
v_mul_f32 v111, v111, v119
v_fma_f32 v240, v240, v202, v202
v_fma_f32 v241, v241, v202, v202
s_waitcnt lgkmcnt(2)
v_mfma_f32_16x16x32_bf16 v[88:91], v[56:59], a[16:19], v[88:91]
ds_read_b128 v[48:51], v2 offset:26624
s_add_u32 m0, s21, 49152
s_add_u32 s47, s20, 32768
v_mfma_f32_16x16x32_bf16 v[92:95], v[56:59], a[20:23], v[92:95]
buffer_load_dwordx4 v1, s[4:7], s47 offen offset:0 sc1 lds
v_mfma_f32_16x16x32_bf16 v[96:99], v[60:63], a[16:19], v[96:99]
ds_read_b128 v[52:55], v2 offset:27648
v_fma_f32 v242, v242, v202, v202
v_fma_f32 v243, v243, v202, v202
v_mfma_f32_16x16x32_bf16 v[100:103], v[60:63], a[20:23], v[100:103]
v_fma_f32 v244, v244, v203, v203
v_fma_f32 v245, v245, v203, v203
v_fma_f32 v246, v246, v203, v203
v_mfma_f32_16x16x32_bf16 v[88:91], v[64:67], a[24:27], v[88:91]
ds_read_b128 v[56:59], v2 offset:28672
v_fma_f32 v247, v247, v203, v203
v_rcp_f32 v240, v240
v_mfma_f32_16x16x32_bf16 v[92:95], v[64:67], a[28:31], v[92:95]
v_rcp_f32 v241, v241
v_mfma_f32_16x16x32_bf16 v[96:99], v[68:71], a[24:27], v[96:99]
ds_read_b128 v[60:63], v2 offset:29696
buffer_load_dwordx4 v1, s[4:7], s47 offen offset:1024 sc1 lds
v_mfma_f32_16x16x32_bf16 v[100:103], v[68:71], a[28:31], v[100:103]
v_rcp_f32 v242, v242
s_waitcnt lgkmcnt(2)
v_mfma_f32_16x16x32_bf16 v[88:91], v[40:43], a[32:35], v[88:91]
ds_read_b128 v[64:67], v2 offset:30720
v_rcp_f32 v243, v243
v_mfma_f32_16x16x32_bf16 v[92:95], v[40:43], a[36:39], v[92:95]
v_rcp_f32 v244, v244
v_mfma_f32_16x16x32_bf16 v[96:99], v[44:47], a[32:35], v[96:99]
s_waitcnt vmcnt(11)
s_barrier
ds_read_b128 v[68:71], v2 offset:31744
v_mfma_f32_16x16x32_bf16 v[100:103], v[44:47], a[36:39], v[100:103]
buffer_load_dwordx4 v1, s[4:7], s47 offen offset:2048 sc1 lds
v_mfma_f32_16x16x32_bf16 v[88:91], v[48:51], a[40:43], v[88:91]
ds_read_b128 v[40:43], v1 offset:0
v_rcp_f32 v245, v245
v_mfma_f32_16x16x32_bf16 v[92:95], v[48:51], a[44:47], v[92:95]
v_rcp_f32 v246, v246
v_mfma_f32_16x16x32_bf16 v[96:99], v[52:55], a[40:43], v[96:99]
ds_read_b128 v[44:47], v1 offset:1024
buffer_load_dwordx4 v1, s[4:7], s47 offen offset:3072 sc1 lds
v_mfma_f32_16x16x32_bf16 v[100:103], v[52:55], a[44:47], v[100:103]
v_rcp_f32 v247, v247
v_mul_f32 v104, v104, v240
s_waitcnt lgkmcnt(2)
v_mfma_f32_16x16x32_bf16 v[88:91], v[56:59], a[48:51], v[88:91]
ds_read_b128 v[48:51], v1 offset:2048
s_waitcnt vmcnt(11)
buffer_store_dwordx2 v[36:37], v26, s[4:7], s40 offen offset:0
v_mfma_f32_16x16x32_bf16 v[92:95], v[56:59], a[52:55], v[92:95]
v_mul_f32 v105, v105, v241
v_mul_f32 v106, v106, v242
v_mfma_f32_16x16x32_bf16 v[96:99], v[60:63], a[48:51], v[96:99]
ds_read_b128 v[52:55], v1 offset:3072
v_mul_f32 v107, v107, v243
v_mul_f32 v108, v108, v244
v_mfma_f32_16x16x32_bf16 v[100:103], v[60:63], a[52:55], v[100:103]
v_mul_f32 v109, v109, v245
v_mul_f32 v110, v110, v246
v_mfma_f32_16x16x32_bf16 v[88:91], v[64:67], a[56:59], v[88:91]
ds_read_b128 v[56:59], v1 offset:4096
s_add_u32 m0, s21, 65536
s_add_u32 s47, s19, 180224
v_mfma_f32_16x16x32_bf16 v[92:95], v[64:67], a[60:63], v[92:95]
buffer_load_dwordx4 v1, s[4:7], s47 offen offset:0 sc1 lds
v_mul_f32 v111, v111, v247
v_mfma_f32_16x16x32_bf16 v[96:99], v[68:71], a[56:59], v[96:99]
ds_read_b128 v[60:63], v1 offset:5120
v_cvt_pk_bf16_f32 v248, v104, v105
v_cvt_pk_bf16_f32 v249, v106, v107
v_mfma_f32_16x16x32_bf16 v[100:103], v[68:71], a[60:63], v[100:103]
v_cvt_pk_bf16_f32 v252, v108, v109
v_cvt_pk_bf16_f32 v253, v110, v111
s_waitcnt lgkmcnt(2)
v_mfma_f32_16x16x32_bf16 v[88:91], v[40:43], a[64:67], v[88:91]
ds_read_b128 v[64:67], v1 offset:6144
buffer_load_dwordx4 v1, s[4:7], s47 offen offset:1024 sc1 lds
v_mfma_f32_16x16x32_bf16 v[92:95], v[40:43], a[68:71], v[92:95]
v_mul_f32 v240, v200, v72
v_mul_f32 v241, v200, v73
v_mfma_f32_16x16x32_bf16 v[96:99], v[44:47], a[64:67], v[96:99]
ds_read_b128 v[68:71], v1 offset:7168
v_mul_f32 v242, v200, v74
v_mul_f32 v243, v200, v75
v_mfma_f32_16x16x32_bf16 v[100:103], v[44:47], a[68:71], v[100:103]
v_mul_f32 v244, v201, v76
v_mul_f32 v245, v201, v77
v_mfma_f32_16x16x32_bf16 v[88:91], v[48:51], a[72:75], v[88:91]
ds_read_b128 v[40:43], v1 offset:8192
buffer_load_dwordx4 v1, s[4:7], s47 offen offset:2048 sc1 lds
v_mfma_f32_16x16x32_bf16 v[92:95], v[48:51], a[76:79], v[92:95]
v_mul_f32 v246, v201, v78
v_mul_f32 v247, v201, v79
v_mfma_f32_16x16x32_bf16 v[96:99], v[52:55], a[72:75], v[96:99]
ds_read_b128 v[44:47], v1 offset:9216
v_exp_f32 v240, v240
v_mfma_f32_16x16x32_bf16 v[100:103], v[52:55], a[76:79], v[100:103]
v_mul_f32 v72, v72, v80
v_exp_f32 v241, v241
s_waitcnt lgkmcnt(2)
v_mfma_f32_16x16x32_bf16 v[88:91], v[56:59], a[80:83], v[88:91]
ds_read_b128 v[48:51], v1 offset:10240
v_mul_f32 v73, v73, v81
v_mfma_f32_16x16x32_bf16 v[92:95], v[56:59], a[84:87], v[92:95]
v_exp_f32 v242, v242
v_mfma_f32_16x16x32_bf16 v[96:99], v[60:63], a[80:83], v[96:99]
ds_read_b128 v[52:55], v1 offset:11264
buffer_load_dwordx4 v1, s[4:7], s47 offen offset:3072 sc1 lds
v_mfma_f32_16x16x32_bf16 v[100:103], v[60:63], a[84:87], v[100:103]
v_mul_f32 v74, v74, v82
v_exp_f32 v243, v243
v_mfma_f32_16x16x32_bf16 v[88:91], v[64:67], a[88:91], v[88:91]
ds_read_b128 v[56:59], v1 offset:12288
v_mul_f32 v75, v75, v83
v_mfma_f32_16x16x32_bf16 v[92:95], v[64:67], a[92:95], v[92:95]
v_exp_f32 v244, v244
v_mfma_f32_16x16x32_bf16 v[96:99], v[68:71], a[88:91], v[96:99]
ds_read_b128 v[60:63], v1 offset:13312
s_add_u32 s57, s20, 114688
v_mfma_f32_16x16x32_bf16 v[100:103], v[68:71], a[92:95], v[100:103]
buffer_load_dwordx4 a[240:243], v1, s[4:7], s57 offen offset:0 sc1
v_mul_f32 v76, v76, v84
s_waitcnt lgkmcnt(2)
v_mfma_f32_16x16x32_bf16 v[88:91], v[40:43], a[96:99], v[88:91]
ds_read_b128 v[64:67], v1 offset:14336
v_exp_f32 v245, v245
v_mfma_f32_16x16x32_bf16 v[92:95], v[40:43], a[100:103], v[92:95]
v_mul_f32 v77, v77, v85
v_exp_f32 v246, v246
v_mfma_f32_16x16x32_bf16 v[96:99], v[44:47], a[96:99], v[96:99]
s_waitcnt vmcnt(10)
s_barrier
ds_read_b128 v[68:71], v1 offset:15360
v_mfma_f32_16x16x32_bf16 v[100:103], v[44:47], a[100:103], v[100:103]
buffer_load_dwordx4 a[244:247], v1, s[4:7], s57 offen offset:1024 sc1
v_mfma_f32_16x16x32_bf16 v[88:91], v[48:51], a[104:107], v[88:91]
ds_read_b128 v[40:43], v2 offset:32768
v_mul_f32 v78, v78, v86
v_mfma_f32_16x16x32_bf16 v[92:95], v[48:51], a[108:111], v[92:95]
v_exp_f32 v247, v247
v_mfma_f32_16x16x32_bf16 v[96:99], v[52:55], a[104:107], v[96:99]
ds_read_b128 v[44:47], v2 offset:33792
ds_read_b64 v[224:225], v25 offset:1024
ds_read_b64 v[228:229], v25 offset:1152
v_mfma_f32_16x16x32_bf16 v[100:103], v[52:55], a[108:111], v[100:103]
v_mul_f32 v79, v79, v87
v_fma_f32 v240, v240, v202, v202
s_waitcnt lgkmcnt(4)
v_mfma_f32_16x16x32_bf16 v[88:91], v[56:59], a[112:115], v[88:91]
ds_read_b128 v[48:51], v2 offset:34816
s_add_u32 m0, s21, 81920
s_add_u32 s47, s19, 196608
v_mfma_f32_16x16x32_bf16 v[92:95], v[56:59], a[116:119], v[92:95]
buffer_load_dwordx4 v1, s[4:7], s47 offen offset:0 sc1 lds
v_fma_f32 v241, v241, v202, v202
v_mfma_f32_16x16x32_bf16 v[96:99], v[60:63], a[112:115], v[96:99]
ds_read_b128 v[52:55], v2 offset:35840
v_fma_f32 v242, v242, v202, v202
v_fma_f32 v243, v243, v202, v202
v_mfma_f32_16x16x32_bf16 v[100:103], v[60:63], a[116:119], v[100:103]
v_fma_f32 v244, v244, v203, v203
v_fma_f32 v245, v245, v203, v203
v_mfma_f32_16x16x32_bf16 v[88:91], v[64:67], a[120:123], v[88:91]
ds_read_b128 v[56:59], v2 offset:36864
buffer_load_dwordx4 v1, s[4:7], s47 offen offset:1024 sc1 lds
v_mfma_f32_16x16x32_bf16 v[92:95], v[64:67], a[124:127], v[92:95]
v_fma_f32 v246, v246, v203, v203
v_fma_f32 v247, v247, v203, v203
v_mfma_f32_16x16x32_bf16 v[96:99], v[68:71], a[120:123], v[96:99]
ds_read_b128 v[60:63], v2 offset:37888
v_rcp_f32 v240, v240
v_mfma_f32_16x16x32_bf16 v[100:103], v[68:71], a[124:127], v[100:103]
v_rcp_f32 v241, v241
s_waitcnt lgkmcnt(5)
v_mfma_f32_16x16x32_bf16 v[88:91], v[224:227], v[232:235], v[88:91]
v_mfma_f32_16x16x32_bf16 v[92:95], v[224:227], v[236:239], v[92:95]
s_waitcnt lgkmcnt(4)
v_mfma_f32_16x16x32_bf16 v[96:99], v[228:231], v[232:235], v[96:99]
v_mfma_f32_16x16x32_bf16 v[100:103], v[228:231], v[236:239], v[100:103]
s_waitcnt lgkmcnt(2)
v_mfma_f32_16x16x32_bf16 v[104:107], v[40:43], a[0:3], 0
ds_read_b128 v[64:67], v2 offset:38912
v_rcp_f32 v242, v242
v_mfma_f32_16x16x32_bf16 v[108:111], v[40:43], a[4:7], 0
v_rcp_f32 v243, v243
v_mfma_f32_16x16x32_bf16 v[112:115], v[44:47], a[0:3], 0
ds_read_b128 v[68:71], v2 offset:39936
buffer_load_dwordx4 v1, s[4:7], s47 offen offset:2048 sc1 lds
v_mfma_f32_16x16x32_bf16 v[116:119], v[44:47], a[4:7], 0
v_rcp_f32 v244, v244
v_mfma_f32_16x16x32_bf16 v[104:107], v[48:51], a[8:11], v[104:107]
ds_read_b128 v[40:43], v2 offset:40960
v_rcp_f32 v245, v245
v_mfma_f32_16x16x32_bf16 v[108:111], v[48:51], a[12:15], v[108:111]
v_rcp_f32 v246, v246
v_mfma_f32_16x16x32_bf16 v[112:115], v[52:55], a[8:11], v[112:115]
ds_read_b128 v[44:47], v2 offset:41984
buffer_load_dwordx4 v1, s[4:7], s47 offen offset:3072 sc1 lds
v_mfma_f32_16x16x32_bf16 v[116:119], v[52:55], a[12:15], v[116:119]
v_rcp_f32 v247, v247
s_waitcnt lgkmcnt(2)
v_mfma_f32_16x16x32_bf16 v[104:107], v[56:59], a[16:19], v[104:107]
ds_read_b128 v[48:51], v2 offset:43008
v_mul_f32 v72, v72, v240
v_mul_f32 v73, v73, v241
v_mfma_f32_16x16x32_bf16 v[108:111], v[56:59], a[20:23], v[108:111]
v_mul_f32 v74, v74, v242
v_mul_f32 v75, v75, v243
v_mfma_f32_16x16x32_bf16 v[112:115], v[60:63], a[16:19], v[112:115]
ds_read_b128 v[52:55], v2 offset:44032
s_add_u32 m0, s21, 114688
s_add_u32 s47, s20, 49152
v_mfma_f32_16x16x32_bf16 v[116:119], v[60:63], a[20:23], v[116:119]
buffer_load_dwordx4 v1, s[4:7], s47 offen offset:0 sc1 lds
v_mfma_f32_16x16x32_bf16 v[104:107], v[64:67], a[24:27], v[104:107]
ds_read_b128 v[56:59], v2 offset:45056
v_mul_f32 v76, v76, v244
v_mul_f32 v77, v77, v245
v_mfma_f32_16x16x32_bf16 v[108:111], v[64:67], a[28:31], v[108:111]
v_mul_f32 v78, v78, v246
v_mul_f32 v79, v79, v247
v_mfma_f32_16x16x32_bf16 v[112:115], v[68:71], a[24:27], v[112:115]
ds_read_b128 v[60:63], v2 offset:46080
v_cvt_pk_bf16_f32 v250, v72, v73
v_cvt_pk_bf16_f32 v251, v74, v75
v_mfma_f32_16x16x32_bf16 v[116:119], v[68:71], a[28:31], v[116:119]
v_cvt_pk_bf16_f32 v254, v76, v77
v_cvt_pk_bf16_f32 v255, v78, v79
s_waitcnt lgkmcnt(2)
v_mfma_f32_16x16x32_bf16 v[104:107], v[40:43], a[32:35], v[104:107]
ds_read_b128 v[64:67], v2 offset:47104
buffer_load_dwordx4 v1, s[4:7], s47 offen offset:1024 sc1 lds
v_mfma_f32_16x16x32_bf16 v[108:111], v[40:43], a[36:39], v[108:111]
buffer_store_dwordx4 v[248:251], v1, s[4:7], s32 offen offset:1024 sc1
v_mfma_f32_16x16x32_bf16 v[112:115], v[44:47], a[32:35], v[112:115]
s_waitcnt vmcnt(9)
s_barrier
ds_read_b128 v[68:71], v2 offset:48128
v_mfma_f32_16x16x32_bf16 v[116:119], v[44:47], a[36:39], v[116:119]
buffer_store_dwordx4 v[252:255], v1, s[4:7], s58 offen offset:1024 sc1
v_mfma_f32_16x16x32_bf16 v[104:107], v[48:51], a[40:43], v[104:107]
ds_read_b128 v[40:43], v2 offset:0
buffer_load_dwordx4 v1, s[4:7], s47 offen offset:2048 sc1 lds
v_mfma_f32_16x16x32_bf16 v[108:111], v[48:51], a[44:47], v[108:111]
v_mul_f32 v240, v200, v88
v_mul_f32 v241, v200, v89
v_mfma_f32_16x16x32_bf16 v[112:115], v[52:55], a[40:43], v[112:115]
ds_read_b128 v[44:47], v2 offset:1024
v_mul_f32 v242, v200, v90
v_mul_f32 v243, v200, v91
v_mfma_f32_16x16x32_bf16 v[116:119], v[52:55], a[44:47], v[116:119]
v_mul_f32 v244, v201, v92
v_mul_f32 v245, v201, v93
s_waitcnt lgkmcnt(2)
v_mfma_f32_16x16x32_bf16 v[104:107], v[56:59], a[48:51], v[104:107]
ds_read_b128 v[48:51], v2 offset:2048
buffer_load_dwordx4 v1, s[4:7], s47 offen offset:3072 sc1 lds
v_mfma_f32_16x16x32_bf16 v[108:111], v[56:59], a[52:55], v[108:111]
v_mul_f32 v246, v201, v94
v_mul_f32 v247, v201, v95
v_mfma_f32_16x16x32_bf16 v[112:115], v[60:63], a[48:51], v[112:115]
ds_read_b128 v[52:55], v2 offset:3072
v_exp_f32 v240, v240
v_mfma_f32_16x16x32_bf16 v[116:119], v[60:63], a[52:55], v[116:119]
v_mul_f32 v88, v88, v96
v_mfma_f32_16x16x32_bf16 v[104:107], v[64:67], a[56:59], v[104:107]
ds_read_b128 v[56:59], v2 offset:4096
v_exp_f32 v241, v241
v_mfma_f32_16x16x32_bf16 v[108:111], v[64:67], a[60:63], v[108:111]
v_mul_f32 v89, v89, v97
v_exp_f32 v242, v242
v_mfma_f32_16x16x32_bf16 v[112:115], v[68:71], a[56:59], v[112:115]
ds_read_b128 v[60:63], v2 offset:5120
s_add_u32 m0, s21, 0
s_add_u32 s47, s19, 212992
v_mfma_f32_16x16x32_bf16 v[116:119], v[68:71], a[60:63], v[116:119]
buffer_load_dwordx4 v1, s[4:7], s47 offen offset:0 sc1 lds
s_waitcnt lgkmcnt(2)
v_mfma_f32_16x16x32_bf16 v[104:107], v[40:43], a[64:67], v[104:107]
ds_read_b128 v[64:67], v2 offset:6144
v_mul_f32 v90, v90, v98
v_mfma_f32_16x16x32_bf16 v[108:111], v[40:43], a[68:71], v[108:111]
v_exp_f32 v243, v243
v_mfma_f32_16x16x32_bf16 v[112:115], v[44:47], a[64:67], v[112:115]
ds_read_b128 v[68:71], v2 offset:7168
buffer_load_dwordx4 v1, s[4:7], s47 offen offset:1024 sc1 lds
v_mfma_f32_16x16x32_bf16 v[116:119], v[44:47], a[68:71], v[116:119]
v_mul_f32 v91, v91, v99
v_exp_f32 v244, v244
v_mfma_f32_16x16x32_bf16 v[104:107], v[48:51], a[72:75], v[104:107]
ds_read_b128 v[40:43], v2 offset:8192
v_mul_f32 v92, v92, v100
v_mfma_f32_16x16x32_bf16 v[108:111], v[48:51], a[76:79], v[108:111]
v_exp_f32 v245, v245
v_mfma_f32_16x16x32_bf16 v[112:115], v[52:55], a[72:75], v[112:115]
ds_read_b128 v[44:47], v2 offset:9216
buffer_load_dwordx4 v1, s[4:7], s47 offen offset:2048 sc1 lds
v_mfma_f32_16x16x32_bf16 v[116:119], v[52:55], a[76:79], v[116:119]
v_mul_f32 v93, v93, v101
s_waitcnt lgkmcnt(2)
v_mfma_f32_16x16x32_bf16 v[104:107], v[56:59], a[80:83], v[104:107]
ds_read_b128 v[48:51], v2 offset:10240
v_exp_f32 v246, v246
v_mfma_f32_16x16x32_bf16 v[108:111], v[56:59], a[84:87], v[108:111]
v_mul_f32 v94, v94, v102
v_exp_f32 v247, v247
v_mfma_f32_16x16x32_bf16 v[112:115], v[60:63], a[80:83], v[112:115]
ds_read_b128 v[52:55], v2 offset:11264
v_mul_f32 v95, v95, v103
v_fma_f32 v240, v240, v202, v202
v_mfma_f32_16x16x32_bf16 v[116:119], v[60:63], a[84:87], v[116:119]
v_fma_f32 v241, v241, v202, v202
v_fma_f32 v242, v242, v202, v202
v_mfma_f32_16x16x32_bf16 v[104:107], v[64:67], a[88:91], v[104:107]
ds_read_b128 v[56:59], v2 offset:12288
buffer_load_dwordx4 v1, s[4:7], s47 offen offset:3072 sc1 lds
v_mfma_f32_16x16x32_bf16 v[108:111], v[64:67], a[92:95], v[108:111]
v_fma_f32 v243, v243, v202, v202
v_fma_f32 v244, v244, v203, v203
v_mfma_f32_16x16x32_bf16 v[112:115], v[68:71], a[88:91], v[112:115]
ds_read_b128 v[60:63], v2 offset:13312
v_fma_f32 v245, v245, v203, v203
v_mfma_f32_16x16x32_bf16 v[116:119], v[68:71], a[92:95], v[116:119]
v_fma_f32 v246, v246, v203, v203
v_fma_f32 v247, v247, v203, v203
s_waitcnt lgkmcnt(2)
v_mfma_f32_16x16x32_bf16 v[104:107], v[40:43], a[96:99], v[104:107]
ds_read_b128 v[64:67], v2 offset:14336
buffer_load_dwordx4 a[248:251], v1, s[4:7], s57 offen offset:2048 sc1
v_mfma_f32_16x16x32_bf16 v[108:111], v[40:43], a[100:103], v[108:111]
v_rcp_f32 v240, v240
v_mfma_f32_16x16x32_bf16 v[112:115], v[44:47], a[96:99], v[112:115]
s_waitcnt vmcnt(11)
s_barrier
ds_read_b128 v[68:71], v2 offset:15360
v_mfma_f32_16x16x32_bf16 v[116:119], v[44:47], a[100:103], v[116:119]
v_rcp_f32 v241, v241
v_mfma_f32_16x16x32_bf16 v[104:107], v[48:51], a[104:107], v[104:107]
ds_read_b128 v[40:43], v2 offset:16384
buffer_load_dwordx4 a[252:255], v1, s[4:7], s57 offen offset:3072 sc1
v_mfma_f32_16x16x32_bf16 v[108:111], v[48:51], a[108:111], v[108:111]
v_rcp_f32 v242, v242
v_mfma_f32_16x16x32_bf16 v[112:115], v[52:55], a[104:107], v[112:115]
ds_read_b128 v[44:47], v2 offset:17408
ds_read_b64 v[224:225], v25 offset:1280
ds_read_b64 v[228:229], v25 offset:1408
v_mfma_f32_16x16x32_bf16 v[116:119], v[52:55], a[108:111], v[116:119]
v_rcp_f32 v243, v243
s_waitcnt lgkmcnt(4)
v_mfma_f32_16x16x32_bf16 v[104:107], v[56:59], a[112:115], v[104:107]
ds_read_b128 v[48:51], v2 offset:18432
v_rcp_f32 v244, v244
v_mfma_f32_16x16x32_bf16 v[108:111], v[56:59], a[116:119], v[108:111]
v_rcp_f32 v245, v245
v_mfma_f32_16x16x32_bf16 v[112:115], v[60:63], a[112:115], v[112:115]
ds_read_b128 v[52:55], v2 offset:19456
s_add_u32 m0, s21, 131072
s_add_u32 s47, s20, 65536
v_mfma_f32_16x16x32_bf16 v[116:119], v[60:63], a[116:119], v[116:119]
buffer_load_dwordx4 v1, s[4:7], s47 offen offset:0 sc1 lds
v_mfma_f32_16x16x32_bf16 v[104:107], v[64:67], a[120:123], v[104:107]
ds_read_b128 v[56:59], v2 offset:20480
v_rcp_f32 v246, v246
v_mfma_f32_16x16x32_bf16 v[108:111], v[64:67], a[124:127], v[108:111]
v_rcp_f32 v247, v247
v_mfma_f32_16x16x32_bf16 v[112:115], v[68:71], a[120:123], v[112:115]
ds_read_b128 v[60:63], v2 offset:21504
buffer_load_dwordx4 v1, s[4:7], s47 offen offset:1024 sc1 lds
v_mfma_f32_16x16x32_bf16 v[116:119], v[68:71], a[124:127], v[116:119]
v_mul_f32 v88, v88, v240
s_waitcnt lgkmcnt(5)
v_mfma_f32_16x16x32_bf16 v[104:107], v[224:227], v[232:235], v[104:107]
v_mfma_f32_16x16x32_bf16 v[108:111], v[224:227], v[236:239], v[108:111]
s_waitcnt lgkmcnt(4)
v_mfma_f32_16x16x32_bf16 v[112:115], v[228:231], v[232:235], v[112:115]
v_mfma_f32_16x16x32_bf16 v[116:119], v[228:231], v[236:239], v[116:119]
s_waitcnt lgkmcnt(2)
v_mfma_f32_16x16x32_bf16 v[72:75], v[40:43], a[0:3], 0
ds_read_b128 v[64:67], v2 offset:22528
s_waitcnt vmcnt(10)
v_mfma_f32_16x16x32_bf16 v[76:79], v[40:43], a[4:7], 0
buffer_store_dwordx2 v[36:37], v26, s[4:7], s40 offen offset:512
v_mul_f32 v89, v89, v241
v_mfma_f32_16x16x32_bf16 v[80:83], v[44:47], a[0:3], 0
ds_read_b128 v[68:71], v2 offset:23552
buffer_load_dwordx4 v1, s[4:7], s47 offen offset:2048 sc1 lds
v_mfma_f32_16x16x32_bf16 v[84:87], v[44:47], a[4:7], 0
v_mul_f32 v90, v90, v242
v_mul_f32 v91, v91, v243
v_mfma_f32_16x16x32_bf16 v[72:75], v[48:51], a[8:11], v[72:75]
ds_read_b128 v[40:43], v2 offset:24576
v_mul_f32 v92, v92, v244
v_mul_f32 v93, v93, v245
v_mfma_f32_16x16x32_bf16 v[76:79], v[48:51], a[12:15], v[76:79]
v_mul_f32 v94, v94, v246
v_mul_f32 v95, v95, v247
v_mfma_f32_16x16x32_bf16 v[80:83], v[52:55], a[8:11], v[80:83]
ds_read_b128 v[44:47], v2 offset:25600
v_cvt_pk_bf16_f32 v248, v88, v89
v_cvt_pk_bf16_f32 v249, v90, v91
v_mfma_f32_16x16x32_bf16 v[84:87], v[52:55], a[12:15], v[84:87]
v_cvt_pk_bf16_f32 v252, v92, v93
v_cvt_pk_bf16_f32 v253, v94, v95
s_waitcnt lgkmcnt(2)
v_mfma_f32_16x16x32_bf16 v[72:75], v[56:59], a[16:19], v[72:75]
ds_read_b128 v[48:51], v2 offset:26624
buffer_load_dwordx2 v[38:39], v17, s[4:7], s41 offen offset:0 sc1
v_mfma_f32_16x16x32_bf16 v[76:79], v[56:59], a[20:23], v[76:79]
buffer_load_dwordx4 v1, s[4:7], s47 offen offset:3072 sc1 lds
v_mul_f32 v240, v200, v104
v_mfma_f32_16x16x32_bf16 v[80:83], v[60:63], a[16:19], v[80:83]
ds_read_b128 v[52:55], v2 offset:27648
v_mul_f32 v241, v200, v105
v_mul_f32 v242, v200, v106
v_mfma_f32_16x16x32_bf16 v[84:87], v[60:63], a[20:23], v[84:87]
v_mul_f32 v243, v200, v107
v_mul_f32 v244, v201, v108
v_mul_f32 v245, v201, v109
v_mfma_f32_16x16x32_bf16 v[72:75], v[64:67], a[24:27], v[72:75]
ds_read_b128 v[56:59], v2 offset:28672
s_add_u32 m0, s21, 98304
s_add_u32 s47, s20, 81920
v_mfma_f32_16x16x32_bf16 v[76:79], v[64:67], a[28:31], v[76:79]
buffer_load_dwordx4 v1, s[4:7], s47 offen offset:0 sc1 lds
v_mul_f32 v246, v201, v110
v_mul_f32 v247, v201, v111
v_mfma_f32_16x16x32_bf16 v[80:83], v[68:71], a[24:27], v[80:83]
ds_read_b128 v[60:63], v2 offset:29696
v_exp_f32 v240, v240
v_mfma_f32_16x16x32_bf16 v[84:87], v[68:71], a[28:31], v[84:87]
v_mul_f32 v104, v104, v112
v_exp_f32 v241, v241
s_waitcnt lgkmcnt(2)
v_mfma_f32_16x16x32_bf16 v[72:75], v[40:43], a[32:35], v[72:75]
ds_read_b128 v[64:67], v2 offset:30720
buffer_load_dwordx4 v1, s[4:7], s47 offen offset:1024 sc1 lds
v_mfma_f32_16x16x32_bf16 v[76:79], v[40:43], a[36:39], v[76:79]
v_mul_f32 v105, v105, v113
v_exp_f32 v242, v242
v_mfma_f32_16x16x32_bf16 v[80:83], v[44:47], a[32:35], v[80:83]
s_waitcnt vmcnt(10)
s_barrier
ds_read_b128 v[68:71], v2 offset:31744
v_mfma_f32_16x16x32_bf16 v[84:87], v[44:47], a[36:39], v[84:87]
v_mul_f32 v106, v106, v114
v_exp_f32 v243, v243
v_mfma_f32_16x16x32_bf16 v[72:75], v[48:51], a[40:43], v[72:75]
ds_read_b128 v[40:43], v1 offset:0
v_mul_f32 v107, v107, v115
v_exp_f32 v244, v244
v_mfma_f32_16x16x32_bf16 v[76:79], v[48:51], a[44:47], v[76:79]
v_mul_f32 v108, v108, v116
v_exp_f32 v245, v245
v_mfma_f32_16x16x32_bf16 v[80:83], v[52:55], a[40:43], v[80:83]
ds_read_b128 v[44:47], v1 offset:1024
buffer_load_dwordx4 v1, s[4:7], s47 offen offset:2048 sc1 lds
v_mfma_f32_16x16x32_bf16 v[84:87], v[52:55], a[44:47], v[84:87]
v_mul_f32 v109, v109, v117
v_exp_f32 v246, v246
s_waitcnt lgkmcnt(2)
v_mfma_f32_16x16x32_bf16 v[72:75], v[56:59], a[48:51], v[72:75]
ds_read_b128 v[48:51], v1 offset:2048
v_mul_f32 v110, v110, v118
v_exp_f32 v247, v247
v_mfma_f32_16x16x32_bf16 v[76:79], v[56:59], a[52:55], v[76:79]
v_mul_f32 v111, v111, v119
v_fma_f32 v240, v240, v202, v202
v_mfma_f32_16x16x32_bf16 v[80:83], v[60:63], a[48:51], v[80:83]
ds_read_b128 v[52:55], v1 offset:3072
buffer_load_dwordx4 v1, s[4:7], s47 offen offset:3072 sc1 lds
v_mfma_f32_16x16x32_bf16 v[84:87], v[60:63], a[52:55], v[84:87]
v_fma_f32 v241, v241, v202, v202
v_fma_f32 v242, v242, v202, v202
v_fma_f32 v243, v243, v202, v202
v_mfma_f32_16x16x32_bf16 v[72:75], v[64:67], a[56:59], v[72:75]
ds_read_b128 v[56:59], v1 offset:4096
v_fma_f32 v244, v244, v203, v203
v_fma_f32 v245, v245, v203, v203
v_fma_f32 v246, v246, v203, v203
v_mfma_f32_16x16x32_bf16 v[76:79], v[64:67], a[60:63], v[76:79]
v_fma_f32 v247, v247, v203, v203
v_rcp_f32 v240, v240
v_mfma_f32_16x16x32_bf16 v[80:83], v[68:71], a[56:59], v[80:83]
ds_read_b128 v[60:63], v1 offset:5120
s_waitcnt vmcnt(5)
v_cmp_ne_u64 vcc, s[66:67], v[38:39]
s_nop 0
s_cbranch_vccnz LF0_sp11
LF0_ok10:
v_mfma_f32_16x16x32_bf16 v[84:87], v[68:71], a[60:63], v[84:87]
v_rcp_f32 v241, v241
s_waitcnt lgkmcnt(2)
v_mfma_f32_16x16x32_bf16 v[72:75], v[40:43], a[64:67], v[72:75]
ds_read_b128 v[64:67], v1 offset:6144
buffer_load_dwordx4 a[0:3], v1, s[4:7], s76 offen offset:0 sc1
v_mfma_f32_16x16x32_bf16 v[76:79], v[40:43], a[68:71], v[76:79]
v_rcp_f32 v242, v242
v_rcp_f32 v243, v243
v_mfma_f32_16x16x32_bf16 v[80:83], v[44:47], a[64:67], v[80:83]
ds_read_b128 v[68:71], v1 offset:7168
v_mfma_f32_16x16x32_bf16 v[84:87], v[44:47], a[68:71], v[84:87]
ds_write_b128 v12, a[224:227] offset:0
v_mfma_f32_16x16x32_bf16 v[72:75], v[48:51], a[72:75], v[72:75]
ds_read_b128 v[40:43], v1 offset:8192
buffer_load_dwordx4 a[4:7], v1, s[4:7], s80 offen offset:0 sc1
v_mfma_f32_16x16x32_bf16 v[76:79], v[48:51], a[76:79], v[76:79]
v_rcp_f32 v244, v244
v_mfma_f32_16x16x32_bf16 v[80:83], v[52:55], a[72:75], v[80:83]
ds_read_b128 v[44:47], v1 offset:9216
v_mfma_f32_16x16x32_bf16 v[84:87], v[52:55], a[76:79], v[84:87]
ds_write_b128 v12, a[228:231] offset:1024
s_waitcnt lgkmcnt(4)
v_mfma_f32_16x16x32_bf16 v[72:75], v[56:59], a[80:83], v[72:75]
ds_read_b128 v[48:51], v1 offset:10240
buffer_load_dwordx4 a[8:11], v5, s[4:7], s76 offen offset:0 sc1
v_mfma_f32_16x16x32_bf16 v[76:79], v[56:59], a[84:87], v[76:79]
v_rcp_f32 v245, v245
v_rcp_f32 v246, v246
v_mfma_f32_16x16x32_bf16 v[80:83], v[60:63], a[80:83], v[80:83]
ds_read_b128 v[52:55], v1 offset:11264
v_mfma_f32_16x16x32_bf16 v[84:87], v[60:63], a[84:87], v[84:87]
ds_write_b128 v12, a[232:235] offset:2048
v_mfma_f32_16x16x32_bf16 v[72:75], v[64:67], a[88:91], v[72:75]
ds_read_b128 v[56:59], v1 offset:12288
buffer_load_dwordx4 a[12:15], v5, s[4:7], s80 offen offset:0 sc1
v_mfma_f32_16x16x32_bf16 v[76:79], v[64:67], a[92:95], v[76:79]
v_rcp_f32 v247, v247
v_mul_f32 v104, v104, v240
v_mul_f32 v105, v105, v241
v_mfma_f32_16x16x32_bf16 v[80:83], v[68:71], a[88:91], v[80:83]
ds_read_b128 v[60:63], v1 offset:13312
v_mfma_f32_16x16x32_bf16 v[84:87], v[68:71], a[92:95], v[84:87]
ds_write_b128 v12, a[236:239] offset:3072
s_waitcnt lgkmcnt(4)
v_mfma_f32_16x16x32_bf16 v[72:75], v[40:43], a[96:99], v[72:75]
ds_read_b128 v[64:67], v1 offset:14336
buffer_load_dwordx4 a[16:19], v1, s[4:7], s77 offen offset:0 sc1
v_mfma_f32_16x16x32_bf16 v[76:79], v[40:43], a[100:103], v[76:79]
v_mul_f32 v106, v106, v242
v_mul_f32 v107, v107, v243
v_mul_f32 v108, v108, v244
v_mfma_f32_16x16x32_bf16 v[80:83], v[44:47], a[96:99], v[80:83]
s_barrier
ds_read_b128 v[68:71], v1 offset:15360
v_mfma_f32_16x16x32_bf16 v[84:87], v[44:47], a[100:103], v[84:87]
v_mul_f32 v109, v109, v245
v_mul_f32 v110, v110, v246
v_mul_f32 v111, v111, v247
v_mfma_f32_16x16x32_bf16 v[72:75], v[48:51], a[104:107], v[72:75]
ds_read_b128 v[40:43], v8 offset:16384
buffer_load_dwordx4 a[20:23], v1, s[4:7], s81 offen offset:0 sc1
v_mfma_f32_16x16x32_bf16 v[76:79], v[48:51], a[108:111], v[76:79]
v_cvt_pk_bf16_f32 v250, v104, v105
v_cvt_pk_bf16_f32 v251, v106, v107
v_cvt_pk_bf16_f32 v254, v108, v109
v_mfma_f32_16x16x32_bf16 v[80:83], v[52:55], a[104:107], v[80:83]
ds_read_b128 v[44:47], v8 offset:17408
ds_read_b64 v[224:225], v25 offset:1536
ds_read_b64 v[228:229], v25 offset:1664
v_mfma_f32_16x16x32_bf16 v[84:87], v[52:55], a[108:111], v[84:87]
ds_write_b128 v12, a[240:243] offset:16384
s_waitcnt lgkmcnt(5)
v_mfma_f32_16x16x32_bf16 v[72:75], v[56:59], a[112:115], v[72:75]
ds_read_b128 v[48:51], v8 offset:18432
buffer_load_dwordx4 a[24:27], v5, s[4:7], s77 offen offset:0 sc1
v_mfma_f32_16x16x32_bf16 v[76:79], v[56:59], a[116:119], v[76:79]
v_cvt_pk_bf16_f32 v255, v110, v111
v_mfma_f32_16x16x32_bf16 v[80:83], v[60:63], a[112:115], v[80:83]
ds_read_b128 v[52:55], v8 offset:19456
v_mfma_f32_16x16x32_bf16 v[84:87], v[60:63], a[116:119], v[84:87]
ds_write_b128 v12, a[244:247] offset:17408
v_mfma_f32_16x16x32_bf16 v[72:75], v[64:67], a[120:123], v[72:75]
ds_read_b128 v[56:59], v8 offset:20480
buffer_load_dwordx4 a[28:31], v5, s[4:7], s81 offen offset:0 sc1
v_mfma_f32_16x16x32_bf16 v[76:79], v[64:67], a[124:127], v[76:79]
buffer_store_dwordx4 v[248:251], v1, s[4:7], s32 offen offset:2048 sc1
buffer_store_dwordx4 v[252:255], v1, s[4:7], s58 offen offset:2048 sc1
v_mfma_f32_16x16x32_bf16 v[80:83], v[68:71], a[120:123], v[80:83]
ds_read_b128 v[60:63], v8 offset:21504
v_mfma_f32_16x16x32_bf16 v[84:87], v[68:71], a[124:127], v[84:87]
s_waitcnt lgkmcnt(7)
v_mfma_f32_16x16x32_bf16 v[72:75], v[224:227], v[232:235], v[72:75]
v_mfma_f32_16x16x32_bf16 v[76:79], v[224:227], v[236:239], v[76:79]
s_waitcnt lgkmcnt(6)
v_mfma_f32_16x16x32_bf16 v[80:83], v[228:231], v[232:235], v[80:83]
v_mfma_f32_16x16x32_bf16 v[84:87], v[228:231], v[236:239], v[84:87]
s_waitcnt vmcnt(8) lgkmcnt(3)
v_mfma_f32_16x16x32_bf16 v[168:171], v[40:43], a[0:3], v[168:171]
ds_read_b128 v[64:67], v8 offset:22528
v_mfma_f32_16x16x32_bf16 v[176:179], v[40:43], a[4:7], v[176:179]
buffer_load_dwordx4 a[32:35], v1, s[4:7], s78 offen offset:0 sc1
v_mfma_f32_16x16x32_bf16 v[172:175], v[44:47], a[0:3], v[172:175]
ds_read_b128 v[68:71], v8 offset:23552
ds_write_b128 v12, a[248:251] offset:18432
v_mfma_f32_16x16x32_bf16 v[180:183], v[44:47], a[4:7], v[180:183]
v_mul_f32 v240, v200, v72
v_mfma_f32_16x16x32_bf16 v[184:187], v[48:51], a[0:3], 0
ds_read_b128 v[40:43], v8 offset:32768
buffer_load_dwordx4 a[36:39], v1, s[4:7], s82 offen offset:0 sc1
v_mul_f32 v241, v200, v73
v_mfma_f32_16x16x32_bf16 v[192:195], v[48:51], a[4:7], 0
v_mul_f32 v242, v200, v74
v_mul_f32 v243, v200, v75
v_mul_f32 v244, v201, v76
v_mfma_f32_16x16x32_bf16 v[188:191], v[52:55], a[0:3], 0
ds_read_b128 v[44:47], v8 offset:33792
v_mul_f32 v245, v201, v77
v_mul_f32 v246, v201, v78
v_mul_f32 v247, v201, v79
v_mfma_f32_16x16x32_bf16 v[196:199], v[52:55], a[4:7], 0
v_exp_f32 v240, v240
v_mul_f32 v72, v72, v80
s_waitcnt vmcnt(8) lgkmcnt(3)
v_mfma_f32_16x16x32_bf16 v[168:171], v[56:59], a[8:11], v[168:171]
ds_read_b128 v[48:51], v8 offset:34816
buffer_load_dwordx4 a[40:43], v5, s[4:7], s78 offen offset:0 sc1
v_mfma_f32_16x16x32_bf16 v[176:179], v[56:59], a[12:15], v[176:179]
buffer_load_dwordx2 v[38:39], v17, s[4:7], s41 offen offset:512 sc1
v_exp_f32 v241, v241
v_mfma_f32_16x16x32_bf16 v[172:175], v[60:63], a[8:11], v[172:175]
ds_read_b128 v[52:55], v8 offset:35840
ds_write_b128 v12, a[252:255] offset:19456
v_mfma_f32_16x16x32_bf16 v[180:183], v[60:63], a[12:15], v[180:183]
v_mul_f32 v73, v73, v81
v_mfma_f32_16x16x32_bf16 v[184:187], v[64:67], a[8:11], v[184:187]
ds_read_b128 v[56:59], v8 offset:36864
buffer_load_dwordx4 a[44:47], v5, s[4:7], s82 offen offset:0 sc1
v_mfma_f32_16x16x32_bf16 v[192:195], v[64:67], a[12:15], v[192:195]
v_exp_f32 v242, v242
v_mul_f32 v74, v74, v82
v_mfma_f32_16x16x32_bf16 v[188:191], v[68:71], a[8:11], v[188:191]
ds_read_b128 v[60:63], v8 offset:37888
v_exp_f32 v243, v243
v_mul_f32 v75, v75, v83
v_mfma_f32_16x16x32_bf16 v[196:199], v[68:71], a[12:15], v[196:199]
v_exp_f32 v244, v244
v_mul_f32 v76, v76, v84
s_waitcnt vmcnt(9) lgkmcnt(3)
v_mfma_f32_16x16x32_bf16 v[168:171], v[40:43], a[16:19], v[168:171]
ds_read_b128 v[64:67], v8 offset:38912
buffer_load_dwordx4 a[48:51], v1, s[4:7], s79 offen offset:0 sc1
v_exp_f32 v245, v245
v_mfma_f32_16x16x32_bf16 v[176:179], v[40:43], a[20:23], v[176:179]
v_mul_f32 v77, v77, v85
v_exp_f32 v246, v246
v_mfma_f32_16x16x32_bf16 v[172:175], v[44:47], a[16:19], v[172:175]
s_barrier
ds_read_b128 v[68:71], v8 offset:39936
v_mfma_f32_16x16x32_bf16 v[180:183], v[44:47], a[20:23], v[180:183]
v_mul_f32 v78, v78, v86
v_exp_f32 v247, v247
v_mfma_f32_16x16x32_bf16 v[184:187], v[48:51], a[16:19], v[184:187]
ds_read_b128 v[40:43], v8 offset:49152
buffer_load_dwordx4 a[52:55], v1, s[4:7], s83 offen offset:0 sc1
v_mul_f32 v79, v79, v87
v_mfma_f32_16x16x32_bf16 v[192:195], v[48:51], a[20:23], v[192:195]
v_fma_f32 v240, v240, v202, v202
v_fma_f32 v241, v241, v202, v202
v_fma_f32 v242, v242, v202, v202
v_mfma_f32_16x16x32_bf16 v[188:191], v[52:55], a[16:19], v[188:191]
ds_read_b128 v[44:47], v8 offset:50176
s_add_u32 m0, s21, 0
s_add_u32 s47, s20, 131072
v_mfma_f32_16x16x32_bf16 v[196:199], v[52:55], a[20:23], v[196:199]
buffer_load_dwordx4 v1, s[4:7], s47 offen offset:0 sc1 lds
buffer_load_dwordx4 v1, s[4:7], s47 offen offset:1024 sc1 lds
s_waitcnt vmcnt(11) lgkmcnt(2)
v_mfma_f32_16x16x32_bf16 v[168:171], v[56:59], a[24:27], v[168:171]
ds_read_b128 v[48:51], v8 offset:51200
buffer_load_dwordx4 a[56:59], v5, s[4:7], s79 offen offset:0 sc1
v_fma_f32 v243, v243, v202, v202
v_mfma_f32_16x16x32_bf16 v[176:179], v[56:59], a[28:31], v[176:179]
v_fma_f32 v244, v244, v203, v203
v_fma_f32 v245, v245, v203, v203
v_fma_f32 v246, v246, v203, v203
v_mfma_f32_16x16x32_bf16 v[172:175], v[60:63], a[24:27], v[172:175]
ds_read_b128 v[52:55], v8 offset:52224
buffer_load_dwordx4 v1, s[4:7], s47 offen offset:2048 sc1 lds
v_mfma_f32_16x16x32_bf16 v[180:183], v[60:63], a[28:31], v[180:183]
v_fma_f32 v247, v247, v203, v203
v_rcp_f32 v240, v240
v_mfma_f32_16x16x32_bf16 v[184:187], v[64:67], a[24:27], v[184:187]
ds_read_b128 v[56:59], v8 offset:53248
buffer_load_dwordx4 a[60:63], v5, s[4:7], s83 offen offset:0 sc1
v_mfma_f32_16x16x32_bf16 v[192:195], v[64:67], a[28:31], v[192:195]
v_rcp_f32 v241, v241
v_rcp_f32 v242, v242
v_mfma_f32_16x16x32_bf16 v[188:191], v[68:71], a[24:27], v[188:191]
ds_read_b128 v[60:63], v8 offset:54272
s_waitcnt vmcnt(8)
v_cmp_ne_u64 vcc, s[66:67], v[38:39]
s_nop 0
s_cbranch_vccnz LF0_sp13
LF0_ok12:
v_mfma_f32_16x16x32_bf16 v[196:199], v[68:71], a[28:31], v[196:199]
buffer_load_dwordx4 v1, s[4:7], s47 offen offset:3072 sc1 lds
v_rcp_f32 v243, v243
s_waitcnt lgkmcnt(2)
v_mfma_f32_16x16x32_bf16 v[168:171], v[40:43], a[32:35], v[168:171]
ds_read_b128 v[64:67], v8 offset:55296
buffer_load_dwordx4 a[64:67], v1, s[4:7], s76 offen offset:1024 sc1
v_mfma_f32_16x16x32_bf16 v[176:179], v[40:43], a[36:39], v[176:179]
v_rcp_f32 v244, v244
v_rcp_f32 v245, v245
v_mfma_f32_16x16x32_bf16 v[172:175], v[44:47], a[32:35], v[172:175]
ds_read_b128 v[68:71], v8 offset:56320
s_add_u32 m0, s21, 16384
s_add_u32 s47, s20, 147456
buffer_load_dwordx4 v1, s[4:7], s47 offen offset:0 sc1 lds
v_mfma_f32_16x16x32_bf16 v[180:183], v[44:47], a[36:39], v[180:183]
buffer_store_dwordx2 v[36:37], v26, s[4:7], s40 offen offset:1024
v_mfma_f32_16x16x32_bf16 v[184:187], v[48:51], a[32:35], v[184:187]
ds_read_b128 v[40:43], v9 offset:49152
buffer_load_dwordx4 a[68:71], v1, s[4:7], s80 offen offset:1024 sc1
v_mfma_f32_16x16x32_bf16 v[192:195], v[48:51], a[36:39], v[192:195]
v_rcp_f32 v246, v246
v_rcp_f32 v247, v247
v_mfma_f32_16x16x32_bf16 v[188:191], v[52:55], a[32:35], v[188:191]
ds_read_b128 v[44:47], v9 offset:50176
buffer_load_dwordx4 v1, s[4:7], s47 offen offset:1024 sc1 lds
v_mfma_f32_16x16x32_bf16 v[196:199], v[52:55], a[36:39], v[196:199]
v_mul_f32 v72, v72, v240
v_mul_f32 v73, v73, v241
v_mul_f32 v74, v74, v242
s_waitcnt vmcnt(13) lgkmcnt(2)
v_mfma_f32_16x16x32_bf16 v[168:171], v[56:59], a[40:43], v[168:171]
ds_read_b128 v[48:51], v9 offset:51200
buffer_load_dwordx4 a[72:75], v5, s[4:7], s76 offen offset:1024 sc1
v_mul_f32 v75, v75, v243
v_mfma_f32_16x16x32_bf16 v[176:179], v[56:59], a[44:47], v[176:179]
v_mul_f32 v76, v76, v244
v_mul_f32 v77, v77, v245
v_mul_f32 v78, v78, v246
v_mfma_f32_16x16x32_bf16 v[172:175], v[60:63], a[40:43], v[172:175]
ds_read_b128 v[52:55], v9 offset:52224
buffer_load_dwordx4 v1, s[4:7], s47 offen offset:2048 sc1 lds
v_mul_f32 v79, v79, v247
v_mfma_f32_16x16x32_bf16 v[180:183], v[60:63], a[44:47], v[180:183]
v_bfe_u32 v240, v0, 4, 1
v_mul_u32_u24 v240, 57088, v240
v_bfe_u32 v241, v0, 5, 1
v_mfma_f32_16x16x32_bf16 v[184:187], v[64:67], a[40:43], v[184:187]
ds_read_b128 v[56:59], v9 offset:53248
buffer_load_dwordx4 a[76:79], v5, s[4:7], s80 offen offset:1024 sc1
v_mfma_f32_16x16x32_bf16 v[192:195], v[64:67], a[44:47], v[192:195]
v_mul_u32_u24 v241, 256, v241
v_sub_u32 v240, v240, v241
v_add_u32 v240, v240, v1
v_mfma_f32_16x16x32_bf16 v[188:191], v[68:71], a[40:43], v[188:191]
ds_read_b128 v[60:63], v9 offset:54272
buffer_load_dwordx4 v1, s[4:7], s47 offen offset:3072 sc1 lds
v_mfma_f32_16x16x32_bf16 v[196:199], v[68:71], a[44:47], v[196:199]
s_bitcmp1_b32 s13, 0
s_cselect_b32 s48, -512, 0
s_cselect_b32 s49, 0, 3072
s_add_u32 s48, s48, s49
s_add_u32 s48, s48, s32
s_waitcnt vmcnt(15) lgkmcnt(2)
v_mfma_f32_16x16x32_bf16 v[168:171], v[40:43], a[48:51], v[168:171]
ds_read_b128 v[64:67], v9 offset:55296
buffer_load_dwordx4 a[80:83], v1, s[4:7], s77 offen offset:1024 sc1
v_cvt_pk_bf16_f32 v248, v72, v73
v_mfma_f32_16x16x32_bf16 v[176:179], v[40:43], a[52:55], v[176:179]
v_cvt_pk_bf16_f32 v249, v74, v75
v_cvt_pk_bf16_f32 v250, v76, v77
v_cvt_pk_bf16_f32 v251, v78, v79
v_mfma_f32_16x16x32_bf16 v[172:175], v[44:47], a[48:51], v[172:175]
s_barrier
ds_read_b128 v[68:71], v9 offset:56320
v_permlane16_swap_b32 v248, v250
v_mfma_f32_16x16x32_bf16 v[180:183], v[44:47], a[52:55], v[180:183]
v_permlane16_swap_b32 v249, v251
buffer_store_dwordx4 v[248:251], v240, s[4:7], s48 offen sc1
v_mfma_f32_16x16x32_bf16 v[184:187], v[48:51], a[48:51], v[184:187]
ds_read_b128 v[40:43], v10 offset:0
v_mfma_f32_16x16x32_bf16 v[192:195], v[48:51], a[52:55], v[192:195]
buffer_load_dwordx4 a[84:87], v1, s[4:7], s81 offen offset:1024 sc1
v_mfma_f32_16x16x32_bf16 v[188:191], v[52:55], a[48:51], v[188:191]
ds_read_b128 v[44:47], v10 offset:1024
s_add_u32 m0, s21, 32768
s_add_u32 s47, s20, 163840
v_mfma_f32_16x16x32_bf16 v[196:199], v[52:55], a[52:55], v[196:199]
buffer_load_dwordx4 v1, s[4:7], s47 offen offset:0 sc1 lds
buffer_load_dwordx4 v1, s[4:7], s47 offen offset:1024 sc1 lds
s_waitcnt vmcnt(15) lgkmcnt(2)
v_mfma_f32_16x16x32_bf16 v[168:171], v[56:59], a[56:59], v[168:171]
ds_read_b128 v[48:51], v10 offset:2048
v_mfma_f32_16x16x32_bf16 v[176:179], v[56:59], a[60:63], v[176:179]
buffer_load_dwordx4 a[88:91], v5, s[4:7], s77 offen offset:1024 sc1
v_mfma_f32_16x16x32_bf16 v[172:175], v[60:63], a[56:59], v[172:175]
ds_read_b128 v[52:55], v10 offset:3072
v_mfma_f32_16x16x32_bf16 v[180:183], v[60:63], a[60:63], v[180:183]
buffer_load_dwordx4 v1, s[4:7], s47 offen offset:2048 sc1 lds
v_mfma_f32_16x16x32_bf16 v[184:187], v[64:67], a[56:59], v[184:187]
ds_read_b128 v[56:59], v10 offset:4096
buffer_load_dwordx4 a[92:95], v5, s[4:7], s81 offen offset:1024 sc1
s_getpc_b64 s[64:65]
LF0_pc19:
s_lshr_b32 s51, s2, 3
s_lshl_b32 s51, s51, 2
s_add_u32 s51, s51, s14
v_mfma_f32_16x16x32_bf16 v[192:195], v[64:67], a[60:63], v[192:195]
s_lshl_b32 s51, s51, 8
s_add_u32 s51, s51, 0
v_lshrrev_b32 v160, 2, v1
v_add_u32 v160, s51, v160
global_load_dword v29, v160, s[64:65]
v_mfma_f32_16x16x32_bf16 v[188:191], v[68:71], a[56:59], v[188:191]
ds_read_b128 v[60:63], v10 offset:5120
v_mfma_f32_16x16x32_bf16 v[196:199], v[68:71], a[60:63], v[196:199]
buffer_load_dwordx4 v1, s[4:7], s47 offen offset:3072 sc1 lds
s_waitcnt vmcnt(15) lgkmcnt(2)
v_mfma_f32_16x16x32_bf16 v[168:171], v[40:43], a[64:67], v[168:171]
ds_read_b128 v[64:67], v10 offset:6144
v_mfma_f32_16x16x32_bf16 v[176:179], v[40:43], a[68:71], v[176:179]
buffer_load_dwordx4 a[96:99], v1, s[4:7], s78 offen offset:1024 sc1
v_mfma_f32_16x16x32_bf16 v[172:175], v[44:47], a[64:67], v[172:175]
ds_read_b128 v[68:71], v10 offset:7168
s_add_u32 m0, s21, 49152
s_add_u32 s47, s20, 180224
v_mfma_f32_16x16x32_bf16 v[180:183], v[44:47], a[68:71], v[180:183]
buffer_load_dwordx4 v1, s[4:7], s47 offen offset:0 sc1 lds
v_mfma_f32_16x16x32_bf16 v[184:187], v[48:51], a[64:67], v[184:187]
ds_read_b128 v[40:43], v9 offset:32768
v_mfma_f32_16x16x32_bf16 v[192:195], v[48:51], a[68:71], v[192:195]
buffer_load_dwordx4 a[100:103], v1, s[4:7], s82 offen offset:1024 sc1
v_mfma_f32_16x16x32_bf16 v[188:191], v[52:55], a[64:67], v[188:191]
ds_read_b128 v[44:47], v9 offset:33792
v_mfma_f32_16x16x32_bf16 v[196:199], v[52:55], a[68:71], v[196:199]
buffer_load_dwordx4 v1, s[4:7], s47 offen offset:1024 sc1 lds
s_waitcnt vmcnt(15) lgkmcnt(2)
v_mfma_f32_16x16x32_bf16 v[168:171], v[56:59], a[72:75], v[168:171]
ds_read_b128 v[48:51], v9 offset:34816
buffer_load_dwordx4 a[104:107], v5, s[4:7], s78 offen offset:1024 sc1
v_mfma_f32_16x16x32_bf16 v[176:179], v[56:59], a[76:79], v[176:179]
buffer_load_dwordx2 v[38:39], v17, s[4:7], s41 offen offset:1024 sc1
v_mfma_f32_16x16x32_bf16 v[172:175], v[60:63], a[72:75], v[172:175]
ds_read_b128 v[52:55], v9 offset:35840
v_mfma_f32_16x16x32_bf16 v[180:183], v[60:63], a[76:79], v[180:183]
buffer_load_dwordx4 v1, s[4:7], s47 offen offset:2048 sc1 lds
v_mfma_f32_16x16x32_bf16 v[184:187], v[64:67], a[72:75], v[184:187]
ds_read_b128 v[56:59], v9 offset:36864
v_mfma_f32_16x16x32_bf16 v[192:195], v[64:67], a[76:79], v[192:195]
buffer_load_dwordx4 a[108:111], v5, s[4:7], s82 offen offset:1024 sc1
v_mfma_f32_16x16x32_bf16 v[188:191], v[68:71], a[72:75], v[188:191]
ds_read_b128 v[60:63], v9 offset:37888
v_mfma_f32_16x16x32_bf16 v[196:199], v[68:71], a[76:79], v[196:199]
buffer_load_dwordx4 v1, s[4:7], s47 offen offset:3072 sc1 lds
s_waitcnt vmcnt(16) lgkmcnt(2)
v_mfma_f32_16x16x32_bf16 v[168:171], v[40:43], a[80:83], v[168:171]
ds_read_b128 v[64:67], v9 offset:38912
v_mfma_f32_16x16x32_bf16 v[176:179], v[40:43], a[84:87], v[176:179]
buffer_load_dwordx4 a[112:115], v1, s[4:7], s79 offen offset:1024 sc1
v_mfma_f32_16x16x32_bf16 v[172:175], v[44:47], a[80:83], v[172:175]
s_barrier
v_mfma_f32_16x16x32_bf16 v[180:183], v[44:47], a[84:87], v[180:183]
ds_read_b128 v[68:71], v9 offset:39936
v_mfma_f32_16x16x32_bf16 v[184:187], v[48:51], a[80:83], v[184:187]
ds_read_b128 v[40:43], v9 offset:0
v_mfma_f32_16x16x32_bf16 v[192:195], v[48:51], a[84:87], v[192:195]
buffer_load_dwordx4 a[116:119], v1, s[4:7], s83 offen offset:1024 sc1
v_mfma_f32_16x16x32_bf16 v[188:191], v[52:55], a[80:83], v[188:191]
ds_read_b128 v[44:47], v9 offset:1024
s_add_u32 m0, s21, 114688
s_add_u32 s47, s20, 196608
v_mfma_f32_16x16x32_bf16 v[196:199], v[52:55], a[84:87], v[196:199]
buffer_load_dwordx4 v1, s[4:7], s47 offen offset:0 sc1 lds
buffer_load_dwordx4 v1, s[4:7], s47 offen offset:1024 sc1 lds
s_waitcnt vmcnt(15) lgkmcnt(2)
v_mfma_f32_16x16x32_bf16 v[168:171], v[56:59], a[88:91], v[168:171]
ds_read_b128 v[48:51], v9 offset:2048
v_mfma_f32_16x16x32_bf16 v[176:179], v[56:59], a[92:95], v[176:179]
buffer_load_dwordx4 a[120:123], v5, s[4:7], s79 offen offset:1024 sc1
v_mfma_f32_16x16x32_bf16 v[172:175], v[60:63], a[88:91], v[172:175]
ds_read_b128 v[52:55], v9 offset:3072
v_mfma_f32_16x16x32_bf16 v[180:183], v[60:63], a[92:95], v[180:183]
buffer_load_dwordx4 v1, s[4:7], s47 offen offset:2048 sc1 lds
v_mfma_f32_16x16x32_bf16 v[184:187], v[64:67], a[88:91], v[184:187]
ds_read_b128 v[56:59], v9 offset:4096
v_mfma_f32_16x16x32_bf16 v[192:195], v[64:67], a[92:95], v[192:195]
buffer_load_dwordx4 a[124:127], v5, s[4:7], s83 offen offset:1024 sc1
v_mfma_f32_16x16x32_bf16 v[188:191], v[68:71], a[88:91], v[188:191]
ds_read_b128 v[60:63], v9 offset:5120
s_waitcnt vmcnt(10)
v_cmp_ne_u64 vcc, s[66:67], v[38:39]
s_nop 0
s_cbranch_vccnz LF0_sp15
LF0_ok14:
v_mfma_f32_16x16x32_bf16 v[196:199], v[68:71], a[92:95], v[196:199]
buffer_load_dwordx4 v1, s[4:7], s47 offen offset:3072 sc1 lds
s_waitcnt lgkmcnt(2)
v_mfma_f32_16x16x32_bf16 v[168:171], v[40:43], a[96:99], v[168:171]
ds_read_b128 v[64:67], v9 offset:6144
buffer_load_dwordx4 a[0:3], v1, s[4:7], s76 offen offset:2048 sc1
v_mfma_f32_16x16x32_bf16 v[176:179], v[40:43], a[100:103], v[176:179]
buffer_store_dwordx2 v[36:37], v26, s[4:7], s40 offen offset:1536
v_mfma_f32_16x16x32_bf16 v[172:175], v[44:47], a[96:99], v[172:175]
ds_read_b128 v[68:71], v9 offset:7168
s_add_u32 m0, s21, 131072
s_add_u32 s47, s20, 212992
v_mfma_f32_16x16x32_bf16 v[180:183], v[44:47], a[100:103], v[180:183]
buffer_load_dwordx4 v1, s[4:7], s47 offen offset:0 sc1 lds
v_mfma_f32_16x16x32_bf16 v[184:187], v[48:51], a[96:99], v[184:187]
ds_read_b128 v[40:43], v9 offset:16384
v_mfma_f32_16x16x32_bf16 v[192:195], v[48:51], a[100:103], v[192:195]
buffer_load_dwordx4 a[4:7], v1, s[4:7], s80 offen offset:2048 sc1
v_mfma_f32_16x16x32_bf16 v[188:191], v[52:55], a[96:99], v[188:191]
ds_read_b128 v[44:47], v9 offset:17408
v_mfma_f32_16x16x32_bf16 v[196:199], v[52:55], a[100:103], v[196:199]
buffer_load_dwordx4 v1, s[4:7], s47 offen offset:1024 sc1 lds
s_waitcnt vmcnt(14) lgkmcnt(2)
v_mfma_f32_16x16x32_bf16 v[168:171], v[56:59], a[104:107], v[168:171]
ds_read_b128 v[48:51], v9 offset:18432
buffer_load_dwordx4 a[8:11], v5, s[4:7], s76 offen offset:2048 sc1
s_lshl_b32 s51, s14, 10
v_mfma_f32_16x16x32_bf16 v[176:179], v[56:59], a[108:111], v[176:179]
v_add_u32 v208, s51, v1
v_add_u32 v209, s51, v2
v_add_u32 v210, s51, v3
v_mfma_f32_16x16x32_bf16 v[172:175], v[60:63], a[104:107], v[172:175]
ds_read_b128 v[52:55], v9 offset:19456
v_mfma_f32_16x16x32_bf16 v[180:183], v[60:63], a[108:111], v[180:183]
buffer_load_dwordx4 v1, s[4:7], s47 offen offset:2048 sc1 lds
v_mfma_f32_16x16x32_bf16 v[184:187], v[64:67], a[104:107], v[184:187]
ds_read_b128 v[56:59], v9 offset:20480
v_mfma_f32_16x16x32_bf16 v[192:195], v[64:67], a[108:111], v[192:195]
buffer_load_dwordx4 a[12:15], v5, s[4:7], s80 offen offset:2048 sc1
v_mfma_f32_16x16x32_bf16 v[188:191], v[68:71], a[104:107], v[188:191]
ds_read_b128 v[60:63], v9 offset:21504
v_mfma_f32_16x16x32_bf16 v[196:199], v[68:71], a[108:111], v[196:199]
buffer_load_dwordx4 v1, s[4:7], s47 offen offset:3072 sc1 lds
s_waitcnt vmcnt(15) lgkmcnt(2)
v_mfma_f32_16x16x32_bf16 v[168:171], v[40:43], a[112:115], v[168:171]
ds_read_b128 v[64:67], v9 offset:22528
v_mfma_f32_16x16x32_bf16 v[176:179], v[40:43], a[116:119], v[176:179]
buffer_load_dwordx4 a[16:19], v1, s[4:7], s77 offen offset:2048 sc1
v_mfma_f32_16x16x32_bf16 v[172:175], v[44:47], a[112:115], v[172:175]
s_barrier
v_mfma_f32_16x16x32_bf16 v[180:183], v[44:47], a[116:119], v[180:183]
ds_read_b128 v[68:71], v9 offset:23552
v_mfma_f32_16x16x32_bf16 v[184:187], v[48:51], a[112:115], v[184:187]
ds_read_b128 v[40:43], v8 offset:0
v_mfma_f32_16x16x32_bf16 v[192:195], v[48:51], a[116:119], v[192:195]
buffer_load_dwordx4 a[20:23], v1, s[4:7], s81 offen offset:2048 sc1
v_mfma_f32_16x16x32_bf16 v[188:191], v[52:55], a[112:115], v[188:191]
ds_read_b128 v[44:47], v8 offset:1024
ds_write_b128 v209, a[128:131] offset:32768
v_mfma_f32_16x16x32_bf16 v[196:199], v[52:55], a[116:119], v[196:199]
ds_write_b128 v209, a[132:135] offset:36864
s_waitcnt vmcnt(12) lgkmcnt(4)
v_mfma_f32_16x16x32_bf16 v[168:171], v[56:59], a[120:123], v[168:171]
ds_read_b128 v[48:51], v8 offset:2048
v_mfma_f32_16x16x32_bf16 v[176:179], v[56:59], a[124:127], v[176:179]
buffer_load_dwordx4 a[24:27], v5, s[4:7], s77 offen offset:2048 sc1
v_mfma_f32_16x16x32_bf16 v[172:175], v[60:63], a[120:123], v[172:175]
ds_read_b128 v[52:55], v8 offset:3072
ds_write_b128 v209, a[136:139] offset:40960
v_mfma_f32_16x16x32_bf16 v[180:183], v[60:63], a[124:127], v[180:183]
v_lshrrev_b32 v25, 4, v0
v_and_b32 v25, 3, v25
s_lshl_b32 s51, s14, 9
v_mfma_f32_16x16x32_bf16 v[184:187], v[64:67], a[120:123], v[184:187]
ds_read_b128 v[56:59], v8 offset:4096
v_mfma_f32_16x16x32_bf16 v[192:195], v[64:67], a[124:127], v[192:195]
buffer_load_dwordx4 a[28:31], v5, s[4:7], s81 offen offset:2048 sc1
v_mfma_f32_16x16x32_bf16 v[188:191], v[68:71], a[120:123], v[188:191]
ds_read_b128 v[60:63], v8 offset:5120
ds_write_b128 v209, a[140:143] offset:45056
v_mfma_f32_16x16x32_bf16 v[196:199], v[68:71], a[124:127], v[196:199]
s_add_u32 s51, s51, 157696
v_lshl_add_u32 v25, v25, 4, s51
s_waitcnt vmcnt(9) lgkmcnt(4)
v_mfma_f32_16x16x32_bf16 v[168:171], v[40:43], a[0:3], v[168:171]
ds_read_b128 v[64:67], v8 offset:6144
v_mfma_f32_16x16x32_bf16 v[176:179], v[40:43], a[4:7], v[176:179]
buffer_load_dwordx4 a[32:35], v1, s[4:7], s78 offen offset:2048 sc1
v_mfma_f32_16x16x32_bf16 v[172:175], v[44:47], a[0:3], v[172:175]
ds_read_b128 v[68:71], v8 offset:7168
v_mfma_f32_16x16x32_bf16 v[180:183], v[44:47], a[4:7], v[180:183]
ds_write_b128 v209, a[144:147] offset:0
v_mfma_f32_16x16x32_bf16 v[184:187], v[48:51], a[0:3], v[184:187]
ds_read_b128 v[40:43], v8 offset:16384
buffer_load_dwordx4 a[36:39], v1, s[4:7], s82 offen offset:2048 sc1
v_mfma_f32_16x16x32_bf16 v[192:195], v[48:51], a[4:7], v[192:195]
buffer_load_dword v29, v26, s[4:7], s43 offen offset:0 sc1
v_mfma_f32_16x16x32_bf16 v[188:191], v[52:55], a[0:3], v[188:191]
ds_read_b128 v[44:47], v8 offset:17408
v_mfma_f32_16x16x32_bf16 v[196:199], v[52:55], a[4:7], v[196:199]
ds_write_b128 v209, a[148:151] offset:4096
s_waitcnt vmcnt(8) lgkmcnt(4)
v_mfma_f32_16x16x32_bf16 v[168:171], v[56:59], a[8:11], v[168:171]
ds_read_b128 v[48:51], v8 offset:18432
buffer_load_dwordx4 a[40:43], v5, s[4:7], s78 offen offset:2048 sc1
v_mfma_f32_16x16x32_bf16 v[176:179], v[56:59], a[12:15], v[176:179]
buffer_load_dwordx2 v[38:39], v17, s[4:7], s41 offen offset:1536 sc1
v_mfma_f32_16x16x32_bf16 v[172:175], v[60:63], a[8:11], v[172:175]
ds_read_b128 v[52:55], v8 offset:19456
v_mfma_f32_16x16x32_bf16 v[180:183], v[60:63], a[12:15], v[180:183]
ds_write_b128 v209, a[152:155] offset:8192
v_mfma_f32_16x16x32_bf16 v[184:187], v[64:67], a[8:11], v[184:187]
ds_read_b128 v[56:59], v8 offset:20480
buffer_load_dwordx4 a[44:47], v5, s[4:7], s82 offen offset:2048 sc1
v_mfma_f32_16x16x32_bf16 v[192:195], v[64:67], a[12:15], v[192:195]
s_sub_u32 s48, s34, 16777216
buffer_load_dword v29, v1, s[4:7], s48 offen offset:0 sc1
v_mfma_f32_16x16x32_bf16 v[188:191], v[68:71], a[8:11], v[188:191]
ds_read_b128 v[60:63], v8 offset:21504
v_mfma_f32_16x16x32_bf16 v[196:199], v[68:71], a[12:15], v[196:199]
ds_write_b128 v209, a[156:159] offset:12288
s_waitcnt vmcnt(9) lgkmcnt(4)
v_mfma_f32_16x16x32_bf16 v[168:171], v[40:43], a[16:19], v[168:171]
ds_read_b128 v[64:67], v8 offset:22528
v_mfma_f32_16x16x32_bf16 v[176:179], v[40:43], a[20:23], v[176:179]
buffer_load_dwordx4 a[48:51], v1, s[4:7], s79 offen offset:2048 sc1
v_mfma_f32_16x16x32_bf16 v[172:175], v[44:47], a[16:19], v[172:175]
s_barrier
v_mfma_f32_16x16x32_bf16 v[180:183], v[44:47], a[20:23], v[180:183]
ds_read_b128 v[68:71], v8 offset:23552
v_mfma_f32_16x16x32_bf16 v[184:187], v[48:51], a[16:19], v[184:187]
ds_read_b128 v[40:43], v8 offset:32768
buffer_load_dwordx4 a[52:55], v1, s[4:7], s83 offen offset:2048 sc1
v_mfma_f32_16x16x32_bf16 v[192:195], v[48:51], a[20:23], v[192:195]
buffer_load_dword v29, v4, s[4:7], s48 offen offset:0 sc1
v_mfma_f32_16x16x32_bf16 v[188:191], v[52:55], a[16:19], v[188:191]
ds_read_b128 v[44:47], v8 offset:33792
ds_write_b128 v209, a[160:163] offset:16384
v_mfma_f32_16x16x32_bf16 v[196:199], v[52:55], a[20:23], v[196:199]
ds_write_b128 v209, a[164:167] offset:20480
s_waitcnt vmcnt(10) lgkmcnt(4)
v_mfma_f32_16x16x32_bf16 v[168:171], v[56:59], a[24:27], v[168:171]
ds_read_b128 v[48:51], v8 offset:34816
v_mfma_f32_16x16x32_bf16 v[176:179], v[56:59], a[28:31], v[176:179]
buffer_load_dwordx4 a[56:59], v5, s[4:7], s79 offen offset:2048 sc1
v_mfma_f32_16x16x32_bf16 v[172:175], v[60:63], a[24:27], v[172:175]
ds_read_b128 v[52:55], v8 offset:35840
v_mfma_f32_16x16x32_bf16 v[180:183], v[60:63], a[28:31], v[180:183]
ds_write_b128 v209, a[168:171] offset:24576
v_mfma_f32_16x16x32_bf16 v[184:187], v[64:67], a[24:27], v[184:187]
ds_read_b128 v[56:59], v8 offset:36864
buffer_load_dwordx4 a[60:63], v5, s[4:7], s83 offen offset:2048 sc1
v_mfma_f32_16x16x32_bf16 v[192:195], v[64:67], a[28:31], v[192:195]
buffer_load_dword v29, v7, s[4:7], s35 offen offset:0 sc1
v_mfma_f32_16x16x32_bf16 v[188:191], v[68:71], a[24:27], v[188:191]
ds_read_b128 v[60:63], v8 offset:37888
s_waitcnt vmcnt(8)
v_cmp_ne_u64 vcc, s[66:67], v[38:39]
s_nop 0
s_cbranch_vccnz LF0_sp17
LF0_ok16:
v_mfma_f32_16x16x32_bf16 v[196:199], v[68:71], a[28:31], v[196:199]
ds_write_b128 v209, a[172:175] offset:28672
s_waitcnt lgkmcnt(4)
v_mfma_f32_16x16x32_bf16 v[168:171], v[40:43], a[32:35], v[168:171]
ds_read_b128 v[64:67], v8 offset:38912
v_mfma_f32_16x16x32_bf16 v[176:179], v[40:43], a[36:39], v[176:179]
buffer_load_dwordx4 a[64:67], v1, s[4:7], s76 offen offset:3072 sc1
v_mfma_f32_16x16x32_bf16 v[172:175], v[44:47], a[32:35], v[172:175]
ds_read_b128 v[68:71], v8 offset:39936
v_mfma_f32_16x16x32_bf16 v[180:183], v[44:47], a[36:39], v[180:183]
ds_write_b128 v208, a[176:179] offset:0
v_mfma_f32_16x16x32_bf16 v[184:187], v[48:51], a[32:35], v[184:187]
ds_read_b128 v[40:43], v8 offset:49152
v_mfma_f32_16x16x32_bf16 v[192:195], v[48:51], a[36:39], v[192:195]
buffer_load_dwordx4 a[68:71], v1, s[4:7], s80 offen offset:3072 sc1
v_mfma_f32_16x16x32_bf16 v[188:191], v[52:55], a[32:35], v[188:191]
ds_read_b128 v[44:47], v8 offset:50176
v_mfma_f32_16x16x32_bf16 v[196:199], v[52:55], a[36:39], v[196:199]
ds_write_b128 v208, a[180:183] offset:4096
s_waitcnt vmcnt(9) lgkmcnt(4)
v_mfma_f32_16x16x32_bf16 v[168:171], v[56:59], a[40:43], v[168:171]
ds_read_b128 v[48:51], v8 offset:51200
v_mfma_f32_16x16x32_bf16 v[176:179], v[56:59], a[44:47], v[176:179]
buffer_load_dwordx4 a[72:75], v1, s[4:7], s77 offen offset:3072 sc1
v_mfma_f32_16x16x32_bf16 v[172:175], v[60:63], a[40:43], v[172:175]
ds_read_b128 v[52:55], v8 offset:52224
v_mfma_f32_16x16x32_bf16 v[180:183], v[60:63], a[44:47], v[180:183]
ds_write_b128 v208, a[184:187] offset:8192
v_mfma_f32_16x16x32_bf16 v[184:187], v[64:67], a[40:43], v[184:187]
ds_read_b128 v[56:59], v8 offset:53248
v_mfma_f32_16x16x32_bf16 v[192:195], v[64:67], a[44:47], v[192:195]
buffer_load_dwordx4 a[76:79], v1, s[4:7], s81 offen offset:3072 sc1
v_mfma_f32_16x16x32_bf16 v[188:191], v[68:71], a[40:43], v[188:191]
ds_read_b128 v[60:63], v8 offset:54272
v_mfma_f32_16x16x32_bf16 v[196:199], v[68:71], a[44:47], v[196:199]
ds_write_b128 v208, a[188:191] offset:12288
s_waitcnt vmcnt(8) lgkmcnt(4)
v_mfma_f32_16x16x32_bf16 v[168:171], v[40:43], a[48:51], v[168:171]
ds_read_b128 v[64:67], v8 offset:55296
v_mfma_f32_16x16x32_bf16 v[176:179], v[40:43], a[52:55], v[176:179]
buffer_load_dwordx4 a[80:83], v1, s[4:7], s78 offen offset:3072 sc1
v_mfma_f32_16x16x32_bf16 v[172:175], v[44:47], a[48:51], v[172:175]
s_barrier
v_mfma_f32_16x16x32_bf16 v[180:183], v[44:47], a[52:55], v[180:183]
ds_read_b128 v[68:71], v8 offset:56320
v_mfma_f32_16x16x32_bf16 v[184:187], v[48:51], a[48:51], v[184:187]
ds_read_b128 v[40:43], v9 offset:49152
v_mfma_f32_16x16x32_bf16 v[192:195], v[48:51], a[52:55], v[192:195]
buffer_load_dwordx4 a[84:87], v1, s[4:7], s82 offen offset:3072 sc1
v_mfma_f32_16x16x32_bf16 v[188:191], v[52:55], a[48:51], v[188:191]
ds_read_b128 v[44:47], v9 offset:50176
ds_write_b128 v208, a[192:195] offset:16384
v_mfma_f32_16x16x32_bf16 v[196:199], v[52:55], a[52:55], v[196:199]
ds_write_b128 v208, a[196:199] offset:20480
s_waitcnt vmcnt(7) lgkmcnt(4)
v_mfma_f32_16x16x32_bf16 v[168:171], v[56:59], a[56:59], v[168:171]
ds_read_b128 v[48:51], v9 offset:51200
v_mfma_f32_16x16x32_bf16 v[176:179], v[56:59], a[60:63], v[176:179]
buffer_load_dwordx4 a[88:91], v1, s[4:7], s79 offen offset:3072 sc1
v_mfma_f32_16x16x32_bf16 v[172:175], v[60:63], a[56:59], v[172:175]
ds_read_b128 v[52:55], v9 offset:52224
v_mfma_f32_16x16x32_bf16 v[180:183], v[60:63], a[60:63], v[180:183]
ds_write_b128 v208, a[200:203] offset:24576
v_mfma_f32_16x16x32_bf16 v[184:187], v[64:67], a[56:59], v[184:187]
ds_read_b128 v[56:59], v9 offset:53248
v_mfma_f32_16x16x32_bf16 v[192:195], v[64:67], a[60:63], v[192:195]
buffer_load_dwordx4 a[92:95], v1, s[4:7], s83 offen offset:3072 sc1
v_mfma_f32_16x16x32_bf16 v[188:191], v[68:71], a[56:59], v[188:191]
ds_read_b128 v[60:63], v9 offset:54272
v_mfma_f32_16x16x32_bf16 v[196:199], v[68:71], a[60:63], v[196:199]
ds_write_b128 v208, a[204:207] offset:28672
s_waitcnt vmcnt(6) lgkmcnt(4)
v_mfma_f32_16x16x32_bf16 v[168:171], v[40:43], a[64:67], v[168:171]
ds_read_b128 v[64:67], v9 offset:55296
v_mfma_f32_16x16x32_bf16 v[176:179], v[40:43], a[68:71], v[176:179]
v_mfma_f32_16x16x32_bf16 v[172:175], v[44:47], a[64:67], v[172:175]
ds_read_b128 v[68:71], v9 offset:56320
v_mfma_f32_16x16x32_bf16 v[180:183], v[44:47], a[68:71], v[180:183]
ds_write_b128 v208, a[208:211] offset:32768
v_mfma_f32_16x16x32_bf16 v[184:187], v[48:51], a[64:67], v[184:187]
ds_read_b128 v[40:43], v10 offset:0
v_mfma_f32_16x16x32_bf16 v[192:195], v[48:51], a[68:71], v[192:195]
v_mfma_f32_16x16x32_bf16 v[188:191], v[52:55], a[64:67], v[188:191]
ds_read_b128 v[44:47], v10 offset:1024
v_mfma_f32_16x16x32_bf16 v[196:199], v[52:55], a[68:71], v[196:199]
ds_write_b128 v208, a[212:215] offset:36864
s_waitcnt vmcnt(4) lgkmcnt(4)
v_mfma_f32_16x16x32_bf16 v[168:171], v[56:59], a[72:75], v[168:171]
ds_read_b128 v[48:51], v10 offset:2048
v_mfma_f32_16x16x32_bf16 v[176:179], v[56:59], a[76:79], v[176:179]
v_mfma_f32_16x16x32_bf16 v[172:175], v[60:63], a[72:75], v[172:175]
ds_read_b128 v[52:55], v10 offset:3072
v_mfma_f32_16x16x32_bf16 v[180:183], v[60:63], a[76:79], v[180:183]
ds_write_b128 v208, a[216:219] offset:40960
v_mfma_f32_16x16x32_bf16 v[184:187], v[64:67], a[72:75], v[184:187]
ds_read_b128 v[56:59], v10 offset:4096
v_mfma_f32_16x16x32_bf16 v[192:195], v[64:67], a[76:79], v[192:195]
v_mfma_f32_16x16x32_bf16 v[188:191], v[68:71], a[72:75], v[188:191]
ds_read_b128 v[60:63], v10 offset:5120
v_mfma_f32_16x16x32_bf16 v[196:199], v[68:71], a[76:79], v[196:199]
ds_write_b128 v208, a[220:223] offset:45056
s_waitcnt vmcnt(2) lgkmcnt(4)
ds_read_b128 v[64:67], v10 offset:6144
ds_read_b128 v[68:71], v10 offset:7168
v_mfma_f32_16x16x32_bf16 v[184:187], v[48:51], a[80:83], v[184:187]
v_mfma_f32_16x16x32_bf16 v[192:195], v[48:51], a[84:87], v[192:195]
v_mfma_f32_16x16x32_bf16 v[188:191], v[52:55], a[80:83], v[188:191]
v_mfma_f32_16x16x32_bf16 v[196:199], v[52:55], a[84:87], v[196:199]
s_waitcnt vmcnt(1) lgkmcnt(1)
v_mfma_f32_16x16x32_bf16 v[184:187], v[64:67], a[88:91], v[184:187]
s_waitcnt vmcnt(0)
v_mfma_f32_16x16x32_bf16 v[192:195], v[64:67], a[92:95], v[192:195]
s_waitcnt lgkmcnt(0)
v_mfma_f32_16x16x32_bf16 v[188:191], v[68:71], a[88:91], v[188:191]
v_mfma_f32_16x16x32_bf16 v[196:199], v[68:71], a[92:95], v[196:199]
v_mfma_f32_16x16x32_bf16 v[168:171], v[40:43], a[80:83], v[168:171]
v_mfma_f32_16x16x32_bf16 v[176:179], v[40:43], a[84:87], v[176:179]
v_mfma_f32_16x16x32_bf16 v[172:175], v[44:47], a[80:83], v[172:175]
v_mfma_f32_16x16x32_bf16 v[180:183], v[44:47], a[84:87], v[180:183]
ds_write_b128 v18, v[184:187] offset:0
v_mfma_f32_16x16x32_bf16 v[168:171], v[56:59], a[88:91], v[168:171]
s_nop 0
ds_write_b128 v18, v[188:191] offset:1024
v_mfma_f32_16x16x32_bf16 v[176:179], v[56:59], a[92:95], v[176:179]
ds_write_b128 v18, v[192:195] offset:2048
v_mfma_f32_16x16x32_bf16 v[172:175], v[60:63], a[88:91], v[172:175]
ds_write_b128 v18, v[196:199] offset:3072
v_mfma_f32_16x16x32_bf16 v[180:183], v[60:63], a[92:95], v[180:183]
s_waitcnt lgkmcnt(0)
s_barrier
ds_read_b128 v[224:227], v19 offset:0
ds_read_b128 v[228:231], v19 offset:1024
ds_read_b128 v[232:235], v19 offset:2048
ds_read_b128 v[236:239], v19 offset:3072
s_waitcnt lgkmcnt(3)
v_pk_add_f32 v[168:169], v[168:169], v[224:225]
v_pk_add_f32 v[170:171], v[170:171], v[226:227]
s_waitcnt lgkmcnt(2)
v_pk_add_f32 v[172:173], v[172:173], v[228:229]
v_pk_add_f32 v[174:175], v[174:175], v[230:231]
s_waitcnt lgkmcnt(1)
v_pk_add_f32 v[176:177], v[176:177], v[232:233]
v_pk_add_f32 v[178:179], v[178:179], v[234:235]
s_waitcnt lgkmcnt(0)
v_pk_add_f32 v[180:181], v[180:181], v[236:237]
v_pk_add_f32 v[182:183], v[182:183], v[238:239]
v_cvt_pk_bf16_f32 v124, v168, v169
v_cvt_pk_bf16_f32 v125, v170, v171
v_cvt_pk_bf16_f32 v126, v172, v173
v_cvt_pk_bf16_f32 v127, v174, v175
v_cvt_pk_bf16_f32 v128, v176, v177
v_cvt_pk_bf16_f32 v129, v178, v179
v_cvt_pk_bf16_f32 v130, v180, v181
v_cvt_pk_bf16_f32 v131, v182, v183
s_sub_u32 s48, s34, 16777216
s_add_u32 s49, s35, 524288
buffer_store_dwordx4 v[124:127], v1, s[4:7], s48 offen
buffer_store_dwordx4 v[128:131], v4, s[4:7], s48 offen
v_pk_mul_f32 v[226:227], v[168:169], v[168:169]
v_pk_add_f32 v[224:225], v[168:169], v[170:171]
v_pk_mul_f32 v[230:231], v[176:177], v[176:177]
v_pk_add_f32 v[228:229], v[176:177], v[178:179]
v_pk_fma_f32 v[226:227], v[170:171], v[170:171], v[226:227]
v_pk_fma_f32 v[230:231], v[178:179], v[178:179], v[230:231]
v_pk_fma_f32 v[226:227], v[172:173], v[172:173], v[226:227]
v_pk_add_f32 v[224:225], v[224:225], v[172:173]
v_pk_fma_f32 v[230:231], v[180:181], v[180:181], v[230:231]
v_pk_add_f32 v[228:229], v[228:229], v[180:181]
v_pk_fma_f32 v[226:227], v[174:175], v[174:175], v[226:227]
v_pk_add_f32 v[224:225], v[224:225], v[174:175]
v_pk_fma_f32 v[230:231], v[182:183], v[182:183], v[230:231]
v_pk_add_f32 v[228:229], v[228:229], v[182:183]
v_add_f32 v224, v224, v225
v_add_f32 v226, v226, v227
v_add_f32 v228, v228, v229
v_add_f32 v230, v230, v231
v_permlane32_swap_b32 v224, v226
s_nop 0
v_permlane32_swap_b32 v228, v230
v_add_f32 v224, v224, v226
v_add_f32 v228, v228, v230
s_nop 1
v_permlane16_swap_b32 v224, v228
v_add_f32 v224, v224, v228
buffer_store_dword v224, v7, s[4:7], s35 offen
s_waitcnt vmcnt(0)
buffer_store_dwordx2 v[36:37], v26, s[4:7], s42 offen offset:0
s_cmp_eq_u32 s53, 0
s_cbranch_scc1 LF0_c20
buffer_store_dwordx4 v[124:127], v1, s[4:7], s34 offen sc1
buffer_store_dwordx4 v[128:131], v4, s[4:7], s34 offen sc1
buffer_store_dword v224, v7, s[4:7], s49 offen sc1
s_waitcnt vmcnt(0)
buffer_store_dwordx2 v[36:37], v26, s[4:7], s44 offen sc1
LF0_c20:
s_add_u32 s23, s31, -262144
s_lshl_b32 s48, s13, 10
s_add_u32 s26, s30, s48
s_add_u32 s26, s26, -2097152
s_add_u32 s36, s40, -4096
s_add_u32 s48, s12, 15
s_and_b32 s48, s48, 15
s_lshl_b32 s48, s48, 14
s_add_u32 s25, s48, 15216640
v_add_u32 v20, 2048, v22
s_lshl_b32 s48, s16, 10
s_lshl_b32 s49, s15, 3
s_add_u32 s48, s48, s49
s_add_u32 s48, s48, 147456
v_add_u32 v21, s48, v1
s_and_b32 s48, s12, 7
s_or_b32 s48, s48, s14
s_cmp_eq_u32 s48, 0
s_cselect_b64 vcc, -1, 0
v_mov_b32 v232, 0xf149f2ca
v_cndmask_b32 v140, v136, v232, vcc
v_cndmask_b32 v141, v137, v232, vcc
v_cndmask_b32 v142, v138, v232, vcc
v_cndmask_b32 v143, v139, v232, vcc
s_cmp_lg_u32 s16, 0
s_cselect_b64 vcc, -1, 0
v_cndmask_b32 v232, v34, v35, vcc
v_cndmask_b32 v160, v152, v156, vcc
v_cndmask_b32 v161, v153, v157, vcc
v_cndmask_b32 v162, v154, v158, vcc
v_cndmask_b32 v163, v155, v159, vcc
s_cmp_lg_u32 s15, 0
s_cselect_b64 vcc, -1, 0
v_cndmask_b32 v160, v160, v232, vcc
v_cndmask_b32 v161, v161, v232, vcc
v_cndmask_b32 v162, v162, v232, vcc
v_cndmask_b32 v163, v163, v232, vcc
s_add_u32 s23, s23, 16777216
s_add_u32 s24, s24, 16777216
s_add_u32 s25, s25, 16777216
s_add_u32 s40, s40, 2560
s_add_u32 s41, s41, 2560
LF1_top:
s_cmp_eq_u32 s15, 0
s_mov_b32 s48, 81920
s_cselect_b32 s48, s48, 0
s_mov_b32 s49, 16384
s_cselect_b32 s49, s49, 32768
s_cmp_eq_u32 s16, 0
s_cselect_b32 s48, s48, s49
s_cmp_eq_u32 s15, 0
s_cselect_b32 s49, s48, 131072
s_cselect_b32 s48, 131072, s48
v_add_u32 v14, s49, v1
v_add_u32 v15, s48, v1
buffer_load_dwordx2 v[38:39], v16, s[4:7], s43 offen offset:0 sc1
buffer_load_dwordx2 v[252:253], v16, s[4:7], s43 offen offset:0 sc1
s_waitcnt vmcnt(1)
v_cmp_ne_u64 vcc, s[66:67], v[38:39]
s_nop 0
s_cbranch_vccnz LF1_sp2
LF1_ok1:
s_add_u32 s48, s22, 0
buffer_load_dwordx4 a[0:3], v1, s[4:7], s48 offen offset:0 sc1
s_add_u32 s49, s22, 16384
buffer_load_dwordx4 a[4:7], v1, s[4:7], s49 offen offset:0 sc1
buffer_load_dwordx4 a[8:11], v1, s[4:7], s48 offen offset:1024 sc1
buffer_load_dwordx4 a[12:15], v1, s[4:7], s49 offen offset:1024 sc1
buffer_load_dwordx4 a[16:19], v1, s[4:7], s48 offen offset:2048 sc1
buffer_load_dwordx4 a[20:23], v1, s[4:7], s49 offen offset:2048 sc1
buffer_load_dwordx4 a[24:27], v1, s[4:7], s48 offen offset:3072 sc1
buffer_load_dwordx4 a[28:31], v1, s[4:7], s49 offen offset:3072 sc1
s_barrier
ds_read_b128 v[40:43], v2 offset:32768
ds_read_b128 v[44:47], v2 offset:0
ds_read_b128 v[48:51], v2 offset:16384
ds_read_b128 v[52:55], v1 offset:0
ds_read_b128 v[56:59], v1 offset:16384
ds_read_b128 v[60:63], v1 offset:32768
s_add_u32 s50, s26, 16384
s_waitcnt vmcnt(6) lgkmcnt(3)
v_mfma_f32_16x16x32_bf16 v[72:75], v[40:43], a[0:3], 0
ds_read_b128 v[64:67], v2 offset:33792
v_mfma_f32_16x16x32_bf16 v[76:79], v[40:43], a[4:7], 0
s_add_u32 s48, s22, 4096
buffer_load_dwordx4 a[32:35], v1, s[4:7], s48 offen offset:0 sc1
v_mfma_f32_16x16x32_bf16 v[80:83], v[44:47], a[0:3], 0
ds_read_b128 v[68:71], v2 offset:1024
buffer_load_dwordx4 v[224:227], v6, s[4:7], s23 offen offset:0 sc1
v_mfma_f32_16x16x32_bf16 v[84:87], v[44:47], a[4:7], 0
buffer_load_dwordx4 v[228:231], v6, s[4:7], s23 offen offset:1024 sc1
v_mfma_f32_16x16x32_bf16 v[88:91], v[48:51], a[0:3], 0
ds_read_b128 v[240:243], v2 offset:17408
v_mfma_f32_16x16x32_bf16 v[92:95], v[48:51], a[4:7], 0
s_waitcnt lgkmcnt(3)
v_mfma_f32_16x16x32_bf16 v[96:99], a[0:3], v[52:55], 0
ds_read_b128 v[244:247], v1 offset:1024
buffer_load_dwordx4 v[232:235], v6, s[4:7], s23 offen offset:2048 sc1
v_mfma_f32_16x16x32_bf16 v[100:103], a[4:7], v[52:55], 0
s_add_u32 s49, s22, 20480
buffer_load_dwordx4 a[36:39], v1, s[4:7], s49 offen offset:0 sc1
v_mfma_f32_16x16x32_bf16 v[104:107], v[56:59], a[0:3], 0
ds_read_b128 v[248:251], v1 offset:17408
v_mfma_f32_16x16x32_bf16 v[108:111], v[56:59], a[4:7], 0
buffer_load_dwordx4 v[236:239], v6, s[4:7], s23 offen offset:3072 sc1
v_mfma_f32_16x16x32_bf16 v[112:115], a[0:3], v[60:63], 0
ds_read_b128 v[252:255], v1 offset:33792
v_mfma_f32_16x16x32_bf16 v[116:119], a[4:7], v[60:63], 0
s_waitcnt vmcnt(10) lgkmcnt(3)
v_mfma_f32_16x16x32_bf16 v[72:75], v[64:67], a[8:11], v[72:75]
ds_read_b128 v[40:43], v2 offset:34816
v_mfma_f32_16x16x32_bf16 v[76:79], v[64:67], a[12:15], v[76:79]
buffer_load_dwordx4 a[40:43], v1, s[4:7], s48 offen offset:1024 sc1
v_mfma_f32_16x16x32_bf16 v[80:83], v[68:71], a[8:11], v[80:83]
ds_read_b128 v[44:47], v2 offset:2048
v_mfma_f32_16x16x32_bf16 v[84:87], v[68:71], a[12:15], v[84:87]
v_mfma_f32_16x16x32_bf16 v[88:91], v[240:243], a[8:11], v[88:91]
ds_read_b128 v[48:51], v2 offset:18432
v_mfma_f32_16x16x32_bf16 v[92:95], v[240:243], a[12:15], v[92:95]
s_waitcnt lgkmcnt(3)
v_mfma_f32_16x16x32_bf16 v[96:99], a[8:11], v[244:247], v[96:99]
ds_read_b128 v[52:55], v1 offset:2048
v_mfma_f32_16x16x32_bf16 v[100:103], a[12:15], v[244:247], v[100:103]
buffer_load_dwordx4 a[44:47], v1, s[4:7], s49 offen offset:1024 sc1
v_mfma_f32_16x16x32_bf16 v[104:107], v[248:251], a[8:11], v[104:107]
ds_read_b128 v[56:59], v1 offset:18432
v_mfma_f32_16x16x32_bf16 v[108:111], v[248:251], a[12:15], v[108:111]
v_mfma_f32_16x16x32_bf16 v[112:115], a[8:11], v[252:255], v[112:115]
ds_read_b128 v[60:63], v1 offset:34816
v_mfma_f32_16x16x32_bf16 v[116:119], a[12:15], v[252:255], v[116:119]
s_waitcnt vmcnt(10) lgkmcnt(3)
v_mfma_f32_16x16x32_bf16 v[72:75], v[40:43], a[16:19], v[72:75]
ds_read_b128 v[64:67], v2 offset:35840
v_mfma_f32_16x16x32_bf16 v[76:79], v[40:43], a[20:23], v[76:79]
buffer_load_dwordx4 a[48:51], v1, s[4:7], s48 offen offset:2048 sc1
v_mfma_f32_16x16x32_bf16 v[80:83], v[44:47], a[16:19], v[80:83]
ds_read_b128 v[68:71], v2 offset:3072
v_mfma_f32_16x16x32_bf16 v[84:87], v[44:47], a[20:23], v[84:87]
v_mfma_f32_16x16x32_bf16 v[88:91], v[48:51], a[16:19], v[88:91]
ds_read_b128 v[240:243], v2 offset:19456
v_mfma_f32_16x16x32_bf16 v[92:95], v[48:51], a[20:23], v[92:95]
s_waitcnt lgkmcnt(3)
v_mfma_f32_16x16x32_bf16 v[96:99], a[16:19], v[52:55], v[96:99]
ds_read_b128 v[244:247], v1 offset:3072
v_mfma_f32_16x16x32_bf16 v[100:103], a[20:23], v[52:55], v[100:103]
buffer_load_dwordx4 a[52:55], v1, s[4:7], s49 offen offset:2048 sc1
v_mfma_f32_16x16x32_bf16 v[104:107], v[56:59], a[16:19], v[104:107]
ds_read_b128 v[248:251], v1 offset:19456
v_mfma_f32_16x16x32_bf16 v[108:111], v[56:59], a[20:23], v[108:111]
v_mfma_f32_16x16x32_bf16 v[112:115], a[16:19], v[60:63], v[112:115]
ds_read_b128 v[252:255], v1 offset:35840
v_mfma_f32_16x16x32_bf16 v[116:119], a[20:23], v[60:63], v[116:119]
s_waitcnt vmcnt(10) lgkmcnt(3)
v_mfma_f32_16x16x32_bf16 v[72:75], v[64:67], a[24:27], v[72:75]
ds_read_b128 v[40:43], v2 offset:36864
s_waitcnt vmcnt(8)
v_add_f32 v224, v224, v226
v_mfma_f32_16x16x32_bf16 v[76:79], v[64:67], a[28:31], v[76:79]
buffer_load_dwordx4 a[56:59], v1, s[4:7], s48 offen offset:3072 sc1
v_mfma_f32_16x16x32_bf16 v[80:83], v[68:71], a[24:27], v[80:83]
ds_read_b128 v[44:47], v2 offset:4096
v_mfma_f32_16x16x32_bf16 v[84:87], v[68:71], a[28:31], v[84:87]
v_add_f32 v225, v225, v227
s_waitcnt vmcnt(8)
v_add_f32 v228, v228, v230
v_mfma_f32_16x16x32_bf16 v[88:91], v[240:243], a[24:27], v[88:91]
ds_read_b128 v[48:51], v2 offset:20480
v_mfma_f32_16x16x32_bf16 v[92:95], v[240:243], a[28:31], v[92:95]
v_add_f32 v229, v229, v231
s_waitcnt vmcnt(7)
v_add_f32 v232, v232, v234
s_waitcnt lgkmcnt(3)
v_mfma_f32_16x16x32_bf16 v[96:99], a[24:27], v[244:247], v[96:99]
ds_read_b128 v[52:55], v1 offset:4096
v_add_f32 v233, v233, v235
v_mfma_f32_16x16x32_bf16 v[100:103], a[28:31], v[244:247], v[100:103]
buffer_load_dwordx4 a[60:63], v1, s[4:7], s49 offen offset:3072 sc1
v_mfma_f32_16x16x32_bf16 v[104:107], v[248:251], a[24:27], v[104:107]
ds_read_b128 v[56:59], v1 offset:20480
v_mfma_f32_16x16x32_bf16 v[108:111], v[248:251], a[28:31], v[108:111]
s_waitcnt vmcnt(6)
v_add_f32 v236, v236, v238
buffer_load_dwordx2 v[38:39], v16, s[4:7], s45 offen offset:0 sc1
v_mfma_f32_16x16x32_bf16 v[112:115], a[24:27], v[252:255], v[112:115]
ds_read_b128 v[60:63], v1 offset:36864
v_add_f32 v237, v237, v239
v_mfma_f32_16x16x32_bf16 v[116:119], a[28:31], v[252:255], v[116:119]
v_add_f32 v224, v224, v228
v_add_f32 v225, v225, v229
s_waitcnt lgkmcnt(3)
v_mfma_f32_16x16x32_bf16 v[72:75], v[40:43], a[32:35], v[72:75]
ds_read_b128 v[64:67], v2 offset:37888
v_mfma_f32_16x16x32_bf16 v[76:79], v[40:43], a[36:39], v[76:79]
s_add_u32 s48, s22, 8192
buffer_load_dwordx4 a[64:67], v1, s[4:7], s48 offen offset:0 sc1
v_mfma_f32_16x16x32_bf16 v[80:83], v[44:47], a[32:35], v[80:83]
ds_read_b128 v[68:71], v2 offset:5120
v_mfma_f32_16x16x32_bf16 v[84:87], v[44:47], a[36:39], v[84:87]
v_add_f32 v232, v232, v236
v_mfma_f32_16x16x32_bf16 v[88:91], v[48:51], a[32:35], v[88:91]
ds_read_b128 v[240:243], v2 offset:21504
v_add_f32 v233, v233, v237
v_mfma_f32_16x16x32_bf16 v[92:95], v[48:51], a[36:39], v[92:95]
v_add_f32 v224, v224, v232
v_add_f32 v225, v225, v233
s_waitcnt lgkmcnt(3)
v_mfma_f32_16x16x32_bf16 v[96:99], a[32:35], v[52:55], v[96:99]
ds_read_b128 v[244:247], v1 offset:5120
v_mfma_f32_16x16x32_bf16 v[100:103], a[36:39], v[52:55], v[100:103]
s_add_u32 s49, s22, 24576
buffer_load_dwordx4 a[68:71], v1, s[4:7], s49 offen offset:0 sc1
v_mfma_f32_16x16x32_bf16 v[104:107], v[56:59], a[32:35], v[104:107]
ds_read_b128 v[248:251], v1 offset:21504
v_mfma_f32_16x16x32_bf16 v[108:111], v[56:59], a[36:39], v[108:111]
v_mov_b32 v226, v224
v_mfma_f32_16x16x32_bf16 v[112:115], a[32:35], v[60:63], v[112:115]
ds_read_b128 v[252:255], v1 offset:37888
v_mov_b32 v227, v225
v_mfma_f32_16x16x32_bf16 v[116:119], a[36:39], v[60:63], v[116:119]
v_permlane32_swap_b32 v224, v226
v_permlane32_swap_b32 v225, v227
s_waitcnt vmcnt(7) lgkmcnt(3)
v_mfma_f32_16x16x32_bf16 v[72:75], v[64:67], a[40:43], v[72:75]
ds_read_b128 v[40:43], v2 offset:38912
v_mfma_f32_16x16x32_bf16 v[76:79], v[64:67], a[44:47], v[76:79]
buffer_load_dwordx4 a[72:75], v1, s[4:7], s48 offen offset:1024 sc1
v_mfma_f32_16x16x32_bf16 v[80:83], v[68:71], a[40:43], v[80:83]
ds_read_b128 v[44:47], v2 offset:6144
v_mfma_f32_16x16x32_bf16 v[84:87], v[68:71], a[44:47], v[84:87]
v_add_f32 v224, v224, v226
v_add_f32 v225, v225, v227
v_mfma_f32_16x16x32_bf16 v[88:91], v[240:243], a[40:43], v[88:91]
ds_read_b128 v[48:51], v2 offset:22528
v_mul_f32 v224, 0xbb000000, v224
v_mfma_f32_16x16x32_bf16 v[92:95], v[240:243], a[44:47], v[92:95]
v_mul_f32 v225, 0x3b000000, v225
s_waitcnt lgkmcnt(3)
v_mfma_f32_16x16x32_bf16 v[96:99], a[40:43], v[244:247], v[96:99]
ds_read_b128 v[52:55], v1 offset:6144
v_fma_f32 v225, -v224, v224, v225
v_mfma_f32_16x16x32_bf16 v[100:103], a[44:47], v[244:247], v[100:103]
buffer_load_dwordx4 a[76:79], v1, s[4:7], s49 offen offset:1024 sc1
v_mfma_f32_16x16x32_bf16 v[104:107], v[248:251], a[40:43], v[104:107]
ds_read_b128 v[56:59], v1 offset:22528
v_mfma_f32_16x16x32_bf16 v[108:111], v[248:251], a[44:47], v[108:111]
v_max_f32 v225, 0, v225
v_add_f32 v225, 0x3727c5ac, v225
v_mfma_f32_16x16x32_bf16 v[112:115], a[40:43], v[252:255], v[112:115]
ds_read_b128 v[60:63], v1 offset:38912
v_mfma_f32_16x16x32_bf16 v[116:119], a[44:47], v[252:255], v[116:119]
v_rsq_f32 v226, v225
s_waitcnt vmcnt(7) lgkmcnt(3)
v_mfma_f32_16x16x32_bf16 v[72:75], v[40:43], a[48:51], v[72:75]
ds_read_b128 v[64:67], v2 offset:39936
v_cndmask_b32 v227, v224, v226, s[62:63]
s_waitcnt vmcnt(4)
v_cmp_ne_u64 vcc, s[66:67], v[38:39]
s_nop 0
s_cbranch_vccnz LF1_sp4
LF1_ok3:
v_mfma_f32_16x16x32_bf16 v[76:79], v[40:43], a[52:55], v[76:79]
buffer_load_dwordx4 a[80:83], v1, s[4:7], s48 offen offset:2048 sc1
v_mfma_f32_16x16x32_bf16 v[80:83], v[44:47], a[48:51], v[80:83]
ds_read_b128 v[68:71], v2 offset:7168
v_mfma_f32_16x16x32_bf16 v[84:87], v[44:47], a[52:55], v[84:87]
ds_write_b32 v23, v227
ds_read2_b32 v[200:201], v24 offset0:0 offset1:32
v_mfma_f32_16x16x32_bf16 v[88:91], v[48:51], a[48:51], v[88:91]
ds_read_b128 v[240:243], v2 offset:23552
s_add_u32 m0, s21, 131072
s_add_u32 s47, s24, 0
buffer_load_dwordx4 v1, s[4:7], s47 offen offset:0 sc1 lds
v_mfma_f32_16x16x32_bf16 v[92:95], v[48:51], a[52:55], v[92:95]
ds_read2_b32 v[202:203], v24 offset0:16 offset1:48
ds_read_b128 v[208:211], v25 offset:0
s_waitcnt lgkmcnt(7)
v_mfma_f32_16x16x32_bf16 v[96:99], a[48:51], v[52:55], v[96:99]
ds_read_b128 v[244:247], v1 offset:7168
ds_read_b128 v[212:215], v25 offset:128
v_mfma_f32_16x16x32_bf16 v[100:103], a[52:55], v[52:55], v[100:103]
buffer_load_dwordx4 a[84:87], v1, s[4:7], s49 offen offset:2048 sc1
v_mfma_f32_16x16x32_bf16 v[104:107], v[56:59], a[48:51], v[104:107]
ds_read_b128 v[248:251], v1 offset:23552
v_mfma_f32_16x16x32_bf16 v[108:111], v[56:59], a[52:55], v[108:111]
ds_read_b128 v[216:219], v25 offset:64
ds_read_b128 v[220:223], v25 offset:192
v_mfma_f32_16x16x32_bf16 v[112:115], a[48:51], v[60:63], v[112:115]
ds_read_b128 v[252:255], v1 offset:39936
buffer_load_dwordx4 v1, s[4:7], s47 offen offset:1024 sc1 lds
v_mfma_f32_16x16x32_bf16 v[116:119], a[52:55], v[60:63], v[116:119]
s_waitcnt lgkmcnt(9)
v_mul_f32 v204, 0x3eb8aa3b, v201
s_waitcnt lgkmcnt(7)
v_mul_f32 v205, 0x3eb8aa3b, v203
v_mfma_f32_16x16x32_bf16 v[72:75], v[64:67], a[56:59], v[72:75]
ds_read_b128 v[40:43], v2 offset:40960
v_mfma_f32_16x16x32_bf16 v[76:79], v[64:67], a[60:63], v[76:79]
buffer_load_dwordx4 a[88:91], v1, s[4:7], s48 offen offset:3072 sc1
v_mfma_f32_16x16x32_bf16 v[80:83], v[68:71], a[56:59], v[80:83]
ds_read_b128 v[44:47], v2 offset:8192
v_mfma_f32_16x16x32_bf16 v[84:87], v[68:71], a[60:63], v[84:87]
buffer_load_dwordx4 v1, s[4:7], s47 offen offset:2048 sc1 lds
v_mfma_f32_16x16x32_bf16 v[88:91], v[240:243], a[56:59], v[88:91]
ds_read_b128 v[48:51], v2 offset:24576
v_mfma_f32_16x16x32_bf16 v[92:95], v[240:243], a[60:63], v[92:95]
s_waitcnt lgkmcnt(3)
v_mfma_f32_16x16x32_bf16 v[96:99], a[56:59], v[244:247], v[96:99]
ds_read_b128 v[52:55], v1 offset:8192
v_mfma_f32_16x16x32_bf16 v[100:103], a[60:63], v[244:247], v[100:103]
buffer_load_dwordx4 a[92:95], v1, s[4:7], s49 offen offset:3072 sc1
v_mfma_f32_16x16x32_bf16 v[104:107], v[248:251], a[56:59], v[104:107]
ds_read_b128 v[56:59], v1 offset:24576
buffer_load_dwordx4 v1, s[4:7], s47 offen offset:3072 sc1 lds
v_mfma_f32_16x16x32_bf16 v[108:111], v[248:251], a[60:63], v[108:111]
v_mfma_f32_16x16x32_bf16 v[112:115], a[56:59], v[252:255], v[112:115]
ds_read_b128 v[60:63], v1 offset:40960
v_mfma_f32_16x16x32_bf16 v[116:119], a[60:63], v[252:255], v[116:119]
s_waitcnt vmcnt(10) lgkmcnt(3)
v_mfma_f32_16x16x32_bf16 v[72:75], v[40:43], a[64:67], v[72:75]
ds_read_b128 v[64:67], v2 offset:41984
buffer_load_dwordx4 v[224:227], v6, s[4:7], s25 offen offset:0 sc1
v_mfma_f32_16x16x32_bf16 v[76:79], v[40:43], a[68:71], v[76:79]
s_add_u32 s48, s22, 12288
buffer_load_dwordx4 a[96:99], v1, s[4:7], s48 offen offset:0 sc1
v_mfma_f32_16x16x32_bf16 v[80:83], v[44:47], a[64:67], v[80:83]
ds_read_b128 v[68:71], v2 offset:9216
v_mfma_f32_16x16x32_bf16 v[84:87], v[44:47], a[68:71], v[84:87]
v_mfma_f32_16x16x32_bf16 v[88:91], v[48:51], a[64:67], v[88:91]
ds_read_b128 v[240:243], v2 offset:25600
v_mfma_f32_16x16x32_bf16 v[92:95], v[48:51], a[68:71], v[92:95]
s_waitcnt lgkmcnt(3)
v_mfma_f32_16x16x32_bf16 v[96:99], a[64:67], v[52:55], v[96:99]
ds_read_b128 v[244:247], v1 offset:9216
buffer_load_dwordx4 v[228:231], v6, s[4:7], s25 offen offset:1024 sc1
v_mfma_f32_16x16x32_bf16 v[100:103], a[68:71], v[52:55], v[100:103]
s_add_u32 s49, s22, 28672
buffer_load_dwordx4 a[100:103], v1, s[4:7], s49 offen offset:0 sc1
v_mfma_f32_16x16x32_bf16 v[104:107], v[56:59], a[64:67], v[104:107]
ds_read_b128 v[248:251], v1 offset:25600
v_mfma_f32_16x16x32_bf16 v[108:111], v[56:59], a[68:71], v[108:111]
v_mfma_f32_16x16x32_bf16 v[112:115], a[64:67], v[60:63], v[112:115]
ds_read_b128 v[252:255], v1 offset:41984
v_mfma_f32_16x16x32_bf16 v[116:119], a[68:71], v[60:63], v[116:119]
s_waitcnt vmcnt(12) lgkmcnt(3)
v_mfma_f32_16x16x32_bf16 v[72:75], v[64:67], a[72:75], v[72:75]
ds_read_b128 v[40:43], v2 offset:43008
buffer_load_dwordx4 v[232:235], v6, s[4:7], s25 offen offset:2048 sc1
v_mfma_f32_16x16x32_bf16 v[76:79], v[64:67], a[76:79], v[76:79]
buffer_load_dwordx4 a[104:107], v1, s[4:7], s48 offen offset:1024 sc1
v_mfma_f32_16x16x32_bf16 v[80:83], v[68:71], a[72:75], v[80:83]
ds_read_b128 v[44:47], v2 offset:10240
v_mfma_f32_16x16x32_bf16 v[84:87], v[68:71], a[76:79], v[84:87]
v_mfma_f32_16x16x32_bf16 v[88:91], v[240:243], a[72:75], v[88:91]
ds_read_b128 v[48:51], v2 offset:26624
v_mfma_f32_16x16x32_bf16 v[92:95], v[240:243], a[76:79], v[92:95]
s_waitcnt lgkmcnt(3)
v_mfma_f32_16x16x32_bf16 v[96:99], a[72:75], v[244:247], v[96:99]
ds_read_b128 v[52:55], v1 offset:10240
buffer_load_dwordx4 v[236:239], v6, s[4:7], s25 offen offset:3072 sc1
v_mfma_f32_16x16x32_bf16 v[100:103], a[76:79], v[244:247], v[100:103]
buffer_load_dwordx4 a[108:111], v1, s[4:7], s49 offen offset:1024 sc1
v_mfma_f32_16x16x32_bf16 v[104:107], v[248:251], a[72:75], v[104:107]
ds_read_b128 v[56:59], v1 offset:26624
v_mfma_f32_16x16x32_bf16 v[108:111], v[248:251], a[76:79], v[108:111]
v_mfma_f32_16x16x32_bf16 v[112:115], a[72:75], v[252:255], v[112:115]
ds_read_b128 v[60:63], v1 offset:43008
v_mfma_f32_16x16x32_bf16 v[116:119], a[76:79], v[252:255], v[116:119]
s_waitcnt vmcnt(13) lgkmcnt(3)
v_mfma_f32_16x16x32_bf16 v[72:75], v[40:43], a[80:83], v[72:75]
ds_read_b128 v[64:67], v2 offset:44032
v_mfma_f32_16x16x32_bf16 v[76:79], v[40:43], a[84:87], v[76:79]
buffer_load_dwordx4 a[112:115], v1, s[4:7], s48 offen offset:2048 sc1
v_mfma_f32_16x16x32_bf16 v[80:83], v[44:47], a[80:83], v[80:83]
ds_read_b128 v[68:71], v2 offset:11264
v_mfma_f32_16x16x32_bf16 v[84:87], v[44:47], a[84:87], v[84:87]
v_mfma_f32_16x16x32_bf16 v[88:91], v[48:51], a[80:83], v[88:91]
ds_read_b128 v[240:243], v2 offset:27648
v_mfma_f32_16x16x32_bf16 v[92:95], v[48:51], a[84:87], v[92:95]
s_waitcnt lgkmcnt(3)
v_mfma_f32_16x16x32_bf16 v[96:99], a[80:83], v[52:55], v[96:99]
ds_read_b128 v[244:247], v1 offset:11264
v_mfma_f32_16x16x32_bf16 v[100:103], a[84:87], v[52:55], v[100:103]
buffer_load_dwordx4 a[116:119], v1, s[4:7], s49 offen offset:2048 sc1
v_mfma_f32_16x16x32_bf16 v[104:107], v[56:59], a[80:83], v[104:107]
ds_read_b128 v[248:251], v1 offset:27648
v_mfma_f32_16x16x32_bf16 v[108:111], v[56:59], a[84:87], v[108:111]
v_mfma_f32_16x16x32_bf16 v[112:115], a[80:83], v[60:63], v[112:115]
ds_read_b128 v[252:255], v1 offset:44032
v_mfma_f32_16x16x32_bf16 v[116:119], a[84:87], v[60:63], v[116:119]
s_waitcnt vmcnt(11) lgkmcnt(3)
v_mfma_f32_16x16x32_bf16 v[72:75], v[64:67], a[88:91], v[72:75]
ds_read_b128 v[40:43], v2 offset:45056
s_add_u32 m0, s21, 49152
s_add_u32 s47, s19, 0
buffer_load_dwordx4 v1, s[4:7], s47 offen offset:0 sc1 lds
v_mfma_f32_16x16x32_bf16 v[76:79], v[64:67], a[92:95], v[76:79]
buffer_load_dwordx4 a[120:123], v1, s[4:7], s48 offen offset:3072 sc1
v_mfma_f32_16x16x32_bf16 v[80:83], v[68:71], a[88:91], v[80:83]
ds_read_b128 v[44:47], v2 offset:12288
v_mfma_f32_16x16x32_bf16 v[84:87], v[68:71], a[92:95], v[84:87]
v_mfma_f32_16x16x32_bf16 v[88:91], v[240:243], a[88:91], v[88:91]
ds_read_b128 v[48:51], v2 offset:28672
v_mfma_f32_16x16x32_bf16 v[92:95], v[240:243], a[92:95], v[92:95]
buffer_load_dwordx4 v1, s[4:7], s47 offen offset:1024 sc1 lds
s_waitcnt lgkmcnt(3)
v_mfma_f32_16x16x32_bf16 v[96:99], a[88:91], v[244:247], v[96:99]
ds_read_b128 v[52:55], v1 offset:12288
v_mfma_f32_16x16x32_bf16 v[100:103], a[92:95], v[244:247], v[100:103]
buffer_load_dwordx4 a[124:127], v1, s[4:7], s49 offen offset:3072 sc1
v_mfma_f32_16x16x32_bf16 v[104:107], v[248:251], a[88:91], v[104:107]
ds_read_b128 v[56:59], v1 offset:28672
v_mfma_f32_16x16x32_bf16 v[108:111], v[248:251], a[92:95], v[108:111]
s_waitcnt vmcnt(14)
s_barrier
ds_read_b128 v[168:171], v14 offset:0
ds_read_b128 v[172:175], v15 offset:0
ds_read_b128 v[176:179], v14 offset:1024
ds_read_b128 v[180:183], v15 offset:1024
v_mfma_f32_16x16x32_bf16 v[112:115], a[88:91], v[252:255], v[112:115]
ds_read_b128 v[60:63], v1 offset:45056
buffer_load_dwordx4 v1, s[4:7], s47 offen offset:2048 sc1 lds
v_mfma_f32_16x16x32_bf16 v[116:119], a[92:95], v[252:255], v[116:119]
s_waitcnt vmcnt(11) lgkmcnt(7)
v_mfma_f32_16x16x32_bf16 v[72:75], v[40:43], a[96:99], v[72:75]
ds_read_b128 v[64:67], v2 offset:46080
v_mfma_f32_16x16x32_bf16 v[76:79], v[40:43], a[100:103], v[76:79]
buffer_load_dwordx4 v1, s[4:7], s47 offen offset:3072 sc1 lds
v_mfma_f32_16x16x32_bf16 v[80:83], v[44:47], a[96:99], v[80:83]
ds_read_b128 v[68:71], v2 offset:13312
v_mfma_f32_16x16x32_bf16 v[84:87], v[44:47], a[100:103], v[84:87]
v_mfma_f32_16x16x32_bf16 v[88:91], v[48:51], a[96:99], v[88:91]
ds_read_b128 v[240:243], v2 offset:29696
v_mfma_f32_16x16x32_bf16 v[92:95], v[48:51], a[100:103], v[92:95]
s_waitcnt lgkmcnt(6)
v_mfma_f32_16x16x32_bf16 v[120:123], v[168:171], v[172:175], 0
ds_read_b128 v[168:171], v14 offset:2048
ds_read_b128 v[172:175], v15 offset:2048
s_waitcnt lgkmcnt(5)
v_mfma_f32_16x16x32_bf16 v[96:99], a[96:99], v[52:55], v[96:99]
ds_read_b128 v[244:247], v1 offset:13312
s_add_u32 m0, s21, 114688
s_add_u32 s47, s19, 16384
buffer_load_dwordx4 v1, s[4:7], s47 offen offset:0 sc1 lds
v_mfma_f32_16x16x32_bf16 v[100:103], a[100:103], v[52:55], v[100:103]
v_mfma_f32_16x16x32_bf16 v[120:123], v[176:179], v[180:183], v[120:123]
ds_read_b128 v[176:179], v14 offset:3072
ds_read_b128 v[180:183], v15 offset:3072
v_mfma_f32_16x16x32_bf16 v[104:107], v[56:59], a[96:99], v[104:107]
ds_read_b128 v[248:251], v1 offset:29696
v_mfma_f32_16x16x32_bf16 v[108:111], v[56:59], a[100:103], v[108:111]
buffer_load_dwordx4 v1, s[4:7], s47 offen offset:1024 sc1 lds
s_waitcnt lgkmcnt(4)
v_mfma_f32_16x16x32_bf16 v[120:123], v[168:171], v[172:175], v[120:123]
ds_read_b128 v[168:171], v14 offset:4096
ds_read_b128 v[172:175], v15 offset:4096
v_mfma_f32_16x16x32_bf16 v[112:115], a[96:99], v[60:63], v[112:115]
ds_read_b128 v[252:255], v1 offset:46080
v_mfma_f32_16x16x32_bf16 v[116:119], a[100:103], v[60:63], v[116:119]
s_waitcnt lgkmcnt(4)
v_mfma_f32_16x16x32_bf16 v[120:123], v[176:179], v[180:183], v[120:123]
ds_read_b128 v[176:179], v14 offset:5120
ds_read_b128 v[180:183], v15 offset:5120
s_waitcnt vmcnt(10)
v_mfma_f32_16x16x32_bf16 v[72:75], v[64:67], a[104:107], v[72:75]
ds_read_b128 v[40:43], v2 offset:47104
buffer_load_dwordx4 v1, s[4:7], s47 offen offset:2048 sc1 lds
v_mfma_f32_16x16x32_bf16 v[76:79], v[64:67], a[108:111], v[76:79]
v_mfma_f32_16x16x32_bf16 v[80:83], v[68:71], a[104:107], v[80:83]
ds_read_b128 v[44:47], v2 offset:14336
v_mfma_f32_16x16x32_bf16 v[84:87], v[68:71], a[108:111], v[84:87]
v_mfma_f32_16x16x32_bf16 v[88:91], v[240:243], a[104:107], v[88:91]
ds_read_b128 v[48:51], v2 offset:30720
v_mfma_f32_16x16x32_bf16 v[92:95], v[240:243], a[108:111], v[92:95]
buffer_load_dwordx4 v1, s[4:7], s47 offen offset:3072 sc1 lds
s_waitcnt lgkmcnt(6)
v_mfma_f32_16x16x32_bf16 v[120:123], v[168:171], v[172:175], v[120:123]
ds_read_b128 v[168:171], v14 offset:6144
ds_read_b128 v[172:175], v15 offset:6144
s_waitcnt lgkmcnt(7)
v_mfma_f32_16x16x32_bf16 v[96:99], a[104:107], v[244:247], v[96:99]
ds_read_b128 v[52:55], v1 offset:14336
v_mfma_f32_16x16x32_bf16 v[100:103], a[108:111], v[244:247], v[100:103]
s_waitcnt lgkmcnt(6)
v_mfma_f32_16x16x32_bf16 v[120:123], v[176:179], v[180:183], v[120:123]
ds_read_b128 v[176:179], v14 offset:7168
ds_read_b128 v[180:183], v15 offset:7168
v_mfma_f32_16x16x32_bf16 v[104:107], v[248:251], a[104:107], v[104:107]
ds_read_b128 v[56:59], v1 offset:30720
buffer_load_dword v29, v1, s[4:7], s26 offen offset:0 sc1
v_mfma_f32_16x16x32_bf16 v[108:111], v[248:251], a[108:111], v[108:111]
s_waitcnt lgkmcnt(4)
v_mfma_f32_16x16x32_bf16 v[120:123], v[168:171], v[172:175], v[120:123]
ds_read_b128 v[168:171], v14 offset:8192
ds_read_b128 v[172:175], v15 offset:8192
v_mfma_f32_16x16x32_bf16 v[112:115], a[104:107], v[252:255], v[112:115]
ds_read_b128 v[60:63], v1 offset:47104
v_mfma_f32_16x16x32_bf16 v[116:119], a[108:111], v[252:255], v[116:119]
buffer_load_dword v29, v4, s[4:7], s26 offen offset:0 sc1
s_waitcnt lgkmcnt(4)
v_mfma_f32_16x16x32_bf16 v[120:123], v[176:179], v[180:183], v[120:123]
ds_read_b128 v[176:179], v14 offset:9216
ds_read_b128 v[180:183], v15 offset:9216
s_waitcnt vmcnt(12)
v_mfma_f32_16x16x32_bf16 v[72:75], v[40:43], a[112:115], v[72:75]
ds_read_b128 v[64:67], v2 offset:48128
v_mfma_f32_16x16x32_bf16 v[76:79], v[40:43], a[116:119], v[76:79]
v_mfma_f32_16x16x32_bf16 v[80:83], v[44:47], a[112:115], v[80:83]
ds_read_b128 v[68:71], v2 offset:15360
v_mfma_f32_16x16x32_bf16 v[84:87], v[44:47], a[116:119], v[84:87]
buffer_load_dword v29, v1, s[4:7], s28 offen offset:0 sc1
v_mfma_f32_16x16x32_bf16 v[88:91], v[48:51], a[112:115], v[88:91]
ds_read_b128 v[240:243], v2 offset:31744
v_mfma_f32_16x16x32_bf16 v[92:95], v[48:51], a[116:119], v[92:95]
s_waitcnt lgkmcnt(6)
v_mfma_f32_16x16x32_bf16 v[120:123], v[168:171], v[172:175], v[120:123]
ds_read_b128 v[168:171], v14 offset:10240
ds_read_b128 v[172:175], v15 offset:10240
s_waitcnt lgkmcnt(7)
v_mfma_f32_16x16x32_bf16 v[96:99], a[112:115], v[52:55], v[96:99]
ds_read_b128 v[244:247], v1 offset:15360
buffer_load_dword v29, v4, s[4:7], s28 offen offset:0 sc1
v_mfma_f32_16x16x32_bf16 v[100:103], a[116:119], v[52:55], v[100:103]
s_waitcnt lgkmcnt(6)
v_mfma_f32_16x16x32_bf16 v[120:123], v[176:179], v[180:183], v[120:123]
ds_read_b128 v[176:179], v14 offset:11264
ds_read_b128 v[180:183], v15 offset:11264
v_mfma_f32_16x16x32_bf16 v[104:107], v[56:59], a[112:115], v[104:107]
ds_read_b128 v[248:251], v1 offset:31744
v_mfma_f32_16x16x32_bf16 v[108:111], v[56:59], a[116:119], v[108:111]
buffer_load_dword v29, v7, s[4:7], s29 offen offset:0 sc1
s_waitcnt lgkmcnt(4)
v_mfma_f32_16x16x32_bf16 v[120:123], v[168:171], v[172:175], v[120:123]
ds_read_b128 v[168:171], v14 offset:12288
ds_read_b128 v[172:175], v15 offset:12288
v_mfma_f32_16x16x32_bf16 v[112:115], a[112:115], v[60:63], v[112:115]
ds_read_b128 v[252:255], v1 offset:48128
v_mfma_f32_16x16x32_bf16 v[116:119], a[116:119], v[60:63], v[116:119]
s_waitcnt lgkmcnt(4)
v_mfma_f32_16x16x32_bf16 v[120:123], v[176:179], v[180:183], v[120:123]
ds_read_b128 v[176:179], v14 offset:13312
ds_read_b128 v[180:183], v15 offset:13312
s_waitcnt vmcnt(11)
v_mfma_f32_16x16x32_bf16 v[72:75], v[64:67], a[120:123], v[72:75]
buffer_load_dword v29, v26, s[4:7], s37 offen offset:512 sc1
v_mfma_f32_16x16x32_bf16 v[76:79], v[64:67], a[124:127], v[76:79]
v_mfma_f32_16x16x32_bf16 v[80:83], v[68:71], a[120:123], v[80:83]
v_mfma_f32_16x16x32_bf16 v[84:87], v[68:71], a[124:127], v[84:87]
v_mfma_f32_16x16x32_bf16 v[88:91], v[240:243], a[120:123], v[88:91]
buffer_load_dword v29, v26, s[4:7], s39 offen offset:512 sc1
v_mfma_f32_16x16x32_bf16 v[92:95], v[240:243], a[124:127], v[92:95]
s_waitcnt lgkmcnt(3)
v_mfma_f32_16x16x32_bf16 v[120:123], v[168:171], v[172:175], v[120:123]
ds_read_b128 v[168:171], v14 offset:14336
ds_read_b128 v[172:175], v15 offset:14336
s_waitcnt lgkmcnt(4)
v_mfma_f32_16x16x32_bf16 v[96:99], a[120:123], v[244:247], v[96:99]
v_mfma_f32_16x16x32_bf16 v[100:103], a[124:127], v[244:247], v[100:103]
s_waitcnt lgkmcnt(2)
v_mfma_f32_16x16x32_bf16 v[120:123], v[176:179], v[180:183], v[120:123]
ds_read_b128 v[176:179], v14 offset:15360
ds_read_b128 v[180:183], v15 offset:15360
v_mfma_f32_16x16x32_bf16 v[104:107], v[248:251], a[120:123], v[104:107]
s_getpc_b64 s[64:65]
LF1_pc5:
s_lshr_b32 s51, s2, 3
s_lshl_b32 s51, s51, 2
s_add_u32 s51, s51, s14
s_lshl_b32 s51, s51, 8
s_add_u32 s51, s51, 0
v_lshrrev_b32 v192, 2, v1
v_add_u32 v192, s51, v192
global_load_dword v29, v192, s[64:65]
v_mfma_f32_16x16x32_bf16 v[108:111], v[248:251], a[124:127], v[108:111]
s_waitcnt lgkmcnt(2)
v_mfma_f32_16x16x32_bf16 v[120:123], v[168:171], v[172:175], v[120:123]
v_mfma_f32_16x16x32_bf16 v[112:115], a[120:123], v[252:255], v[112:115]
v_mfma_f32_16x16x32_bf16 v[116:119], a[124:127], v[252:255], v[116:119]
s_waitcnt lgkmcnt(0)
v_mfma_f32_16x16x32_bf16 v[120:123], v[176:179], v[180:183], v[120:123]
LF1_tail:
v_pk_add_f32 v[224:225], v[224:225], v[226:227]
v_pk_add_f32 v[228:229], v[228:229], v[230:231]
v_pk_add_f32 v[232:233], v[232:233], v[234:235]
v_pk_add_f32 v[236:237], v[236:237], v[238:239]
v_pk_add_f32 v[224:225], v[224:225], v[228:229]
v_pk_add_f32 v[232:233], v[232:233], v[236:237]
v_pk_add_f32 v[224:225], v[224:225], v[232:233]
v_mov_b32 v226, v224
v_mov_b32 v227, v225
s_nop 0
v_permlane32_swap_b32 v224, v226
v_permlane32_swap_b32 v225, v227
v_add_f32 v224, v224, v226
v_add_f32 v225, v225, v227
v_mul_f32 v224, 0xbb000000, v224
v_mul_f32 v225, 0x3b000000, v225
v_fma_f32 v225, -v224, v224, v225
v_max_f32 v225, 0, v225
v_add_f32 v225, 0x3727c5ac, v225
v_rsq_f32 v226, v225
s_nop 0
v_cndmask_b32 v227, v224, v226, s[62:63]
ds_write_b32 v23, v227 offset:256
v_add_u32 v226, s56, v30
v_add_u32 v228, s56, v226
v_add_u32 v230, s56, v228
ds_read2_b32 v[224:225], v30 offset0:0 offset1:32
ds_read2_b32 v[226:227], v226 offset0:0 offset1:32
ds_read2_b32 v[228:229], v228 offset0:0 offset1:32
ds_read2_b32 v[230:231], v230 offset0:0 offset1:32
v_pk_fma_f32 v[92:93], v[202:203], v[152:153], v[92:93] op_sel:[0,0,0] op_sel_hi:[0,1,1]
v_pk_fma_f32 v[94:95], v[202:203], v[154:155], v[94:95] op_sel:[0,0,0] op_sel_hi:[0,1,1]
v_pk_mul_f32 v[92:93], v[202:203], v[92:93] op_sel:[1,0] op_sel_hi:[1,1]
v_pk_mul_f32 v[94:95], v[202:203], v[94:95] op_sel:[1,0] op_sel_hi:[1,1]
v_cvt_pk_bf16_f32 v172, v92, v93
v_cvt_pk_bf16_f32 v173, v94, v95
v_pk_fma_f32 v[100:101], v[216:217], v[34:35], v[100:101] op_sel:[0,0,0] op_sel_hi:[1,0,1]
v_pk_fma_f32 v[102:103], v[218:219], v[34:35], v[102:103] op_sel:[0,0,0] op_sel_hi:[1,0,1]
v_pk_mul_f32 v[100:101], v[220:221], v[100:101] op_sel:[0,0] op_sel_hi:[1,1]
v_pk_mul_f32 v[102:103], v[222:223], v[102:103] op_sel:[0,0] op_sel_hi:[1,1]
v_cvt_pk_bf16_f32 v184, v100, v101
v_cvt_pk_bf16_f32 v185, v102, v103
ds_write_b64 v20, v[172:173] offset:0
ds_write_b64 v20, v[184:185] offset:8
v_pk_fma_f32 v[108:109], v[202:203], v[156:157], v[108:109] op_sel:[0,0,0] op_sel_hi:[0,1,1]
v_pk_fma_f32 v[110:111], v[202:203], v[158:159], v[110:111] op_sel:[0,0,0] op_sel_hi:[0,1,1]
v_pk_mul_f32 v[108:109], v[202:203], v[108:109] op_sel:[1,0] op_sel_hi:[1,1]
v_pk_mul_f32 v[110:111], v[202:203], v[110:111] op_sel:[1,0] op_sel_hi:[1,1]
v_cvt_pk_bf16_f32 v178, v108, v109
v_cvt_pk_bf16_f32 v179, v110, v111
v_pk_fma_f32 v[116:117], v[216:217], v[34:35], v[116:117] op_sel:[0,1,0] op_sel_hi:[1,1,1]
v_pk_fma_f32 v[118:119], v[218:219], v[34:35], v[118:119] op_sel:[0,1,0] op_sel_hi:[1,1,1]
v_pk_mul_f32 v[116:117], v[220:221], v[116:117] op_sel:[0,0] op_sel_hi:[1,1]
v_pk_mul_f32 v[118:119], v[222:223], v[118:119] op_sel:[0,0] op_sel_hi:[1,1]
v_cvt_pk_bf16_f32 v190, v116, v117
v_cvt_pk_bf16_f32 v191, v118, v119
ds_write_b64 v20, v[178:179] offset:1024
ds_write_b64 v20, v[190:191] offset:1032
s_waitcnt lgkmcnt(7)
v_fmac_f32 v120, v224, v160
s_waitcnt lgkmcnt(6)
v_fmac_f32 v121, v226, v161
s_waitcnt lgkmcnt(5)
v_fmac_f32 v122, v228, v162
s_waitcnt lgkmcnt(4)
v_fmac_f32 v123, v230, v163
v_mul_f32 v120, v225, v120
v_mul_f32 v121, v227, v121
v_mul_f32 v122, v229, v122
v_mul_f32 v123, v231, v123
v_cvt_pk_bf16_f32 v120, v120, v121
v_cvt_pk_bf16_f32 v121, v122, v123
ds_write_b64 v21, v[120:121]
v_pk_fma_f32 v[88:89], v[200:201], v[152:153], v[88:89] op_sel:[0,0,0] op_sel_hi:[0,1,1]
v_pk_fma_f32 v[90:91], v[200:201], v[154:155], v[90:91] op_sel:[0,0,0] op_sel_hi:[0,1,1]
v_pk_mul_f32 v[88:89], v[200:201], v[88:89] op_sel:[1,0] op_sel_hi:[1,1]
v_pk_mul_f32 v[90:91], v[200:201], v[90:91] op_sel:[1,0] op_sel_hi:[1,1]
v_cvt_pk_bf16_f32 v170, v88, v89
v_cvt_pk_bf16_f32 v171, v90, v91
v_pk_fma_f32 v[96:97], v[208:209], v[34:35], v[96:97] op_sel:[0,0,0] op_sel_hi:[1,0,1]
v_pk_fma_f32 v[98:99], v[210:211], v[34:35], v[98:99] op_sel:[0,0,0] op_sel_hi:[1,0,1]
v_pk_mul_f32 v[96:97], v[212:213], v[96:97] op_sel:[0,0] op_sel_hi:[1,1]
v_pk_mul_f32 v[98:99], v[214:215], v[98:99] op_sel:[0,0] op_sel_hi:[1,1]
v_cvt_pk_bf16_f32 v182, v96, v97
v_cvt_pk_bf16_f32 v183, v98, v99
v_pk_fma_f32 v[76:77], v[202:203], v[144:145], v[76:77] op_sel:[0,0,0] op_sel_hi:[0,1,1]
v_pk_fma_f32 v[78:79], v[202:203], v[146:147], v[78:79] op_sel:[0,0,0] op_sel_hi:[0,1,1]
v_cvt_pk_bf16_f32 v76, v76, v77
v_cvt_pk_bf16_f32 v77, v78, v79
v_pk_fma_f32 v[72:73], v[200:201], v[144:145], v[72:73] op_sel:[0,0,0] op_sel_hi:[0,1,1]
v_pk_fma_f32 v[74:75], v[200:201], v[146:147], v[74:75] op_sel:[0,0,0] op_sel_hi:[0,1,1]
v_cvt_pk_bf16_f32 v72, v72, v73
v_cvt_pk_bf16_f32 v73, v74, v75
v_pk_fma_f32 v[104:105], v[200:201], v[156:157], v[104:105] op_sel:[0,0,0] op_sel_hi:[0,1,1]
v_pk_fma_f32 v[106:107], v[200:201], v[158:159], v[106:107] op_sel:[0,0,0] op_sel_hi:[0,1,1]
v_pk_mul_f32 v[104:105], v[200:201], v[104:105] op_sel:[1,0] op_sel_hi:[1,1]
v_pk_mul_f32 v[106:107], v[200:201], v[106:107] op_sel:[1,0] op_sel_hi:[1,1]
v_cvt_pk_bf16_f32 v176, v104, v105
v_cvt_pk_bf16_f32 v177, v106, v107
v_pk_fma_f32 v[112:113], v[208:209], v[34:35], v[112:113] op_sel:[0,1,0] op_sel_hi:[1,1,1]
v_pk_fma_f32 v[114:115], v[210:211], v[34:35], v[114:115] op_sel:[0,1,0] op_sel_hi:[1,1,1]
v_pk_mul_f32 v[112:113], v[212:213], v[112:113] op_sel:[0,0] op_sel_hi:[1,1]
v_pk_mul_f32 v[114:115], v[214:215], v[114:115] op_sel:[0,0] op_sel_hi:[1,1]
v_cvt_pk_bf16_f32 v188, v112, v113
v_cvt_pk_bf16_f32 v189, v114, v115
v_pk_fma_f32 v[84:85], v[202:203], v[148:149], v[84:85] op_sel:[0,0,0] op_sel_hi:[0,1,1]
v_pk_fma_f32 v[86:87], v[202:203], v[150:151], v[86:87] op_sel:[0,0,0] op_sel_hi:[0,1,1]
v_cvt_pk_bf16_f32 v84, v84, v85
v_cvt_pk_bf16_f32 v85, v86, v87
v_pk_fma_f32 v[80:81], v[200:201], v[148:149], v[80:81] op_sel:[0,0,0] op_sel_hi:[0,1,1]
v_pk_fma_f32 v[82:83], v[200:201], v[150:151], v[82:83] op_sel:[0,0,0] op_sel_hi:[0,1,1]
v_cvt_pk_bf16_f32 v80, v80, v81
v_cvt_pk_bf16_f32 v81, v82, v83
s_waitcnt lgkmcnt(0)
s_barrier
ds_read_b64 v[168:169], v22 offset:0
ds_read_b64 v[180:181], v22 offset:8
ds_read_b64 v[174:175], v22 offset:1024
ds_read_b64 v[186:187], v22 offset:1032
v_mfma_f32_16x16x16_bf16 v[224:227], v[170:171], v[76:77], v[136:139]
s_add_u32 m0, s21, 98304
s_add_u32 s47, s18, 0
buffer_load_dwordx4 v1, s[4:7], s47 offen offset:0 sc1 lds
v_mfma_f32_16x16x16_bf16 v[228:231], v[172:173], v[76:77], v[132:135]
v_mfma_f32_16x16x16_bf16 v[240:243], v[176:177], v[84:85], v[136:139]
v_mfma_f32_16x16x16_bf16 v[244:247], v[178:179], v[84:85], v[132:135]
s_waitcnt lgkmcnt(3)
v_mfma_f32_16x16x16_bf16 v[40:43], v[168:169], v[72:73], v[140:143]
v_mfma_f32_16x16x16_bf16 v[44:47], v[170:171], v[72:73], v[132:135]
s_waitcnt lgkmcnt(1)
v_mfma_f32_16x16x16_bf16 v[56:59], v[174:175], v[80:81], v[140:143]
buffer_load_dwordx4 v1, s[4:7], s47 offen offset:1024 sc1 lds
v_mfma_f32_16x16x16_bf16 v[60:63], v[176:177], v[80:81], v[132:135]
v_max3_f32 v232, v224, v225, v226
v_max3_f32 v233, v227, v228, v229
v_max3_f32 v232, v232, v230, v231
v_max_f32 v232, v232, v233
v_mov_b32 v233, v232
buffer_load_dwordx4 v1, s[4:7], s47 offen offset:2048 sc1 lds
v_max3_f32 v248, v240, v241, v242
v_max3_f32 v249, v243, v244, v245
v_max3_f32 v248, v248, v246, v247
v_max_f32 v248, v248, v249
v_mov_b32 v249, v248
v_max3_f32 v48, v40, v41, v42
buffer_load_dwordx4 v1, s[4:7], s47 offen offset:3072 sc1 lds
v_max3_f32 v49, v43, v44, v45
v_max3_f32 v48, v48, v46, v47
v_max_f32 v48, v48, v49
v_mov_b32 v49, v48
v_max3_f32 v64, v56, v57, v58
v_max3_f32 v65, v59, v60, v61
v_max3_f32 v64, v64, v62, v63
s_add_u32 m0, s21, 65536
s_add_u32 s47, s18, 16384
buffer_load_dwordx4 v1, s[4:7], s47 offen offset:0 sc1 lds
v_max_f32 v64, v64, v65
v_mov_b32 v65, v64
v_permlane32_swap_b32 v232, v233
v_max_f32 v232, v232, v233
v_mov_b32 v233, v232
v_permlane32_swap_b32 v248, v249
buffer_load_dwordx4 v1, s[4:7], s47 offen offset:1024 sc1 lds
v_max_f32 v248, v248, v249
v_mov_b32 v249, v248
v_permlane32_swap_b32 v48, v49
v_max_f32 v48, v48, v49
v_mov_b32 v49, v48
v_permlane32_swap_b32 v64, v65
buffer_load_dwordx4 v1, s[4:7], s47 offen offset:2048 sc1 lds
v_max_f32 v64, v64, v65
v_mov_b32 v65, v64
v_permlane16_swap_b32 v232, v233
v_max_f32 v232, v232, v233
v_mul_f32 v232, v205, v232
v_permlane16_swap_b32 v248, v249
buffer_load_dwordx4 v1, s[4:7], s47 offen offset:3072 sc1 lds
v_max_f32 v248, v248, v249
v_mul_f32 v248, v205, v248
v_permlane16_swap_b32 v48, v49
v_max_f32 v48, v48, v49
v_mul_f32 v48, v204, v48
v_permlane16_swap_b32 v64, v65
v_max_f32 v64, v64, v65
s_add_u32 m0, s21, 81920
s_add_u32 s47, s18, 32768
buffer_load_dwordx4 v1, s[4:7], s47 offen offset:0 sc1 lds
v_mul_f32 v64, v204, v64
v_pk_fma_f32 v[224:225], v[224:225], v[204:205], v[232:233] op_sel:[0,1,0] op_sel_hi:[1,1,0] neg_lo:[0,0,1] neg_hi:[0,0,1]
v_pk_fma_f32 v[226:227], v[226:227], v[204:205], v[232:233] op_sel:[0,1,0] op_sel_hi:[1,1,0] neg_lo:[0,0,1] neg_hi:[0,0,1]
v_pk_fma_f32 v[228:229], v[228:229], v[204:205], v[232:233] op_sel:[0,1,0] op_sel_hi:[1,1,0] neg_lo:[0,0,1] neg_hi:[0,0,1]
v_pk_fma_f32 v[230:231], v[230:231], v[204:205], v[232:233] op_sel:[0,1,0] op_sel_hi:[1,1,0] neg_lo:[0,0,1] neg_hi:[0,0,1]
v_pk_fma_f32 v[240:241], v[240:241], v[204:205], v[248:249] op_sel:[0,1,0] op_sel_hi:[1,1,0] neg_lo:[0,0,1] neg_hi:[0,0,1]
buffer_load_dwordx4 v1, s[4:7], s47 offen offset:1024 sc1 lds
v_pk_fma_f32 v[242:243], v[242:243], v[204:205], v[248:249] op_sel:[0,1,0] op_sel_hi:[1,1,0] neg_lo:[0,0,1] neg_hi:[0,0,1]
v_pk_fma_f32 v[244:245], v[244:245], v[204:205], v[248:249] op_sel:[0,1,0] op_sel_hi:[1,1,0] neg_lo:[0,0,1] neg_hi:[0,0,1]
v_pk_fma_f32 v[246:247], v[246:247], v[204:205], v[248:249] op_sel:[0,1,0] op_sel_hi:[1,1,0] neg_lo:[0,0,1] neg_hi:[0,0,1]
v_pk_fma_f32 v[40:41], v[40:41], v[204:205], v[48:49] op_sel:[0,0,0] op_sel_hi:[1,0,0] neg_lo:[0,0,1] neg_hi:[0,0,1]
v_pk_fma_f32 v[42:43], v[42:43], v[204:205], v[48:49] op_sel:[0,0,0] op_sel_hi:[1,0,0] neg_lo:[0,0,1] neg_hi:[0,0,1]
v_pk_fma_f32 v[44:45], v[44:45], v[204:205], v[48:49] op_sel:[0,0,0] op_sel_hi:[1,0,0] neg_lo:[0,0,1] neg_hi:[0,0,1]
buffer_load_dwordx4 v1, s[4:7], s47 offen offset:2048 sc1 lds
v_pk_fma_f32 v[46:47], v[46:47], v[204:205], v[48:49] op_sel:[0,0,0] op_sel_hi:[1,0,0] neg_lo:[0,0,1] neg_hi:[0,0,1]
v_pk_fma_f32 v[56:57], v[56:57], v[204:205], v[64:65] op_sel:[0,0,0] op_sel_hi:[1,0,0] neg_lo:[0,0,1] neg_hi:[0,0,1]
v_pk_fma_f32 v[58:59], v[58:59], v[204:205], v[64:65] op_sel:[0,0,0] op_sel_hi:[1,0,0] neg_lo:[0,0,1] neg_hi:[0,0,1]
v_pk_fma_f32 v[60:61], v[60:61], v[204:205], v[64:65] op_sel:[0,0,0] op_sel_hi:[1,0,0] neg_lo:[0,0,1] neg_hi:[0,0,1]
v_pk_fma_f32 v[62:63], v[62:63], v[204:205], v[64:65] op_sel:[0,0,0] op_sel_hi:[1,0,0] neg_lo:[0,0,1] neg_hi:[0,0,1]
v_exp_f32 v224, v224
buffer_load_dwordx4 v1, s[4:7], s47 offen offset:3072 sc1 lds
v_exp_f32 v225, v225
v_exp_f32 v226, v226
v_exp_f32 v227, v227
v_exp_f32 v228, v228
v_exp_f32 v229, v229
v_exp_f32 v230, v230
v_exp_f32 v231, v231
s_add_u32 m0, s21, 0
s_add_u32 s47, s18, 49152
buffer_load_dwordx4 v1, s[4:7], s47 offen offset:0 sc1 lds
v_exp_f32 v240, v240
v_exp_f32 v241, v241
v_exp_f32 v242, v242
v_exp_f32 v243, v243
v_exp_f32 v244, v244
v_exp_f32 v245, v245
buffer_load_dwordx4 v1, s[4:7], s47 offen offset:1024 sc1 lds
v_exp_f32 v246, v246
v_exp_f32 v247, v247
v_exp_f32 v40, v40
v_exp_f32 v41, v41
v_exp_f32 v42, v42
v_exp_f32 v43, v43
buffer_load_dwordx4 v1, s[4:7], s47 offen offset:2048 sc1 lds
v_exp_f32 v44, v44
v_exp_f32 v45, v45
v_exp_f32 v46, v46
v_exp_f32 v47, v47
v_exp_f32 v56, v56
v_exp_f32 v57, v57
buffer_load_dwordx4 v1, s[4:7], s47 offen offset:3072 sc1 lds
v_exp_f32 v58, v58
v_exp_f32 v59, v59
v_exp_f32 v60, v60
v_exp_f32 v61, v61
v_exp_f32 v62, v62
v_exp_f32 v63, v63
v_cvt_pk_bf16_f32 v234, v224, v225
v_cvt_pk_bf16_f32 v235, v226, v227
v_cvt_pk_bf16_f32 v236, v228, v229
v_cvt_pk_bf16_f32 v237, v230, v231
v_cvt_pk_bf16_f32 v250, v240, v241
v_cvt_pk_bf16_f32 v251, v242, v243
v_cvt_pk_bf16_f32 v252, v244, v245
v_cvt_pk_bf16_f32 v253, v246, v247
v_cvt_pk_bf16_f32 v50, v40, v41
v_cvt_pk_bf16_f32 v51, v42, v43
v_cvt_pk_bf16_f32 v52, v44, v45
v_cvt_pk_bf16_f32 v53, v46, v47
v_cvt_pk_bf16_f32 v66, v56, v57
v_cvt_pk_bf16_f32 v67, v58, v59
v_cvt_pk_bf16_f32 v68, v60, v61
v_cvt_pk_bf16_f32 v69, v62, v63
v_mfma_f32_16x16x32_bf16 v[228:231], v[164:167], v[234:237], 0
v_mfma_f32_16x16x32_bf16 v[224:227], v[182:185], v[234:237], 0
v_mfma_f32_16x16x32_bf16 v[244:247], v[164:167], v[250:253], 0
v_mfma_f32_16x16x32_bf16 v[240:243], v[188:191], v[250:253], 0
v_mfma_f32_16x16x32_bf16 v[44:47], v[164:167], v[50:53], 0
v_mfma_f32_16x16x32_bf16 v[40:43], v[180:183], v[50:53], 0
v_mfma_f32_16x16x32_bf16 v[60:63], v[164:167], v[66:69], 0
s_waitcnt lgkmcnt(0)
v_mfma_f32_16x16x32_bf16 v[56:59], v[186:189], v[66:69], 0
v_rcp_f32 v228, v228
s_nop 0
v_rcp_f32 v244, v244
s_nop 0
v_rcp_f32 v44, v44
s_nop 0
v_rcp_f32 v60, v60
v_pk_mul_f32 v[224:225], v[228:229], v[224:225] op_sel_hi:[0,1]
v_pk_mul_f32 v[226:227], v[228:229], v[226:227] op_sel_hi:[0,1]
v_pk_mul_f32 v[240:241], v[244:245], v[240:241] op_sel_hi:[0,1]
v_pk_mul_f32 v[242:243], v[244:245], v[242:243] op_sel_hi:[0,1]
v_pk_mul_f32 v[40:41], v[44:45], v[40:41] op_sel_hi:[0,1]
v_pk_mul_f32 v[42:43], v[44:45], v[42:43] op_sel_hi:[0,1]
v_pk_mul_f32 v[56:57], v[60:61], v[56:57] op_sel_hi:[0,1]
v_pk_mul_f32 v[58:59], v[60:61], v[58:59] op_sel_hi:[0,1]
v_cvt_pk_bf16_f32 v196, v224, v225
v_cvt_pk_bf16_f32 v197, v226, v227
v_cvt_pk_bf16_f32 v198, v240, v241
v_cvt_pk_bf16_f32 v199, v242, v243
v_cvt_pk_bf16_f32 v192, v40, v41
v_cvt_pk_bf16_f32 v193, v42, v43
v_cvt_pk_bf16_f32 v194, v56, v57
v_cvt_pk_bf16_f32 v195, v58, v59
s_add_u32 s48, s26, 16384
buffer_store_dwordx4 v[192:195], v1, s[4:7], s26 offen
buffer_store_dwordx4 v[196:199], v1, s[4:7], s48 offen
s_waitcnt vmcnt(0)
buffer_store_dwordx2 v[36:37], v26, s[4:7], s36 offen offset:512
v_lshlrev_b32 v168, 16, v124
v_and_b32 v169, 0xffff0000, v124
v_lshlrev_b32 v170, 16, v125
v_and_b32 v171, 0xffff0000, v125
v_lshlrev_b32 v172, 16, v126
v_and_b32 v173, 0xffff0000, v126
v_lshlrev_b32 v174, 16, v127
v_and_b32 v175, 0xffff0000, v127
v_lshlrev_b32 v176, 16, v128
v_and_b32 v177, 0xffff0000, v128
v_lshlrev_b32 v178, 16, v129
v_and_b32 v179, 0xffff0000, v129
v_lshlrev_b32 v180, 16, v130
v_and_b32 v181, 0xffff0000, v130
v_lshlrev_b32 v182, 16, v131
v_and_b32 v183, 0xffff0000, v131
buffer_load_dwordx2 v[38:39], v17, s[4:7], s37 offen offset:512 sc1
buffer_load_dwordx2 v[252:253], v17, s[4:7], s37 offen offset:512 sc1
s_waitcnt vmcnt(1)
v_cmp_ne_u64 vcc, s[66:67], v[38:39]
s_nop 0
s_cbranch_vccnz LF1_sp7
LF1_ok6:
s_add_u32 s48, s27, 0
buffer_load_dwordx4 a[0:3], v1, s[4:7], s48 offen offset:0 sc1
buffer_load_dwordx4 a[4:7], v4, s[4:7], s48 offen offset:0 sc1
buffer_load_dwordx4 a[8:11], v1, s[4:7], s48 offen offset:1024 sc1
buffer_load_dwordx4 a[12:15], v4, s[4:7], s48 offen offset:1024 sc1
buffer_load_dwordx4 a[16:19], v1, s[4:7], s48 offen offset:2048 sc1
buffer_load_dwordx4 a[20:23], v4, s[4:7], s48 offen offset:2048 sc1
buffer_load_dwordx4 a[24:27], v1, s[4:7], s48 offen offset:3072 sc1
buffer_load_dwordx4 a[28:31], v4, s[4:7], s48 offen offset:3072 sc1
s_add_u32 s48, s27, 4096
buffer_load_dwordx4 a[32:35], v1, s[4:7], s48 offen offset:0 sc1
buffer_load_dwordx4 a[36:39], v4, s[4:7], s48 offen offset:0 sc1
s_barrier
ds_read_b128 v[40:43], v9 offset:32768
ds_read_b128 v[44:47], v9 offset:33792
ds_read_b128 v[48:51], v9 offset:34816
ds_read_b128 v[52:55], v9 offset:35840
s_waitcnt vmcnt(8) lgkmcnt(2)
v_mfma_f32_16x16x32_bf16 v[168:171], v[40:43], a[0:3], v[168:171]
ds_read_b128 v[56:59], v9 offset:36864
v_mfma_f32_16x16x32_bf16 v[176:179], v[40:43], a[4:7], v[176:179]
buffer_load_dwordx4 a[40:43], v1, s[4:7], s48 offen offset:1024 sc1
v_mfma_f32_16x16x32_bf16 v[172:175], v[44:47], a[0:3], v[172:175]
ds_read_b128 v[60:63], v9 offset:37888
v_mfma_f32_16x16x32_bf16 v[180:183], v[44:47], a[4:7], v[180:183]
s_waitcnt lgkmcnt(2)
v_mfma_f32_16x16x32_bf16 v[184:187], v[48:51], a[0:3], 0
ds_read_b128 v[64:67], v9 offset:38912
v_mfma_f32_16x16x32_bf16 v[192:195], v[48:51], a[4:7], 0
buffer_load_dwordx4 a[44:47], v4, s[4:7], s48 offen offset:1024 sc1
v_mfma_f32_16x16x32_bf16 v[188:191], v[52:55], a[0:3], 0
ds_read_b128 v[68:71], v9 offset:39936
v_mfma_f32_16x16x32_bf16 v[196:199], v[52:55], a[4:7], 0
s_waitcnt vmcnt(8) lgkmcnt(2)
v_mfma_f32_16x16x32_bf16 v[168:171], v[56:59], a[8:11], v[168:171]
ds_read_b128 v[40:43], v9 offset:0
v_mfma_f32_16x16x32_bf16 v[176:179], v[56:59], a[12:15], v[176:179]
buffer_load_dwordx4 a[48:51], v1, s[4:7], s48 offen offset:2048 sc1
v_mfma_f32_16x16x32_bf16 v[172:175], v[60:63], a[8:11], v[172:175]
ds_read_b128 v[44:47], v9 offset:1024
v_mfma_f32_16x16x32_bf16 v[180:183], v[60:63], a[12:15], v[180:183]
s_waitcnt lgkmcnt(2)
v_mfma_f32_16x16x32_bf16 v[184:187], v[64:67], a[8:11], v[184:187]
ds_read_b128 v[48:51], v9 offset:2048
v_mfma_f32_16x16x32_bf16 v[192:195], v[64:67], a[12:15], v[192:195]
buffer_load_dwordx4 a[52:55], v4, s[4:7], s48 offen offset:2048 sc1
v_mfma_f32_16x16x32_bf16 v[188:191], v[68:71], a[8:11], v[188:191]
ds_read_b128 v[52:55], v9 offset:3072
v_mfma_f32_16x16x32_bf16 v[196:199], v[68:71], a[12:15], v[196:199]
s_waitcnt vmcnt(8) lgkmcnt(2)
v_mfma_f32_16x16x32_bf16 v[168:171], v[40:43], a[16:19], v[168:171]
ds_read_b128 v[56:59], v9 offset:4096
v_mfma_f32_16x16x32_bf16 v[176:179], v[40:43], a[20:23], v[176:179]
buffer_load_dwordx4 a[56:59], v1, s[4:7], s48 offen offset:3072 sc1
v_mfma_f32_16x16x32_bf16 v[172:175], v[44:47], a[16:19], v[172:175]
ds_read_b128 v[60:63], v9 offset:5120
v_mfma_f32_16x16x32_bf16 v[180:183], v[44:47], a[20:23], v[180:183]
s_waitcnt lgkmcnt(2)
v_mfma_f32_16x16x32_bf16 v[184:187], v[48:51], a[16:19], v[184:187]
ds_read_b128 v[64:67], v9 offset:6144
v_mfma_f32_16x16x32_bf16 v[192:195], v[48:51], a[20:23], v[192:195]
buffer_load_dwordx4 a[60:63], v4, s[4:7], s48 offen offset:3072 sc1
v_mfma_f32_16x16x32_bf16 v[188:191], v[52:55], a[16:19], v[188:191]
ds_read_b128 v[68:71], v9 offset:7168
v_mfma_f32_16x16x32_bf16 v[196:199], v[52:55], a[20:23], v[196:199]
s_waitcnt vmcnt(8) lgkmcnt(2)
v_mfma_f32_16x16x32_bf16 v[168:171], v[56:59], a[24:27], v[168:171]
ds_read_b128 v[40:43], v9 offset:16384
s_add_u32 m0, s21, 131072
s_add_u32 s47, s19, 32768
v_mfma_f32_16x16x32_bf16 v[176:179], v[56:59], a[28:31], v[176:179]
buffer_load_dwordx4 v1, s[4:7], s47 offen offset:0 sc1 lds
v_mfma_f32_16x16x32_bf16 v[172:175], v[60:63], a[24:27], v[172:175]
ds_read_b128 v[44:47], v9 offset:17408
v_mfma_f32_16x16x32_bf16 v[180:183], v[60:63], a[28:31], v[180:183]
s_waitcnt lgkmcnt(2)
v_mfma_f32_16x16x32_bf16 v[184:187], v[64:67], a[24:27], v[184:187]
ds_read_b128 v[48:51], v9 offset:18432
v_mfma_f32_16x16x32_bf16 v[192:195], v[64:67], a[28:31], v[192:195]
buffer_load_dwordx4 v1, s[4:7], s47 offen offset:1024 sc1 lds
v_mfma_f32_16x16x32_bf16 v[188:191], v[68:71], a[24:27], v[188:191]
ds_read_b128 v[52:55], v9 offset:19456
v_mfma_f32_16x16x32_bf16 v[196:199], v[68:71], a[28:31], v[196:199]
s_waitcnt vmcnt(8) lgkmcnt(2)
v_mfma_f32_16x16x32_bf16 v[168:171], v[40:43], a[32:35], v[168:171]
ds_read_b128 v[56:59], v9 offset:20480
v_mfma_f32_16x16x32_bf16 v[176:179], v[40:43], a[36:39], v[176:179]
v_mfma_f32_16x16x32_bf16 v[172:175], v[44:47], a[32:35], v[172:175]
ds_read_b128 v[60:63], v9 offset:21504
v_mfma_f32_16x16x32_bf16 v[180:183], v[44:47], a[36:39], v[180:183]
buffer_load_dwordx4 v1, s[4:7], s47 offen offset:2048 sc1 lds
s_waitcnt lgkmcnt(2)
v_mfma_f32_16x16x32_bf16 v[184:187], v[48:51], a[32:35], v[184:187]
ds_read_b128 v[64:67], v9 offset:22528
v_mfma_f32_16x16x32_bf16 v[192:195], v[48:51], a[36:39], v[192:195]
v_mfma_f32_16x16x32_bf16 v[188:191], v[52:55], a[32:35], v[188:191]
ds_read_b128 v[68:71], v9 offset:23552
v_mfma_f32_16x16x32_bf16 v[196:199], v[52:55], a[36:39], v[196:199]
buffer_load_dwordx4 v1, s[4:7], s47 offen offset:3072 sc1 lds
s_waitcnt vmcnt(8) lgkmcnt(2)
v_mfma_f32_16x16x32_bf16 v[168:171], v[56:59], a[40:43], v[168:171]
ds_read_b128 v[40:43], v8 offset:0
v_mfma_f32_16x16x32_bf16 v[176:179], v[56:59], a[44:47], v[176:179]
v_mfma_f32_16x16x32_bf16 v[172:175], v[60:63], a[40:43], v[172:175]
ds_read_b128 v[44:47], v8 offset:1024
v_mfma_f32_16x16x32_bf16 v[180:183], v[60:63], a[44:47], v[180:183]
s_waitcnt lgkmcnt(2)
v_mfma_f32_16x16x32_bf16 v[184:187], v[64:67], a[40:43], v[184:187]
ds_read_b128 v[48:51], v8 offset:2048
s_add_u32 m0, s21, 16384
s_add_u32 s47, s19, 49152
v_mfma_f32_16x16x32_bf16 v[192:195], v[64:67], a[44:47], v[192:195]
buffer_load_dwordx4 v1, s[4:7], s47 offen offset:0 sc1 lds
v_mfma_f32_16x16x32_bf16 v[188:191], v[68:71], a[40:43], v[188:191]
ds_read_b128 v[52:55], v8 offset:3072
v_mfma_f32_16x16x32_bf16 v[196:199], v[68:71], a[44:47], v[196:199]
s_waitcnt vmcnt(7) lgkmcnt(2)
ds_read_b128 v[56:59], v8 offset:4096
buffer_load_dwordx4 v1, s[4:7], s47 offen offset:1024 sc1 lds
ds_read_b128 v[60:63], v8 offset:5120
ds_read_b128 v[64:67], v8 offset:6144
ds_read_b128 v[68:71], v8 offset:7168
buffer_load_dwordx4 v1, s[4:7], s47 offen offset:2048 sc1 lds
buffer_load_dwordx4 v1, s[4:7], s47 offen offset:3072 sc1 lds
s_waitcnt lgkmcnt(5)
v_mfma_f32_16x16x32_bf16 v[184:187], v[48:51], a[48:51], v[184:187]
v_mfma_f32_16x16x32_bf16 v[192:195], v[48:51], a[52:55], v[192:195]
s_waitcnt lgkmcnt(4)
v_mfma_f32_16x16x32_bf16 v[188:191], v[52:55], a[48:51], v[188:191]
v_mfma_f32_16x16x32_bf16 v[196:199], v[52:55], a[52:55], v[196:199]
s_waitcnt vmcnt(9) lgkmcnt(1)
v_mfma_f32_16x16x32_bf16 v[184:187], v[64:67], a[56:59], v[184:187]
s_waitcnt vmcnt(8)
v_mfma_f32_16x16x32_bf16 v[192:195], v[64:67], a[60:63], v[192:195]
s_waitcnt lgkmcnt(0)
v_mfma_f32_16x16x32_bf16 v[188:191], v[68:71], a[56:59], v[188:191]
v_mfma_f32_16x16x32_bf16 v[196:199], v[68:71], a[60:63], v[196:199]
v_mfma_f32_16x16x32_bf16 v[168:171], v[40:43], a[48:51], v[168:171]
v_mfma_f32_16x16x32_bf16 v[176:179], v[40:43], a[52:55], v[176:179]
v_mfma_f32_16x16x32_bf16 v[172:175], v[44:47], a[48:51], v[172:175]
v_mfma_f32_16x16x32_bf16 v[180:183], v[44:47], a[52:55], v[180:183]
ds_write_b128 v18, v[184:187] offset:0
v_mfma_f32_16x16x32_bf16 v[168:171], v[56:59], a[56:59], v[168:171]
s_nop 0
ds_write_b128 v18, v[188:191] offset:1024
v_mfma_f32_16x16x32_bf16 v[176:179], v[56:59], a[60:63], v[176:179]
ds_write_b128 v18, v[192:195] offset:2048
v_mfma_f32_16x16x32_bf16 v[172:175], v[60:63], a[56:59], v[172:175]
ds_write_b128 v18, v[196:199] offset:3072
v_mfma_f32_16x16x32_bf16 v[180:183], v[60:63], a[60:63], v[180:183]
s_waitcnt lgkmcnt(0)
s_barrier
ds_read_b128 v[224:227], v19 offset:0
ds_read_b128 v[228:231], v19 offset:1024
ds_read_b128 v[232:235], v19 offset:2048
ds_read_b128 v[236:239], v19 offset:3072
s_waitcnt lgkmcnt(3)
v_pk_add_f32 v[168:169], v[168:169], v[224:225]
v_pk_add_f32 v[170:171], v[170:171], v[226:227]
s_waitcnt lgkmcnt(2)
v_pk_add_f32 v[172:173], v[172:173], v[228:229]
v_pk_add_f32 v[174:175], v[174:175], v[230:231]
s_waitcnt lgkmcnt(1)
v_pk_add_f32 v[176:177], v[176:177], v[232:233]
v_pk_add_f32 v[178:179], v[178:179], v[234:235]
s_waitcnt lgkmcnt(0)
v_pk_add_f32 v[180:181], v[180:181], v[236:237]
v_pk_add_f32 v[182:183], v[182:183], v[238:239]
v_cvt_pk_bf16_f32 v124, v168, v169
v_cvt_pk_bf16_f32 v125, v170, v171
v_cvt_pk_bf16_f32 v126, v172, v173
v_cvt_pk_bf16_f32 v127, v174, v175
v_cvt_pk_bf16_f32 v128, v176, v177
v_cvt_pk_bf16_f32 v129, v178, v179
v_cvt_pk_bf16_f32 v130, v180, v181
v_cvt_pk_bf16_f32 v131, v182, v183
buffer_store_dwordx4 v[124:127], v1, s[4:7], s28 offen
buffer_store_dwordx4 v[128:131], v4, s[4:7], s28 offen
v_pk_mul_f32 v[226:227], v[168:169], v[168:169]
v_pk_add_f32 v[224:225], v[168:169], v[170:171]
v_pk_mul_f32 v[230:231], v[176:177], v[176:177]
v_pk_add_f32 v[228:229], v[176:177], v[178:179]
v_pk_fma_f32 v[226:227], v[170:171], v[170:171], v[226:227]
v_pk_fma_f32 v[230:231], v[178:179], v[178:179], v[230:231]
v_pk_fma_f32 v[226:227], v[172:173], v[172:173], v[226:227]
v_pk_add_f32 v[224:225], v[224:225], v[172:173]
v_pk_fma_f32 v[230:231], v[180:181], v[180:181], v[230:231]
v_pk_add_f32 v[228:229], v[228:229], v[180:181]
v_pk_fma_f32 v[226:227], v[174:175], v[174:175], v[226:227]
v_pk_add_f32 v[224:225], v[224:225], v[174:175]
v_pk_fma_f32 v[230:231], v[182:183], v[182:183], v[230:231]
v_pk_add_f32 v[228:229], v[228:229], v[182:183]
v_add_f32 v224, v224, v225
v_add_f32 v226, v226, v227
v_add_f32 v228, v228, v229
v_add_f32 v230, v230, v231
v_permlane32_swap_b32 v224, v226
s_nop 0
v_permlane32_swap_b32 v228, v230
v_add_f32 v224, v224, v226
v_add_f32 v228, v228, v230
s_nop 1
v_permlane16_swap_b32 v224, v228
v_add_f32 v224, v224, v228
buffer_store_dword v224, v7, s[4:7], s29 offen
s_waitcnt vmcnt(0)
buffer_store_dwordx2 v[36:37], v26, s[4:7], s38 offen offset:512
s_add_u32 m0, s21, 32768
s_add_u32 s47, s19, 65536
buffer_load_dwordx4 v1, s[4:7], s47 offen offset:0 sc1 lds
buffer_load_dwordx4 v1, s[4:7], s47 offen offset:1024 sc1 lds
buffer_load_dwordx4 v1, s[4:7], s47 offen offset:2048 sc1 lds
buffer_load_dwordx4 v1, s[4:7], s47 offen offset:3072 sc1 lds
buffer_load_dwordx2 v[38:39], v16, s[4:7], s39 offen offset:512 sc1
buffer_load_dwordx2 v[252:253], v16, s[4:7], s39 offen offset:512 sc1
s_waitcnt vmcnt(1)
v_cmp_ne_u64 vcc, s[66:67], v[38:39]
s_nop 0
s_cbranch_vccnz LF1_sp9
LF1_ok8:
s_add_u32 s48, s30, 0
buffer_load_dwordx4 a[0:3], v1, s[4:7], s48 offen offset:0 sc1
buffer_load_dwordx4 a[4:7], v4, s[4:7], s48 offen offset:0 sc1
buffer_load_dwordx4 a[8:11], v1, s[4:7], s48 offen offset:1024 sc1
buffer_load_dwordx4 a[12:15], v4, s[4:7], s48 offen offset:1024 sc1
buffer_load_dwordx4 a[16:19], v1, s[4:7], s48 offen offset:2048 sc1
buffer_load_dwordx4 a[20:23], v4, s[4:7], s48 offen offset:2048 sc1
buffer_load_dwordx4 a[24:27], v1, s[4:7], s48 offen offset:3072 sc1
buffer_load_dwordx4 a[28:31], v4, s[4:7], s48 offen offset:3072 sc1
s_add_u32 s48, s30, 4096
buffer_load_dwordx4 a[32:35], v1, s[4:7], s48 offen offset:0 sc1
buffer_load_dwordx4 a[36:39], v4, s[4:7], s48 offen offset:0 sc1
s_barrier
v_lshlrev_b32 v240, 3, v0
v_add_u32 v240, 147456, v240
ds_write_b64 v240, v[32:33]
v_and_b32 v25, 15, v0
v_lshlrev_b32 v25, 3, v25
v_add_u32 v25, 147456, v25
ds_read_b128 v[40:43], v1 offset:49152
ds_read_b128 v[44:47], v1 offset:50176
ds_read_b128 v[48:51], v1 offset:51200
ds_read_b128 v[52:55], v1 offset:52224
ds_read_b128 v[56:59], v1 offset:53248
ds_read_b128 v[60:63], v1 offset:54272
s_waitcnt vmcnt(8) lgkmcnt(2)
v_mfma_f32_16x16x32_bf16 v[72:75], v[40:43], a[0:3], 0
ds_read_b128 v[64:67], v1 offset:55296
v_mfma_f32_16x16x32_bf16 v[76:79], v[40:43], a[4:7], 0
buffer_load_dwordx4 a[40:43], v1, s[4:7], s48 offen offset:1024 sc1
v_mfma_f32_16x16x32_bf16 v[80:83], v[44:47], a[0:3], 0
ds_read_b128 v[68:71], v1 offset:56320
v_mfma_f32_16x16x32_bf16 v[84:87], v[44:47], a[4:7], 0
buffer_load_dwordx4 v[224:227], v6, s[4:7], s31 offen offset:0 sc1
v_mfma_f32_16x16x32_bf16 v[88:91], v[48:51], a[0:3], 0
ds_read_b128 v[40:43], v1 offset:57344
v_mfma_f32_16x16x32_bf16 v[92:95], v[48:51], a[4:7], 0
buffer_load_dwordx4 a[44:47], v4, s[4:7], s48 offen offset:1024 sc1
v_mfma_f32_16x16x32_bf16 v[96:99], v[52:55], a[0:3], 0
ds_read_b128 v[44:47], v1 offset:58368
v_mfma_f32_16x16x32_bf16 v[100:103], v[52:55], a[4:7], 0
buffer_load_dwordx4 v[228:231], v6, s[4:7], s31 offen offset:1024 sc1
s_waitcnt vmcnt(10) lgkmcnt(2)
v_mfma_f32_16x16x32_bf16 v[72:75], v[56:59], a[8:11], v[72:75]
ds_read_b128 v[48:51], v1 offset:59392
v_mfma_f32_16x16x32_bf16 v[76:79], v[56:59], a[12:15], v[76:79]
buffer_load_dwordx4 a[48:51], v1, s[4:7], s48 offen offset:2048 sc1
v_mfma_f32_16x16x32_bf16 v[80:83], v[60:63], a[8:11], v[80:83]
ds_read_b128 v[52:55], v1 offset:60416
v_mfma_f32_16x16x32_bf16 v[84:87], v[60:63], a[12:15], v[84:87]
buffer_load_dwordx4 v[232:235], v6, s[4:7], s31 offen offset:2048 sc1
v_mfma_f32_16x16x32_bf16 v[88:91], v[64:67], a[8:11], v[88:91]
ds_read_b128 v[56:59], v1 offset:61440
v_mfma_f32_16x16x32_bf16 v[92:95], v[64:67], a[12:15], v[92:95]
buffer_load_dwordx4 a[52:55], v4, s[4:7], s48 offen offset:2048 sc1
v_mfma_f32_16x16x32_bf16 v[96:99], v[68:71], a[8:11], v[96:99]
ds_read_b128 v[60:63], v1 offset:62464
v_mfma_f32_16x16x32_bf16 v[100:103], v[68:71], a[12:15], v[100:103]
buffer_load_dwordx4 v[236:239], v6, s[4:7], s31 offen offset:3072 sc1
s_waitcnt vmcnt(12) lgkmcnt(2)
v_mfma_f32_16x16x32_bf16 v[72:75], v[40:43], a[16:19], v[72:75]
ds_read_b128 v[64:67], v1 offset:63488
v_mfma_f32_16x16x32_bf16 v[76:79], v[40:43], a[20:23], v[76:79]
buffer_load_dwordx4 a[56:59], v1, s[4:7], s48 offen offset:3072 sc1
v_mfma_f32_16x16x32_bf16 v[80:83], v[44:47], a[16:19], v[80:83]
ds_read_b128 v[68:71], v1 offset:64512
v_mfma_f32_16x16x32_bf16 v[84:87], v[44:47], a[20:23], v[84:87]
v_mfma_f32_16x16x32_bf16 v[88:91], v[48:51], a[16:19], v[88:91]
ds_read_b128 v[40:43], v2 offset:49152
v_mfma_f32_16x16x32_bf16 v[92:95], v[48:51], a[20:23], v[92:95]
buffer_load_dwordx4 a[60:63], v4, s[4:7], s48 offen offset:3072 sc1
v_mfma_f32_16x16x32_bf16 v[96:99], v[52:55], a[16:19], v[96:99]
ds_read_b128 v[44:47], v2 offset:50176
v_mfma_f32_16x16x32_bf16 v[100:103], v[52:55], a[20:23], v[100:103]
s_waitcnt vmcnt(12) lgkmcnt(2)
v_mfma_f32_16x16x32_bf16 v[72:75], v[56:59], a[24:27], v[72:75]
ds_read_b128 v[48:51], v2 offset:51200
s_add_u32 s48, s30, 8192
v_mfma_f32_16x16x32_bf16 v[76:79], v[56:59], a[28:31], v[76:79]
buffer_load_dwordx4 a[64:67], v1, s[4:7], s48 offen offset:0 sc1
v_mfma_f32_16x16x32_bf16 v[80:83], v[60:63], a[24:27], v[80:83]
ds_read_b128 v[52:55], v2 offset:52224
v_mfma_f32_16x16x32_bf16 v[84:87], v[60:63], a[28:31], v[84:87]
v_mfma_f32_16x16x32_bf16 v[88:91], v[64:67], a[24:27], v[88:91]
ds_read_b128 v[56:59], v2 offset:53248
v_mfma_f32_16x16x32_bf16 v[92:95], v[64:67], a[28:31], v[92:95]
buffer_load_dwordx4 a[68:71], v4, s[4:7], s48 offen offset:0 sc1
v_mfma_f32_16x16x32_bf16 v[96:99], v[68:71], a[24:27], v[96:99]
ds_read_b128 v[60:63], v2 offset:54272
v_mfma_f32_16x16x32_bf16 v[100:103], v[68:71], a[28:31], v[100:103]
s_waitcnt vmcnt(12) lgkmcnt(2)
v_mfma_f32_16x16x32_bf16 v[72:75], v[40:43], a[32:35], v[72:75]
ds_read_b128 v[64:67], v2 offset:55296
v_mfma_f32_16x16x32_bf16 v[76:79], v[40:43], a[36:39], v[76:79]
buffer_load_dwordx4 a[72:75], v1, s[4:7], s48 offen offset:1024 sc1
v_mfma_f32_16x16x32_bf16 v[80:83], v[44:47], a[32:35], v[80:83]
ds_read_b128 v[68:71], v2 offset:56320
v_mfma_f32_16x16x32_bf16 v[84:87], v[44:47], a[36:39], v[84:87]
v_mfma_f32_16x16x32_bf16 v[88:91], v[48:51], a[32:35], v[88:91]
ds_read_b128 v[40:43], v2 offset:57344
v_mfma_f32_16x16x32_bf16 v[92:95], v[48:51], a[36:39], v[92:95]
buffer_load_dwordx4 a[76:79], v4, s[4:7], s48 offen offset:1024 sc1
v_mfma_f32_16x16x32_bf16 v[96:99], v[52:55], a[32:35], v[96:99]
ds_read_b128 v[44:47], v2 offset:58368
v_mfma_f32_16x16x32_bf16 v[100:103], v[52:55], a[36:39], v[100:103]
s_waitcnt vmcnt(11) lgkmcnt(2)
v_mfma_f32_16x16x32_bf16 v[72:75], v[56:59], a[40:43], v[72:75]
ds_read_b128 v[48:51], v2 offset:59392
v_mfma_f32_16x16x32_bf16 v[76:79], v[56:59], a[44:47], v[76:79]
buffer_load_dwordx4 a[80:83], v1, s[4:7], s48 offen offset:2048 sc1
v_mfma_f32_16x16x32_bf16 v[80:83], v[60:63], a[40:43], v[80:83]
ds_read_b128 v[52:55], v2 offset:60416
v_mfma_f32_16x16x32_bf16 v[84:87], v[60:63], a[44:47], v[84:87]
v_mfma_f32_16x16x32_bf16 v[88:91], v[64:67], a[40:43], v[88:91]
ds_read_b128 v[56:59], v2 offset:61440
v_mfma_f32_16x16x32_bf16 v[92:95], v[64:67], a[44:47], v[92:95]
buffer_load_dwordx4 a[84:87], v4, s[4:7], s48 offen offset:2048 sc1
v_mfma_f32_16x16x32_bf16 v[96:99], v[68:71], a[40:43], v[96:99]
ds_read_b128 v[60:63], v2 offset:62464
v_mfma_f32_16x16x32_bf16 v[100:103], v[68:71], a[44:47], v[100:103]
s_waitcnt vmcnt(9) lgkmcnt(2)
v_mfma_f32_16x16x32_bf16 v[72:75], v[40:43], a[48:51], v[72:75]
ds_read_b128 v[64:67], v2 offset:63488
buffer_load_dwordx4 a[88:91], v1, s[4:7], s48 offen offset:3072 sc1
v_mfma_f32_16x16x32_bf16 v[76:79], v[40:43], a[52:55], v[76:79]
v_add_f32 v224, v224, v226
v_mfma_f32_16x16x32_bf16 v[80:83], v[44:47], a[48:51], v[80:83]
ds_read_b128 v[68:71], v2 offset:64512
v_add_f32 v225, v225, v227
v_mfma_f32_16x16x32_bf16 v[84:87], v[44:47], a[52:55], v[84:87]
v_add_f32 v228, v228, v230
v_mfma_f32_16x16x32_bf16 v[88:91], v[48:51], a[48:51], v[88:91]
ds_read_b128 v[40:43], v3 offset:0
buffer_load_dwordx4 a[92:95], v4, s[4:7], s48 offen offset:3072 sc1
v_mfma_f32_16x16x32_bf16 v[92:95], v[48:51], a[52:55], v[92:95]
v_add_f32 v229, v229, v231
v_mfma_f32_16x16x32_bf16 v[96:99], v[52:55], a[48:51], v[96:99]
ds_read_b128 v[44:47], v3 offset:1024
v_add_f32 v232, v232, v234
v_mfma_f32_16x16x32_bf16 v[100:103], v[52:55], a[52:55], v[100:103]
v_add_f32 v233, v233, v235
s_waitcnt vmcnt(10)
v_add_f32 v236, v236, v238
s_waitcnt vmcnt(8) lgkmcnt(2)
v_mfma_f32_16x16x32_bf16 v[72:75], v[56:59], a[56:59], v[72:75]
ds_read_b128 v[48:51], v3 offset:2048
s_add_u32 s48, s30, 12288
v_mfma_f32_16x16x32_bf16 v[76:79], v[56:59], a[60:63], v[76:79]
buffer_load_dwordx4 a[96:99], v1, s[4:7], s48 offen offset:0 sc1
v_mfma_f32_16x16x32_bf16 v[80:83], v[60:63], a[56:59], v[80:83]
ds_read_b128 v[52:55], v3 offset:3072
v_add_f32 v237, v237, v239
v_mfma_f32_16x16x32_bf16 v[84:87], v[60:63], a[60:63], v[84:87]
v_add_f32 v224, v224, v228
v_mfma_f32_16x16x32_bf16 v[88:91], v[64:67], a[56:59], v[88:91]
ds_read_b128 v[56:59], v3 offset:4096
v_mfma_f32_16x16x32_bf16 v[92:95], v[64:67], a[60:63], v[92:95]
buffer_load_dwordx4 a[100:103], v4, s[4:7], s48 offen offset:0 sc1
v_mfma_f32_16x16x32_bf16 v[96:99], v[68:71], a[56:59], v[96:99]
ds_read_b128 v[60:63], v3 offset:5120
v_add_f32 v225, v225, v229
v_mfma_f32_16x16x32_bf16 v[100:103], v[68:71], a[60:63], v[100:103]
v_add_f32 v232, v232, v236
v_add_f32 v233, v233, v237
s_waitcnt vmcnt(8) lgkmcnt(2)
v_mfma_f32_16x16x32_bf16 v[72:75], v[40:43], a[64:67], v[72:75]
ds_read_b128 v[64:67], v3 offset:6144
buffer_load_dwordx4 a[104:107], v1, s[4:7], s48 offen offset:1024 sc1
v_mfma_f32_16x16x32_bf16 v[76:79], v[40:43], a[68:71], v[76:79]
v_add_f32 v224, v224, v232
v_mfma_f32_16x16x32_bf16 v[80:83], v[44:47], a[64:67], v[80:83]
ds_read_b128 v[68:71], v3 offset:7168
v_add_f32 v225, v225, v233
v_mfma_f32_16x16x32_bf16 v[84:87], v[44:47], a[68:71], v[84:87]
v_mov_b32 v226, v224
v_mfma_f32_16x16x32_bf16 v[88:91], v[48:51], a[64:67], v[88:91]
ds_read_b128 v[40:43], v3 offset:8192
buffer_load_dwordx4 a[108:111], v4, s[4:7], s48 offen offset:1024 sc1
v_mfma_f32_16x16x32_bf16 v[92:95], v[48:51], a[68:71], v[92:95]
v_mov_b32 v227, v225
v_mfma_f32_16x16x32_bf16 v[96:99], v[52:55], a[64:67], v[96:99]
ds_read_b128 v[44:47], v3 offset:9216
v_permlane32_swap_b32 v224, v226
v_mfma_f32_16x16x32_bf16 v[100:103], v[52:55], a[68:71], v[100:103]
v_permlane32_swap_b32 v225, v227
v_add_f32 v224, v224, v226
s_waitcnt vmcnt(8) lgkmcnt(2)
v_mfma_f32_16x16x32_bf16 v[72:75], v[56:59], a[72:75], v[72:75]
ds_read_b128 v[48:51], v3 offset:10240
v_mfma_f32_16x16x32_bf16 v[76:79], v[56:59], a[76:79], v[76:79]
buffer_load_dwordx4 a[112:115], v1, s[4:7], s48 offen offset:2048 sc1
v_mfma_f32_16x16x32_bf16 v[80:83], v[60:63], a[72:75], v[80:83]
ds_read_b128 v[52:55], v3 offset:11264
v_add_f32 v225, v225, v227
v_mfma_f32_16x16x32_bf16 v[84:87], v[60:63], a[76:79], v[84:87]
v_mul_f32 v224, 0xbb000000, v224
v_mul_f32 v225, 0x3b000000, v225
v_mfma_f32_16x16x32_bf16 v[88:91], v[64:67], a[72:75], v[88:91]
ds_read_b128 v[56:59], v3 offset:12288
v_mfma_f32_16x16x32_bf16 v[92:95], v[64:67], a[76:79], v[92:95]
buffer_load_dwordx4 a[116:119], v4, s[4:7], s48 offen offset:2048 sc1
v_mfma_f32_16x16x32_bf16 v[96:99], v[68:71], a[72:75], v[96:99]
ds_read_b128 v[60:63], v3 offset:13312
v_fma_f32 v225, -v224, v224, v225
v_mfma_f32_16x16x32_bf16 v[100:103], v[68:71], a[76:79], v[100:103]
v_max_f32 v225, 0, v225
v_add_f32 v225, 0x3727c5ac, v225
s_waitcnt vmcnt(8) lgkmcnt(2)
v_mfma_f32_16x16x32_bf16 v[72:75], v[40:43], a[80:83], v[72:75]
ds_read_b128 v[64:67], v3 offset:14336
v_mfma_f32_16x16x32_bf16 v[76:79], v[40:43], a[84:87], v[76:79]
buffer_load_dwordx4 a[120:123], v1, s[4:7], s48 offen offset:3072 sc1
v_mfma_f32_16x16x32_bf16 v[80:83], v[44:47], a[80:83], v[80:83]
ds_read_b128 v[68:71], v3 offset:15360
v_rsq_f32 v226, v225
v_mfma_f32_16x16x32_bf16 v[84:87], v[44:47], a[84:87], v[84:87]
v_mul_f32 v200, 0xbfb8aa3b, v226
v_mfma_f32_16x16x32_bf16 v[88:91], v[48:51], a[80:83], v[88:91]
ds_read_b128 v[40:43], v1 offset:16384
buffer_load_dwordx4 a[124:127], v4, s[4:7], s48 offen offset:3072 sc1
v_mfma_f32_16x16x32_bf16 v[92:95], v[48:51], a[84:87], v[92:95]
v_mov_b32 v202, v225
v_mfma_f32_16x16x32_bf16 v[96:99], v[52:55], a[80:83], v[96:99]
ds_read_b128 v[44:47], v1 offset:17408
v_mov_b32 v203, v225
v_mfma_f32_16x16x32_bf16 v[100:103], v[52:55], a[84:87], v[100:103]
v_mov_b32 v201, v200
v_mov_b32 v225, v224
s_waitcnt vmcnt(8) lgkmcnt(2)
v_mfma_f32_16x16x32_bf16 v[72:75], v[56:59], a[88:91], v[72:75]
ds_read_b128 v[48:51], v1 offset:18432
v_permlane16_swap_b32 v202, v203
v_permlane16_swap_b32 v200, v201
s_add_u32 m0, s21, 98304
v_mfma_f32_16x16x32_bf16 v[76:79], v[56:59], a[92:95], v[76:79]
s_add_u32 s47, s19, 81920
buffer_load_dwordx4 v1, s[4:7], s47 offen offset:0 sc1 lds
v_mfma_f32_16x16x32_bf16 v[80:83], v[60:63], a[88:91], v[80:83]
ds_read_b128 v[52:55], v1 offset:19456
v_permlane16_swap_b32 v224, v225
s_mov_b64 vcc, 0xffff
v_cndmask_b32 v224, 0, v224, vcc
v_cndmask_b32 v225, 0, v225, vcc
v_mfma_f32_16x16x32_bf16 v[84:87], v[60:63], a[92:95], v[84:87]
buffer_load_dwordx4 v1, s[4:7], s47 offen offset:1024 sc1 lds
v_mfma_f32_16x16x32_bf16 v[88:91], v[64:67], a[88:91], v[88:91]
ds_read_b128 v[56:59], v1 offset:20480
v_mfma_f32_16x16x32_bf16 v[92:95], v[64:67], a[92:95], v[92:95]
v_cvt_pk_bf16_f32 v232, v224, v224
v_mfma_f32_16x16x32_bf16 v[96:99], v[68:71], a[88:91], v[96:99]
ds_read_b128 v[60:63], v1 offset:21504
v_lshlrev_b32 v226, 16, v232
v_sub_f32 v226, v224, v226
v_mfma_f32_16x16x32_bf16 v[100:103], v[68:71], a[92:95], v[100:103]
v_cvt_pk_bf16_f32 v233, v226, 0
buffer_load_dwordx4 v1, s[4:7], s47 offen offset:2048 sc1 lds
s_waitcnt vmcnt(9) lgkmcnt(2)
v_mfma_f32_16x16x32_bf16 v[72:75], v[40:43], a[96:99], v[72:75]
ds_read_b128 v[64:67], v1 offset:22528
v_cvt_pk_bf16_f32 v236, v225, v225
v_mfma_f32_16x16x32_bf16 v[76:79], v[40:43], a[100:103], v[76:79]
v_lshlrev_b32 v226, 16, v236
v_sub_f32 v226, v225, v226
v_mfma_f32_16x16x32_bf16 v[80:83], v[44:47], a[96:99], v[80:83]
ds_read_b128 v[68:71], v1 offset:23552
v_cvt_pk_bf16_f32 v237, v226, 0
v_mov_b32 v226, 0
v_mfma_f32_16x16x32_bf16 v[84:87], v[44:47], a[100:103], v[84:87]
buffer_load_dwordx4 v1, s[4:7], s47 offen offset:3072 sc1 lds
v_mfma_f32_16x16x32_bf16 v[88:91], v[48:51], a[96:99], v[88:91]
ds_read_b128 v[40:43], v1 offset:24576
v_mov_b32 v227, 0
v_mfma_f32_16x16x32_bf16 v[92:95], v[48:51], a[100:103], v[92:95]
v_mov_b32 v230, 0
v_mov_b32 v231, 0
v_mfma_f32_16x16x32_bf16 v[96:99], v[52:55], a[96:99], v[96:99]
ds_read_b128 v[44:47], v1 offset:25600
v_mov_b32 v234, 0
v_mov_b32 v235, 0
v_mov_b32 v238, 0
v_mfma_f32_16x16x32_bf16 v[100:103], v[52:55], a[100:103], v[100:103]
s_add_u32 s57, s20, 131072
buffer_load_dwordx4 a[128:131], v1, s[4:7], s57 offen offset:0 sc1
s_waitcnt vmcnt(9) lgkmcnt(2)
v_mfma_f32_16x16x32_bf16 v[72:75], v[56:59], a[104:107], v[72:75]
ds_read_b128 v[48:51], v1 offset:26624
v_mov_b32 v239, 0
v_mfma_f32_16x16x32_bf16 v[76:79], v[56:59], a[108:111], v[76:79]
s_add_u32 s76, s33, 0
v_mfma_f32_16x16x32_bf16 v[80:83], v[60:63], a[104:107], v[80:83]
ds_read_b128 v[52:55], v1 offset:27648
s_add_u32 s77, s33, 7168
s_add_u32 s78, s33, 14336
v_mfma_f32_16x16x32_bf16 v[84:87], v[60:63], a[108:111], v[84:87]
s_add_u32 s79, s33, 21504
buffer_load_dwordx4 a[132:135], v1, s[4:7], s57 offen offset:1024 sc1
v_mfma_f32_16x16x32_bf16 v[88:91], v[64:67], a[104:107], v[88:91]
ds_read_b128 v[56:59], v1 offset:28672
s_add_u32 s80, s33, 57344
v_mfma_f32_16x16x32_bf16 v[92:95], v[64:67], a[108:111], v[92:95]
s_add_u32 s81, s33, 64512
v_mfma_f32_16x16x32_bf16 v[96:99], v[68:71], a[104:107], v[96:99]
ds_read_b128 v[60:63], v1 offset:29696
s_add_u32 s82, s33, 71680
s_add_u32 s83, s33, 78848
v_mfma_f32_16x16x32_bf16 v[100:103], v[68:71], a[108:111], v[100:103]
s_add_u32 s58, s32, 57344
buffer_load_dwordx4 a[136:139], v1, s[4:7], s57 offen offset:2048 sc1
s_waitcnt vmcnt(9) lgkmcnt(2)
v_mfma_f32_16x16x32_bf16 v[72:75], v[40:43], a[112:115], v[72:75]
ds_read_b128 v[64:67], v1 offset:30720
v_mfma_f32_16x16x32_bf16 v[76:79], v[40:43], a[116:119], v[76:79]
v_mfma_f32_16x16x32_bf16 v[80:83], v[44:47], a[112:115], v[80:83]
s_barrier
ds_read_b128 v[68:71], v1 offset:31744
v_mfma_f32_16x16x32_bf16 v[84:87], v[44:47], a[116:119], v[84:87]
buffer_load_dwordx4 a[140:143], v1, s[4:7], s57 offen offset:3072 sc1
v_mfma_f32_16x16x32_bf16 v[88:91], v[48:51], a[112:115], v[88:91]
ds_read_b128 v[40:43], v1 offset:32768
v_mfma_f32_16x16x32_bf16 v[92:95], v[48:51], a[116:119], v[92:95]
v_mfma_f32_16x16x32_bf16 v[96:99], v[52:55], a[112:115], v[96:99]
ds_read_b128 v[44:47], v1 offset:33792
s_add_u32 m0, s21, 49152
s_add_u32 s47, s19, 98304
v_mfma_f32_16x16x32_bf16 v[100:103], v[52:55], a[116:119], v[100:103]
buffer_load_dwordx4 v1, s[4:7], s47 offen offset:0 sc1 lds
s_waitcnt vmcnt(9) lgkmcnt(2)
v_mfma_f32_16x16x32_bf16 v[72:75], v[56:59], a[120:123], v[72:75]
ds_read_b128 v[48:51], v1 offset:34816
ds_read_b64 v[224:225], v25 offset:0
v_mfma_f32_16x16x32_bf16 v[76:79], v[56:59], a[124:127], v[76:79]
ds_read_b64 v[228:229], v25 offset:128
v_mfma_f32_16x16x32_bf16 v[80:83], v[60:63], a[120:123], v[80:83]
ds_read_b128 v[52:55], v1 offset:35840
v_mfma_f32_16x16x32_bf16 v[84:87], v[60:63], a[124:127], v[84:87]
buffer_load_dwordx4 v1, s[4:7], s47 offen offset:1024 sc1 lds
v_mfma_f32_16x16x32_bf16 v[88:91], v[64:67], a[120:123], v[88:91]
ds_read_b128 v[56:59], v1 offset:36864
v_mfma_f32_16x16x32_bf16 v[92:95], v[64:67], a[124:127], v[92:95]
buffer_load_dword v29, v26, s[4:7], s41 offen offset:0 sc1
v_mfma_f32_16x16x32_bf16 v[96:99], v[68:71], a[120:123], v[96:99]
ds_read_b128 v[60:63], v1 offset:37888
v_mfma_f32_16x16x32_bf16 v[100:103], v[68:71], a[124:127], v[100:103]
buffer_load_dwordx4 v1, s[4:7], s47 offen offset:2048 sc1 lds
s_waitcnt lgkmcnt(4)
v_mfma_f32_16x16x32_bf16 v[72:75], v[224:227], v[232:235], v[72:75]
v_mfma_f32_16x16x32_bf16 v[76:79], v[224:227], v[236:239], v[76:79]
s_waitcnt lgkmcnt(3)
v_mfma_f32_16x16x32_bf16 v[80:83], v[228:231], v[232:235], v[80:83]
v_mfma_f32_16x16x32_bf16 v[84:87], v[228:231], v[236:239], v[84:87]
s_waitcnt lgkmcnt(2)
v_mfma_f32_16x16x32_bf16 v[104:107], v[40:43], a[0:3], 0
ds_read_b128 v[64:67], v1 offset:38912
ds_read_b64 v[224:225], v25 offset:256
v_mfma_f32_16x16x32_bf16 v[108:111], v[40:43], a[4:7], 0
ds_read_b64 v[228:229], v25 offset:384
v_mfma_f32_16x16x32_bf16 v[112:115], v[44:47], a[0:3], 0
ds_read_b128 v[68:71], v1 offset:39936
v_mfma_f32_16x16x32_bf16 v[116:119], v[44:47], a[4:7], 0
buffer_load_dwordx4 v1, s[4:7], s47 offen offset:3072 sc1 lds
v_mfma_f32_16x16x32_bf16 v[104:107], v[48:51], a[8:11], v[104:107]
ds_read_b128 v[40:43], v1 offset:40960
v_mul_f32 v240, v200, v72
v_mul_f32 v241, v200, v73
v_mfma_f32_16x16x32_bf16 v[108:111], v[48:51], a[12:15], v[108:111]
v_mul_f32 v242, v200, v74
v_mul_f32 v243, v200, v75
v_mfma_f32_16x16x32_bf16 v[112:115], v[52:55], a[8:11], v[112:115]
ds_read_b128 v[44:47], v1 offset:41984
s_add_u32 m0, s21, 65536
s_add_u32 s47, s20, 0
v_mfma_f32_16x16x32_bf16 v[116:119], v[52:55], a[12:15], v[116:119]
buffer_load_dwordx4 v1, s[4:7], s47 offen offset:0 sc1 lds
s_waitcnt lgkmcnt(4)
v_mfma_f32_16x16x32_bf16 v[88:91], v[224:227], v[232:235], v[88:91]
v_mfma_f32_16x16x32_bf16 v[92:95], v[224:227], v[236:239], v[92:95]
s_waitcnt lgkmcnt(3)
v_mfma_f32_16x16x32_bf16 v[96:99], v[228:231], v[232:235], v[96:99]
v_mfma_f32_16x16x32_bf16 v[100:103], v[228:231], v[236:239], v[100:103]
s_waitcnt lgkmcnt(2)
v_mfma_f32_16x16x32_bf16 v[104:107], v[56:59], a[16:19], v[104:107]
ds_read_b128 v[48:51], v1 offset:43008
v_mul_f32 v244, v201, v76
v_mul_f32 v245, v201, v77
v_mfma_f32_16x16x32_bf16 v[108:111], v[56:59], a[20:23], v[108:111]
v_mul_f32 v246, v201, v78
v_mul_f32 v247, v201, v79
v_mfma_f32_16x16x32_bf16 v[112:115], v[60:63], a[16:19], v[112:115]
ds_read_b128 v[52:55], v1 offset:44032
buffer_load_dwordx4 v1, s[4:7], s47 offen offset:1024 sc1 lds
v_mfma_f32_16x16x32_bf16 v[116:119], v[60:63], a[20:23], v[116:119]
v_exp_f32 v240, v240
v_mul_f32 v72, v72, v80
v_mfma_f32_16x16x32_bf16 v[104:107], v[64:67], a[24:27], v[104:107]
ds_read_b128 v[56:59], v1 offset:45056
v_exp_f32 v241, v241
v_mfma_f32_16x16x32_bf16 v[108:111], v[64:67], a[28:31], v[108:111]
v_mul_f32 v73, v73, v81
v_mfma_f32_16x16x32_bf16 v[112:115], v[68:71], a[24:27], v[112:115]
ds_read_b128 v[60:63], v1 offset:46080
buffer_load_dwordx4 v1, s[4:7], s47 offen offset:2048 sc1 lds
v_mfma_f32_16x16x32_bf16 v[116:119], v[68:71], a[28:31], v[116:119]
v_exp_f32 v242, v242
v_mul_f32 v74, v74, v82
s_waitcnt lgkmcnt(2)
v_mfma_f32_16x16x32_bf16 v[104:107], v[40:43], a[32:35], v[104:107]
ds_read_b128 v[64:67], v1 offset:47104
v_exp_f32 v243, v243
v_mfma_f32_16x16x32_bf16 v[108:111], v[40:43], a[36:39], v[108:111]
v_mul_f32 v75, v75, v83
v_exp_f32 v244, v244
v_mfma_f32_16x16x32_bf16 v[112:115], v[44:47], a[32:35], v[112:115]
s_waitcnt vmcnt(12)
s_barrier
ds_read_b128 v[68:71], v1 offset:48128
v_mfma_f32_16x16x32_bf16 v[116:119], v[44:47], a[36:39], v[116:119]
buffer_load_dwordx4 v1, s[4:7], s47 offen offset:3072 sc1 lds
v_mfma_f32_16x16x32_bf16 v[104:107], v[48:51], a[40:43], v[104:107]
ds_read_b128 v[40:43], v2 offset:32768
v_mul_f32 v76, v76, v84
v_mfma_f32_16x16x32_bf16 v[108:111], v[48:51], a[44:47], v[108:111]
v_exp_f32 v245, v245
v_mul_f32 v77, v77, v85
v_mfma_f32_16x16x32_bf16 v[112:115], v[52:55], a[40:43], v[112:115]
ds_read_b128 v[44:47], v2 offset:33792
s_add_u32 m0, s21, 16384
s_add_u32 s47, s19, 114688
v_mfma_f32_16x16x32_bf16 v[116:119], v[52:55], a[44:47], v[116:119]
buffer_load_dwordx4 v1, s[4:7], s47 offen offset:0 sc1 lds
s_waitcnt lgkmcnt(2)
v_mfma_f32_16x16x32_bf16 v[104:107], v[56:59], a[48:51], v[104:107]
ds_read_b128 v[48:51], v2 offset:34816
v_exp_f32 v246, v246
v_mfma_f32_16x16x32_bf16 v[108:111], v[56:59], a[52:55], v[108:111]
v_mul_f32 v78, v78, v86
v_exp_f32 v247, v247
v_mfma_f32_16x16x32_bf16 v[112:115], v[60:63], a[48:51], v[112:115]
ds_read_b128 v[52:55], v2 offset:35840
buffer_load_dwordx4 v1, s[4:7], s47 offen offset:1024 sc1 lds
v_mfma_f32_16x16x32_bf16 v[116:119], v[60:63], a[52:55], v[116:119]
v_mul_f32 v79, v79, v87
v_mfma_f32_16x16x32_bf16 v[104:107], v[64:67], a[56:59], v[104:107]
ds_read_b128 v[56:59], v2 offset:36864
buffer_load_dword v29, v26, s[4:7], s41 offen offset:512 sc1
v_mfma_f32_16x16x32_bf16 v[108:111], v[64:67], a[60:63], v[108:111]
v_fma_f32 v240, v240, v202, v202
v_fma_f32 v241, v241, v202, v202
v_fma_f32 v242, v242, v202, v202
v_mfma_f32_16x16x32_bf16 v[112:115], v[68:71], a[56:59], v[112:115]
ds_read_b128 v[60:63], v2 offset:37888
buffer_load_dwordx4 v1, s[4:7], s47 offen offset:2048 sc1 lds
v_mfma_f32_16x16x32_bf16 v[116:119], v[68:71], a[60:63], v[116:119]
v_fma_f32 v243, v243, v202, v202
v_fma_f32 v244, v244, v203, v203
s_waitcnt lgkmcnt(2)
v_mfma_f32_16x16x32_bf16 v[104:107], v[40:43], a[64:67], v[104:107]
ds_read_b128 v[64:67], v2 offset:38912
v_fma_f32 v245, v245, v203, v203
v_mfma_f32_16x16x32_bf16 v[108:111], v[40:43], a[68:71], v[108:111]
v_fma_f32 v246, v246, v203, v203
v_fma_f32 v247, v247, v203, v203
v_mfma_f32_16x16x32_bf16 v[112:115], v[44:47], a[64:67], v[112:115]
ds_read_b128 v[68:71], v2 offset:39936
buffer_load_dwordx4 v1, s[4:7], s47 offen offset:3072 sc1 lds
v_mfma_f32_16x16x32_bf16 v[116:119], v[44:47], a[68:71], v[116:119]
v_rcp_f32 v240, v240
v_rcp_f32 v241, v241
v_mfma_f32_16x16x32_bf16 v[104:107], v[48:51], a[72:75], v[104:107]
ds_read_b128 v[40:43], v2 offset:40960
v_rcp_f32 v242, v242
v_mfma_f32_16x16x32_bf16 v[108:111], v[48:51], a[76:79], v[108:111]
v_rcp_f32 v243, v243
v_mfma_f32_16x16x32_bf16 v[112:115], v[52:55], a[72:75], v[112:115]
ds_read_b128 v[44:47], v2 offset:41984
s_add_u32 s57, s20, 147456
v_mfma_f32_16x16x32_bf16 v[116:119], v[52:55], a[76:79], v[116:119]
buffer_load_dwordx4 a[144:147], v1, s[4:7], s57 offen offset:0 sc1
s_waitcnt lgkmcnt(2)
v_mfma_f32_16x16x32_bf16 v[104:107], v[56:59], a[80:83], v[104:107]
ds_read_b128 v[48:51], v2 offset:43008
v_rcp_f32 v244, v244
v_mfma_f32_16x16x32_bf16 v[108:111], v[56:59], a[84:87], v[108:111]
v_rcp_f32 v245, v245
v_mfma_f32_16x16x32_bf16 v[112:115], v[60:63], a[80:83], v[112:115]
ds_read_b128 v[52:55], v2 offset:44032
buffer_load_dwordx4 a[148:151], v1, s[4:7], s57 offen offset:1024 sc1
v_mfma_f32_16x16x32_bf16 v[116:119], v[60:63], a[84:87], v[116:119]
v_rcp_f32 v246, v246
v_mfma_f32_16x16x32_bf16 v[104:107], v[64:67], a[88:91], v[104:107]
ds_read_b128 v[56:59], v2 offset:45056
v_rcp_f32 v247, v247
v_mfma_f32_16x16x32_bf16 v[108:111], v[64:67], a[92:95], v[108:111]
v_mul_f32 v72, v72, v240
v_mul_f32 v73, v73, v241
v_mul_f32 v74, v74, v242
v_mfma_f32_16x16x32_bf16 v[112:115], v[68:71], a[88:91], v[112:115]
ds_read_b128 v[60:63], v2 offset:46080
buffer_load_dwordx4 a[152:155], v1, s[4:7], s57 offen offset:2048 sc1
v_mfma_f32_16x16x32_bf16 v[116:119], v[68:71], a[92:95], v[116:119]
v_mul_f32 v75, v75, v243
v_mul_f32 v76, v76, v244
s_waitcnt lgkmcnt(2)
v_mfma_f32_16x16x32_bf16 v[104:107], v[40:43], a[96:99], v[104:107]
ds_read_b128 v[64:67], v2 offset:47104
v_mul_f32 v77, v77, v245
v_mul_f32 v78, v78, v246
v_mfma_f32_16x16x32_bf16 v[108:111], v[40:43], a[100:103], v[108:111]
v_mul_f32 v79, v79, v247
v_cvt_pk_bf16_f32 v248, v72, v73
v_mfma_f32_16x16x32_bf16 v[112:115], v[44:47], a[96:99], v[112:115]
s_waitcnt vmcnt(12)
s_barrier
ds_read_b128 v[68:71], v2 offset:48128
v_mfma_f32_16x16x32_bf16 v[116:119], v[44:47], a[100:103], v[116:119]
buffer_load_dwordx4 a[156:159], v1, s[4:7], s57 offen offset:3072 sc1
v_cvt_pk_bf16_f32 v249, v74, v75
v_mfma_f32_16x16x32_bf16 v[104:107], v[48:51], a[104:107], v[104:107]
ds_read_b128 v[40:43], v1 offset:49152
v_cvt_pk_bf16_f32 v252, v76, v77
v_mfma_f32_16x16x32_bf16 v[108:111], v[48:51], a[108:111], v[108:111]
v_cvt_pk_bf16_f32 v253, v78, v79
v_mfma_f32_16x16x32_bf16 v[112:115], v[52:55], a[104:107], v[112:115]
ds_read_b128 v[44:47], v1 offset:50176
ds_read_b64 v[224:225], v25 offset:512
ds_read_b64 v[228:229], v25 offset:640
s_add_u32 m0, s21, 32768
v_mfma_f32_16x16x32_bf16 v[116:119], v[52:55], a[108:111], v[116:119]
s_add_u32 s47, s19, 131072
buffer_load_dwordx4 v1, s[4:7], s47 offen offset:0 sc1 lds
s_waitcnt lgkmcnt(4)
v_mfma_f32_16x16x32_bf16 v[104:107], v[56:59], a[112:115], v[104:107]
ds_read_b128 v[48:51], v1 offset:51200
buffer_load_dword v29, v26, s[4:7], s41 offen offset:1024 sc1
v_mfma_f32_16x16x32_bf16 v[108:111], v[56:59], a[116:119], v[108:111]
v_mul_f32 v240, v200, v88
v_mul_f32 v241, v200, v89
v_mfma_f32_16x16x32_bf16 v[112:115], v[60:63], a[112:115], v[112:115]
ds_read_b128 v[52:55], v1 offset:52224
buffer_load_dwordx4 v1, s[4:7], s47 offen offset:1024 sc1 lds
v_mfma_f32_16x16x32_bf16 v[116:119], v[60:63], a[116:119], v[116:119]
v_mul_f32 v242, v200, v90
v_mul_f32 v243, v200, v91
v_mfma_f32_16x16x32_bf16 v[104:107], v[64:67], a[120:123], v[104:107]
ds_read_b128 v[56:59], v1 offset:53248
v_mul_f32 v244, v201, v92
v_mul_f32 v245, v201, v93
v_mfma_f32_16x16x32_bf16 v[108:111], v[64:67], a[124:127], v[108:111]
v_mul_f32 v246, v201, v94
v_mul_f32 v247, v201, v95
v_mfma_f32_16x16x32_bf16 v[112:115], v[68:71], a[120:123], v[112:115]
ds_read_b128 v[60:63], v1 offset:54272
buffer_load_dwordx4 v1, s[4:7], s47 offen offset:2048 sc1 lds
v_mfma_f32_16x16x32_bf16 v[116:119], v[68:71], a[124:127], v[116:119]
v_exp_f32 v240, v240
v_mul_f32 v88, v88, v96
s_waitcnt lgkmcnt(5)
v_mfma_f32_16x16x32_bf16 v[104:107], v[224:227], v[232:235], v[104:107]
v_mfma_f32_16x16x32_bf16 v[108:111], v[224:227], v[236:239], v[108:111]
s_waitcnt lgkmcnt(4)
v_mfma_f32_16x16x32_bf16 v[112:115], v[228:231], v[232:235], v[112:115]
v_mfma_f32_16x16x32_bf16 v[116:119], v[228:231], v[236:239], v[116:119]
s_waitcnt lgkmcnt(2)
v_mfma_f32_16x16x32_bf16 v[72:75], v[40:43], a[0:3], 0
ds_read_b128 v[64:67], v1 offset:55296
v_exp_f32 v241, v241
v_mfma_f32_16x16x32_bf16 v[76:79], v[40:43], a[4:7], 0
v_mul_f32 v89, v89, v97
v_mfma_f32_16x16x32_bf16 v[80:83], v[44:47], a[0:3], 0
ds_read_b128 v[68:71], v1 offset:56320
buffer_load_dwordx4 v1, s[4:7], s47 offen offset:3072 sc1 lds
v_mfma_f32_16x16x32_bf16 v[84:87], v[44:47], a[4:7], 0
v_exp_f32 v242, v242
v_mul_f32 v90, v90, v98
v_mfma_f32_16x16x32_bf16 v[72:75], v[48:51], a[8:11], v[72:75]
ds_read_b128 v[40:43], v1 offset:57344
v_exp_f32 v243, v243
v_mfma_f32_16x16x32_bf16 v[76:79], v[48:51], a[12:15], v[76:79]
v_mul_f32 v91, v91, v99
v_exp_f32 v244, v244
v_mfma_f32_16x16x32_bf16 v[80:83], v[52:55], a[8:11], v[80:83]
ds_read_b128 v[44:47], v1 offset:58368
s_add_u32 m0, s21, 81920
s_add_u32 s47, s20, 16384
v_mfma_f32_16x16x32_bf16 v[84:87], v[52:55], a[12:15], v[84:87]
buffer_load_dwordx4 v1, s[4:7], s47 offen offset:0 sc1 lds
s_waitcnt lgkmcnt(2)
v_mfma_f32_16x16x32_bf16 v[72:75], v[56:59], a[16:19], v[72:75]
ds_read_b128 v[48:51], v1 offset:59392
buffer_load_dwordx4 v1, s[4:7], s47 offen offset:1024 sc1 lds
v_mfma_f32_16x16x32_bf16 v[76:79], v[56:59], a[20:23], v[76:79]
v_mul_f32 v92, v92, v100
v_mfma_f32_16x16x32_bf16 v[80:83], v[60:63], a[16:19], v[80:83]
ds_read_b128 v[52:55], v1 offset:60416
v_exp_f32 v245, v245
v_mfma_f32_16x16x32_bf16 v[84:87], v[60:63], a[20:23], v[84:87]
v_mul_f32 v93, v93, v101
v_exp_f32 v246, v246
v_mfma_f32_16x16x32_bf16 v[72:75], v[64:67], a[24:27], v[72:75]
ds_read_b128 v[56:59], v1 offset:61440
buffer_load_dwordx4 v1, s[4:7], s47 offen offset:2048 sc1 lds
v_mfma_f32_16x16x32_bf16 v[76:79], v[64:67], a[28:31], v[76:79]
v_mul_f32 v94, v94, v102
v_exp_f32 v247, v247
v_mfma_f32_16x16x32_bf16 v[80:83], v[68:71], a[24:27], v[80:83]
ds_read_b128 v[60:63], v1 offset:62464
v_mul_f32 v95, v95, v103
v_mfma_f32_16x16x32_bf16 v[84:87], v[68:71], a[28:31], v[84:87]
v_fma_f32 v240, v240, v202, v202
v_fma_f32 v241, v241, v202, v202
s_waitcnt lgkmcnt(2)
v_mfma_f32_16x16x32_bf16 v[72:75], v[40:43], a[32:35], v[72:75]
ds_read_b128 v[64:67], v1 offset:63488
buffer_load_dwordx4 v1, s[4:7], s47 offen offset:3072 sc1 lds
v_mfma_f32_16x16x32_bf16 v[76:79], v[40:43], a[36:39], v[76:79]
v_fma_f32 v242, v242, v202, v202
v_fma_f32 v243, v243, v202, v202
v_fma_f32 v244, v244, v203, v203
v_mfma_f32_16x16x32_bf16 v[80:83], v[44:47], a[32:35], v[80:83]
s_waitcnt vmcnt(13)
s_barrier
ds_read_b128 v[68:71], v1 offset:64512
v_mfma_f32_16x16x32_bf16 v[84:87], v[44:47], a[36:39], v[84:87]
v_fma_f32 v245, v245, v203, v203
v_fma_f32 v246, v246, v203, v203
v_mfma_f32_16x16x32_bf16 v[72:75], v[48:51], a[40:43], v[72:75]
ds_read_b128 v[40:43], v1 offset:16384
s_add_u32 m0, s21, 98304
s_add_u32 s47, s19, 147456
v_mfma_f32_16x16x32_bf16 v[76:79], v[48:51], a[44:47], v[76:79]
buffer_load_dwordx4 v1, s[4:7], s47 offen offset:0 sc1 lds
v_mfma_f32_16x16x32_bf16 v[80:83], v[52:55], a[40:43], v[80:83]
ds_read_b128 v[44:47], v1 offset:17408
buffer_load_dword v29, v26, s[4:7], s41 offen offset:1536 sc1
v_mfma_f32_16x16x32_bf16 v[84:87], v[52:55], a[44:47], v[84:87]
v_fma_f32 v247, v247, v203, v203
v_rcp_f32 v240, v240
s_waitcnt lgkmcnt(2)
v_mfma_f32_16x16x32_bf16 v[72:75], v[56:59], a[48:51], v[72:75]
ds_read_b128 v[48:51], v1 offset:18432
buffer_load_dwordx4 v1, s[4:7], s47 offen offset:1024 sc1 lds
v_mfma_f32_16x16x32_bf16 v[76:79], v[56:59], a[52:55], v[76:79]
v_rcp_f32 v241, v241
v_mfma_f32_16x16x32_bf16 v[80:83], v[60:63], a[48:51], v[80:83]
ds_read_b128 v[52:55], v1 offset:19456
v_rcp_f32 v242, v242
v_mfma_f32_16x16x32_bf16 v[84:87], v[60:63], a[52:55], v[84:87]
v_rcp_f32 v243, v243
v_mfma_f32_16x16x32_bf16 v[72:75], v[64:67], a[56:59], v[72:75]
ds_read_b128 v[56:59], v1 offset:20480
buffer_load_dwordx4 v1, s[4:7], s47 offen offset:2048 sc1 lds
v_mfma_f32_16x16x32_bf16 v[76:79], v[64:67], a[60:63], v[76:79]
v_rcp_f32 v244, v244
v_mfma_f32_16x16x32_bf16 v[80:83], v[68:71], a[56:59], v[80:83]
ds_read_b128 v[60:63], v1 offset:21504
v_rcp_f32 v245, v245
v_mfma_f32_16x16x32_bf16 v[84:87], v[68:71], a[60:63], v[84:87]
v_rcp_f32 v246, v246
s_waitcnt lgkmcnt(2)
v_mfma_f32_16x16x32_bf16 v[72:75], v[40:43], a[64:67], v[72:75]
ds_read_b128 v[64:67], v1 offset:22528
buffer_load_dwordx4 v1, s[4:7], s47 offen offset:3072 sc1 lds
v_mfma_f32_16x16x32_bf16 v[76:79], v[40:43], a[68:71], v[76:79]
v_rcp_f32 v247, v247
v_mfma_f32_16x16x32_bf16 v[80:83], v[44:47], a[64:67], v[80:83]
ds_read_b128 v[68:71], v1 offset:23552
v_mul_f32 v88, v88, v240
v_mul_f32 v89, v89, v241
v_mfma_f32_16x16x32_bf16 v[84:87], v[44:47], a[68:71], v[84:87]
v_mul_f32 v90, v90, v242
v_mul_f32 v91, v91, v243
v_mfma_f32_16x16x32_bf16 v[72:75], v[48:51], a[72:75], v[72:75]
ds_read_b128 v[40:43], v1 offset:24576
s_add_u32 s57, s20, 163840
v_mfma_f32_16x16x32_bf16 v[76:79], v[48:51], a[76:79], v[76:79]
buffer_load_dwordx4 a[160:163], v1, s[4:7], s57 offen offset:0 sc1
v_mul_f32 v92, v92, v244
v_mfma_f32_16x16x32_bf16 v[80:83], v[52:55], a[72:75], v[80:83]
ds_read_b128 v[44:47], v1 offset:25600
v_mul_f32 v93, v93, v245
v_mul_f32 v94, v94, v246
v_mfma_f32_16x16x32_bf16 v[84:87], v[52:55], a[76:79], v[84:87]
v_mul_f32 v95, v95, v247
v_cvt_pk_bf16_f32 v250, v88, v89
v_cvt_pk_bf16_f32 v251, v90, v91
s_waitcnt lgkmcnt(2)
v_mfma_f32_16x16x32_bf16 v[72:75], v[56:59], a[80:83], v[72:75]
ds_read_b128 v[48:51], v1 offset:26624
buffer_load_dwordx4 a[164:167], v1, s[4:7], s57 offen offset:1024 sc1
v_mfma_f32_16x16x32_bf16 v[76:79], v[56:59], a[84:87], v[76:79]
v_cvt_pk_bf16_f32 v254, v92, v93
v_cvt_pk_bf16_f32 v255, v94, v95
v_mfma_f32_16x16x32_bf16 v[80:83], v[60:63], a[80:83], v[80:83]
ds_read_b128 v[52:55], v1 offset:27648
buffer_store_dwordx4 v[248:251], v1, s[4:7], s32 offen offset:0
v_mfma_f32_16x16x32_bf16 v[84:87], v[60:63], a[84:87], v[84:87]
buffer_store_dwordx4 v[252:255], v1, s[4:7], s58 offen offset:0
v_mfma_f32_16x16x32_bf16 v[72:75], v[64:67], a[88:91], v[72:75]
ds_read_b128 v[56:59], v1 offset:28672
buffer_load_dwordx4 a[168:171], v1, s[4:7], s57 offen offset:2048 sc1
v_mfma_f32_16x16x32_bf16 v[76:79], v[64:67], a[92:95], v[76:79]
v_mul_f32 v240, v200, v104
v_mul_f32 v241, v200, v105
v_mul_f32 v242, v200, v106
v_mfma_f32_16x16x32_bf16 v[80:83], v[68:71], a[88:91], v[80:83]
ds_read_b128 v[60:63], v1 offset:29696
v_mul_f32 v243, v200, v107
v_mul_f32 v244, v201, v108
v_mfma_f32_16x16x32_bf16 v[84:87], v[68:71], a[92:95], v[84:87]
v_mul_f32 v245, v201, v109
v_mul_f32 v246, v201, v110
s_waitcnt lgkmcnt(2)
v_mfma_f32_16x16x32_bf16 v[72:75], v[40:43], a[96:99], v[72:75]
ds_read_b128 v[64:67], v1 offset:30720
buffer_load_dwordx4 a[172:175], v1, s[4:7], s57 offen offset:3072 sc1
v_mfma_f32_16x16x32_bf16 v[76:79], v[40:43], a[100:103], v[76:79]
v_mul_f32 v247, v201, v111
v_exp_f32 v240, v240
v_mfma_f32_16x16x32_bf16 v[80:83], v[44:47], a[96:99], v[80:83]
s_waitcnt vmcnt(15)
s_barrier
ds_read_b128 v[68:71], v1 offset:31744
v_mfma_f32_16x16x32_bf16 v[84:87], v[44:47], a[100:103], v[84:87]
v_mul_f32 v104, v104, v112
v_exp_f32 v241, v241
v_mfma_f32_16x16x32_bf16 v[72:75], v[48:51], a[104:107], v[72:75]
ds_read_b128 v[40:43], v1 offset:32768
s_add_u32 m0, s21, 49152
s_add_u32 s47, s19, 163840
v_mfma_f32_16x16x32_bf16 v[76:79], v[48:51], a[108:111], v[76:79]
buffer_load_dwordx4 v1, s[4:7], s47 offen offset:0 sc1 lds
v_mfma_f32_16x16x32_bf16 v[80:83], v[52:55], a[104:107], v[80:83]
ds_read_b128 v[44:47], v1 offset:33792
ds_read_b64 v[224:225], v25 offset:768
ds_read_b64 v[228:229], v25 offset:896
v_mfma_f32_16x16x32_bf16 v[84:87], v[52:55], a[108:111], v[84:87]
v_mul_f32 v105, v105, v113
v_exp_f32 v242, v242
s_waitcnt lgkmcnt(4)
v_mfma_f32_16x16x32_bf16 v[72:75], v[56:59], a[112:115], v[72:75]
ds_read_b128 v[48:51], v1 offset:34816
buffer_load_dwordx4 v1, s[4:7], s47 offen offset:1024 sc1 lds
v_mfma_f32_16x16x32_bf16 v[76:79], v[56:59], a[116:119], v[76:79]
v_mul_f32 v106, v106, v114
v_exp_f32 v243, v243
v_mfma_f32_16x16x32_bf16 v[80:83], v[60:63], a[112:115], v[80:83]
ds_read_b128 v[52:55], v1 offset:35840
v_mul_f32 v107, v107, v115
v_mfma_f32_16x16x32_bf16 v[84:87], v[60:63], a[116:119], v[84:87]
v_exp_f32 v244, v244
v_mul_f32 v108, v108, v116
v_mfma_f32_16x16x32_bf16 v[72:75], v[64:67], a[120:123], v[72:75]
ds_read_b128 v[56:59], v1 offset:36864
buffer_load_dwordx4 v1, s[4:7], s47 offen offset:2048 sc1 lds
v_mfma_f32_16x16x32_bf16 v[76:79], v[64:67], a[124:127], v[76:79]
v_exp_f32 v245, v245
v_mfma_f32_16x16x32_bf16 v[80:83], v[68:71], a[120:123], v[80:83]
ds_read_b128 v[60:63], v1 offset:37888
s_getpc_b64 s[64:65]
LF1_pc18:
s_lshr_b32 s51, s2, 3
s_lshl_b32 s51, s51, 2
s_add_u32 s51, s51, s14
s_lshl_b32 s51, s51, 8
v_mfma_f32_16x16x32_bf16 v[84:87], v[68:71], a[124:127], v[84:87]
s_add_u32 s51, s51, 0
v_lshrrev_b32 v212, 2, v1
v_add_u32 v212, s51, v212
global_load_dword v29, v212, s[64:65]
s_waitcnt lgkmcnt(5)
v_mfma_f32_16x16x32_bf16 v[72:75], v[224:227], v[232:235], v[72:75]
v_mfma_f32_16x16x32_bf16 v[76:79], v[224:227], v[236:239], v[76:79]
s_waitcnt lgkmcnt(4)
v_mfma_f32_16x16x32_bf16 v[80:83], v[228:231], v[232:235], v[80:83]
v_mfma_f32_16x16x32_bf16 v[84:87], v[228:231], v[236:239], v[84:87]
s_waitcnt lgkmcnt(2)
v_mfma_f32_16x16x32_bf16 v[88:91], v[40:43], a[0:3], 0
ds_read_b128 v[64:67], v1 offset:38912
v_mfma_f32_16x16x32_bf16 v[92:95], v[40:43], a[4:7], 0
buffer_load_dwordx4 v1, s[4:7], s47 offen offset:3072 sc1 lds
v_mfma_f32_16x16x32_bf16 v[96:99], v[44:47], a[0:3], 0
ds_read_b128 v[68:71], v1 offset:39936
v_mfma_f32_16x16x32_bf16 v[100:103], v[44:47], a[4:7], 0
v_mul_f32 v109, v109, v117
v_mfma_f32_16x16x32_bf16 v[88:91], v[48:51], a[8:11], v[88:91]
ds_read_b128 v[40:43], v1 offset:40960
s_add_u32 m0, s21, 0
s_add_u32 s47, s20, 32768
v_mfma_f32_16x16x32_bf16 v[92:95], v[48:51], a[12:15], v[92:95]
buffer_load_dwordx4 v1, s[4:7], s47 offen offset:0 sc1 lds
v_exp_f32 v246, v246
v_mfma_f32_16x16x32_bf16 v[96:99], v[52:55], a[8:11], v[96:99]
ds_read_b128 v[44:47], v1 offset:41984
v_mul_f32 v110, v110, v118
v_mfma_f32_16x16x32_bf16 v[100:103], v[52:55], a[12:15], v[100:103]
v_exp_f32 v247, v247
v_mul_f32 v111, v111, v119
s_waitcnt lgkmcnt(2)
v_mfma_f32_16x16x32_bf16 v[88:91], v[56:59], a[16:19], v[88:91]
ds_read_b128 v[48:51], v1 offset:43008
buffer_load_dwordx4 v1, s[4:7], s47 offen offset:1024 sc1 lds
v_mfma_f32_16x16x32_bf16 v[92:95], v[56:59], a[20:23], v[92:95]
v_fma_f32 v240, v240, v202, v202
v_fma_f32 v241, v241, v202, v202
v_fma_f32 v242, v242, v202, v202
v_mfma_f32_16x16x32_bf16 v[96:99], v[60:63], a[16:19], v[96:99]
ds_read_b128 v[52:55], v1 offset:44032
v_fma_f32 v243, v243, v202, v202
v_fma_f32 v244, v244, v203, v203
v_mfma_f32_16x16x32_bf16 v[100:103], v[60:63], a[20:23], v[100:103]
v_fma_f32 v245, v245, v203, v203
v_fma_f32 v246, v246, v203, v203
v_mfma_f32_16x16x32_bf16 v[88:91], v[64:67], a[24:27], v[88:91]
ds_read_b128 v[56:59], v1 offset:45056
buffer_load_dwordx4 v1, s[4:7], s47 offen offset:2048 sc1 lds
v_mfma_f32_16x16x32_bf16 v[92:95], v[64:67], a[28:31], v[92:95]
v_fma_f32 v247, v247, v203, v203
v_rcp_f32 v240, v240
v_mfma_f32_16x16x32_bf16 v[96:99], v[68:71], a[24:27], v[96:99]
ds_read_b128 v[60:63], v1 offset:46080
v_rcp_f32 v241, v241
v_mfma_f32_16x16x32_bf16 v[100:103], v[68:71], a[28:31], v[100:103]
v_rcp_f32 v242, v242
s_waitcnt lgkmcnt(2)
v_mfma_f32_16x16x32_bf16 v[88:91], v[40:43], a[32:35], v[88:91]
ds_read_b128 v[64:67], v1 offset:47104
buffer_load_dwordx4 v1, s[4:7], s47 offen offset:3072 sc1 lds
v_mfma_f32_16x16x32_bf16 v[92:95], v[40:43], a[36:39], v[92:95]
v_rcp_f32 v243, v243
v_mfma_f32_16x16x32_bf16 v[96:99], v[44:47], a[32:35], v[96:99]
s_waitcnt vmcnt(15)
s_barrier
ds_read_b128 v[68:71], v1 offset:48128
v_mfma_f32_16x16x32_bf16 v[100:103], v[44:47], a[36:39], v[100:103]
v_rcp_f32 v244, v244
v_rcp_f32 v245, v245
v_mfma_f32_16x16x32_bf16 v[88:91], v[48:51], a[40:43], v[88:91]
ds_read_b128 v[40:43], v2 offset:32768
s_add_u32 m0, s21, 16384
s_add_u32 s47, s19, 180224
v_mfma_f32_16x16x32_bf16 v[92:95], v[48:51], a[44:47], v[92:95]
buffer_load_dwordx4 v1, s[4:7], s47 offen offset:0 sc1 lds
v_mfma_f32_16x16x32_bf16 v[96:99], v[52:55], a[40:43], v[96:99]
ds_read_b128 v[44:47], v2 offset:33792
v_rcp_f32 v246, v246
v_mfma_f32_16x16x32_bf16 v[100:103], v[52:55], a[44:47], v[100:103]
v_rcp_f32 v247, v247
v_mul_f32 v104, v104, v240
s_waitcnt lgkmcnt(2)
v_mfma_f32_16x16x32_bf16 v[88:91], v[56:59], a[48:51], v[88:91]
ds_read_b128 v[48:51], v2 offset:34816
buffer_load_dwordx4 v1, s[4:7], s47 offen offset:1024 sc1 lds
v_mfma_f32_16x16x32_bf16 v[92:95], v[56:59], a[52:55], v[92:95]
s_waitcnt vmcnt(13)
buffer_store_dwordx2 v[36:37], v26, s[4:7], s40 offen offset:0
v_mfma_f32_16x16x32_bf16 v[96:99], v[60:63], a[48:51], v[96:99]
ds_read_b128 v[52:55], v2 offset:35840
v_mul_f32 v105, v105, v241
v_mul_f32 v106, v106, v242
v_mfma_f32_16x16x32_bf16 v[100:103], v[60:63], a[52:55], v[100:103]
v_mul_f32 v107, v107, v243
v_mul_f32 v108, v108, v244
v_mfma_f32_16x16x32_bf16 v[88:91], v[64:67], a[56:59], v[88:91]
ds_read_b128 v[56:59], v2 offset:36864
buffer_load_dwordx4 v1, s[4:7], s47 offen offset:2048 sc1 lds
v_mfma_f32_16x16x32_bf16 v[92:95], v[64:67], a[60:63], v[92:95]
v_mul_f32 v109, v109, v245
v_mul_f32 v110, v110, v246
v_mfma_f32_16x16x32_bf16 v[96:99], v[68:71], a[56:59], v[96:99]
ds_read_b128 v[60:63], v2 offset:37888
v_mul_f32 v111, v111, v247
v_cvt_pk_bf16_f32 v248, v104, v105
v_mfma_f32_16x16x32_bf16 v[100:103], v[68:71], a[60:63], v[100:103]
v_cvt_pk_bf16_f32 v249, v106, v107
v_cvt_pk_bf16_f32 v252, v108, v109
v_cvt_pk_bf16_f32 v253, v110, v111
s_waitcnt lgkmcnt(2)
v_mfma_f32_16x16x32_bf16 v[88:91], v[40:43], a[64:67], v[88:91]
ds_read_b128 v[64:67], v2 offset:38912
buffer_load_dwordx4 v1, s[4:7], s47 offen offset:3072 sc1 lds
v_mfma_f32_16x16x32_bf16 v[92:95], v[40:43], a[68:71], v[92:95]
v_mul_f32 v240, v200, v72
v_mul_f32 v241, v200, v73
v_mfma_f32_16x16x32_bf16 v[96:99], v[44:47], a[64:67], v[96:99]
ds_read_b128 v[68:71], v2 offset:39936
v_mul_f32 v242, v200, v74
v_mul_f32 v243, v200, v75
v_mfma_f32_16x16x32_bf16 v[100:103], v[44:47], a[68:71], v[100:103]
v_mul_f32 v244, v201, v76
v_mul_f32 v245, v201, v77
v_mul_f32 v246, v201, v78
v_mfma_f32_16x16x32_bf16 v[88:91], v[48:51], a[72:75], v[88:91]
ds_read_b128 v[40:43], v2 offset:40960
s_add_u32 s57, s20, 180224
v_mfma_f32_16x16x32_bf16 v[92:95], v[48:51], a[76:79], v[92:95]
buffer_load_dwordx4 a[176:179], v1, s[4:7], s57 offen offset:0 sc1
v_mul_f32 v247, v201, v79
v_mfma_f32_16x16x32_bf16 v[96:99], v[52:55], a[72:75], v[96:99]
ds_read_b128 v[44:47], v2 offset:41984
v_exp_f32 v240, v240
v_mfma_f32_16x16x32_bf16 v[100:103], v[52:55], a[76:79], v[100:103]
v_mul_f32 v72, v72, v80
v_exp_f32 v241, v241
s_waitcnt lgkmcnt(2)
v_mfma_f32_16x16x32_bf16 v[88:91], v[56:59], a[80:83], v[88:91]
ds_read_b128 v[48:51], v2 offset:43008
buffer_load_dwordx4 a[180:183], v1, s[4:7], s57 offen offset:1024 sc1
v_mfma_f32_16x16x32_bf16 v[92:95], v[56:59], a[84:87], v[92:95]
v_mul_f32 v73, v73, v81
v_mfma_f32_16x16x32_bf16 v[96:99], v[60:63], a[80:83], v[96:99]
ds_read_b128 v[52:55], v2 offset:44032
v_exp_f32 v242, v242
v_mfma_f32_16x16x32_bf16 v[100:103], v[60:63], a[84:87], v[100:103]
v_mul_f32 v74, v74, v82
v_exp_f32 v243, v243
v_mfma_f32_16x16x32_bf16 v[88:91], v[64:67], a[88:91], v[88:91]
ds_read_b128 v[56:59], v2 offset:45056
buffer_load_dwordx4 a[184:187], v1, s[4:7], s57 offen offset:2048 sc1
v_mfma_f32_16x16x32_bf16 v[92:95], v[64:67], a[92:95], v[92:95]
v_mul_f32 v75, v75, v83
v_exp_f32 v244, v244
v_mfma_f32_16x16x32_bf16 v[96:99], v[68:71], a[88:91], v[96:99]
ds_read_b128 v[60:63], v2 offset:46080
v_mul_f32 v76, v76, v84
v_mfma_f32_16x16x32_bf16 v[100:103], v[68:71], a[92:95], v[100:103]
v_exp_f32 v245, v245
s_waitcnt lgkmcnt(2)
v_mfma_f32_16x16x32_bf16 v[88:91], v[40:43], a[96:99], v[88:91]
ds_read_b128 v[64:67], v2 offset:47104
buffer_load_dwordx4 a[188:191], v1, s[4:7], s57 offen offset:3072 sc1
v_mfma_f32_16x16x32_bf16 v[92:95], v[40:43], a[100:103], v[92:95]
v_mul_f32 v77, v77, v85
v_exp_f32 v246, v246
v_mfma_f32_16x16x32_bf16 v[96:99], v[44:47], a[96:99], v[96:99]
s_waitcnt vmcnt(13)
s_barrier
ds_read_b128 v[68:71], v2 offset:48128
v_mfma_f32_16x16x32_bf16 v[100:103], v[44:47], a[100:103], v[100:103]
v_mul_f32 v78, v78, v86
v_exp_f32 v247, v247
v_mfma_f32_16x16x32_bf16 v[88:91], v[48:51], a[104:107], v[88:91]
ds_read_b128 v[40:43], v1 offset:49152
s_add_u32 m0, s21, 32768
s_add_u32 s47, s19, 196608
v_mfma_f32_16x16x32_bf16 v[92:95], v[48:51], a[108:111], v[92:95]
buffer_load_dwordx4 v1, s[4:7], s47 offen offset:0 sc1 lds
v_mfma_f32_16x16x32_bf16 v[96:99], v[52:55], a[104:107], v[96:99]
ds_read_b128 v[44:47], v1 offset:50176
ds_read_b64 v[224:225], v25 offset:1024
ds_read_b64 v[228:229], v25 offset:1152
v_mfma_f32_16x16x32_bf16 v[100:103], v[52:55], a[108:111], v[100:103]
v_mul_f32 v79, v79, v87
v_fma_f32 v240, v240, v202, v202
s_waitcnt lgkmcnt(4)
v_mfma_f32_16x16x32_bf16 v[88:91], v[56:59], a[112:115], v[88:91]
ds_read_b128 v[48:51], v1 offset:51200
buffer_load_dwordx4 v1, s[4:7], s47 offen offset:1024 sc1 lds
v_mfma_f32_16x16x32_bf16 v[92:95], v[56:59], a[116:119], v[92:95]
v_fma_f32 v241, v241, v202, v202
v_fma_f32 v242, v242, v202, v202
v_mfma_f32_16x16x32_bf16 v[96:99], v[60:63], a[112:115], v[96:99]
ds_read_b128 v[52:55], v1 offset:52224
buffer_load_dwordx4 v1, s[4:7], s47 offen offset:2048 sc1 lds
v_mfma_f32_16x16x32_bf16 v[100:103], v[60:63], a[116:119], v[100:103]
v_fma_f32 v243, v243, v202, v202
v_fma_f32 v244, v244, v203, v203
v_mfma_f32_16x16x32_bf16 v[88:91], v[64:67], a[120:123], v[88:91]
ds_read_b128 v[56:59], v1 offset:53248
v_fma_f32 v245, v245, v203, v203
v_fma_f32 v246, v246, v203, v203
v_mfma_f32_16x16x32_bf16 v[92:95], v[64:67], a[124:127], v[92:95]
v_fma_f32 v247, v247, v203, v203
v_rcp_f32 v240, v240
v_mfma_f32_16x16x32_bf16 v[96:99], v[68:71], a[120:123], v[96:99]
ds_read_b128 v[60:63], v1 offset:54272
buffer_load_dwordx4 v1, s[4:7], s47 offen offset:3072 sc1 lds
v_mfma_f32_16x16x32_bf16 v[100:103], v[68:71], a[124:127], v[100:103]
v_rcp_f32 v241, v241
s_waitcnt lgkmcnt(5)
v_mfma_f32_16x16x32_bf16 v[88:91], v[224:227], v[232:235], v[88:91]
v_mfma_f32_16x16x32_bf16 v[92:95], v[224:227], v[236:239], v[92:95]
s_waitcnt lgkmcnt(4)
v_mfma_f32_16x16x32_bf16 v[96:99], v[228:231], v[232:235], v[96:99]
v_mfma_f32_16x16x32_bf16 v[100:103], v[228:231], v[236:239], v[100:103]
s_waitcnt lgkmcnt(2)
v_mfma_f32_16x16x32_bf16 v[104:107], v[40:43], a[0:3], 0
ds_read_b128 v[64:67], v1 offset:55296
v_rcp_f32 v242, v242
v_mfma_f32_16x16x32_bf16 v[108:111], v[40:43], a[4:7], 0
v_rcp_f32 v243, v243
v_mfma_f32_16x16x32_bf16 v[112:115], v[44:47], a[0:3], 0
ds_read_b128 v[68:71], v1 offset:56320
s_add_u32 m0, s21, 114688
s_add_u32 s47, s20, 49152
v_mfma_f32_16x16x32_bf16 v[116:119], v[44:47], a[4:7], 0
buffer_load_dwordx4 v1, s[4:7], s47 offen offset:0 sc1 lds
v_mfma_f32_16x16x32_bf16 v[104:107], v[48:51], a[8:11], v[104:107]
ds_read_b128 v[40:43], v1 offset:57344
v_rcp_f32 v244, v244
v_mfma_f32_16x16x32_bf16 v[108:111], v[48:51], a[12:15], v[108:111]
v_rcp_f32 v245, v245
v_mfma_f32_16x16x32_bf16 v[112:115], v[52:55], a[8:11], v[112:115]
ds_read_b128 v[44:47], v1 offset:58368
buffer_load_dwordx4 v1, s[4:7], s47 offen offset:1024 sc1 lds
v_mfma_f32_16x16x32_bf16 v[116:119], v[52:55], a[12:15], v[116:119]
v_rcp_f32 v246, v246
v_rcp_f32 v247, v247
s_waitcnt lgkmcnt(2)
v_mfma_f32_16x16x32_bf16 v[104:107], v[56:59], a[16:19], v[104:107]
ds_read_b128 v[48:51], v1 offset:59392
v_mul_f32 v72, v72, v240
v_mfma_f32_16x16x32_bf16 v[108:111], v[56:59], a[20:23], v[108:111]
v_mul_f32 v73, v73, v241
v_mul_f32 v74, v74, v242
v_mfma_f32_16x16x32_bf16 v[112:115], v[60:63], a[16:19], v[112:115]
ds_read_b128 v[52:55], v1 offset:60416
buffer_load_dwordx4 v1, s[4:7], s47 offen offset:2048 sc1 lds
v_mfma_f32_16x16x32_bf16 v[116:119], v[60:63], a[20:23], v[116:119]
v_mul_f32 v75, v75, v243
v_mul_f32 v76, v76, v244
v_mul_f32 v77, v77, v245
v_mfma_f32_16x16x32_bf16 v[104:107], v[64:67], a[24:27], v[104:107]
ds_read_b128 v[56:59], v1 offset:61440
v_mul_f32 v78, v78, v246
v_mul_f32 v79, v79, v247
v_mfma_f32_16x16x32_bf16 v[108:111], v[64:67], a[28:31], v[108:111]
v_cvt_pk_bf16_f32 v250, v72, v73
v_cvt_pk_bf16_f32 v251, v74, v75
v_mfma_f32_16x16x32_bf16 v[112:115], v[68:71], a[24:27], v[112:115]
ds_read_b128 v[60:63], v1 offset:62464
buffer_load_dwordx4 v1, s[4:7], s47 offen offset:3072 sc1 lds
v_mfma_f32_16x16x32_bf16 v[116:119], v[68:71], a[28:31], v[116:119]
v_cvt_pk_bf16_f32 v254, v76, v77
v_cvt_pk_bf16_f32 v255, v78, v79
s_waitcnt lgkmcnt(2)
v_mfma_f32_16x16x32_bf16 v[104:107], v[40:43], a[32:35], v[104:107]
ds_read_b128 v[64:67], v1 offset:63488
buffer_store_dwordx4 v[248:251], v1, s[4:7], s32 offen offset:1024
v_mfma_f32_16x16x32_bf16 v[108:111], v[40:43], a[36:39], v[108:111]
buffer_store_dwordx4 v[252:255], v1, s[4:7], s58 offen offset:1024
v_mfma_f32_16x16x32_bf16 v[112:115], v[44:47], a[32:35], v[112:115]
s_waitcnt vmcnt(14)
s_barrier
ds_read_b128 v[68:71], v1 offset:64512
v_mfma_f32_16x16x32_bf16 v[116:119], v[44:47], a[36:39], v[116:119]
s_add_u32 s57, s20, 196608
buffer_load_dwordx4 a[192:195], v1, s[4:7], s57 offen offset:0 sc1
v_mfma_f32_16x16x32_bf16 v[104:107], v[48:51], a[40:43], v[104:107]
ds_read_b128 v[40:43], v1 offset:16384
v_mul_f32 v240, v200, v88
v_mul_f32 v241, v200, v89
v_mfma_f32_16x16x32_bf16 v[108:111], v[48:51], a[44:47], v[108:111]
v_mul_f32 v242, v200, v90
v_mul_f32 v243, v200, v91
v_mfma_f32_16x16x32_bf16 v[112:115], v[52:55], a[40:43], v[112:115]
ds_read_b128 v[44:47], v1 offset:17408
s_add_u32 m0, s21, 98304
s_add_u32 s47, s19, 212992
v_mfma_f32_16x16x32_bf16 v[116:119], v[52:55], a[44:47], v[116:119]
buffer_load_dwordx4 v1, s[4:7], s47 offen offset:0 sc1 lds
s_waitcnt lgkmcnt(2)
v_mfma_f32_16x16x32_bf16 v[104:107], v[56:59], a[48:51], v[104:107]
ds_read_b128 v[48:51], v1 offset:18432
v_mul_f32 v244, v201, v92
v_mul_f32 v245, v201, v93
v_mfma_f32_16x16x32_bf16 v[108:111], v[56:59], a[52:55], v[108:111]
v_mul_f32 v246, v201, v94
v_mul_f32 v247, v201, v95
v_mfma_f32_16x16x32_bf16 v[112:115], v[60:63], a[48:51], v[112:115]
ds_read_b128 v[52:55], v1 offset:19456
buffer_load_dwordx4 v1, s[4:7], s47 offen offset:1024 sc1 lds
v_mfma_f32_16x16x32_bf16 v[116:119], v[60:63], a[52:55], v[116:119]
v_exp_f32 v240, v240
v_mfma_f32_16x16x32_bf16 v[104:107], v[64:67], a[56:59], v[104:107]
ds_read_b128 v[56:59], v1 offset:20480
v_mul_f32 v88, v88, v96
v_mfma_f32_16x16x32_bf16 v[108:111], v[64:67], a[60:63], v[108:111]
v_exp_f32 v241, v241
v_mul_f32 v89, v89, v97
v_mfma_f32_16x16x32_bf16 v[112:115], v[68:71], a[56:59], v[112:115]
ds_read_b128 v[60:63], v1 offset:21504
buffer_load_dwordx4 v1, s[4:7], s47 offen offset:2048 sc1 lds
v_mfma_f32_16x16x32_bf16 v[116:119], v[68:71], a[60:63], v[116:119]
v_exp_f32 v242, v242
v_mul_f32 v90, v90, v98
s_waitcnt lgkmcnt(2)
v_mfma_f32_16x16x32_bf16 v[104:107], v[40:43], a[64:67], v[104:107]
ds_read_b128 v[64:67], v1 offset:22528
v_exp_f32 v243, v243
v_mfma_f32_16x16x32_bf16 v[108:111], v[40:43], a[68:71], v[108:111]
v_mul_f32 v91, v91, v99
v_mfma_f32_16x16x32_bf16 v[112:115], v[44:47], a[64:67], v[112:115]
ds_read_b128 v[68:71], v1 offset:23552
buffer_load_dwordx4 v1, s[4:7], s47 offen offset:3072 sc1 lds
v_mfma_f32_16x16x32_bf16 v[116:119], v[44:47], a[68:71], v[116:119]
v_exp_f32 v244, v244
v_mul_f32 v92, v92, v100
v_mfma_f32_16x16x32_bf16 v[104:107], v[48:51], a[72:75], v[104:107]
ds_read_b128 v[40:43], v1 offset:24576
v_exp_f32 v245, v245
v_mfma_f32_16x16x32_bf16 v[108:111], v[48:51], a[76:79], v[108:111]
v_mul_f32 v93, v93, v101
v_exp_f32 v246, v246
v_mfma_f32_16x16x32_bf16 v[112:115], v[52:55], a[72:75], v[112:115]
ds_read_b128 v[44:47], v1 offset:25600
s_add_u32 m0, s21, 131072
s_add_u32 s47, s20, 65536
v_mfma_f32_16x16x32_bf16 v[116:119], v[52:55], a[76:79], v[116:119]
buffer_load_dwordx4 v1, s[4:7], s47 offen offset:0 sc1 lds
s_waitcnt lgkmcnt(2)
v_mfma_f32_16x16x32_bf16 v[104:107], v[56:59], a[80:83], v[104:107]
ds_read_b128 v[48:51], v1 offset:26624
v_mul_f32 v94, v94, v102
v_mfma_f32_16x16x32_bf16 v[108:111], v[56:59], a[84:87], v[108:111]
v_exp_f32 v247, v247
v_mfma_f32_16x16x32_bf16 v[112:115], v[60:63], a[80:83], v[112:115]
ds_read_b128 v[52:55], v1 offset:27648
buffer_load_dwordx4 v1, s[4:7], s47 offen offset:1024 sc1 lds
v_mfma_f32_16x16x32_bf16 v[116:119], v[60:63], a[84:87], v[116:119]
v_mul_f32 v95, v95, v103
v_fma_f32 v240, v240, v202, v202
v_mfma_f32_16x16x32_bf16 v[104:107], v[64:67], a[88:91], v[104:107]
ds_read_b128 v[56:59], v1 offset:28672
v_fma_f32 v241, v241, v202, v202
v_fma_f32 v242, v242, v202, v202
v_mfma_f32_16x16x32_bf16 v[108:111], v[64:67], a[92:95], v[108:111]
v_fma_f32 v243, v243, v202, v202
v_fma_f32 v244, v244, v203, v203
v_fma_f32 v245, v245, v203, v203
v_mfma_f32_16x16x32_bf16 v[112:115], v[68:71], a[88:91], v[112:115]
ds_read_b128 v[60:63], v1 offset:29696
buffer_load_dwordx4 v1, s[4:7], s47 offen offset:2048 sc1 lds
v_mfma_f32_16x16x32_bf16 v[116:119], v[68:71], a[92:95], v[116:119]
v_fma_f32 v246, v246, v203, v203
v_fma_f32 v247, v247, v203, v203
s_waitcnt lgkmcnt(2)
v_mfma_f32_16x16x32_bf16 v[104:107], v[40:43], a[96:99], v[104:107]
ds_read_b128 v[64:67], v1 offset:30720
v_rcp_f32 v240, v240
v_mfma_f32_16x16x32_bf16 v[108:111], v[40:43], a[100:103], v[108:111]
v_rcp_f32 v241, v241
v_mfma_f32_16x16x32_bf16 v[112:115], v[44:47], a[96:99], v[112:115]
s_waitcnt vmcnt(14)
s_barrier
ds_read_b128 v[68:71], v1 offset:31744
v_mfma_f32_16x16x32_bf16 v[116:119], v[44:47], a[100:103], v[116:119]
buffer_load_dwordx4 v1, s[4:7], s47 offen offset:3072 sc1 lds
v_mfma_f32_16x16x32_bf16 v[104:107], v[48:51], a[104:107], v[104:107]
ds_read_b128 v[40:43], v1 offset:32768
v_rcp_f32 v242, v242
v_mfma_f32_16x16x32_bf16 v[108:111], v[48:51], a[108:111], v[108:111]
v_rcp_f32 v243, v243
v_mfma_f32_16x16x32_bf16 v[112:115], v[52:55], a[104:107], v[112:115]
ds_read_b128 v[44:47], v1 offset:33792
ds_read_b64 v[224:225], v25 offset:1280
ds_read_b64 v[228:229], v25 offset:1408
s_add_u32 m0, s21, 49152
v_mfma_f32_16x16x32_bf16 v[116:119], v[52:55], a[108:111], v[116:119]
s_add_u32 s47, s20, 81920
buffer_load_dwordx4 v1, s[4:7], s47 offen offset:0 sc1 lds
s_waitcnt lgkmcnt(4)
v_mfma_f32_16x16x32_bf16 v[104:107], v[56:59], a[112:115], v[104:107]
ds_read_b128 v[48:51], v1 offset:34816
v_mfma_f32_16x16x32_bf16 v[108:111], v[56:59], a[116:119], v[108:111]
v_rcp_f32 v244, v244
v_mfma_f32_16x16x32_bf16 v[112:115], v[60:63], a[112:115], v[112:115]
ds_read_b128 v[52:55], v1 offset:35840
buffer_load_dwordx4 v1, s[4:7], s47 offen offset:1024 sc1 lds
v_mfma_f32_16x16x32_bf16 v[116:119], v[60:63], a[116:119], v[116:119]
v_rcp_f32 v245, v245
v_mfma_f32_16x16x32_bf16 v[104:107], v[64:67], a[120:123], v[104:107]
ds_read_b128 v[56:59], v1 offset:36864
v_rcp_f32 v246, v246
v_mfma_f32_16x16x32_bf16 v[108:111], v[64:67], a[124:127], v[108:111]
v_rcp_f32 v247, v247
v_mfma_f32_16x16x32_bf16 v[112:115], v[68:71], a[120:123], v[112:115]
ds_read_b128 v[60:63], v1 offset:37888
buffer_load_dwordx4 v1, s[4:7], s47 offen offset:2048 sc1 lds
v_mul_f32 v88, v88, v240
v_mfma_f32_16x16x32_bf16 v[116:119], v[68:71], a[124:127], v[116:119]
s_waitcnt vmcnt(12)
buffer_store_dwordx2 v[36:37], v26, s[4:7], s40 offen offset:512
s_waitcnt lgkmcnt(5)
v_mfma_f32_16x16x32_bf16 v[104:107], v[224:227], v[232:235], v[104:107]
v_mfma_f32_16x16x32_bf16 v[108:111], v[224:227], v[236:239], v[108:111]
s_waitcnt lgkmcnt(4)
v_mfma_f32_16x16x32_bf16 v[112:115], v[228:231], v[232:235], v[112:115]
v_mfma_f32_16x16x32_bf16 v[116:119], v[228:231], v[236:239], v[116:119]
s_waitcnt lgkmcnt(2)
v_mfma_f32_16x16x32_bf16 v[72:75], v[40:43], a[0:3], 0
ds_read_b128 v[64:67], v1 offset:38912
v_mul_f32 v89, v89, v241
v_mfma_f32_16x16x32_bf16 v[76:79], v[40:43], a[4:7], 0
v_mul_f32 v90, v90, v242
v_mul_f32 v91, v91, v243
v_mfma_f32_16x16x32_bf16 v[80:83], v[44:47], a[0:3], 0
ds_read_b128 v[68:71], v1 offset:39936
buffer_load_dwordx4 v1, s[4:7], s47 offen offset:3072 sc1 lds
v_mfma_f32_16x16x32_bf16 v[84:87], v[44:47], a[4:7], 0
v_mul_f32 v92, v92, v244
v_mul_f32 v93, v93, v245
v_mfma_f32_16x16x32_bf16 v[72:75], v[48:51], a[8:11], v[72:75]
ds_read_b128 v[40:43], v1 offset:40960
v_mul_f32 v94, v94, v246
v_mul_f32 v95, v95, v247
v_mfma_f32_16x16x32_bf16 v[76:79], v[48:51], a[12:15], v[76:79]
v_cvt_pk_bf16_f32 v248, v88, v89
v_cvt_pk_bf16_f32 v249, v90, v91
v_mfma_f32_16x16x32_bf16 v[80:83], v[52:55], a[8:11], v[80:83]
ds_read_b128 v[44:47], v1 offset:41984
buffer_load_dwordx4 a[196:199], v1, s[4:7], s57 offen offset:1024 sc1
v_mfma_f32_16x16x32_bf16 v[84:87], v[52:55], a[12:15], v[84:87]
v_cvt_pk_bf16_f32 v252, v92, v93
v_cvt_pk_bf16_f32 v253, v94, v95
s_waitcnt lgkmcnt(2)
v_mfma_f32_16x16x32_bf16 v[72:75], v[56:59], a[16:19], v[72:75]
ds_read_b128 v[48:51], v1 offset:43008
buffer_load_dwordx2 v[38:39], v17, s[4:7], s41 offen offset:0 sc1
v_mfma_f32_16x16x32_bf16 v[76:79], v[56:59], a[20:23], v[76:79]
v_mul_f32 v240, v200, v104
v_mul_f32 v241, v200, v105
v_mul_f32 v242, v200, v106
v_mfma_f32_16x16x32_bf16 v[80:83], v[60:63], a[16:19], v[80:83]
ds_read_b128 v[52:55], v1 offset:44032
buffer_load_dwordx4 a[200:203], v1, s[4:7], s57 offen offset:2048 sc1
v_mfma_f32_16x16x32_bf16 v[84:87], v[60:63], a[20:23], v[84:87]
v_mul_f32 v243, v200, v107
v_mul_f32 v244, v201, v108
v_mul_f32 v245, v201, v109
v_mfma_f32_16x16x32_bf16 v[72:75], v[64:67], a[24:27], v[72:75]
ds_read_b128 v[56:59], v1 offset:45056
v_mul_f32 v246, v201, v110
v_mul_f32 v247, v201, v111
v_mfma_f32_16x16x32_bf16 v[76:79], v[64:67], a[28:31], v[76:79]
v_exp_f32 v240, v240
v_mul_f32 v104, v104, v112
v_mfma_f32_16x16x32_bf16 v[80:83], v[68:71], a[24:27], v[80:83]
ds_read_b128 v[60:63], v1 offset:46080
buffer_load_dwordx4 a[204:207], v1, s[4:7], s57 offen offset:3072 sc1
v_mfma_f32_16x16x32_bf16 v[84:87], v[68:71], a[28:31], v[84:87]
v_exp_f32 v241, v241
v_mul_f32 v105, v105, v113
s_waitcnt lgkmcnt(2)
v_mfma_f32_16x16x32_bf16 v[72:75], v[40:43], a[32:35], v[72:75]
ds_read_b128 v[64:67], v1 offset:47104
v_exp_f32 v242, v242
v_mul_f32 v106, v106, v114
v_mfma_f32_16x16x32_bf16 v[76:79], v[40:43], a[36:39], v[76:79]
v_exp_f32 v243, v243
v_mul_f32 v107, v107, v115
v_mfma_f32_16x16x32_bf16 v[80:83], v[44:47], a[32:35], v[80:83]
s_waitcnt vmcnt(13)
s_barrier
ds_read_b128 v[68:71], v1 offset:48128
v_mfma_f32_16x16x32_bf16 v[84:87], v[44:47], a[36:39], v[84:87]
s_add_u32 s57, s20, 212992
buffer_load_dwordx4 a[208:211], v1, s[4:7], s57 offen offset:0 sc1
v_mfma_f32_16x16x32_bf16 v[72:75], v[48:51], a[40:43], v[72:75]
ds_read_b128 v[40:43], v2 offset:32768
v_exp_f32 v244, v244
v_mul_f32 v108, v108, v116
v_mfma_f32_16x16x32_bf16 v[76:79], v[48:51], a[44:47], v[76:79]
v_exp_f32 v245, v245
v_mul_f32 v109, v109, v117
v_mfma_f32_16x16x32_bf16 v[80:83], v[52:55], a[40:43], v[80:83]
ds_read_b128 v[44:47], v2 offset:33792
buffer_load_dwordx4 a[212:215], v1, s[4:7], s57 offen offset:1024 sc1
v_mfma_f32_16x16x32_bf16 v[84:87], v[52:55], a[44:47], v[84:87]
v_exp_f32 v246, v246
v_mul_f32 v110, v110, v118
s_waitcnt lgkmcnt(2)
v_mfma_f32_16x16x32_bf16 v[72:75], v[56:59], a[48:51], v[72:75]
ds_read_b128 v[48:51], v2 offset:34816
v_exp_f32 v247, v247
v_mfma_f32_16x16x32_bf16 v[76:79], v[56:59], a[52:55], v[76:79]
v_mul_f32 v111, v111, v119
v_fma_f32 v240, v240, v202, v202
v_fma_f32 v241, v241, v202, v202
v_mfma_f32_16x16x32_bf16 v[80:83], v[60:63], a[48:51], v[80:83]
ds_read_b128 v[52:55], v2 offset:35840
buffer_load_dwordx4 a[216:219], v1, s[4:7], s57 offen offset:2048 sc1
v_mfma_f32_16x16x32_bf16 v[84:87], v[60:63], a[52:55], v[84:87]
v_fma_f32 v242, v242, v202, v202
v_fma_f32 v243, v243, v202, v202
v_fma_f32 v244, v244, v203, v203
v_mfma_f32_16x16x32_bf16 v[72:75], v[64:67], a[56:59], v[72:75]
ds_read_b128 v[56:59], v2 offset:36864
v_fma_f32 v245, v245, v203, v203
v_fma_f32 v246, v246, v203, v203
v_mfma_f32_16x16x32_bf16 v[76:79], v[64:67], a[60:63], v[76:79]
v_fma_f32 v247, v247, v203, v203
v_rcp_f32 v240, v240
v_mfma_f32_16x16x32_bf16 v[80:83], v[68:71], a[56:59], v[80:83]
ds_read_b128 v[60:63], v2 offset:37888
s_waitcnt vmcnt(5)
v_cmp_ne_u64 vcc, s[66:67], v[38:39]
s_nop 0
s_cbranch_vccnz LF1_sp11
LF1_ok10:
v_mfma_f32_16x16x32_bf16 v[84:87], v[68:71], a[60:63], v[84:87]
buffer_load_dwordx4 a[220:223], v1, s[4:7], s57 offen offset:3072 sc1
v_rcp_f32 v241, v241
s_waitcnt lgkmcnt(2)
v_mfma_f32_16x16x32_bf16 v[72:75], v[40:43], a[64:67], v[72:75]
ds_read_b128 v[64:67], v2 offset:38912
buffer_load_dwordx4 a[0:3], v1, s[4:7], s76 offen offset:0 sc1
v_mfma_f32_16x16x32_bf16 v[76:79], v[40:43], a[68:71], v[76:79]
v_rcp_f32 v242, v242
v_mfma_f32_16x16x32_bf16 v[80:83], v[44:47], a[64:67], v[80:83]
ds_read_b128 v[68:71], v2 offset:39936
ds_write_b128 v11, a[224:227] offset:16384
v_mfma_f32_16x16x32_bf16 v[84:87], v[44:47], a[68:71], v[84:87]
v_rcp_f32 v243, v243
v_mfma_f32_16x16x32_bf16 v[72:75], v[48:51], a[72:75], v[72:75]
ds_read_b128 v[40:43], v2 offset:40960
buffer_load_dwordx4 a[4:7], v1, s[4:7], s80 offen offset:0 sc1
v_mfma_f32_16x16x32_bf16 v[76:79], v[48:51], a[76:79], v[76:79]
v_rcp_f32 v244, v244
v_mfma_f32_16x16x32_bf16 v[80:83], v[52:55], a[72:75], v[80:83]
ds_read_b128 v[44:47], v2 offset:41984
v_mfma_f32_16x16x32_bf16 v[84:87], v[52:55], a[76:79], v[84:87]
ds_write_b128 v11, a[228:231] offset:17408
s_waitcnt lgkmcnt(4)
v_mfma_f32_16x16x32_bf16 v[72:75], v[56:59], a[80:83], v[72:75]
ds_read_b128 v[48:51], v2 offset:43008
buffer_load_dwordx4 a[8:11], v5, s[4:7], s76 offen offset:0 sc1
v_mfma_f32_16x16x32_bf16 v[76:79], v[56:59], a[84:87], v[76:79]
v_rcp_f32 v245, v245
v_rcp_f32 v246, v246
v_mfma_f32_16x16x32_bf16 v[80:83], v[60:63], a[80:83], v[80:83]
ds_read_b128 v[52:55], v2 offset:44032
v_mfma_f32_16x16x32_bf16 v[84:87], v[60:63], a[84:87], v[84:87]
ds_write_b128 v11, a[232:235] offset:18432
v_mfma_f32_16x16x32_bf16 v[72:75], v[64:67], a[88:91], v[72:75]
ds_read_b128 v[56:59], v2 offset:45056
buffer_load_dwordx4 a[12:15], v5, s[4:7], s80 offen offset:0 sc1
v_mfma_f32_16x16x32_bf16 v[76:79], v[64:67], a[92:95], v[76:79]
v_rcp_f32 v247, v247
v_mul_f32 v104, v104, v240
v_mfma_f32_16x16x32_bf16 v[80:83], v[68:71], a[88:91], v[80:83]
ds_read_b128 v[60:63], v2 offset:46080
v_mfma_f32_16x16x32_bf16 v[84:87], v[68:71], a[92:95], v[84:87]
ds_write_b128 v11, a[236:239] offset:19456
s_waitcnt lgkmcnt(4)
v_mfma_f32_16x16x32_bf16 v[72:75], v[40:43], a[96:99], v[72:75]
ds_read_b128 v[64:67], v2 offset:47104
buffer_load_dwordx4 a[16:19], v1, s[4:7], s77 offen offset:0 sc1
v_mul_f32 v105, v105, v241
v_mfma_f32_16x16x32_bf16 v[76:79], v[40:43], a[100:103], v[76:79]
v_mul_f32 v106, v106, v242
v_mul_f32 v107, v107, v243
v_mul_f32 v108, v108, v244
v_mfma_f32_16x16x32_bf16 v[80:83], v[44:47], a[96:99], v[80:83]
s_barrier
ds_read_b128 v[68:71], v2 offset:48128
v_mfma_f32_16x16x32_bf16 v[84:87], v[44:47], a[100:103], v[84:87]
v_mul_f32 v109, v109, v245
v_mul_f32 v110, v110, v246
v_mul_f32 v111, v111, v247
v_mfma_f32_16x16x32_bf16 v[72:75], v[48:51], a[104:107], v[72:75]
ds_read_b128 v[40:43], v9 offset:0
buffer_load_dwordx4 a[20:23], v1, s[4:7], s81 offen offset:0 sc1
v_mfma_f32_16x16x32_bf16 v[76:79], v[48:51], a[108:111], v[76:79]
v_cvt_pk_bf16_f32 v250, v104, v105
v_cvt_pk_bf16_f32 v251, v106, v107
v_cvt_pk_bf16_f32 v254, v108, v109
v_mfma_f32_16x16x32_bf16 v[80:83], v[52:55], a[104:107], v[80:83]
ds_read_b128 v[44:47], v9 offset:1024
ds_read_b64 v[224:225], v25 offset:1536
ds_read_b64 v[228:229], v25 offset:1664
v_mfma_f32_16x16x32_bf16 v[84:87], v[52:55], a[108:111], v[84:87]
ds_write_b128 v11, a[240:243] offset:32768
s_waitcnt lgkmcnt(5)
v_mfma_f32_16x16x32_bf16 v[72:75], v[56:59], a[112:115], v[72:75]
ds_read_b128 v[48:51], v9 offset:2048
buffer_load_dwordx4 a[24:27], v5, s[4:7], s77 offen offset:0 sc1
v_mfma_f32_16x16x32_bf16 v[76:79], v[56:59], a[116:119], v[76:79]
v_cvt_pk_bf16_f32 v255, v110, v111
v_mfma_f32_16x16x32_bf16 v[80:83], v[60:63], a[112:115], v[80:83]
ds_read_b128 v[52:55], v9 offset:3072
v_mfma_f32_16x16x32_bf16 v[84:87], v[60:63], a[116:119], v[84:87]
ds_write_b128 v11, a[244:247] offset:33792
v_mfma_f32_16x16x32_bf16 v[72:75], v[64:67], a[120:123], v[72:75]
ds_read_b128 v[56:59], v9 offset:4096
buffer_load_dwordx4 a[28:31], v5, s[4:7], s81 offen offset:0 sc1
v_mfma_f32_16x16x32_bf16 v[76:79], v[64:67], a[124:127], v[76:79]
buffer_store_dwordx4 v[248:251], v1, s[4:7], s32 offen offset:2048
buffer_store_dwordx4 v[252:255], v1, s[4:7], s58 offen offset:2048
v_mfma_f32_16x16x32_bf16 v[80:83], v[68:71], a[120:123], v[80:83]
ds_read_b128 v[60:63], v9 offset:5120
v_mfma_f32_16x16x32_bf16 v[84:87], v[68:71], a[124:127], v[84:87]
s_waitcnt lgkmcnt(7)
v_mfma_f32_16x16x32_bf16 v[72:75], v[224:227], v[232:235], v[72:75]
v_mfma_f32_16x16x32_bf16 v[76:79], v[224:227], v[236:239], v[76:79]
s_waitcnt lgkmcnt(6)
v_mfma_f32_16x16x32_bf16 v[80:83], v[228:231], v[232:235], v[80:83]
v_mfma_f32_16x16x32_bf16 v[84:87], v[228:231], v[236:239], v[84:87]
s_waitcnt vmcnt(8) lgkmcnt(3)
v_mfma_f32_16x16x32_bf16 v[168:171], v[40:43], a[0:3], v[168:171]
ds_read_b128 v[64:67], v9 offset:6144
v_mfma_f32_16x16x32_bf16 v[176:179], v[40:43], a[4:7], v[176:179]
buffer_load_dwordx4 a[32:35], v1, s[4:7], s78 offen offset:0 sc1
v_mfma_f32_16x16x32_bf16 v[172:175], v[44:47], a[0:3], v[172:175]
ds_read_b128 v[68:71], v9 offset:7168
ds_write_b128 v11, a[248:251] offset:34816
v_mfma_f32_16x16x32_bf16 v[180:183], v[44:47], a[4:7], v[180:183]
v_mul_f32 v240, v200, v72
v_mul_f32 v241, v200, v73
v_mfma_f32_16x16x32_bf16 v[184:187], v[48:51], a[0:3], 0
ds_read_b128 v[40:43], v9 offset:16384
buffer_load_dwordx4 a[36:39], v1, s[4:7], s82 offen offset:0 sc1
v_mul_f32 v242, v200, v74
v_mfma_f32_16x16x32_bf16 v[192:195], v[48:51], a[4:7], 0
v_mul_f32 v243, v200, v75
v_mul_f32 v244, v201, v76
v_mul_f32 v245, v201, v77
v_mfma_f32_16x16x32_bf16 v[188:191], v[52:55], a[0:3], 0
ds_read_b128 v[44:47], v9 offset:17408
v_mul_f32 v246, v201, v78
v_mul_f32 v247, v201, v79
v_exp_f32 v240, v240
v_mfma_f32_16x16x32_bf16 v[196:199], v[52:55], a[4:7], 0
v_mul_f32 v72, v72, v80
v_exp_f32 v241, v241
s_waitcnt vmcnt(8) lgkmcnt(3)
v_mfma_f32_16x16x32_bf16 v[168:171], v[56:59], a[8:11], v[168:171]
ds_read_b128 v[48:51], v9 offset:18432
buffer_load_dwordx4 a[40:43], v5, s[4:7], s78 offen offset:0 sc1
buffer_load_dwordx2 v[38:39], v17, s[4:7], s41 offen offset:512 sc1
v_mfma_f32_16x16x32_bf16 v[176:179], v[56:59], a[12:15], v[176:179]
v_mul_f32 v73, v73, v81
v_exp_f32 v242, v242
v_mfma_f32_16x16x32_bf16 v[172:175], v[60:63], a[8:11], v[172:175]
ds_read_b128 v[52:55], v9 offset:19456
ds_write_b128 v11, a[252:255] offset:35840
v_mfma_f32_16x16x32_bf16 v[180:183], v[60:63], a[12:15], v[180:183]
v_mul_f32 v74, v74, v82
v_mfma_f32_16x16x32_bf16 v[184:187], v[64:67], a[8:11], v[184:187]
ds_read_b128 v[56:59], v9 offset:20480
buffer_load_dwordx4 a[44:47], v5, s[4:7], s82 offen offset:0 sc1
v_exp_f32 v243, v243
v_mfma_f32_16x16x32_bf16 v[192:195], v[64:67], a[12:15], v[192:195]
v_mul_f32 v75, v75, v83
v_exp_f32 v244, v244
v_mfma_f32_16x16x32_bf16 v[188:191], v[68:71], a[8:11], v[188:191]
ds_read_b128 v[60:63], v9 offset:21504
v_mul_f32 v76, v76, v84
v_exp_f32 v245, v245
v_mfma_f32_16x16x32_bf16 v[196:199], v[68:71], a[12:15], v[196:199]
v_mul_f32 v77, v77, v85
v_exp_f32 v246, v246
v_mul_f32 v78, v78, v86
s_waitcnt vmcnt(9) lgkmcnt(3)
v_mfma_f32_16x16x32_bf16 v[168:171], v[40:43], a[16:19], v[168:171]
ds_read_b128 v[64:67], v9 offset:22528
buffer_load_dwordx4 a[48:51], v1, s[4:7], s79 offen offset:0 sc1
v_exp_f32 v247, v247
v_mfma_f32_16x16x32_bf16 v[176:179], v[40:43], a[20:23], v[176:179]
v_mul_f32 v79, v79, v87
v_fma_f32 v240, v240, v202, v202
v_fma_f32 v241, v241, v202, v202
v_mfma_f32_16x16x32_bf16 v[172:175], v[44:47], a[16:19], v[172:175]
s_barrier
ds_read_b128 v[68:71], v9 offset:23552
v_fma_f32 v242, v242, v202, v202
v_mfma_f32_16x16x32_bf16 v[180:183], v[44:47], a[20:23], v[180:183]
v_fma_f32 v243, v243, v202, v202
v_fma_f32 v244, v244, v203, v203
v_fma_f32 v245, v245, v203, v203
v_mfma_f32_16x16x32_bf16 v[184:187], v[48:51], a[16:19], v[184:187]
ds_read_b128 v[40:43], v8 offset:0
buffer_load_dwordx4 a[52:55], v1, s[4:7], s83 offen offset:0 sc1
v_fma_f32 v246, v246, v203, v203
v_fma_f32 v247, v247, v203, v203
v_mfma_f32_16x16x32_bf16 v[192:195], v[48:51], a[20:23], v[192:195]
v_rcp_f32 v240, v240
v_rcp_f32 v241, v241
v_mfma_f32_16x16x32_bf16 v[188:191], v[52:55], a[16:19], v[188:191]
ds_read_b128 v[44:47], v8 offset:1024
ds_write_b128 v12, a[128:131] offset:32768
v_mfma_f32_16x16x32_bf16 v[196:199], v[52:55], a[20:23], v[196:199]
ds_write_b128 v12, a[132:135] offset:33792
s_waitcnt vmcnt(9) lgkmcnt(4)
v_mfma_f32_16x16x32_bf16 v[168:171], v[56:59], a[24:27], v[168:171]
ds_read_b128 v[48:51], v8 offset:2048
v_mfma_f32_16x16x32_bf16 v[176:179], v[56:59], a[28:31], v[176:179]
buffer_load_dwordx4 a[56:59], v5, s[4:7], s79 offen offset:0 sc1
v_mfma_f32_16x16x32_bf16 v[172:175], v[60:63], a[24:27], v[172:175]
ds_read_b128 v[52:55], v8 offset:3072
ds_write_b128 v12, a[136:139] offset:34816
v_mfma_f32_16x16x32_bf16 v[180:183], v[60:63], a[28:31], v[180:183]
v_rcp_f32 v242, v242
v_mfma_f32_16x16x32_bf16 v[184:187], v[64:67], a[24:27], v[184:187]
ds_read_b128 v[56:59], v8 offset:4096
buffer_load_dwordx4 a[60:63], v5, s[4:7], s83 offen offset:0 sc1
v_rcp_f32 v243, v243
v_mfma_f32_16x16x32_bf16 v[192:195], v[64:67], a[28:31], v[192:195]
v_rcp_f32 v244, v244
v_rcp_f32 v245, v245
v_mfma_f32_16x16x32_bf16 v[188:191], v[68:71], a[24:27], v[188:191]
ds_read_b128 v[60:63], v8 offset:5120
s_waitcnt vmcnt(5)
v_cmp_ne_u64 vcc, s[66:67], v[38:39]
s_nop 0
s_cbranch_vccnz LF1_sp13
LF1_ok12:
v_mfma_f32_16x16x32_bf16 v[196:199], v[68:71], a[28:31], v[196:199]
ds_write_b128 v12, a[140:143] offset:35840
s_waitcnt lgkmcnt(4)
v_mfma_f32_16x16x32_bf16 v[168:171], v[40:43], a[32:35], v[168:171]
ds_read_b128 v[64:67], v8 offset:6144
buffer_load_dwordx4 a[64:67], v1, s[4:7], s76 offen offset:1024 sc1
v_mfma_f32_16x16x32_bf16 v[176:179], v[40:43], a[36:39], v[176:179]
buffer_store_dwordx2 v[36:37], v26, s[4:7], s40 offen offset:1024
v_mfma_f32_16x16x32_bf16 v[172:175], v[44:47], a[32:35], v[172:175]
ds_read_b128 v[68:71], v8 offset:7168
ds_write_b128 v12, a[144:147] offset:0
v_mfma_f32_16x16x32_bf16 v[180:183], v[44:47], a[36:39], v[180:183]
v_rcp_f32 v246, v246
v_mfma_f32_16x16x32_bf16 v[184:187], v[48:51], a[32:35], v[184:187]
ds_read_b128 v[40:43], v9 offset:49152
buffer_load_dwordx4 a[68:71], v1, s[4:7], s80 offen offset:1024 sc1
v_rcp_f32 v247, v247
v_mfma_f32_16x16x32_bf16 v[192:195], v[48:51], a[36:39], v[192:195]
v_mul_f32 v72, v72, v240
v_mul_f32 v73, v73, v241
v_mul_f32 v74, v74, v242
v_mfma_f32_16x16x32_bf16 v[188:191], v[52:55], a[32:35], v[188:191]
ds_read_b128 v[44:47], v9 offset:50176
ds_write_b128 v12, a[148:151] offset:1024
v_mfma_f32_16x16x32_bf16 v[196:199], v[52:55], a[36:39], v[196:199]
v_mul_f32 v75, v75, v243
v_mul_f32 v76, v76, v244
s_waitcnt vmcnt(7) lgkmcnt(4)
v_mfma_f32_16x16x32_bf16 v[168:171], v[56:59], a[40:43], v[168:171]
ds_read_b128 v[48:51], v9 offset:51200
buffer_load_dwordx4 a[72:75], v5, s[4:7], s76 offen offset:1024 sc1
v_mul_f32 v77, v77, v245
v_mfma_f32_16x16x32_bf16 v[176:179], v[56:59], a[44:47], v[176:179]
v_mul_f32 v78, v78, v246
v_mul_f32 v79, v79, v247
v_bfe_u32 v240, v0, 4, 1
v_mfma_f32_16x16x32_bf16 v[172:175], v[60:63], a[40:43], v[172:175]
ds_read_b128 v[52:55], v9 offset:52224
ds_write_b128 v12, a[152:155] offset:2048
v_mfma_f32_16x16x32_bf16 v[180:183], v[60:63], a[44:47], v[180:183]
v_mul_u32_u24 v240, 57088, v240
v_bfe_u32 v241, v0, 5, 1
v_mfma_f32_16x16x32_bf16 v[184:187], v[64:67], a[40:43], v[184:187]
ds_read_b128 v[56:59], v9 offset:53248
buffer_load_dwordx4 a[76:79], v5, s[4:7], s80 offen offset:1024 sc1
v_mul_u32_u24 v241, 256, v241
v_sub_u32 v240, v240, v241
v_mfma_f32_16x16x32_bf16 v[192:195], v[64:67], a[44:47], v[192:195]
v_add_u32 v240, v240, v1
s_bitcmp1_b32 s13, 0
s_cselect_b32 s48, -512, 0
s_cselect_b32 s49, 0, 3072
v_mfma_f32_16x16x32_bf16 v[188:191], v[68:71], a[40:43], v[188:191]
ds_read_b128 v[60:63], v9 offset:54272
ds_write_b128 v12, a[156:159] offset:3072
v_mfma_f32_16x16x32_bf16 v[196:199], v[68:71], a[44:47], v[196:199]
s_add_u32 s48, s48, s49
s_waitcnt vmcnt(7) lgkmcnt(4)
v_mfma_f32_16x16x32_bf16 v[168:171], v[40:43], a[48:51], v[168:171]
ds_read_b128 v[64:67], v9 offset:55296
buffer_load_dwordx4 a[80:83], v1, s[4:7], s77 offen offset:1024 sc1
s_add_u32 s48, s48, s32
v_mfma_f32_16x16x32_bf16 v[176:179], v[40:43], a[52:55], v[176:179]
v_cvt_pk_bf16_f32 v248, v72, v73
v_cvt_pk_bf16_f32 v249, v74, v75
v_cvt_pk_bf16_f32 v250, v76, v77
v_mfma_f32_16x16x32_bf16 v[172:175], v[44:47], a[48:51], v[172:175]
s_barrier
ds_read_b128 v[68:71], v9 offset:56320
v_cvt_pk_bf16_f32 v251, v78, v79
v_mfma_f32_16x16x32_bf16 v[180:183], v[44:47], a[52:55], v[180:183]
v_permlane16_swap_b32 v248, v250
v_permlane16_swap_b32 v249, v251
buffer_store_dwordx4 v[248:251], v240, s[4:7], s48 offen
v_mfma_f32_16x16x32_bf16 v[184:187], v[48:51], a[48:51], v[184:187]
ds_read_b128 v[40:43], v10 offset:0
v_mfma_f32_16x16x32_bf16 v[192:195], v[48:51], a[52:55], v[192:195]
buffer_load_dwordx4 a[84:87], v1, s[4:7], s81 offen offset:1024 sc1
v_mfma_f32_16x16x32_bf16 v[188:191], v[52:55], a[48:51], v[188:191]
ds_read_b128 v[44:47], v10 offset:1024
ds_write_b128 v12, a[160:163] offset:16384
v_mfma_f32_16x16x32_bf16 v[196:199], v[52:55], a[52:55], v[196:199]
ds_write_b128 v12, a[164:167] offset:17408
s_waitcnt vmcnt(8) lgkmcnt(4)
v_mfma_f32_16x16x32_bf16 v[168:171], v[56:59], a[56:59], v[168:171]
ds_read_b128 v[48:51], v10 offset:2048
v_mfma_f32_16x16x32_bf16 v[176:179], v[56:59], a[60:63], v[176:179]
buffer_load_dwordx4 a[88:91], v5, s[4:7], s77 offen offset:1024 sc1
v_mfma_f32_16x16x32_bf16 v[172:175], v[60:63], a[56:59], v[172:175]
ds_read_b128 v[52:55], v10 offset:3072
v_mfma_f32_16x16x32_bf16 v[180:183], v[60:63], a[60:63], v[180:183]
ds_write_b128 v12, a[168:171] offset:18432
v_mfma_f32_16x16x32_bf16 v[184:187], v[64:67], a[56:59], v[184:187]
ds_read_b128 v[56:59], v10 offset:4096
v_mfma_f32_16x16x32_bf16 v[192:195], v[64:67], a[60:63], v[192:195]
buffer_load_dwordx4 a[92:95], v5, s[4:7], s81 offen offset:1024 sc1
v_mfma_f32_16x16x32_bf16 v[188:191], v[68:71], a[56:59], v[188:191]
ds_read_b128 v[60:63], v10 offset:5120
v_mfma_f32_16x16x32_bf16 v[196:199], v[68:71], a[60:63], v[196:199]
ds_write_b128 v12, a[172:175] offset:19456
s_waitcnt vmcnt(7) lgkmcnt(4)
v_mfma_f32_16x16x32_bf16 v[168:171], v[40:43], a[64:67], v[168:171]
ds_read_b128 v[64:67], v10 offset:6144
v_mfma_f32_16x16x32_bf16 v[176:179], v[40:43], a[68:71], v[176:179]
buffer_load_dwordx4 a[96:99], v1, s[4:7], s78 offen offset:1024 sc1
v_mfma_f32_16x16x32_bf16 v[172:175], v[44:47], a[64:67], v[172:175]
ds_read_b128 v[68:71], v10 offset:7168
v_mfma_f32_16x16x32_bf16 v[180:183], v[44:47], a[68:71], v[180:183]
ds_write_b128 v11, a[176:179] offset:0
v_mfma_f32_16x16x32_bf16 v[184:187], v[48:51], a[64:67], v[184:187]
ds_read_b128 v[40:43], v8 offset:49152
v_mfma_f32_16x16x32_bf16 v[192:195], v[48:51], a[68:71], v[192:195]
buffer_load_dwordx4 a[100:103], v1, s[4:7], s82 offen offset:1024 sc1
v_mfma_f32_16x16x32_bf16 v[188:191], v[52:55], a[64:67], v[188:191]
ds_read_b128 v[44:47], v8 offset:50176
v_mfma_f32_16x16x32_bf16 v[196:199], v[52:55], a[68:71], v[196:199]
ds_write_b128 v11, a[180:183] offset:1024
s_waitcnt vmcnt(7) lgkmcnt(4)
v_mfma_f32_16x16x32_bf16 v[168:171], v[56:59], a[72:75], v[168:171]
ds_read_b128 v[48:51], v8 offset:51200
buffer_load_dwordx4 a[104:107], v5, s[4:7], s78 offen offset:1024 sc1
v_mfma_f32_16x16x32_bf16 v[176:179], v[56:59], a[76:79], v[176:179]
buffer_load_dwordx2 v[38:39], v17, s[4:7], s41 offen offset:1024 sc1
v_mfma_f32_16x16x32_bf16 v[172:175], v[60:63], a[72:75], v[172:175]
ds_read_b128 v[52:55], v8 offset:52224
v_mfma_f32_16x16x32_bf16 v[180:183], v[60:63], a[76:79], v[180:183]
ds_write_b128 v11, a[184:187] offset:2048
v_mfma_f32_16x16x32_bf16 v[184:187], v[64:67], a[72:75], v[184:187]
ds_read_b128 v[56:59], v8 offset:53248
v_mfma_f32_16x16x32_bf16 v[192:195], v[64:67], a[76:79], v[192:195]
buffer_load_dwordx4 a[108:111], v5, s[4:7], s82 offen offset:1024 sc1
v_mfma_f32_16x16x32_bf16 v[188:191], v[68:71], a[72:75], v[188:191]
ds_read_b128 v[60:63], v8 offset:54272
v_mfma_f32_16x16x32_bf16 v[196:199], v[68:71], a[76:79], v[196:199]
ds_write_b128 v11, a[188:191] offset:3072
s_waitcnt vmcnt(7) lgkmcnt(4)
v_mfma_f32_16x16x32_bf16 v[168:171], v[40:43], a[80:83], v[168:171]
ds_read_b128 v[64:67], v8 offset:55296
v_mfma_f32_16x16x32_bf16 v[176:179], v[40:43], a[84:87], v[176:179]
buffer_load_dwordx4 a[112:115], v1, s[4:7], s79 offen offset:1024 sc1
v_mfma_f32_16x16x32_bf16 v[172:175], v[44:47], a[80:83], v[172:175]
s_barrier
v_mfma_f32_16x16x32_bf16 v[180:183], v[44:47], a[84:87], v[180:183]
ds_read_b128 v[68:71], v8 offset:56320
v_mfma_f32_16x16x32_bf16 v[184:187], v[48:51], a[80:83], v[184:187]
ds_read_b128 v[40:43], v8 offset:16384
v_mfma_f32_16x16x32_bf16 v[192:195], v[48:51], a[84:87], v[192:195]
buffer_load_dwordx4 a[116:119], v1, s[4:7], s83 offen offset:1024 sc1
v_mfma_f32_16x16x32_bf16 v[188:191], v[52:55], a[80:83], v[188:191]
ds_read_b128 v[44:47], v8 offset:17408
ds_write_b128 v12, a[192:195] offset:49152
v_mfma_f32_16x16x32_bf16 v[196:199], v[52:55], a[84:87], v[196:199]
ds_write_b128 v12, a[196:199] offset:50176
s_waitcnt vmcnt(7) lgkmcnt(4)
v_mfma_f32_16x16x32_bf16 v[168:171], v[56:59], a[88:91], v[168:171]
ds_read_b128 v[48:51], v8 offset:18432
v_mfma_f32_16x16x32_bf16 v[176:179], v[56:59], a[92:95], v[176:179]
buffer_load_dwordx4 a[120:123], v5, s[4:7], s79 offen offset:1024 sc1
v_mfma_f32_16x16x32_bf16 v[172:175], v[60:63], a[88:91], v[172:175]
ds_read_b128 v[52:55], v8 offset:19456
v_mfma_f32_16x16x32_bf16 v[180:183], v[60:63], a[92:95], v[180:183]
ds_write_b128 v12, a[200:203] offset:51200
v_mfma_f32_16x16x32_bf16 v[184:187], v[64:67], a[88:91], v[184:187]
ds_read_b128 v[56:59], v8 offset:20480
v_mfma_f32_16x16x32_bf16 v[192:195], v[64:67], a[92:95], v[192:195]
buffer_load_dwordx4 a[124:127], v5, s[4:7], s83 offen offset:1024 sc1
v_mfma_f32_16x16x32_bf16 v[188:191], v[68:71], a[88:91], v[188:191]
ds_read_b128 v[60:63], v8 offset:21504
s_waitcnt vmcnt(5)
v_cmp_ne_u64 vcc, s[66:67], v[38:39]
s_nop 0
s_cbranch_vccnz LF1_sp15
LF1_ok14:
v_mfma_f32_16x16x32_bf16 v[196:199], v[68:71], a[92:95], v[196:199]
ds_write_b128 v12, a[204:207] offset:52224
s_waitcnt lgkmcnt(4)
v_mfma_f32_16x16x32_bf16 v[168:171], v[40:43], a[96:99], v[168:171]
ds_read_b128 v[64:67], v8 offset:22528
buffer_load_dwordx4 a[0:3], v1, s[4:7], s76 offen offset:2048 sc1
v_mfma_f32_16x16x32_bf16 v[176:179], v[40:43], a[100:103], v[176:179]
buffer_store_dwordx2 v[36:37], v26, s[4:7], s40 offen offset:1536
v_mfma_f32_16x16x32_bf16 v[172:175], v[44:47], a[96:99], v[172:175]
ds_read_b128 v[68:71], v8 offset:23552
v_mfma_f32_16x16x32_bf16 v[180:183], v[44:47], a[100:103], v[180:183]
ds_write_b128 v13, a[208:211] offset:0
v_mfma_f32_16x16x32_bf16 v[184:187], v[48:51], a[96:99], v[184:187]
ds_read_b128 v[40:43], v8 offset:32768
v_mfma_f32_16x16x32_bf16 v[192:195], v[48:51], a[100:103], v[192:195]
buffer_load_dwordx4 a[4:7], v1, s[4:7], s80 offen offset:2048 sc1
v_mfma_f32_16x16x32_bf16 v[188:191], v[52:55], a[96:99], v[188:191]
ds_read_b128 v[44:47], v8 offset:33792
v_mfma_f32_16x16x32_bf16 v[196:199], v[52:55], a[100:103], v[196:199]
ds_write_b128 v13, a[212:215] offset:1024
s_waitcnt vmcnt(7) lgkmcnt(4)
v_mfma_f32_16x16x32_bf16 v[168:171], v[56:59], a[104:107], v[168:171]
ds_read_b128 v[48:51], v8 offset:34816
v_mfma_f32_16x16x32_bf16 v[176:179], v[56:59], a[108:111], v[176:179]
buffer_load_dwordx4 a[8:11], v5, s[4:7], s76 offen offset:2048 sc1
v_mfma_f32_16x16x32_bf16 v[172:175], v[60:63], a[104:107], v[172:175]
ds_read_b128 v[52:55], v8 offset:35840
v_mfma_f32_16x16x32_bf16 v[180:183], v[60:63], a[108:111], v[180:183]
ds_write_b128 v13, a[216:219] offset:2048
v_mfma_f32_16x16x32_bf16 v[184:187], v[64:67], a[104:107], v[184:187]
ds_read_b128 v[56:59], v8 offset:36864
v_mfma_f32_16x16x32_bf16 v[192:195], v[64:67], a[108:111], v[192:195]
buffer_load_dwordx4 a[12:15], v5, s[4:7], s80 offen offset:2048 sc1
v_mfma_f32_16x16x32_bf16 v[188:191], v[68:71], a[104:107], v[188:191]
ds_read_b128 v[60:63], v8 offset:37888
v_mfma_f32_16x16x32_bf16 v[196:199], v[68:71], a[108:111], v[196:199]
ds_write_b128 v13, a[220:223] offset:3072
s_waitcnt vmcnt(7) lgkmcnt(4)
v_mfma_f32_16x16x32_bf16 v[168:171], v[40:43], a[112:115], v[168:171]
ds_read_b128 v[64:67], v8 offset:38912
v_mfma_f32_16x16x32_bf16 v[176:179], v[40:43], a[116:119], v[176:179]
buffer_load_dwordx4 a[16:19], v1, s[4:7], s77 offen offset:2048 sc1
v_mfma_f32_16x16x32_bf16 v[172:175], v[44:47], a[112:115], v[172:175]
s_barrier
v_mfma_f32_16x16x32_bf16 v[180:183], v[44:47], a[116:119], v[180:183]
ds_read_b128 v[68:71], v8 offset:39936
v_mfma_f32_16x16x32_bf16 v[184:187], v[48:51], a[112:115], v[184:187]
ds_read_b128 v[40:43], v9 offset:32768
v_mfma_f32_16x16x32_bf16 v[192:195], v[48:51], a[116:119], v[192:195]
buffer_load_dwordx4 a[20:23], v1, s[4:7], s81 offen offset:2048 sc1
v_mfma_f32_16x16x32_bf16 v[188:191], v[52:55], a[112:115], v[188:191]
ds_read_b128 v[44:47], v9 offset:33792
v_mfma_f32_16x16x32_bf16 v[196:199], v[52:55], a[116:119], v[196:199]
s_waitcnt vmcnt(7) lgkmcnt(2)
v_mfma_f32_16x16x32_bf16 v[168:171], v[56:59], a[120:123], v[168:171]
ds_read_b128 v[48:51], v9 offset:34816
v_mfma_f32_16x16x32_bf16 v[176:179], v[56:59], a[124:127], v[176:179]
buffer_load_dwordx4 a[24:27], v5, s[4:7], s77 offen offset:2048 sc1
v_mfma_f32_16x16x32_bf16 v[172:175], v[60:63], a[120:123], v[172:175]
ds_read_b128 v[52:55], v9 offset:35840
v_lshrrev_b32 v25, 4, v0
v_mfma_f32_16x16x32_bf16 v[180:183], v[60:63], a[124:127], v[180:183]
v_and_b32 v25, 3, v25
s_lshl_b32 s51, s14, 9
v_mfma_f32_16x16x32_bf16 v[184:187], v[64:67], a[120:123], v[184:187]
ds_read_b128 v[56:59], v9 offset:36864
v_mfma_f32_16x16x32_bf16 v[192:195], v[64:67], a[124:127], v[192:195]
buffer_load_dwordx4 a[28:31], v5, s[4:7], s81 offen offset:2048 sc1
v_mfma_f32_16x16x32_bf16 v[188:191], v[68:71], a[120:123], v[188:191]
ds_read_b128 v[60:63], v9 offset:37888
s_add_u32 s51, s51, 157696
v_mfma_f32_16x16x32_bf16 v[196:199], v[68:71], a[124:127], v[196:199]
v_lshl_add_u32 v25, v25, 4, s51
s_waitcnt vmcnt(6) lgkmcnt(2)
v_mfma_f32_16x16x32_bf16 v[168:171], v[40:43], a[0:3], v[168:171]
ds_read_b128 v[64:67], v9 offset:38912
v_mfma_f32_16x16x32_bf16 v[176:179], v[40:43], a[4:7], v[176:179]
buffer_load_dwordx4 a[32:35], v1, s[4:7], s78 offen offset:2048 sc1
v_mfma_f32_16x16x32_bf16 v[172:175], v[44:47], a[0:3], v[172:175]
ds_read_b128 v[68:71], v9 offset:39936
v_mfma_f32_16x16x32_bf16 v[180:183], v[44:47], a[4:7], v[180:183]
v_mfma_f32_16x16x32_bf16 v[184:187], v[48:51], a[0:3], v[184:187]
ds_read_b128 v[40:43], v9 offset:0
v_mfma_f32_16x16x32_bf16 v[192:195], v[48:51], a[4:7], v[192:195]
buffer_load_dwordx4 a[36:39], v1, s[4:7], s82 offen offset:2048 sc1
v_mfma_f32_16x16x32_bf16 v[188:191], v[52:55], a[0:3], v[188:191]
ds_read_b128 v[44:47], v9 offset:1024
v_mfma_f32_16x16x32_bf16 v[196:199], v[52:55], a[4:7], v[196:199]
s_waitcnt vmcnt(6) lgkmcnt(2)
v_mfma_f32_16x16x32_bf16 v[168:171], v[56:59], a[8:11], v[168:171]
ds_read_b128 v[48:51], v9 offset:2048
buffer_load_dwordx4 a[40:43], v5, s[4:7], s78 offen offset:2048 sc1
v_mfma_f32_16x16x32_bf16 v[176:179], v[56:59], a[12:15], v[176:179]
buffer_load_dwordx2 v[38:39], v17, s[4:7], s41 offen offset:1536 sc1
v_mfma_f32_16x16x32_bf16 v[172:175], v[60:63], a[8:11], v[172:175]
ds_read_b128 v[52:55], v9 offset:3072
v_mfma_f32_16x16x32_bf16 v[180:183], v[60:63], a[12:15], v[180:183]
v_mfma_f32_16x16x32_bf16 v[184:187], v[64:67], a[8:11], v[184:187]
ds_read_b128 v[56:59], v9 offset:4096
v_mfma_f32_16x16x32_bf16 v[192:195], v[64:67], a[12:15], v[192:195]
buffer_load_dwordx4 a[44:47], v5, s[4:7], s82 offen offset:2048 sc1
v_mfma_f32_16x16x32_bf16 v[188:191], v[68:71], a[8:11], v[188:191]
ds_read_b128 v[60:63], v9 offset:5120
v_mfma_f32_16x16x32_bf16 v[196:199], v[68:71], a[12:15], v[196:199]
s_waitcnt vmcnt(7) lgkmcnt(2)
v_mfma_f32_16x16x32_bf16 v[168:171], v[40:43], a[16:19], v[168:171]
ds_read_b128 v[64:67], v9 offset:6144
v_mfma_f32_16x16x32_bf16 v[176:179], v[40:43], a[20:23], v[176:179]
buffer_load_dwordx4 a[48:51], v1, s[4:7], s79 offen offset:2048 sc1
v_mfma_f32_16x16x32_bf16 v[172:175], v[44:47], a[16:19], v[172:175]
s_barrier
v_mfma_f32_16x16x32_bf16 v[180:183], v[44:47], a[20:23], v[180:183]
ds_read_b128 v[68:71], v9 offset:7168
v_mfma_f32_16x16x32_bf16 v[184:187], v[48:51], a[16:19], v[184:187]
ds_read_b128 v[40:43], v9 offset:16384
v_mfma_f32_16x16x32_bf16 v[192:195], v[48:51], a[20:23], v[192:195]
buffer_load_dwordx4 a[52:55], v1, s[4:7], s83 offen offset:2048 sc1
v_mfma_f32_16x16x32_bf16 v[188:191], v[52:55], a[16:19], v[188:191]
ds_read_b128 v[44:47], v9 offset:17408
v_mfma_f32_16x16x32_bf16 v[196:199], v[52:55], a[20:23], v[196:199]
s_waitcnt vmcnt(7) lgkmcnt(2)
v_mfma_f32_16x16x32_bf16 v[168:171], v[56:59], a[24:27], v[168:171]
ds_read_b128 v[48:51], v9 offset:18432
v_mfma_f32_16x16x32_bf16 v[176:179], v[56:59], a[28:31], v[176:179]
buffer_load_dwordx4 a[56:59], v5, s[4:7], s79 offen offset:2048 sc1
v_mfma_f32_16x16x32_bf16 v[172:175], v[60:63], a[24:27], v[172:175]
ds_read_b128 v[52:55], v9 offset:19456
v_mfma_f32_16x16x32_bf16 v[180:183], v[60:63], a[28:31], v[180:183]
v_mfma_f32_16x16x32_bf16 v[184:187], v[64:67], a[24:27], v[184:187]
ds_read_b128 v[56:59], v9 offset:20480
v_mfma_f32_16x16x32_bf16 v[192:195], v[64:67], a[28:31], v[192:195]
buffer_load_dwordx4 a[60:63], v5, s[4:7], s83 offen offset:2048 sc1
v_mfma_f32_16x16x32_bf16 v[188:191], v[68:71], a[24:27], v[188:191]
ds_read_b128 v[60:63], v9 offset:21504
v_mfma_f32_16x16x32_bf16 v[196:199], v[68:71], a[28:31], v[196:199]
s_waitcnt vmcnt(5)
v_cmp_ne_u64 vcc, s[66:67], v[38:39]
s_nop 0
s_cbranch_vccnz LF1_sp17
LF1_ok16:
s_waitcnt lgkmcnt(2)
v_mfma_f32_16x16x32_bf16 v[168:171], v[40:43], a[32:35], v[168:171]
ds_read_b128 v[64:67], v9 offset:22528
v_mfma_f32_16x16x32_bf16 v[176:179], v[40:43], a[36:39], v[176:179]
buffer_load_dwordx4 a[64:67], v1, s[4:7], s76 offen offset:3072 sc1
v_mfma_f32_16x16x32_bf16 v[172:175], v[44:47], a[32:35], v[172:175]
ds_read_b128 v[68:71], v9 offset:23552
v_mfma_f32_16x16x32_bf16 v[180:183], v[44:47], a[36:39], v[180:183]
v_mfma_f32_16x16x32_bf16 v[184:187], v[48:51], a[32:35], v[184:187]
ds_read_b128 v[40:43], v8 offset:0
v_mfma_f32_16x16x32_bf16 v[192:195], v[48:51], a[36:39], v[192:195]
buffer_load_dwordx4 a[68:71], v1, s[4:7], s80 offen offset:3072 sc1
v_mfma_f32_16x16x32_bf16 v[188:191], v[52:55], a[32:35], v[188:191]
ds_read_b128 v[44:47], v8 offset:1024
v_mfma_f32_16x16x32_bf16 v[196:199], v[52:55], a[36:39], v[196:199]
s_waitcnt vmcnt(6) lgkmcnt(2)
v_mfma_f32_16x16x32_bf16 v[168:171], v[56:59], a[40:43], v[168:171]
ds_read_b128 v[48:51], v8 offset:2048
v_mfma_f32_16x16x32_bf16 v[176:179], v[56:59], a[44:47], v[176:179]
buffer_load_dwordx4 a[72:75], v1, s[4:7], s77 offen offset:3072 sc1
v_mfma_f32_16x16x32_bf16 v[172:175], v[60:63], a[40:43], v[172:175]
ds_read_b128 v[52:55], v8 offset:3072
v_mfma_f32_16x16x32_bf16 v[180:183], v[60:63], a[44:47], v[180:183]
v_mfma_f32_16x16x32_bf16 v[184:187], v[64:67], a[40:43], v[184:187]
ds_read_b128 v[56:59], v8 offset:4096
v_mfma_f32_16x16x32_bf16 v[192:195], v[64:67], a[44:47], v[192:195]
buffer_load_dwordx4 a[76:79], v1, s[4:7], s81 offen offset:3072 sc1
v_mfma_f32_16x16x32_bf16 v[188:191], v[68:71], a[40:43], v[188:191]
ds_read_b128 v[60:63], v8 offset:5120
v_mfma_f32_16x16x32_bf16 v[196:199], v[68:71], a[44:47], v[196:199]
s_waitcnt vmcnt(6) lgkmcnt(2)
v_mfma_f32_16x16x32_bf16 v[168:171], v[40:43], a[48:51], v[168:171]
ds_read_b128 v[64:67], v8 offset:6144
v_mfma_f32_16x16x32_bf16 v[176:179], v[40:43], a[52:55], v[176:179]
buffer_load_dwordx4 a[80:83], v1, s[4:7], s78 offen offset:3072 sc1
v_mfma_f32_16x16x32_bf16 v[172:175], v[44:47], a[48:51], v[172:175]
s_barrier
v_mfma_f32_16x16x32_bf16 v[180:183], v[44:47], a[52:55], v[180:183]
ds_read_b128 v[68:71], v8 offset:7168
v_mfma_f32_16x16x32_bf16 v[184:187], v[48:51], a[48:51], v[184:187]
ds_read_b128 v[40:43], v9 offset:49152
v_mfma_f32_16x16x32_bf16 v[192:195], v[48:51], a[52:55], v[192:195]
buffer_load_dwordx4 a[84:87], v1, s[4:7], s82 offen offset:3072 sc1
v_mfma_f32_16x16x32_bf16 v[188:191], v[52:55], a[48:51], v[188:191]
ds_read_b128 v[44:47], v9 offset:50176
v_mfma_f32_16x16x32_bf16 v[196:199], v[52:55], a[52:55], v[196:199]
s_waitcnt vmcnt(6) lgkmcnt(2)
v_mfma_f32_16x16x32_bf16 v[168:171], v[56:59], a[56:59], v[168:171]
ds_read_b128 v[48:51], v9 offset:51200
v_mfma_f32_16x16x32_bf16 v[176:179], v[56:59], a[60:63], v[176:179]
buffer_load_dwordx4 a[88:91], v1, s[4:7], s79 offen offset:3072 sc1
v_mfma_f32_16x16x32_bf16 v[172:175], v[60:63], a[56:59], v[172:175]
ds_read_b128 v[52:55], v9 offset:52224
v_mfma_f32_16x16x32_bf16 v[180:183], v[60:63], a[60:63], v[180:183]
v_mfma_f32_16x16x32_bf16 v[184:187], v[64:67], a[56:59], v[184:187]
ds_read_b128 v[56:59], v9 offset:53248
v_mfma_f32_16x16x32_bf16 v[192:195], v[64:67], a[60:63], v[192:195]
buffer_load_dwordx4 a[92:95], v1, s[4:7], s83 offen offset:3072 sc1
v_mfma_f32_16x16x32_bf16 v[188:191], v[68:71], a[56:59], v[188:191]
ds_read_b128 v[60:63], v9 offset:54272
v_mfma_f32_16x16x32_bf16 v[196:199], v[68:71], a[60:63], v[196:199]
s_waitcnt vmcnt(6) lgkmcnt(2)
v_mfma_f32_16x16x32_bf16 v[168:171], v[40:43], a[64:67], v[168:171]
ds_read_b128 v[64:67], v9 offset:55296
v_mfma_f32_16x16x32_bf16 v[176:179], v[40:43], a[68:71], v[176:179]
v_mfma_f32_16x16x32_bf16 v[172:175], v[44:47], a[64:67], v[172:175]
ds_read_b128 v[68:71], v9 offset:56320
v_mfma_f32_16x16x32_bf16 v[180:183], v[44:47], a[68:71], v[180:183]
v_mfma_f32_16x16x32_bf16 v[184:187], v[48:51], a[64:67], v[184:187]
ds_read_b128 v[40:43], v10 offset:0
v_mfma_f32_16x16x32_bf16 v[192:195], v[48:51], a[68:71], v[192:195]
v_mfma_f32_16x16x32_bf16 v[188:191], v[52:55], a[64:67], v[188:191]
ds_read_b128 v[44:47], v10 offset:1024
v_mfma_f32_16x16x32_bf16 v[196:199], v[52:55], a[68:71], v[196:199]
s_waitcnt vmcnt(4) lgkmcnt(2)
v_mfma_f32_16x16x32_bf16 v[168:171], v[56:59], a[72:75], v[168:171]
ds_read_b128 v[48:51], v10 offset:2048
v_mfma_f32_16x16x32_bf16 v[176:179], v[56:59], a[76:79], v[176:179]
v_mfma_f32_16x16x32_bf16 v[172:175], v[60:63], a[72:75], v[172:175]
ds_read_b128 v[52:55], v10 offset:3072
v_mfma_f32_16x16x32_bf16 v[180:183], v[60:63], a[76:79], v[180:183]
v_mfma_f32_16x16x32_bf16 v[184:187], v[64:67], a[72:75], v[184:187]
ds_read_b128 v[56:59], v10 offset:4096
v_mfma_f32_16x16x32_bf16 v[192:195], v[64:67], a[76:79], v[192:195]
v_mfma_f32_16x16x32_bf16 v[188:191], v[68:71], a[72:75], v[188:191]
ds_read_b128 v[60:63], v10 offset:5120
v_mfma_f32_16x16x32_bf16 v[196:199], v[68:71], a[76:79], v[196:199]
s_waitcnt vmcnt(2) lgkmcnt(2)
ds_read_b128 v[64:67], v10 offset:6144
ds_read_b128 v[68:71], v10 offset:7168
v_mfma_f32_16x16x32_bf16 v[184:187], v[48:51], a[80:83], v[184:187]
v_mfma_f32_16x16x32_bf16 v[192:195], v[48:51], a[84:87], v[192:195]
v_mfma_f32_16x16x32_bf16 v[188:191], v[52:55], a[80:83], v[188:191]
v_mfma_f32_16x16x32_bf16 v[196:199], v[52:55], a[84:87], v[196:199]
s_waitcnt vmcnt(1) lgkmcnt(1)
v_mfma_f32_16x16x32_bf16 v[184:187], v[64:67], a[88:91], v[184:187]
s_waitcnt vmcnt(0)
v_mfma_f32_16x16x32_bf16 v[192:195], v[64:67], a[92:95], v[192:195]
s_waitcnt lgkmcnt(0)
v_mfma_f32_16x16x32_bf16 v[188:191], v[68:71], a[88:91], v[188:191]
v_mfma_f32_16x16x32_bf16 v[196:199], v[68:71], a[92:95], v[196:199]
v_mfma_f32_16x16x32_bf16 v[168:171], v[40:43], a[80:83], v[168:171]
v_mfma_f32_16x16x32_bf16 v[176:179], v[40:43], a[84:87], v[176:179]
v_mfma_f32_16x16x32_bf16 v[172:175], v[44:47], a[80:83], v[172:175]
v_mfma_f32_16x16x32_bf16 v[180:183], v[44:47], a[84:87], v[180:183]
ds_write_b128 v18, v[184:187] offset:0
v_mfma_f32_16x16x32_bf16 v[168:171], v[56:59], a[88:91], v[168:171]
s_nop 0
ds_write_b128 v18, v[188:191] offset:1024
v_mfma_f32_16x16x32_bf16 v[176:179], v[56:59], a[92:95], v[176:179]
ds_write_b128 v18, v[192:195] offset:2048
v_mfma_f32_16x16x32_bf16 v[172:175], v[60:63], a[88:91], v[172:175]
ds_write_b128 v18, v[196:199] offset:3072
v_mfma_f32_16x16x32_bf16 v[180:183], v[60:63], a[92:95], v[180:183]
s_waitcnt lgkmcnt(0)
s_barrier
ds_read_b128 v[224:227], v19 offset:0
ds_read_b128 v[228:231], v19 offset:1024
ds_read_b128 v[232:235], v19 offset:2048
ds_read_b128 v[236:239], v19 offset:3072
s_waitcnt lgkmcnt(3)
v_pk_add_f32 v[168:169], v[168:169], v[224:225]
v_pk_add_f32 v[170:171], v[170:171], v[226:227]
s_waitcnt lgkmcnt(2)
v_pk_add_f32 v[172:173], v[172:173], v[228:229]
v_pk_add_f32 v[174:175], v[174:175], v[230:231]
s_waitcnt lgkmcnt(1)
v_pk_add_f32 v[176:177], v[176:177], v[232:233]
v_pk_add_f32 v[178:179], v[178:179], v[234:235]
s_waitcnt lgkmcnt(0)
v_pk_add_f32 v[180:181], v[180:181], v[236:237]
v_pk_add_f32 v[182:183], v[182:183], v[238:239]
v_cvt_pk_bf16_f32 v124, v168, v169
v_cvt_pk_bf16_f32 v125, v170, v171
v_cvt_pk_bf16_f32 v126, v172, v173
v_cvt_pk_bf16_f32 v127, v174, v175
v_cvt_pk_bf16_f32 v128, v176, v177
v_cvt_pk_bf16_f32 v129, v178, v179
v_cvt_pk_bf16_f32 v130, v180, v181
v_cvt_pk_bf16_f32 v131, v182, v183
v_and_b32 v224, 15, v0
v_lshlrev_b32 v27, 11, v224
v_bfe_u32 v224, v0, 5, 1
v_lshl_add_u32 v27, v224, 4, v27
v_bfe_u32 v224, v0, 4, 1
v_lshl_add_u32 v27, v224, 5, v27
s_add_u32 s49, s54, 32768
v_permlane16_swap_b32 v124, v126
v_permlane16_swap_b32 v125, v127
v_permlane16_swap_b32 v128, v130
v_permlane16_swap_b32 v129, v131
buffer_store_dwordx4 v[124:127], v27, s[8:11], s54 offen
buffer_store_dwordx4 v[128:131], v27, s[8:11], s49 offen
s_or_b32 s48, s2, s14
s_cbranch_scc1 LF1_c20
s_mov_b32 s48, 8134656
buffer_store_dword v37, v26, s[4:7], s48 offen
LF1_c20:
s_endpgm
LZ_sp19:
buffer_load_dwordx2 v[170:171], v169, s[4:7], 0 offen offset:0 sc1
s_waitcnt vmcnt(0)
v_cmp_ne_u32 vcc, s67, v171
s_nop 0
s_cbranch_vccz LZ_ok18
s_add_u32 s52, s52, 1
s_cmp_lt_u32 s52, 2000000
s_cbranch_scc1 LZ_sp19
s_branch LZ_ok18
LZ_sp21:
buffer_load_dwordx2 v[38:39], v168, s[4:7], 0 offen offset:0 sc1
s_waitcnt vmcnt(0)
v_cmp_ne_u32 vcc, s67, v39
s_nop 0
s_cbranch_vccz LZ_ok20
s_add_u32 s52, s52, 1
s_cmp_lt_u32 s52, 2000000
s_cbranch_scc1 LZ_sp21
s_branch LZ_ok20
LF0_sp4:
buffer_load_dwordx2 v[38:39], v17, s[4:7], s37 offen offset:0 sc1
s_waitcnt vmcnt(1)
v_cmp_ne_u64 vcc, s[66:67], v[252:253]
s_nop 0
s_cbranch_vccz LF0_ok3
buffer_load_dwordx2 v[252:253], v17, s[4:7], s37 offen offset:0 sc1
s_waitcnt vmcnt(1)
v_cmp_ne_u64 vcc, s[66:67], v[38:39]
s_nop 0
s_cbranch_vccz LF0_ok3
s_add_u32 s52, s52, 1
s_cmp_lt_u32 s52, 2000000
s_cbranch_scc1 LF0_sp4
s_branch LF0_ok3
LF0_sp7:
buffer_load_dwordx2 v[38:39], v16, s[4:7], s39 offen offset:0 sc1
s_waitcnt vmcnt(1)
v_cmp_ne_u64 vcc, s[66:67], v[252:253]
s_nop 0
s_cbranch_vccz LF0_ok6
buffer_load_dwordx2 v[252:253], v16, s[4:7], s39 offen offset:0 sc1
s_waitcnt vmcnt(1)
v_cmp_ne_u64 vcc, s[66:67], v[38:39]
s_nop 0
s_cbranch_vccz LF0_ok6
s_add_u32 s52, s52, 1
s_cmp_lt_u32 s52, 2000000
s_cbranch_scc1 LF0_sp7
s_branch LF0_ok6
LF0_sp9:
buffer_load_dwordx2 v[38:39], v254, s[4:7], 0 offen offset:0 sc1
s_waitcnt vmcnt(0)
v_cmp_ne_u64 vcc, s[66:67], v[38:39]
s_nop 0
s_cbranch_vccz LF0_ok8
s_add_u32 s52, s52, 1
s_cmp_lt_u32 s52, 2000000
s_cbranch_scc1 LF0_sp9
s_branch LF0_ok8
LF0_sp11:
buffer_load_dwordx2 v[38:39], v17, s[4:7], s41 offen offset:0 sc1
s_waitcnt vmcnt(0)
v_cmp_ne_u64 vcc, s[66:67], v[38:39]
s_nop 0
s_cbranch_vccz LF0_ok10
s_add_u32 s52, s52, 1
s_cmp_lt_u32 s52, 2000000
s_cbranch_scc1 LF0_sp11
s_branch LF0_ok10
LF0_sp13:
buffer_load_dwordx2 v[38:39], v17, s[4:7], s41 offen offset:512 sc1
s_waitcnt vmcnt(0)
v_cmp_ne_u64 vcc, s[66:67], v[38:39]
s_nop 0
s_cbranch_vccz LF0_ok12
s_add_u32 s52, s52, 1
s_cmp_lt_u32 s52, 2000000
s_cbranch_scc1 LF0_sp13
s_branch LF0_ok12
LF0_sp15:
buffer_load_dwordx2 v[38:39], v17, s[4:7], s41 offen offset:1024 sc1
s_waitcnt vmcnt(0)
v_cmp_ne_u64 vcc, s[66:67], v[38:39]
s_nop 0
s_cbranch_vccz LF0_ok14
s_add_u32 s52, s52, 1
s_cmp_lt_u32 s52, 2000000
s_cbranch_scc1 LF0_sp15
s_branch LF0_ok14
LF0_sp17:
buffer_load_dwordx2 v[38:39], v17, s[4:7], s41 offen offset:1536 sc1
s_waitcnt vmcnt(0)
v_cmp_ne_u64 vcc, s[66:67], v[38:39]
s_nop 0
s_cbranch_vccz LF0_ok16
s_add_u32 s52, s52, 1
s_cmp_lt_u32 s52, 2000000
s_cbranch_scc1 LF0_sp17
s_branch LF0_ok16
LF1_sp2:
buffer_load_dwordx2 v[38:39], v16, s[4:7], s43 offen offset:0 sc1
s_waitcnt vmcnt(1)
v_cmp_ne_u64 vcc, s[66:67], v[252:253]
s_nop 0
s_cbranch_vccz LF1_ok1
buffer_load_dwordx2 v[252:253], v16, s[4:7], s43 offen offset:0 sc1
s_waitcnt vmcnt(1)
v_cmp_ne_u64 vcc, s[66:67], v[38:39]
s_nop 0
s_cbranch_vccz LF1_ok1
s_add_u32 s52, s52, 1
s_cmp_lt_u32 s52, 2000000
s_cbranch_scc1 LF1_sp2
s_branch LF1_ok1
LF1_sp4:
buffer_load_dwordx2 v[38:39], v16, s[4:7], s45 offen offset:0 sc1
s_waitcnt vmcnt(0)
v_cmp_ne_u64 vcc, s[66:67], v[38:39]
s_nop 0
s_cbranch_vccz LF1_ok3
s_add_u32 s52, s52, 1
s_cmp_lt_u32 s52, 2000000
s_cbranch_scc1 LF1_sp4
s_branch LF1_ok3
LF1_sp7:
buffer_load_dwordx2 v[38:39], v17, s[4:7], s37 offen offset:512 sc1
s_waitcnt vmcnt(1)
v_cmp_ne_u64 vcc, s[66:67], v[252:253]
s_nop 0
s_cbranch_vccz LF1_ok6
buffer_load_dwordx2 v[252:253], v17, s[4:7], s37 offen offset:512 sc1
s_waitcnt vmcnt(1)
v_cmp_ne_u64 vcc, s[66:67], v[38:39]
s_nop 0
s_cbranch_vccz LF1_ok6
s_add_u32 s52, s52, 1
s_cmp_lt_u32 s52, 2000000
s_cbranch_scc1 LF1_sp7
s_branch LF1_ok6
LF1_sp9:
buffer_load_dwordx2 v[38:39], v16, s[4:7], s39 offen offset:512 sc1
s_waitcnt vmcnt(1)
v_cmp_ne_u64 vcc, s[66:67], v[252:253]
s_nop 0
s_cbranch_vccz LF1_ok8
buffer_load_dwordx2 v[252:253], v16, s[4:7], s39 offen offset:512 sc1
s_waitcnt vmcnt(1)
v_cmp_ne_u64 vcc, s[66:67], v[38:39]
s_nop 0
s_cbranch_vccz LF1_ok8
s_add_u32 s52, s52, 1
s_cmp_lt_u32 s52, 2000000
s_cbranch_scc1 LF1_sp9
s_branch LF1_ok8
LF1_sp11:
buffer_load_dwordx2 v[38:39], v17, s[4:7], s41 offen offset:0 sc1
s_waitcnt vmcnt(0)
v_cmp_ne_u64 vcc, s[66:67], v[38:39]
s_nop 0
s_cbranch_vccz LF1_ok10
s_add_u32 s52, s52, 1
s_cmp_lt_u32 s52, 2000000
s_cbranch_scc1 LF1_sp11
s_branch LF1_ok10
LF1_sp13:
buffer_load_dwordx2 v[38:39], v17, s[4:7], s41 offen offset:512 sc1
s_waitcnt vmcnt(0)
v_cmp_ne_u64 vcc, s[66:67], v[38:39]
s_nop 0
s_cbranch_vccz LF1_ok12
s_add_u32 s52, s52, 1
s_cmp_lt_u32 s52, 2000000
s_cbranch_scc1 LF1_sp13
s_branch LF1_ok12
LF1_sp15:
buffer_load_dwordx2 v[38:39], v17, s[4:7], s41 offen offset:1024 sc1
s_waitcnt vmcnt(0)
v_cmp_ne_u64 vcc, s[66:67], v[38:39]
s_nop 0
s_cbranch_vccz LF1_ok14
s_add_u32 s52, s52, 1
s_cmp_lt_u32 s52, 2000000
s_cbranch_scc1 LF1_sp15
s_branch LF1_ok14
LF1_sp17:
buffer_load_dwordx2 v[38:39], v17, s[4:7], s41 offen offset:1536 sc1
s_waitcnt vmcnt(0)
v_cmp_ne_u64 vcc, s[66:67], v[38:39]
s_nop 0
s_cbranch_vccz LF1_ok16
s_add_u32 s52, s52, 1
s_cmp_lt_u32 s52, 2000000
s_cbranch_scc1 LF1_sp17
s_branch LF1_ok16
LS0_sp3:
buffer_load_dwordx2 v[38:39], v17, s[4:7], s37 offen offset:0 sc1
s_waitcnt vmcnt(1)
v_cmp_ne_u64 vcc, s[66:67], v[252:253]
s_nop 0
s_cbranch_vccz LS0_ok2
buffer_load_dwordx2 v[252:253], v17, s[4:7], s37 offen offset:0 sc1
s_waitcnt vmcnt(1)
v_cmp_ne_u64 vcc, s[66:67], v[38:39]
s_nop 0
s_cbranch_vccz LS0_ok2
s_add_u32 s52, s52, 1
s_cmp_lt_u32 s52, 2000000
s_cbranch_scc1 LS0_sp3
s_branch LS0_ok2
LS0_sp6:
buffer_load_dwordx2 v[38:39], v16, s[4:7], s39 offen offset:0 sc1
s_waitcnt vmcnt(1)
v_cmp_ne_u64 vcc, s[66:67], v[252:253]
s_nop 0
s_cbranch_vccz LS0_ok5
buffer_load_dwordx2 v[252:253], v16, s[4:7], s39 offen offset:0 sc1
s_waitcnt vmcnt(1)
v_cmp_ne_u64 vcc, s[66:67], v[38:39]
s_nop 0
s_cbranch_vccz LS0_ok5
s_add_u32 s52, s52, 1
s_cmp_lt_u32 s52, 2000000
s_cbranch_scc1 LS0_sp6
s_branch LS0_ok5
LS0_sp8:
buffer_load_dwordx2 v[38:39], v254, s[4:7], 0 offen offset:0 sc1
s_waitcnt vmcnt(0)
v_cmp_ne_u64 vcc, s[66:67], v[38:39]
s_nop 0
s_cbranch_vccz LS0_ok7
s_add_u32 s52, s52, 1
s_cmp_lt_u32 s52, 2000000
s_cbranch_scc1 LS0_sp8
s_branch LS0_ok7
LS0_sp10:
buffer_load_dwordx2 v[38:39], v17, s[4:7], s41 offen offset:0 sc1
s_waitcnt vmcnt(0)
v_cmp_ne_u64 vcc, s[66:67], v[38:39]
s_nop 0
s_cbranch_vccz LS0_ok9
s_add_u32 s52, s52, 1
s_cmp_lt_u32 s52, 2000000
s_cbranch_scc1 LS0_sp10
s_branch LS0_ok9
LS0_sp12:
buffer_load_dwordx2 v[38:39], v17, s[4:7], s41 offen offset:512 sc1
s_waitcnt vmcnt(0)
v_cmp_ne_u64 vcc, s[66:67], v[38:39]
s_nop 0
s_cbranch_vccz LS0_ok11
s_add_u32 s52, s52, 1
s_cmp_lt_u32 s52, 2000000
s_cbranch_scc1 LS0_sp12
s_branch LS0_ok11
LS0_sp14:
buffer_load_dwordx2 v[38:39], v17, s[4:7], s41 offen offset:1024 sc1
s_waitcnt vmcnt(0)
v_cmp_ne_u64 vcc, s[66:67], v[38:39]
s_nop 0
s_cbranch_vccz LS0_ok13
s_add_u32 s52, s52, 1
s_cmp_lt_u32 s52, 2000000
s_cbranch_scc1 LS0_sp14
s_branch LS0_ok13
LS0_sp16:
buffer_load_dwordx2 v[38:39], v17, s[4:7], s41 offen offset:1536 sc1
s_waitcnt vmcnt(0)
v_cmp_ne_u64 vcc, s[66:67], v[38:39]
s_nop 0
s_cbranch_vccz LS0_ok15
s_add_u32 s52, s52, 1
s_cmp_lt_u32 s52, 2000000
s_cbranch_scc1 LS0_sp16
s_branch LS0_ok15
LS1_sp2:
buffer_load_dwordx2 v[38:39], v16, s[4:7], s43 offen offset:0 sc1
s_waitcnt vmcnt(1)
v_cmp_ne_u64 vcc, s[66:67], v[252:253]
s_nop 0
s_cbranch_vccz LS1_ok1
buffer_load_dwordx2 v[252:253], v16, s[4:7], s43 offen offset:0 sc1
s_waitcnt vmcnt(1)
v_cmp_ne_u64 vcc, s[66:67], v[38:39]
s_nop 0
s_cbranch_vccz LS1_ok1
s_add_u32 s52, s52, 1
s_cmp_lt_u32 s52, 2000000
s_cbranch_scc1 LS1_sp2
s_branch LS1_ok1
LS1_sp4:
buffer_load_dwordx2 v[38:39], v16, s[4:7], s45 offen offset:0 sc1
s_waitcnt vmcnt(0)
v_cmp_ne_u64 vcc, s[66:67], v[38:39]
s_nop 0
s_cbranch_vccz LS1_ok3
s_add_u32 s52, s52, 1
s_cmp_lt_u32 s52, 2000000
s_cbranch_scc1 LS1_sp4
s_branch LS1_ok3
LS1_sp6:
buffer_load_dwordx2 v[38:39], v17, s[4:7], s37 offen offset:512 sc1
s_waitcnt vmcnt(1)
v_cmp_ne_u64 vcc, s[66:67], v[252:253]
s_nop 0
s_cbranch_vccz LS1_ok5
buffer_load_dwordx2 v[252:253], v17, s[4:7], s37 offen offset:512 sc1
s_waitcnt vmcnt(1)
v_cmp_ne_u64 vcc, s[66:67], v[38:39]
s_nop 0
s_cbranch_vccz LS1_ok5
s_add_u32 s52, s52, 1
s_cmp_lt_u32 s52, 2000000
s_cbranch_scc1 LS1_sp6
s_branch LS1_ok5
LS1_sp8:
buffer_load_dwordx2 v[38:39], v16, s[4:7], s39 offen offset:512 sc1
s_waitcnt vmcnt(1)
v_cmp_ne_u64 vcc, s[66:67], v[252:253]
s_nop 0
s_cbranch_vccz LS1_ok7
buffer_load_dwordx2 v[252:253], v16, s[4:7], s39 offen offset:512 sc1
s_waitcnt vmcnt(1)
v_cmp_ne_u64 vcc, s[66:67], v[38:39]
s_nop 0
s_cbranch_vccz LS1_ok7
s_add_u32 s52, s52, 1
s_cmp_lt_u32 s52, 2000000
s_cbranch_scc1 LS1_sp8
s_branch LS1_ok7
LS1_sp10:
buffer_load_dwordx2 v[38:39], v17, s[4:7], s41 offen offset:0 sc1
s_waitcnt vmcnt(0)
v_cmp_ne_u64 vcc, s[66:67], v[38:39]
s_nop 0
s_cbranch_vccz LS1_ok9
s_add_u32 s52, s52, 1
s_cmp_lt_u32 s52, 2000000
s_cbranch_scc1 LS1_sp10
s_branch LS1_ok9
LS1_sp12:
buffer_load_dwordx2 v[38:39], v17, s[4:7], s41 offen offset:512 sc1
s_waitcnt vmcnt(0)
v_cmp_ne_u64 vcc, s[66:67], v[38:39]
s_nop 0
s_cbranch_vccz LS1_ok11
s_add_u32 s52, s52, 1
s_cmp_lt_u32 s52, 2000000
s_cbranch_scc1 LS1_sp12
s_branch LS1_ok11
LS1_sp14:
buffer_load_dwordx2 v[38:39], v17, s[4:7], s41 offen offset:1024 sc1
s_waitcnt vmcnt(0)
v_cmp_ne_u64 vcc, s[66:67], v[38:39]
s_nop 0
s_cbranch_vccz LS1_ok13
s_add_u32 s52, s52, 1
s_cmp_lt_u32 s52, 2000000
s_cbranch_scc1 LS1_sp14
s_branch LS1_ok13
LS1_sp16:
buffer_load_dwordx2 v[38:39], v17, s[4:7], s41 offen offset:1536 sc1
s_waitcnt vmcnt(0)
v_cmp_ne_u64 vcc, s[66:67], v[38:39]
s_nop 0
s_cbranch_vccz LS1_ok15
s_add_u32 s52, s52, 1
s_cmp_lt_u32 s52, 2000000
s_cbranch_scc1 LS1_sp16
s_branch LS1_ok15
Lm_exit:
s_endpgm
LS0_tail:
v_pk_add_f32 v[224:225], v[224:225], v[226:227]
s_add_u32 m0, s21, 98304
s_add_u32 s47, s19, 0
buffer_load_dwordx4 v1, s[4:7], s47 offen offset:0 sc1 lds
v_pk_add_f32 v[228:229], v[228:229], v[230:231]
v_pk_add_f32 v[232:233], v[232:233], v[234:235]
v_pk_add_f32 v[236:237], v[236:237], v[238:239]
v_pk_add_f32 v[224:225], v[224:225], v[228:229]
v_pk_add_f32 v[232:233], v[232:233], v[236:237]
v_pk_add_f32 v[224:225], v[224:225], v[232:233]
v_mov_b32 v226, v224
v_mov_b32 v227, v225
s_nop 0
v_permlane32_swap_b32 v224, v226
v_permlane32_swap_b32 v225, v227
v_add_f32 v224, v224, v226
v_add_f32 v225, v225, v227
v_mul_f32 v224, 0xbb000000, v224
v_mul_f32 v225, 0x3b000000, v225
v_fma_f32 v225, -v224, v224, v225
v_max_f32 v225, 0, v225
v_add_f32 v225, 0x3727c5ac, v225
buffer_load_dwordx4 v1, s[4:7], s47 offen offset:1024 sc1 lds
v_rsq_f32 v226, v225
s_nop 0
v_cndmask_b32 v227, v224, v226, s[62:63]
ds_write_b32 v23, v227
ds_read2_b32 v[200:201], v24 offset0:0 offset1:32
ds_read2_b32 v[202:203], v24 offset0:16 offset1:48
ds_read_b128 v[208:211], v25 offset:0
ds_read_b128 v[212:215], v25 offset:128
ds_read_b128 v[216:219], v25 offset:64
ds_read_b128 v[220:223], v25 offset:192
s_waitcnt lgkmcnt(5)
v_mul_f32 v204, 0x3eb8aa3b, v201
s_waitcnt lgkmcnt(4)
v_mul_f32 v205, 0x3eb8aa3b, v203
v_pk_add_f32 v[40:41], v[40:41], v[42:43]
v_pk_add_f32 v[44:45], v[44:45], v[46:47]
v_pk_add_f32 v[48:49], v[48:49], v[50:51]
v_pk_add_f32 v[52:53], v[52:53], v[54:55]
v_pk_add_f32 v[40:41], v[40:41], v[44:45]
v_pk_add_f32 v[48:49], v[48:49], v[52:53]
buffer_load_dwordx4 v1, s[4:7], s47 offen offset:2048 sc1 lds
v_pk_add_f32 v[40:41], v[40:41], v[48:49]
v_mov_b32 v42, v40
v_mov_b32 v43, v41
s_nop 0
v_permlane32_swap_b32 v40, v42
v_permlane32_swap_b32 v41, v43
v_add_f32 v40, v40, v42
v_add_f32 v41, v41, v43
v_mul_f32 v40, 0xbb000000, v40
v_mul_f32 v41, 0x3b000000, v41
v_fma_f32 v41, -v40, v40, v41
v_max_f32 v41, 0, v41
v_add_f32 v41, 0x3727c5ac, v41
v_rsq_f32 v42, v41
s_nop 0
v_cndmask_b32 v43, v40, v42, s[62:63]
ds_write_b32 v23, v43 offset:256
ds_read2_b32 v[40:41], v24 offset0:80 offset1:112
ds_read_b128 v[44:47], v25 offset:320
buffer_load_dwordx4 v1, s[4:7], s47 offen offset:3072 sc1 lds
ds_read_b128 v[48:51], v25 offset:448
s_cmp_lg_u32 s15, 0
s_cselect_b64 vcc, -1, 0
v_cndmask_b32 v52, v34, v35, vcc
v_cndmask_b32 v160, v152, v156, vcc
v_cndmask_b32 v161, v153, v157, vcc
v_cndmask_b32 v162, v154, v158, vcc
v_cndmask_b32 v163, v155, v159, vcc
v_pk_fma_f32 v[92:93], v[202:203], v[152:153], v[92:93] op_sel:[0,0,0] op_sel_hi:[0,1,1]
v_pk_fma_f32 v[94:95], v[202:203], v[154:155], v[94:95] op_sel:[0,0,0] op_sel_hi:[0,1,1]
v_pk_mul_f32 v[92:93], v[202:203], v[92:93] op_sel:[1,0] op_sel_hi:[1,1]
v_pk_mul_f32 v[94:95], v[202:203], v[94:95] op_sel:[1,0] op_sel_hi:[1,1]
v_cvt_pk_bf16_f32 v172, v92, v93
v_cvt_pk_bf16_f32 v173, v94, v95
s_waitcnt lgkmcnt(5)
v_pk_fma_f32 v[100:101], v[216:217], v[34:35], v[100:101] op_sel:[0,0,0] op_sel_hi:[1,0,1]
v_pk_fma_f32 v[102:103], v[218:219], v[34:35], v[102:103] op_sel:[0,0,0] op_sel_hi:[1,0,1]
s_waitcnt lgkmcnt(4)
v_pk_mul_f32 v[100:101], v[220:221], v[100:101] op_sel:[0,0] op_sel_hi:[1,1]
v_pk_mul_f32 v[102:103], v[222:223], v[102:103] op_sel:[0,0] op_sel_hi:[1,1]
s_add_u32 m0, s21, 114688
s_add_u32 s47, s19, 16384
buffer_load_dwordx4 v1, s[4:7], s47 offen offset:0 sc1 lds
v_cvt_pk_bf16_f32 v184, v100, v101
v_cvt_pk_bf16_f32 v185, v102, v103
ds_write_b64 v20, v[172:173] offset:0
ds_write_b64 v20, v[184:185] offset:8
v_pk_fma_f32 v[108:109], v[202:203], v[156:157], v[108:109] op_sel:[0,0,0] op_sel_hi:[0,1,1]
v_pk_fma_f32 v[110:111], v[202:203], v[158:159], v[110:111] op_sel:[0,0,0] op_sel_hi:[0,1,1]
v_pk_mul_f32 v[108:109], v[202:203], v[108:109] op_sel:[1,0] op_sel_hi:[1,1]
v_pk_mul_f32 v[110:111], v[202:203], v[110:111] op_sel:[1,0] op_sel_hi:[1,1]
v_cvt_pk_bf16_f32 v178, v108, v109
v_cvt_pk_bf16_f32 v179, v110, v111
v_pk_fma_f32 v[116:117], v[216:217], v[34:35], v[116:117] op_sel:[0,1,0] op_sel_hi:[1,1,1]
v_pk_fma_f32 v[118:119], v[218:219], v[34:35], v[118:119] op_sel:[0,1,0] op_sel_hi:[1,1,1]
v_pk_mul_f32 v[116:117], v[220:221], v[116:117] op_sel:[0,0] op_sel_hi:[1,1]
v_pk_mul_f32 v[118:119], v[222:223], v[118:119] op_sel:[0,0] op_sel_hi:[1,1]
v_cvt_pk_bf16_f32 v190, v116, v117
v_cvt_pk_bf16_f32 v191, v118, v119
ds_write_b64 v20, v[178:179] offset:1024
buffer_load_dwordx4 v1, s[4:7], s47 offen offset:1024 sc1 lds
ds_write_b64 v20, v[190:191] offset:1032
s_waitcnt lgkmcnt(6)
v_pk_fma_f32 v[120:121], v[40:41], v[160:161], v[120:121] op_sel:[0,0,0] op_sel_hi:[0,1,1]
v_pk_fma_f32 v[122:123], v[40:41], v[162:163], v[122:123] op_sel:[0,0,0] op_sel_hi:[0,1,1]
v_pk_mul_f32 v[120:121], v[40:41], v[120:121] op_sel:[1,0] op_sel_hi:[1,1]
v_pk_mul_f32 v[122:123], v[40:41], v[122:123] op_sel:[1,0] op_sel_hi:[1,1]
v_cvt_pk_bf16_f32 v120, v120, v121
v_cvt_pk_bf16_f32 v121, v122, v123
s_waitcnt lgkmcnt(5)
v_pk_fma_f32 v[196:197], v[44:45], v[52:53], v[196:197] op_sel:[0,0,0] op_sel_hi:[1,0,1]
v_pk_fma_f32 v[198:199], v[46:47], v[52:53], v[198:199] op_sel:[0,0,0] op_sel_hi:[1,0,1]
s_waitcnt lgkmcnt(4)
v_pk_mul_f32 v[196:197], v[48:49], v[196:197] op_sel:[0,0] op_sel_hi:[1,1]
v_pk_mul_f32 v[198:199], v[50:51], v[198:199] op_sel:[0,0] op_sel_hi:[1,1]
v_cvt_pk_bf16_f32 v122, v196, v197
v_cvt_pk_bf16_f32 v123, v198, v199
ds_write_b128 v21, v[120:123]
v_pk_fma_f32 v[88:89], v[200:201], v[152:153], v[88:89] op_sel:[0,0,0] op_sel_hi:[0,1,1]
v_pk_fma_f32 v[90:91], v[200:201], v[154:155], v[90:91] op_sel:[0,0,0] op_sel_hi:[0,1,1]
v_pk_mul_f32 v[88:89], v[200:201], v[88:89] op_sel:[1,0] op_sel_hi:[1,1]
buffer_load_dwordx4 v1, s[4:7], s47 offen offset:2048 sc1 lds
v_pk_mul_f32 v[90:91], v[200:201], v[90:91] op_sel:[1,0] op_sel_hi:[1,1]
v_cvt_pk_bf16_f32 v170, v88, v89
v_cvt_pk_bf16_f32 v171, v90, v91
v_pk_fma_f32 v[96:97], v[208:209], v[34:35], v[96:97] op_sel:[0,0,0] op_sel_hi:[1,0,1]
v_pk_fma_f32 v[98:99], v[210:211], v[34:35], v[98:99] op_sel:[0,0,0] op_sel_hi:[1,0,1]
v_pk_mul_f32 v[96:97], v[212:213], v[96:97] op_sel:[0,0] op_sel_hi:[1,1]
v_pk_mul_f32 v[98:99], v[214:215], v[98:99] op_sel:[0,0] op_sel_hi:[1,1]
v_cvt_pk_bf16_f32 v182, v96, v97
v_cvt_pk_bf16_f32 v183, v98, v99
v_pk_fma_f32 v[76:77], v[202:203], v[144:145], v[76:77] op_sel:[0,0,0] op_sel_hi:[0,1,1]
v_pk_fma_f32 v[78:79], v[202:203], v[146:147], v[78:79] op_sel:[0,0,0] op_sel_hi:[0,1,1]
v_cvt_pk_bf16_f32 v76, v76, v77
v_cvt_pk_bf16_f32 v77, v78, v79
v_pk_fma_f32 v[72:73], v[200:201], v[144:145], v[72:73] op_sel:[0,0,0] op_sel_hi:[0,1,1]
v_pk_fma_f32 v[74:75], v[200:201], v[146:147], v[74:75] op_sel:[0,0,0] op_sel_hi:[0,1,1]
v_cvt_pk_bf16_f32 v72, v72, v73
v_cvt_pk_bf16_f32 v73, v74, v75
buffer_load_dwordx4 v1, s[4:7], s47 offen offset:3072 sc1 lds
v_pk_fma_f32 v[104:105], v[200:201], v[156:157], v[104:105] op_sel:[0,0,0] op_sel_hi:[0,1,1]
v_pk_fma_f32 v[106:107], v[200:201], v[158:159], v[106:107] op_sel:[0,0,0] op_sel_hi:[0,1,1]
v_pk_mul_f32 v[104:105], v[200:201], v[104:105] op_sel:[1,0] op_sel_hi:[1,1]
v_pk_mul_f32 v[106:107], v[200:201], v[106:107] op_sel:[1,0] op_sel_hi:[1,1]
v_cvt_pk_bf16_f32 v176, v104, v105
v_cvt_pk_bf16_f32 v177, v106, v107
v_pk_fma_f32 v[112:113], v[208:209], v[34:35], v[112:113] op_sel:[0,1,0] op_sel_hi:[1,1,1]
v_pk_fma_f32 v[114:115], v[210:211], v[34:35], v[114:115] op_sel:[0,1,0] op_sel_hi:[1,1,1]
v_pk_mul_f32 v[112:113], v[212:213], v[112:113] op_sel:[0,0] op_sel_hi:[1,1]
v_pk_mul_f32 v[114:115], v[214:215], v[114:115] op_sel:[0,0] op_sel_hi:[1,1]
v_cvt_pk_bf16_f32 v188, v112, v113
v_cvt_pk_bf16_f32 v189, v114, v115
v_pk_fma_f32 v[84:85], v[202:203], v[148:149], v[84:85] op_sel:[0,0,0] op_sel_hi:[0,1,1]
v_pk_fma_f32 v[86:87], v[202:203], v[150:151], v[86:87] op_sel:[0,0,0] op_sel_hi:[0,1,1]
v_cvt_pk_bf16_f32 v84, v84, v85
v_cvt_pk_bf16_f32 v85, v86, v87
v_pk_fma_f32 v[80:81], v[200:201], v[148:149], v[80:81] op_sel:[0,0,0] op_sel_hi:[0,1,1]
v_pk_fma_f32 v[82:83], v[200:201], v[150:151], v[82:83] op_sel:[0,0,0] op_sel_hi:[0,1,1]
v_cvt_pk_bf16_f32 v80, v80, v81
v_cvt_pk_bf16_f32 v81, v82, v83
s_lshl_b32 s51, s14, 9
s_sub_u32 s51, s51, 4096
v_subrev_u32 v208, s51, v25
v_subrev_u32 v209, s51, v24
s_and_b32 s51, s13, 1
s_cmp_lg_u32 s51, s16
s_cbranch_scc1 LS0_c1
ds_write_b128 v208, v[144:147] offset:0
ds_write_b128 v208, v[148:151] offset:64
ds_write_b128 v208, v[152:155] offset:128
ds_write_b128 v208, v[156:159] offset:192
ds_write2_b32 v209, v34, v35 offset0:64 offset1:80
LS0_c1:
s_waitcnt vmcnt(8)
s_waitcnt lgkmcnt(0)
s_barrier
ds_read_b64 v[168:169], v22 offset:0
ds_read_b64 v[180:181], v22 offset:8
ds_read_b64 v[174:175], v22 offset:1024
ds_read_b64 v[186:187], v22 offset:1032
ds_read_b128 v[144:147], v208 offset:0
ds_read_b128 v[148:151], v208 offset:64
ds_read_b128 v[152:155], v208 offset:128
ds_read_b128 v[156:159], v208 offset:192
ds_read2_b32 v[34:35], v209 offset0:64 offset1:80
v_mfma_f32_16x16x16_bf16 v[224:227], v[170:171], v[76:77], v[136:139]
s_add_u32 m0, s21, 0
s_add_u32 s47, s18, 0
buffer_load_dwordx4 v1, s[4:7], s47 offen offset:0 sc1 lds
v_mfma_f32_16x16x16_bf16 v[228:231], v[172:173], v[76:77], v[132:135]
v_mfma_f32_16x16x16_bf16 v[240:243], v[176:177], v[84:85], v[136:139]
v_mfma_f32_16x16x16_bf16 v[244:247], v[178:179], v[84:85], v[132:135]
s_waitcnt lgkmcnt(8)
v_mfma_f32_16x16x16_bf16 v[40:43], v[168:169], v[72:73], v[140:143]
v_mfma_f32_16x16x16_bf16 v[44:47], v[170:171], v[72:73], v[132:135]
s_waitcnt lgkmcnt(6)
v_mfma_f32_16x16x16_bf16 v[56:59], v[174:175], v[80:81], v[140:143]
buffer_load_dwordx4 v1, s[4:7], s47 offen offset:1024 sc1 lds
v_mfma_f32_16x16x16_bf16 v[60:63], v[176:177], v[80:81], v[132:135]
v_max3_f32 v232, v224, v225, v226
v_max3_f32 v233, v227, v228, v229
v_max3_f32 v232, v232, v230, v231
v_max_f32 v232, v232, v233
v_mov_b32 v233, v232
buffer_load_dwordx4 v1, s[4:7], s47 offen offset:2048 sc1 lds
v_max3_f32 v248, v240, v241, v242
v_max3_f32 v249, v243, v244, v245
v_max3_f32 v248, v248, v246, v247
v_max_f32 v248, v248, v249
v_mov_b32 v249, v248
v_max3_f32 v48, v40, v41, v42
buffer_load_dwordx4 v1, s[4:7], s47 offen offset:3072 sc1 lds
v_max3_f32 v49, v43, v44, v45
v_max3_f32 v48, v48, v46, v47
v_max_f32 v48, v48, v49
v_mov_b32 v49, v48
v_max3_f32 v64, v56, v57, v58
v_max3_f32 v65, v59, v60, v61
v_max3_f32 v64, v64, v62, v63
s_add_u32 m0, s21, 16384
s_add_u32 s47, s18, 16384
buffer_load_dwordx4 v1, s[4:7], s47 offen offset:0 sc1 lds
v_max_f32 v64, v64, v65
v_mov_b32 v65, v64
v_permlane32_swap_b32 v232, v233
v_max_f32 v232, v232, v233
v_mov_b32 v233, v232
v_permlane32_swap_b32 v248, v249
buffer_load_dwordx4 v1, s[4:7], s47 offen offset:1024 sc1 lds
v_max_f32 v248, v248, v249
v_mov_b32 v249, v248
v_permlane32_swap_b32 v48, v49
v_max_f32 v48, v48, v49
v_mov_b32 v49, v48
v_permlane32_swap_b32 v64, v65
buffer_load_dwordx4 v1, s[4:7], s47 offen offset:2048 sc1 lds
v_max_f32 v64, v64, v65
v_mov_b32 v65, v64
v_permlane16_swap_b32 v232, v233
v_max_f32 v232, v232, v233
v_mul_f32 v232, v205, v232
v_permlane16_swap_b32 v248, v249
buffer_load_dwordx4 v1, s[4:7], s47 offen offset:3072 sc1 lds
v_max_f32 v248, v248, v249
v_mul_f32 v248, v205, v248
v_permlane16_swap_b32 v48, v49
v_max_f32 v48, v48, v49
v_mul_f32 v48, v204, v48
v_permlane16_swap_b32 v64, v65
v_max_f32 v64, v64, v65
s_add_u32 m0, s21, 32768
s_add_u32 s47, s18, 32768
buffer_load_dwordx4 v1, s[4:7], s47 offen offset:0 sc1 lds
v_mul_f32 v64, v204, v64
v_pk_fma_f32 v[224:225], v[224:225], v[204:205], v[232:233] op_sel:[0,1,0] op_sel_hi:[1,1,0] neg_lo:[0,0,1] neg_hi:[0,0,1]
v_pk_fma_f32 v[226:227], v[226:227], v[204:205], v[232:233] op_sel:[0,1,0] op_sel_hi:[1,1,0] neg_lo:[0,0,1] neg_hi:[0,0,1]
v_pk_fma_f32 v[228:229], v[228:229], v[204:205], v[232:233] op_sel:[0,1,0] op_sel_hi:[1,1,0] neg_lo:[0,0,1] neg_hi:[0,0,1]
v_pk_fma_f32 v[230:231], v[230:231], v[204:205], v[232:233] op_sel:[0,1,0] op_sel_hi:[1,1,0] neg_lo:[0,0,1] neg_hi:[0,0,1]
v_pk_fma_f32 v[240:241], v[240:241], v[204:205], v[248:249] op_sel:[0,1,0] op_sel_hi:[1,1,0] neg_lo:[0,0,1] neg_hi:[0,0,1]
buffer_load_dwordx4 v1, s[4:7], s47 offen offset:1024 sc1 lds
v_pk_fma_f32 v[242:243], v[242:243], v[204:205], v[248:249] op_sel:[0,1,0] op_sel_hi:[1,1,0] neg_lo:[0,0,1] neg_hi:[0,0,1]
v_pk_fma_f32 v[244:245], v[244:245], v[204:205], v[248:249] op_sel:[0,1,0] op_sel_hi:[1,1,0] neg_lo:[0,0,1] neg_hi:[0,0,1]
v_pk_fma_f32 v[246:247], v[246:247], v[204:205], v[248:249] op_sel:[0,1,0] op_sel_hi:[1,1,0] neg_lo:[0,0,1] neg_hi:[0,0,1]
v_pk_fma_f32 v[40:41], v[40:41], v[204:205], v[48:49] op_sel:[0,0,0] op_sel_hi:[1,0,0] neg_lo:[0,0,1] neg_hi:[0,0,1]
v_pk_fma_f32 v[42:43], v[42:43], v[204:205], v[48:49] op_sel:[0,0,0] op_sel_hi:[1,0,0] neg_lo:[0,0,1] neg_hi:[0,0,1]
v_pk_fma_f32 v[44:45], v[44:45], v[204:205], v[48:49] op_sel:[0,0,0] op_sel_hi:[1,0,0] neg_lo:[0,0,1] neg_hi:[0,0,1]
buffer_load_dwordx4 v1, s[4:7], s47 offen offset:2048 sc1 lds
v_pk_fma_f32 v[46:47], v[46:47], v[204:205], v[48:49] op_sel:[0,0,0] op_sel_hi:[1,0,0] neg_lo:[0,0,1] neg_hi:[0,0,1]
v_pk_fma_f32 v[56:57], v[56:57], v[204:205], v[64:65] op_sel:[0,0,0] op_sel_hi:[1,0,0] neg_lo:[0,0,1] neg_hi:[0,0,1]
v_pk_fma_f32 v[58:59], v[58:59], v[204:205], v[64:65] op_sel:[0,0,0] op_sel_hi:[1,0,0] neg_lo:[0,0,1] neg_hi:[0,0,1]
v_pk_fma_f32 v[60:61], v[60:61], v[204:205], v[64:65] op_sel:[0,0,0] op_sel_hi:[1,0,0] neg_lo:[0,0,1] neg_hi:[0,0,1]
v_pk_fma_f32 v[62:63], v[62:63], v[204:205], v[64:65] op_sel:[0,0,0] op_sel_hi:[1,0,0] neg_lo:[0,0,1] neg_hi:[0,0,1]
v_exp_f32 v224, v224
buffer_load_dwordx4 v1, s[4:7], s47 offen offset:3072 sc1 lds
v_exp_f32 v225, v225
v_exp_f32 v226, v226
v_exp_f32 v227, v227
v_exp_f32 v228, v228
v_exp_f32 v229, v229
v_exp_f32 v230, v230
v_exp_f32 v231, v231
s_add_u32 m0, s21, 49152
s_add_u32 s47, s18, 49152
buffer_load_dwordx4 v1, s[4:7], s47 offen offset:0 sc1 lds
v_exp_f32 v240, v240
v_exp_f32 v241, v241
v_exp_f32 v242, v242
v_exp_f32 v243, v243
v_exp_f32 v244, v244
v_exp_f32 v245, v245
buffer_load_dwordx4 v1, s[4:7], s47 offen offset:1024 sc1 lds
v_exp_f32 v246, v246
v_exp_f32 v247, v247
v_exp_f32 v40, v40
v_exp_f32 v41, v41
v_exp_f32 v42, v42
v_exp_f32 v43, v43
buffer_load_dwordx4 v1, s[4:7], s47 offen offset:2048 sc1 lds
v_exp_f32 v44, v44
v_exp_f32 v45, v45
v_exp_f32 v46, v46
v_exp_f32 v47, v47
v_exp_f32 v56, v56
v_exp_f32 v57, v57
buffer_load_dwordx4 v1, s[4:7], s47 offen offset:3072 sc1 lds
v_exp_f32 v58, v58
v_exp_f32 v59, v59
v_exp_f32 v60, v60
v_exp_f32 v61, v61
v_exp_f32 v62, v62
v_exp_f32 v63, v63
v_cvt_pk_bf16_f32 v234, v224, v225
v_cvt_pk_bf16_f32 v235, v226, v227
v_cvt_pk_bf16_f32 v236, v228, v229
v_cvt_pk_bf16_f32 v237, v230, v231
v_cvt_pk_bf16_f32 v250, v240, v241
v_cvt_pk_bf16_f32 v251, v242, v243
v_cvt_pk_bf16_f32 v252, v244, v245
v_cvt_pk_bf16_f32 v253, v246, v247
v_cvt_pk_bf16_f32 v50, v40, v41
v_cvt_pk_bf16_f32 v51, v42, v43
v_cvt_pk_bf16_f32 v52, v44, v45
v_cvt_pk_bf16_f32 v53, v46, v47
v_cvt_pk_bf16_f32 v66, v56, v57
v_cvt_pk_bf16_f32 v67, v58, v59
v_cvt_pk_bf16_f32 v68, v60, v61
v_cvt_pk_bf16_f32 v69, v62, v63
v_mfma_f32_16x16x32_bf16 v[228:231], v[164:167], v[234:237], 0
v_mfma_f32_16x16x32_bf16 v[224:227], v[182:185], v[234:237], 0
v_mfma_f32_16x16x32_bf16 v[244:247], v[164:167], v[250:253], 0
v_mfma_f32_16x16x32_bf16 v[240:243], v[188:191], v[250:253], 0
v_mfma_f32_16x16x32_bf16 v[44:47], v[164:167], v[50:53], 0
v_mfma_f32_16x16x32_bf16 v[40:43], v[180:183], v[50:53], 0
v_mfma_f32_16x16x32_bf16 v[60:63], v[164:167], v[66:69], 0
s_waitcnt lgkmcnt(5)
v_mfma_f32_16x16x32_bf16 v[56:59], v[186:189], v[66:69], 0
v_rcp_f32 v228, v228
s_nop 0
v_rcp_f32 v244, v244
s_nop 0
v_rcp_f32 v44, v44
s_nop 0
v_rcp_f32 v60, v60
v_pk_mul_f32 v[224:225], v[228:229], v[224:225] op_sel_hi:[0,1]
v_pk_mul_f32 v[226:227], v[228:229], v[226:227] op_sel_hi:[0,1]
v_pk_mul_f32 v[240:241], v[244:245], v[240:241] op_sel_hi:[0,1]
v_pk_mul_f32 v[242:243], v[244:245], v[242:243] op_sel_hi:[0,1]
v_pk_mul_f32 v[40:41], v[44:45], v[40:41] op_sel_hi:[0,1]
v_pk_mul_f32 v[42:43], v[44:45], v[42:43] op_sel_hi:[0,1]
v_pk_mul_f32 v[56:57], v[60:61], v[56:57] op_sel_hi:[0,1]
v_pk_mul_f32 v[58:59], v[60:61], v[58:59] op_sel_hi:[0,1]
v_cvt_pk_bf16_f32 v196, v224, v225
v_cvt_pk_bf16_f32 v197, v226, v227
v_cvt_pk_bf16_f32 v198, v240, v241
v_cvt_pk_bf16_f32 v199, v242, v243
v_cvt_pk_bf16_f32 v192, v40, v41
v_cvt_pk_bf16_f32 v193, v42, v43
v_cvt_pk_bf16_f32 v194, v56, v57
v_cvt_pk_bf16_f32 v195, v58, v59
s_add_u32 s48, s26, 16384
buffer_store_dwordx4 v[192:195], v1, s[4:7], s26 offen sc1
buffer_store_dwordx4 v[196:199], v1, s[4:7], s48 offen sc1
s_waitcnt vmcnt(0)
buffer_store_dwordx2 v[36:37], v26, s[4:7], s36 offen offset:0 sc1
v_lshlrev_b32 v168, 16, v124
v_and_b32 v169, 0xffff0000, v124
v_lshlrev_b32 v170, 16, v125
v_and_b32 v171, 0xffff0000, v125
v_lshlrev_b32 v172, 16, v126
v_and_b32 v173, 0xffff0000, v126
v_lshlrev_b32 v174, 16, v127
v_and_b32 v175, 0xffff0000, v127
v_lshlrev_b32 v176, 16, v128
v_and_b32 v177, 0xffff0000, v128
v_lshlrev_b32 v178, 16, v129
v_and_b32 v179, 0xffff0000, v129
v_lshlrev_b32 v180, 16, v130
v_and_b32 v181, 0xffff0000, v130
v_lshlrev_b32 v182, 16, v131
v_and_b32 v183, 0xffff0000, v131
buffer_load_dwordx2 v[38:39], v17, s[4:7], s37 offen offset:0 sc1
buffer_load_dwordx2 v[252:253], v17, s[4:7], s37 offen offset:0 sc1
s_waitcnt vmcnt(1)
v_cmp_ne_u64 vcc, s[66:67], v[38:39]
s_nop 0
s_cbranch_vccnz LS0_sp3
LS0_ok2:
s_add_u32 s48, s27, 0
buffer_load_dwordx4 a[0:3], v1, s[4:7], s48 offen offset:0 sc1
buffer_load_dwordx4 a[4:7], v4, s[4:7], s48 offen offset:0 sc1
buffer_load_dwordx4 a[8:11], v1, s[4:7], s48 offen offset:1024 sc1
buffer_load_dwordx4 a[12:15], v4, s[4:7], s48 offen offset:1024 sc1
buffer_load_dwordx4 a[16:19], v1, s[4:7], s48 offen offset:2048 sc1
buffer_load_dwordx4 a[20:23], v4, s[4:7], s48 offen offset:2048 sc1
buffer_load_dwordx4 a[24:27], v1, s[4:7], s48 offen offset:3072 sc1
buffer_load_dwordx4 a[28:31], v4, s[4:7], s48 offen offset:3072 sc1
s_add_u32 s48, s27, 4096
buffer_load_dwordx4 a[32:35], v1, s[4:7], s48 offen offset:0 sc1
buffer_load_dwordx4 a[36:39], v4, s[4:7], s48 offen offset:0 sc1
s_waitcnt lgkmcnt(0)
ds_read_b64_tr_b16 v[232:233], v27 offset:0
ds_read_b64_tr_b16 v[234:235], v14 offset:0
ds_read_b64_tr_b16 v[236:237], v27 offset:32
ds_read_b64_tr_b16 v[238:239], v14 offset:32
s_waitcnt lgkmcnt(0)
s_barrier
ds_read_b128 v[40:43], v8 offset:0
ds_read_b128 v[44:47], v8 offset:1024
ds_read_b128 v[48:51], v8 offset:2048
ds_read_b128 v[52:55], v8 offset:3072
s_waitcnt vmcnt(8) lgkmcnt(2)
v_mfma_f32_16x16x32_bf16 v[168:171], v[40:43], a[0:3], v[168:171]
ds_read_b128 v[56:59], v8 offset:4096
v_mfma_f32_16x16x32_bf16 v[176:179], v[40:43], a[4:7], v[176:179]
buffer_load_dwordx4 a[40:43], v1, s[4:7], s48 offen offset:1024 sc1
v_mfma_f32_16x16x32_bf16 v[172:175], v[44:47], a[0:3], v[172:175]
ds_read_b128 v[60:63], v8 offset:5120
v_mfma_f32_16x16x32_bf16 v[180:183], v[44:47], a[4:7], v[180:183]
s_waitcnt lgkmcnt(2)
v_mfma_f32_16x16x32_bf16 v[184:187], v[48:51], a[0:3], 0
ds_read_b128 v[64:67], v8 offset:6144
v_mfma_f32_16x16x32_bf16 v[192:195], v[48:51], a[4:7], 0
buffer_load_dwordx4 a[44:47], v4, s[4:7], s48 offen offset:1024 sc1
v_mfma_f32_16x16x32_bf16 v[188:191], v[52:55], a[0:3], 0
ds_read_b128 v[68:71], v8 offset:7168
v_mfma_f32_16x16x32_bf16 v[196:199], v[52:55], a[4:7], 0
s_waitcnt vmcnt(8) lgkmcnt(2)
v_mfma_f32_16x16x32_bf16 v[168:171], v[56:59], a[8:11], v[168:171]
ds_read_b128 v[40:43], v8 offset:16384
v_mfma_f32_16x16x32_bf16 v[176:179], v[56:59], a[12:15], v[176:179]
buffer_load_dwordx4 a[48:51], v1, s[4:7], s48 offen offset:2048 sc1
v_mfma_f32_16x16x32_bf16 v[172:175], v[60:63], a[8:11], v[172:175]
ds_read_b128 v[44:47], v8 offset:17408
v_mfma_f32_16x16x32_bf16 v[180:183], v[60:63], a[12:15], v[180:183]
s_waitcnt lgkmcnt(2)
v_mfma_f32_16x16x32_bf16 v[184:187], v[64:67], a[8:11], v[184:187]
ds_read_b128 v[48:51], v8 offset:18432
v_mfma_f32_16x16x32_bf16 v[192:195], v[64:67], a[12:15], v[192:195]
buffer_load_dwordx4 a[52:55], v4, s[4:7], s48 offen offset:2048 sc1
v_mfma_f32_16x16x32_bf16 v[188:191], v[68:71], a[8:11], v[188:191]
ds_read_b128 v[52:55], v8 offset:19456
v_mfma_f32_16x16x32_bf16 v[196:199], v[68:71], a[12:15], v[196:199]
s_waitcnt vmcnt(8) lgkmcnt(2)
v_mfma_f32_16x16x32_bf16 v[168:171], v[40:43], a[16:19], v[168:171]
ds_read_b128 v[56:59], v8 offset:20480
v_mfma_f32_16x16x32_bf16 v[176:179], v[40:43], a[20:23], v[176:179]
buffer_load_dwordx4 a[56:59], v1, s[4:7], s48 offen offset:3072 sc1
v_mfma_f32_16x16x32_bf16 v[172:175], v[44:47], a[16:19], v[172:175]
ds_read_b128 v[60:63], v8 offset:21504
v_mfma_f32_16x16x32_bf16 v[180:183], v[44:47], a[20:23], v[180:183]
s_waitcnt lgkmcnt(2)
v_mfma_f32_16x16x32_bf16 v[184:187], v[48:51], a[16:19], v[184:187]
ds_read_b128 v[64:67], v8 offset:22528
v_mfma_f32_16x16x32_bf16 v[192:195], v[48:51], a[20:23], v[192:195]
buffer_load_dwordx4 a[60:63], v4, s[4:7], s48 offen offset:3072 sc1
v_mfma_f32_16x16x32_bf16 v[188:191], v[52:55], a[16:19], v[188:191]
ds_read_b128 v[68:71], v8 offset:23552
v_mfma_f32_16x16x32_bf16 v[196:199], v[52:55], a[20:23], v[196:199]
s_waitcnt vmcnt(8) lgkmcnt(2)
v_mfma_f32_16x16x32_bf16 v[168:171], v[56:59], a[24:27], v[168:171]
ds_read_b128 v[40:43], v8 offset:32768
s_mul_i32 s49, s13, 14336
v_mfma_f32_16x16x32_bf16 v[176:179], v[56:59], a[28:31], v[176:179]
s_add_u32 s49, s49, 7602176
v_lshlrev_b32 v255, 2, v0
v_mfma_f32_16x16x32_bf16 v[172:175], v[60:63], a[24:27], v[172:175]
ds_read_b128 v[44:47], v8 offset:33792
v_mfma_f32_16x16x32_bf16 v[180:183], v[60:63], a[28:31], v[180:183]
buffer_store_dwordx4 v[232:235], v1, s[4:7], s58 offen offset:0 sc1
s_waitcnt lgkmcnt(2)
v_mfma_f32_16x16x32_bf16 v[184:187], v[64:67], a[24:27], v[184:187]
ds_read_b128 v[48:51], v8 offset:34816
s_add_u32 s50, s49, 0
buffer_load_dword a64, v255, s[4:7], s50 offen offset:0 sc1
buffer_load_dword a65, v255, s[4:7], s50 offen offset:896 sc1
v_mfma_f32_16x16x32_bf16 v[192:195], v[64:67], a[28:31], v[192:195]
buffer_load_dword a66, v255, s[4:7], s50 offen offset:1792 sc1
buffer_load_dword a67, v255, s[4:7], s50 offen offset:2688 sc1
v_mfma_f32_16x16x32_bf16 v[188:191], v[68:71], a[24:27], v[188:191]
ds_read_b128 v[52:55], v8 offset:35840
v_mfma_f32_16x16x32_bf16 v[196:199], v[68:71], a[28:31], v[196:199]
buffer_store_dwordx4 v[236:239], v1, s[4:7], s58 offen offset:1024 sc1
s_waitcnt vmcnt(12) lgkmcnt(2)
v_mfma_f32_16x16x32_bf16 v[168:171], v[40:43], a[32:35], v[168:171]
ds_read_b128 v[56:59], v8 offset:36864
s_add_u32 s50, s49, 3584
buffer_load_dword a68, v255, s[4:7], s50 offen offset:0 sc1
buffer_load_dword a69, v255, s[4:7], s50 offen offset:896 sc1
v_mfma_f32_16x16x32_bf16 v[176:179], v[40:43], a[36:39], v[176:179]
buffer_load_dword a70, v255, s[4:7], s50 offen offset:1792 sc1
buffer_load_dword a71, v255, s[4:7], s50 offen offset:2688 sc1
v_mfma_f32_16x16x32_bf16 v[172:175], v[44:47], a[32:35], v[172:175]
ds_read_b128 v[60:63], v8 offset:37888
s_add_u32 s50, s49, 7168
buffer_load_dword a72, v255, s[4:7], s50 offen offset:0 sc1
buffer_load_dword a73, v255, s[4:7], s50 offen offset:896 sc1
v_mfma_f32_16x16x32_bf16 v[180:183], v[44:47], a[36:39], v[180:183]
buffer_load_dword a74, v255, s[4:7], s50 offen offset:1792 sc1
buffer_load_dword a75, v255, s[4:7], s50 offen offset:2688 sc1
s_waitcnt lgkmcnt(2)
v_mfma_f32_16x16x32_bf16 v[184:187], v[48:51], a[32:35], v[184:187]
ds_read_b128 v[64:67], v8 offset:38912
s_add_u32 s50, s49, 10752
buffer_load_dword a76, v255, s[4:7], s50 offen offset:0 sc1
buffer_load_dword a77, v255, s[4:7], s50 offen offset:896 sc1
v_mfma_f32_16x16x32_bf16 v[192:195], v[48:51], a[36:39], v[192:195]
buffer_load_dword a78, v255, s[4:7], s50 offen offset:1792 sc1
buffer_load_dword a79, v255, s[4:7], s50 offen offset:2688 sc1
v_mfma_f32_16x16x32_bf16 v[188:191], v[52:55], a[32:35], v[188:191]
ds_read_b128 v[68:71], v8 offset:39936
s_add_u32 m0, s21, 131072
s_add_u32 s47, s19, 32768
v_mfma_f32_16x16x32_bf16 v[196:199], v[52:55], a[36:39], v[196:199]
buffer_load_dwordx4 v1, s[4:7], s47 offen offset:0 sc1 lds
s_waitcnt vmcnt(23) lgkmcnt(2)
v_mfma_f32_16x16x32_bf16 v[168:171], v[56:59], a[40:43], v[168:171]
ds_read_b128 v[40:43], v8 offset:49152
v_mfma_f32_16x16x32_bf16 v[176:179], v[56:59], a[44:47], v[176:179]
v_mfma_f32_16x16x32_bf16 v[172:175], v[60:63], a[40:43], v[172:175]
ds_read_b128 v[44:47], v8 offset:50176
v_mfma_f32_16x16x32_bf16 v[180:183], v[60:63], a[44:47], v[180:183]
buffer_load_dwordx4 v1, s[4:7], s47 offen offset:1024 sc1 lds
s_waitcnt lgkmcnt(2)
v_mfma_f32_16x16x32_bf16 v[184:187], v[64:67], a[40:43], v[184:187]
ds_read_b128 v[48:51], v8 offset:51200
v_mfma_f32_16x16x32_bf16 v[192:195], v[64:67], a[44:47], v[192:195]
buffer_load_dwordx4 v1, s[4:7], s47 offen offset:2048 sc1 lds
v_mfma_f32_16x16x32_bf16 v[188:191], v[68:71], a[40:43], v[188:191]
ds_read_b128 v[52:55], v8 offset:52224
v_mfma_f32_16x16x32_bf16 v[196:199], v[68:71], a[44:47], v[196:199]
s_waitcnt vmcnt(23) lgkmcnt(2)
ds_read_b128 v[56:59], v8 offset:53248
buffer_load_dwordx4 v1, s[4:7], s47 offen offset:3072 sc1 lds
ds_read_b128 v[60:63], v8 offset:54272
s_add_u32 m0, s21, 65536
s_add_u32 s47, s19, 49152
buffer_load_dwordx4 v1, s[4:7], s47 offen offset:0 sc1 lds
ds_read_b128 v[64:67], v8 offset:55296
ds_read_b128 v[68:71], v8 offset:56320
buffer_load_dwordx4 v1, s[4:7], s47 offen offset:1024 sc1 lds
buffer_load_dwordx4 v1, s[4:7], s47 offen offset:2048 sc1 lds
buffer_load_dwordx4 v1, s[4:7], s47 offen offset:3072 sc1 lds
s_waitcnt lgkmcnt(5)
v_mfma_f32_16x16x32_bf16 v[184:187], v[48:51], a[48:51], v[184:187]
v_mfma_f32_16x16x32_bf16 v[192:195], v[48:51], a[52:55], v[192:195]
s_waitcnt lgkmcnt(4)
v_mfma_f32_16x16x32_bf16 v[188:191], v[52:55], a[48:51], v[188:191]
v_mfma_f32_16x16x32_bf16 v[196:199], v[52:55], a[52:55], v[196:199]
s_waitcnt vmcnt(27) lgkmcnt(1)
v_mfma_f32_16x16x32_bf16 v[184:187], v[64:67], a[56:59], v[184:187]
s_waitcnt vmcnt(26)
v_mfma_f32_16x16x32_bf16 v[192:195], v[64:67], a[60:63], v[192:195]
s_waitcnt lgkmcnt(0)
v_mfma_f32_16x16x32_bf16 v[188:191], v[68:71], a[56:59], v[188:191]
v_mfma_f32_16x16x32_bf16 v[196:199], v[68:71], a[60:63], v[196:199]
v_mfma_f32_16x16x32_bf16 v[168:171], v[40:43], a[48:51], v[168:171]
v_mfma_f32_16x16x32_bf16 v[176:179], v[40:43], a[52:55], v[176:179]
v_mfma_f32_16x16x32_bf16 v[172:175], v[44:47], a[48:51], v[172:175]
v_mfma_f32_16x16x32_bf16 v[180:183], v[44:47], a[52:55], v[180:183]
ds_write_b128 v18, v[184:187] offset:0
v_mfma_f32_16x16x32_bf16 v[168:171], v[56:59], a[56:59], v[168:171]
s_nop 0
ds_write_b128 v18, v[188:191] offset:1024
v_mfma_f32_16x16x32_bf16 v[176:179], v[56:59], a[60:63], v[176:179]
ds_write_b128 v18, v[192:195] offset:2048
v_mfma_f32_16x16x32_bf16 v[172:175], v[60:63], a[56:59], v[172:175]
ds_write_b128 v18, v[196:199] offset:3072
v_mfma_f32_16x16x32_bf16 v[180:183], v[60:63], a[60:63], v[180:183]
s_waitcnt vmcnt(20)
s_waitcnt lgkmcnt(0)
s_barrier
ds_read_b128 v[224:227], v19 offset:0
ds_read_b128 v[228:231], v19 offset:1024
ds_read_b128 v[232:235], v19 offset:2048
ds_read_b128 v[236:239], v19 offset:3072
s_waitcnt lgkmcnt(3)
v_pk_add_f32 v[168:169], v[168:169], v[224:225]
v_pk_add_f32 v[170:171], v[170:171], v[226:227]
s_waitcnt lgkmcnt(2)
v_pk_add_f32 v[172:173], v[172:173], v[228:229]
v_pk_add_f32 v[174:175], v[174:175], v[230:231]
s_waitcnt lgkmcnt(1)
v_pk_add_f32 v[176:177], v[176:177], v[232:233]
v_pk_add_f32 v[178:179], v[178:179], v[234:235]
s_waitcnt lgkmcnt(0)
v_pk_add_f32 v[180:181], v[180:181], v[236:237]
v_pk_add_f32 v[182:183], v[182:183], v[238:239]
v_cvt_pk_bf16_f32 v124, v168, v169
v_cvt_pk_bf16_f32 v125, v170, v171
v_cvt_pk_bf16_f32 v126, v172, v173
v_cvt_pk_bf16_f32 v127, v174, v175
v_cvt_pk_bf16_f32 v128, v176, v177
v_cvt_pk_bf16_f32 v129, v178, v179
v_cvt_pk_bf16_f32 v130, v180, v181
v_cvt_pk_bf16_f32 v131, v182, v183
buffer_store_dwordx4 v[124:127], v1, s[4:7], s28 offen sc1
buffer_store_dwordx4 v[128:131], v4, s[4:7], s28 offen sc1
v_pk_mul_f32 v[226:227], v[168:169], v[168:169]
v_pk_add_f32 v[224:225], v[168:169], v[170:171]
v_pk_mul_f32 v[230:231], v[176:177], v[176:177]
v_pk_add_f32 v[228:229], v[176:177], v[178:179]
v_pk_fma_f32 v[226:227], v[170:171], v[170:171], v[226:227]
v_pk_fma_f32 v[230:231], v[178:179], v[178:179], v[230:231]
v_pk_fma_f32 v[226:227], v[172:173], v[172:173], v[226:227]
v_pk_add_f32 v[224:225], v[224:225], v[172:173]
v_pk_fma_f32 v[230:231], v[180:181], v[180:181], v[230:231]
v_pk_add_f32 v[228:229], v[228:229], v[180:181]
v_pk_fma_f32 v[226:227], v[174:175], v[174:175], v[226:227]
v_pk_add_f32 v[224:225], v[224:225], v[174:175]
v_pk_fma_f32 v[230:231], v[182:183], v[182:183], v[230:231]
v_pk_add_f32 v[228:229], v[228:229], v[182:183]
v_add_f32 v224, v224, v225
v_add_f32 v226, v226, v227
v_add_f32 v228, v228, v229
v_add_f32 v230, v230, v231
v_permlane32_swap_b32 v224, v226
s_nop 0
v_permlane32_swap_b32 v228, v230
v_add_f32 v224, v224, v226
v_add_f32 v228, v228, v230
s_nop 1
v_permlane16_swap_b32 v224, v228
v_add_f32 v224, v224, v228
buffer_store_dword v224, v7, s[4:7], s29 offen sc1
s_waitcnt vmcnt(0)
buffer_store_dwordx2 v[36:37], v26, s[4:7], s38 offen offset:0 sc1
s_add_u32 m0, s21, 81920
s_add_u32 s47, s19, 65536
buffer_load_dwordx4 v1, s[4:7], s47 offen offset:0 sc1 lds
buffer_load_dwordx4 v1, s[4:7], s47 offen offset:1024 sc1 lds
buffer_load_dwordx4 v1, s[4:7], s47 offen offset:2048 sc1 lds
buffer_load_dwordx4 v1, s[4:7], s47 offen offset:3072 sc1 lds
s_cmp_lg_u32 s14, 0
s_cbranch_scc1 LS0_c4
s_lshl_b32 s51, s2, 3
s_add_u32 s51, s51, 8126464
buffer_store_dwordx2 v[36:37], v26, s[4:7], s51 offen offset:0 sc1
LS0_c4:
s_load_dwordx2 s[8:9], s[0:1], 56
v_accvgpr_read_b32 v40, a64
v_accvgpr_read_b32 v41, a65
v_accvgpr_read_b32 v42, a66
v_accvgpr_read_b32 v43, a67
v_accvgpr_read_b32 v44, a68
v_accvgpr_read_b32 v45, a69
v_accvgpr_read_b32 v46, a70
v_accvgpr_read_b32 v47, a71
v_accvgpr_read_b32 v48, a72
v_accvgpr_read_b32 v49, a73
v_accvgpr_read_b32 v50, a74
v_accvgpr_read_b32 v51, a75
v_accvgpr_read_b32 v52, a76
v_accvgpr_read_b32 v53, a77
v_accvgpr_read_b32 v54, a78
v_accvgpr_read_b32 v55, a79
v_pk_add_f32 v[40:41], v[40:41], v[48:49]
v_pk_add_f32 v[42:43], v[42:43], v[50:51]
v_pk_add_f32 v[44:45], v[44:45], v[52:53]
v_pk_add_f32 v[46:47], v[46:47], v[54:55]
v_pk_add_f32 v[40:41], v[40:41], v[44:45]
v_pk_add_f32 v[42:43], v[42:43], v[46:47]
v_pk_add_f32 v[40:41], v[40:41], v[42:43]
v_add_f32 v40, v40, v41
v_cvt_pk_bf16_f32 v33, v40, 0
v_lshlrev_b32 v41, 16, v33
v_sub_f32 v41, v40, v41
v_cvt_pk_bf16_f32 v32, v40, v41
s_waitcnt lgkmcnt(0)
s_and_b32 s9, s9, 0xffff
s_mov_b32 s10, 0x200000
s_mov_b32 s11, 0x20000
buffer_load_dwordx2 v[38:39], v16, s[4:7], s39 offen offset:0 sc1
buffer_load_dwordx2 v[252:253], v16, s[4:7], s39 offen offset:0 sc1
s_waitcnt vmcnt(1)
v_cmp_ne_u64 vcc, s[66:67], v[38:39]
s_nop 0
s_cbranch_vccnz LS0_sp6
LS0_ok5:
s_add_u32 s48, s30, 0
buffer_load_dwordx4 a[0:3], v1, s[4:7], s48 offen offset:0 sc1
buffer_load_dwordx4 a[4:7], v4, s[4:7], s48 offen offset:0 sc1
buffer_load_dwordx4 a[8:11], v1, s[4:7], s48 offen offset:1024 sc1
buffer_load_dwordx4 a[12:15], v4, s[4:7], s48 offen offset:1024 sc1
buffer_load_dwordx4 a[16:19], v1, s[4:7], s48 offen offset:2048 sc1
buffer_load_dwordx4 a[20:23], v4, s[4:7], s48 offen offset:2048 sc1
buffer_load_dwordx4 a[24:27], v1, s[4:7], s48 offen offset:3072 sc1
buffer_load_dwordx4 a[28:31], v4, s[4:7], s48 offen offset:3072 sc1
s_add_u32 s48, s30, 4096
buffer_load_dwordx4 a[32:35], v1, s[4:7], s48 offen offset:0 sc1
buffer_load_dwordx4 a[36:39], v4, s[4:7], s48 offen offset:0 sc1
s_barrier
v_lshlrev_b32 v240, 3, v0
v_add_u32 v240, 147456, v240
ds_write_b64 v240, v[32:33]
v_and_b32 v25, 15, v0
v_lshlrev_b32 v25, 3, v25
v_add_u32 v25, 147456, v25
ds_read_b128 v[40:43], v2 offset:32768
ds_read_b128 v[44:47], v2 offset:33792
ds_read_b128 v[48:51], v2 offset:34816
ds_read_b128 v[52:55], v2 offset:35840
ds_read_b128 v[56:59], v2 offset:36864
ds_read_b128 v[60:63], v2 offset:37888
s_waitcnt vmcnt(8) lgkmcnt(2)
v_mfma_f32_16x16x32_bf16 v[72:75], v[40:43], a[0:3], 0
ds_read_b128 v[64:67], v2 offset:38912
v_mfma_f32_16x16x32_bf16 v[76:79], v[40:43], a[4:7], 0
buffer_load_dwordx4 a[40:43], v1, s[4:7], s48 offen offset:1024 sc1
v_mfma_f32_16x16x32_bf16 v[80:83], v[44:47], a[0:3], 0
ds_read_b128 v[68:71], v2 offset:39936
v_mfma_f32_16x16x32_bf16 v[84:87], v[44:47], a[4:7], 0
buffer_load_dwordx4 v[224:227], v6, s[4:7], s31 offen offset:0 sc1
v_mfma_f32_16x16x32_bf16 v[88:91], v[48:51], a[0:3], 0
ds_read_b128 v[40:43], v2 offset:40960
v_mfma_f32_16x16x32_bf16 v[92:95], v[48:51], a[4:7], 0
buffer_load_dwordx4 a[44:47], v4, s[4:7], s48 offen offset:1024 sc1
v_mfma_f32_16x16x32_bf16 v[96:99], v[52:55], a[0:3], 0
ds_read_b128 v[44:47], v2 offset:41984
v_mfma_f32_16x16x32_bf16 v[100:103], v[52:55], a[4:7], 0
buffer_load_dwordx4 v[228:231], v6, s[4:7], s31 offen offset:1024 sc1
s_waitcnt vmcnt(10) lgkmcnt(2)
v_mfma_f32_16x16x32_bf16 v[72:75], v[56:59], a[8:11], v[72:75]
ds_read_b128 v[48:51], v2 offset:43008
v_mfma_f32_16x16x32_bf16 v[76:79], v[56:59], a[12:15], v[76:79]
buffer_load_dwordx4 a[48:51], v1, s[4:7], s48 offen offset:2048 sc1
v_mfma_f32_16x16x32_bf16 v[80:83], v[60:63], a[8:11], v[80:83]
ds_read_b128 v[52:55], v2 offset:44032
v_mfma_f32_16x16x32_bf16 v[84:87], v[60:63], a[12:15], v[84:87]
buffer_load_dwordx4 v[232:235], v6, s[4:7], s31 offen offset:2048 sc1
v_mfma_f32_16x16x32_bf16 v[88:91], v[64:67], a[8:11], v[88:91]
ds_read_b128 v[56:59], v2 offset:45056
v_mfma_f32_16x16x32_bf16 v[92:95], v[64:67], a[12:15], v[92:95]
buffer_load_dwordx4 a[52:55], v4, s[4:7], s48 offen offset:2048 sc1
v_mfma_f32_16x16x32_bf16 v[96:99], v[68:71], a[8:11], v[96:99]
ds_read_b128 v[60:63], v2 offset:46080
v_mfma_f32_16x16x32_bf16 v[100:103], v[68:71], a[12:15], v[100:103]
buffer_load_dwordx4 v[236:239], v6, s[4:7], s31 offen offset:3072 sc1
s_waitcnt vmcnt(12) lgkmcnt(2)
v_mfma_f32_16x16x32_bf16 v[72:75], v[40:43], a[16:19], v[72:75]
ds_read_b128 v[64:67], v2 offset:47104
v_mfma_f32_16x16x32_bf16 v[76:79], v[40:43], a[20:23], v[76:79]
buffer_load_dwordx4 a[56:59], v1, s[4:7], s48 offen offset:3072 sc1
v_mfma_f32_16x16x32_bf16 v[80:83], v[44:47], a[16:19], v[80:83]
ds_read_b128 v[68:71], v2 offset:48128
v_mfma_f32_16x16x32_bf16 v[84:87], v[44:47], a[20:23], v[84:87]
v_mfma_f32_16x16x32_bf16 v[88:91], v[48:51], a[16:19], v[88:91]
ds_read_b128 v[40:43], v2 offset:49152
v_mfma_f32_16x16x32_bf16 v[92:95], v[48:51], a[20:23], v[92:95]
buffer_load_dwordx4 a[60:63], v4, s[4:7], s48 offen offset:3072 sc1
v_mfma_f32_16x16x32_bf16 v[96:99], v[52:55], a[16:19], v[96:99]
ds_read_b128 v[44:47], v2 offset:50176
v_mfma_f32_16x16x32_bf16 v[100:103], v[52:55], a[20:23], v[100:103]
s_waitcnt vmcnt(12) lgkmcnt(2)
v_mfma_f32_16x16x32_bf16 v[72:75], v[56:59], a[24:27], v[72:75]
ds_read_b128 v[48:51], v2 offset:51200
s_add_u32 s48, s30, 8192
v_mfma_f32_16x16x32_bf16 v[76:79], v[56:59], a[28:31], v[76:79]
buffer_load_dwordx4 a[64:67], v1, s[4:7], s48 offen offset:0 sc1
v_mfma_f32_16x16x32_bf16 v[80:83], v[60:63], a[24:27], v[80:83]
ds_read_b128 v[52:55], v2 offset:52224
v_mfma_f32_16x16x32_bf16 v[84:87], v[60:63], a[28:31], v[84:87]
v_mfma_f32_16x16x32_bf16 v[88:91], v[64:67], a[24:27], v[88:91]
ds_read_b128 v[56:59], v2 offset:53248
v_mfma_f32_16x16x32_bf16 v[92:95], v[64:67], a[28:31], v[92:95]
buffer_load_dwordx4 a[68:71], v4, s[4:7], s48 offen offset:0 sc1
v_mfma_f32_16x16x32_bf16 v[96:99], v[68:71], a[24:27], v[96:99]
ds_read_b128 v[60:63], v2 offset:54272
v_mfma_f32_16x16x32_bf16 v[100:103], v[68:71], a[28:31], v[100:103]
s_waitcnt vmcnt(12) lgkmcnt(2)
v_mfma_f32_16x16x32_bf16 v[72:75], v[40:43], a[32:35], v[72:75]
ds_read_b128 v[64:67], v2 offset:55296
v_mfma_f32_16x16x32_bf16 v[76:79], v[40:43], a[36:39], v[76:79]
buffer_load_dwordx4 a[72:75], v1, s[4:7], s48 offen offset:1024 sc1
v_mfma_f32_16x16x32_bf16 v[80:83], v[44:47], a[32:35], v[80:83]
ds_read_b128 v[68:71], v2 offset:56320
v_mfma_f32_16x16x32_bf16 v[84:87], v[44:47], a[36:39], v[84:87]
v_mfma_f32_16x16x32_bf16 v[88:91], v[48:51], a[32:35], v[88:91]
ds_read_b128 v[40:43], v2 offset:57344
v_mfma_f32_16x16x32_bf16 v[92:95], v[48:51], a[36:39], v[92:95]
buffer_load_dwordx4 a[76:79], v4, s[4:7], s48 offen offset:1024 sc1
v_mfma_f32_16x16x32_bf16 v[96:99], v[52:55], a[32:35], v[96:99]
ds_read_b128 v[44:47], v2 offset:58368
v_mfma_f32_16x16x32_bf16 v[100:103], v[52:55], a[36:39], v[100:103]
s_waitcnt vmcnt(11) lgkmcnt(2)
v_mfma_f32_16x16x32_bf16 v[72:75], v[56:59], a[40:43], v[72:75]
ds_read_b128 v[48:51], v2 offset:59392
v_mfma_f32_16x16x32_bf16 v[76:79], v[56:59], a[44:47], v[76:79]
buffer_load_dwordx4 a[80:83], v1, s[4:7], s48 offen offset:2048 sc1
v_mfma_f32_16x16x32_bf16 v[80:83], v[60:63], a[40:43], v[80:83]
ds_read_b128 v[52:55], v2 offset:60416
v_mfma_f32_16x16x32_bf16 v[84:87], v[60:63], a[44:47], v[84:87]
v_mfma_f32_16x16x32_bf16 v[88:91], v[64:67], a[40:43], v[88:91]
ds_read_b128 v[56:59], v2 offset:61440
v_mfma_f32_16x16x32_bf16 v[92:95], v[64:67], a[44:47], v[92:95]
buffer_load_dwordx4 a[84:87], v4, s[4:7], s48 offen offset:2048 sc1
v_mfma_f32_16x16x32_bf16 v[96:99], v[68:71], a[40:43], v[96:99]
ds_read_b128 v[60:63], v2 offset:62464
v_lshlrev_b32 v254, 3, v0
v_mfma_f32_16x16x32_bf16 v[100:103], v[68:71], a[44:47], v[100:103]
v_add_u32 v254, 8126464, v254
s_waitcnt vmcnt(9) lgkmcnt(2)
v_mfma_f32_16x16x32_bf16 v[72:75], v[40:43], a[48:51], v[72:75]
ds_read_b128 v[64:67], v2 offset:63488
buffer_load_dwordx4 a[88:91], v1, s[4:7], s48 offen offset:3072 sc1
v_mfma_f32_16x16x32_bf16 v[76:79], v[40:43], a[52:55], v[76:79]
v_add_f32 v224, v224, v226
v_mfma_f32_16x16x32_bf16 v[80:83], v[44:47], a[48:51], v[80:83]
ds_read_b128 v[68:71], v2 offset:64512
v_add_f32 v225, v225, v227
v_mfma_f32_16x16x32_bf16 v[84:87], v[44:47], a[52:55], v[84:87]
v_add_f32 v228, v228, v230
v_mfma_f32_16x16x32_bf16 v[88:91], v[48:51], a[48:51], v[88:91]
ds_read_b128 v[40:43], v3 offset:0
buffer_load_dwordx4 a[92:95], v4, s[4:7], s48 offen offset:3072 sc1
v_mfma_f32_16x16x32_bf16 v[92:95], v[48:51], a[52:55], v[92:95]
v_add_f32 v229, v229, v231
v_mfma_f32_16x16x32_bf16 v[96:99], v[52:55], a[48:51], v[96:99]
ds_read_b128 v[44:47], v3 offset:1024
v_add_f32 v232, v232, v234
v_mfma_f32_16x16x32_bf16 v[100:103], v[52:55], a[52:55], v[100:103]
v_add_f32 v233, v233, v235
s_waitcnt vmcnt(10)
v_add_f32 v236, v236, v238
s_waitcnt vmcnt(8) lgkmcnt(2)
v_mfma_f32_16x16x32_bf16 v[72:75], v[56:59], a[56:59], v[72:75]
ds_read_b128 v[48:51], v3 offset:2048
s_add_u32 s48, s30, 12288
v_mfma_f32_16x16x32_bf16 v[76:79], v[56:59], a[60:63], v[76:79]
buffer_load_dwordx4 a[96:99], v1, s[4:7], s48 offen offset:0 sc1
v_mfma_f32_16x16x32_bf16 v[80:83], v[60:63], a[56:59], v[80:83]
ds_read_b128 v[52:55], v3 offset:3072
v_add_f32 v237, v237, v239
v_mfma_f32_16x16x32_bf16 v[84:87], v[60:63], a[60:63], v[84:87]
v_add_f32 v224, v224, v228
v_mfma_f32_16x16x32_bf16 v[88:91], v[64:67], a[56:59], v[88:91]
ds_read_b128 v[56:59], v3 offset:4096
v_mfma_f32_16x16x32_bf16 v[92:95], v[64:67], a[60:63], v[92:95]
buffer_load_dwordx4 a[100:103], v4, s[4:7], s48 offen offset:0 sc1
v_mfma_f32_16x16x32_bf16 v[96:99], v[68:71], a[56:59], v[96:99]
ds_read_b128 v[60:63], v3 offset:5120
v_add_f32 v225, v225, v229
v_mfma_f32_16x16x32_bf16 v[100:103], v[68:71], a[60:63], v[100:103]
v_add_f32 v232, v232, v236
v_add_f32 v233, v233, v237
s_waitcnt vmcnt(8) lgkmcnt(2)
v_mfma_f32_16x16x32_bf16 v[72:75], v[40:43], a[64:67], v[72:75]
ds_read_b128 v[64:67], v3 offset:6144
buffer_load_dwordx4 a[104:107], v1, s[4:7], s48 offen offset:1024 sc1
v_mfma_f32_16x16x32_bf16 v[76:79], v[40:43], a[68:71], v[76:79]
v_add_f32 v224, v224, v232
v_mfma_f32_16x16x32_bf16 v[80:83], v[44:47], a[64:67], v[80:83]
ds_read_b128 v[68:71], v3 offset:7168
v_add_f32 v225, v225, v233
v_mfma_f32_16x16x32_bf16 v[84:87], v[44:47], a[68:71], v[84:87]
v_mov_b32 v226, v224
v_mfma_f32_16x16x32_bf16 v[88:91], v[48:51], a[64:67], v[88:91]
ds_read_b128 v[40:43], v3 offset:8192
buffer_load_dwordx4 a[108:111], v4, s[4:7], s48 offen offset:1024 sc1
v_mfma_f32_16x16x32_bf16 v[92:95], v[48:51], a[68:71], v[92:95]
v_mov_b32 v227, v225
v_mfma_f32_16x16x32_bf16 v[96:99], v[52:55], a[64:67], v[96:99]
ds_read_b128 v[44:47], v3 offset:9216
v_permlane32_swap_b32 v224, v226
v_mfma_f32_16x16x32_bf16 v[100:103], v[52:55], a[68:71], v[100:103]
v_permlane32_swap_b32 v225, v227
v_add_f32 v224, v224, v226
s_waitcnt vmcnt(8) lgkmcnt(2)
v_mfma_f32_16x16x32_bf16 v[72:75], v[56:59], a[72:75], v[72:75]
ds_read_b128 v[48:51], v3 offset:10240
v_mfma_f32_16x16x32_bf16 v[76:79], v[56:59], a[76:79], v[76:79]
buffer_load_dwordx4 a[112:115], v1, s[4:7], s48 offen offset:2048 sc1
v_mfma_f32_16x16x32_bf16 v[80:83], v[60:63], a[72:75], v[80:83]
ds_read_b128 v[52:55], v3 offset:11264
v_add_f32 v225, v225, v227
v_mfma_f32_16x16x32_bf16 v[84:87], v[60:63], a[76:79], v[84:87]
v_mul_f32 v224, 0xbb000000, v224
v_mul_f32 v225, 0x3b000000, v225
v_mfma_f32_16x16x32_bf16 v[88:91], v[64:67], a[72:75], v[88:91]
ds_read_b128 v[56:59], v3 offset:12288
v_mfma_f32_16x16x32_bf16 v[92:95], v[64:67], a[76:79], v[92:95]
buffer_load_dwordx4 a[116:119], v4, s[4:7], s48 offen offset:2048 sc1
v_mfma_f32_16x16x32_bf16 v[96:99], v[68:71], a[72:75], v[96:99]
ds_read_b128 v[60:63], v3 offset:13312
v_fma_f32 v225, -v224, v224, v225
v_mfma_f32_16x16x32_bf16 v[100:103], v[68:71], a[76:79], v[100:103]
v_max_f32 v225, 0, v225
v_add_f32 v225, 0x3727c5ac, v225
s_waitcnt vmcnt(8) lgkmcnt(2)
v_mfma_f32_16x16x32_bf16 v[72:75], v[40:43], a[80:83], v[72:75]
ds_read_b128 v[64:67], v3 offset:14336
v_mfma_f32_16x16x32_bf16 v[76:79], v[40:43], a[84:87], v[76:79]
buffer_load_dwordx4 a[120:123], v1, s[4:7], s48 offen offset:3072 sc1
v_mfma_f32_16x16x32_bf16 v[80:83], v[44:47], a[80:83], v[80:83]
ds_read_b128 v[68:71], v3 offset:15360
v_rsq_f32 v226, v225
v_mfma_f32_16x16x32_bf16 v[84:87], v[44:47], a[84:87], v[84:87]
v_mul_f32 v200, 0xbfb8aa3b, v226
buffer_load_dwordx2 v[38:39], v254, s[4:7], 0 offen offset:0 sc1
v_mfma_f32_16x16x32_bf16 v[88:91], v[48:51], a[80:83], v[88:91]
ds_read_b128 v[40:43], v2 offset:0
buffer_load_dwordx4 a[124:127], v4, s[4:7], s48 offen offset:3072 sc1
v_mfma_f32_16x16x32_bf16 v[92:95], v[48:51], a[84:87], v[92:95]
v_mov_b32 v202, v225
v_mfma_f32_16x16x32_bf16 v[96:99], v[52:55], a[80:83], v[96:99]
ds_read_b128 v[44:47], v2 offset:1024
v_mov_b32 v203, v225
v_mfma_f32_16x16x32_bf16 v[100:103], v[52:55], a[84:87], v[100:103]
v_mov_b32 v201, v200
v_mov_b32 v225, v224
s_waitcnt vmcnt(9) lgkmcnt(2)
v_mfma_f32_16x16x32_bf16 v[72:75], v[56:59], a[88:91], v[72:75]
ds_read_b128 v[48:51], v2 offset:2048
v_permlane16_swap_b32 v202, v203
v_permlane16_swap_b32 v200, v201
s_add_u32 m0, s21, 0
v_mfma_f32_16x16x32_bf16 v[76:79], v[56:59], a[92:95], v[76:79]
s_add_u32 s47, s19, 81920
buffer_load_dwordx4 v1, s[4:7], s47 offen offset:0 sc1 lds
v_mfma_f32_16x16x32_bf16 v[80:83], v[60:63], a[88:91], v[80:83]
ds_read_b128 v[52:55], v2 offset:3072
v_permlane16_swap_b32 v224, v225
v_mfma_f32_16x16x32_bf16 v[84:87], v[60:63], a[92:95], v[84:87]
s_mov_b64 vcc, 0xffff
v_cndmask_b32 v224, 0, v224, vcc
v_cndmask_b32 v225, 0, v225, vcc
v_mfma_f32_16x16x32_bf16 v[88:91], v[64:67], a[88:91], v[88:91]
ds_read_b128 v[56:59], v2 offset:4096
v_cvt_pk_bf16_f32 v232, v224, v224
v_mfma_f32_16x16x32_bf16 v[92:95], v[64:67], a[92:95], v[92:95]
buffer_load_dwordx4 v1, s[4:7], s47 offen offset:1024 sc1 lds
v_mfma_f32_16x16x32_bf16 v[96:99], v[68:71], a[88:91], v[96:99]
ds_read_b128 v[60:63], v2 offset:5120
v_lshlrev_b32 v226, 16, v232
v_mfma_f32_16x16x32_bf16 v[100:103], v[68:71], a[92:95], v[100:103]
v_sub_f32 v226, v224, v226
v_cvt_pk_bf16_f32 v233, v226, 0
s_waitcnt vmcnt(9) lgkmcnt(2)
v_mfma_f32_16x16x32_bf16 v[72:75], v[40:43], a[96:99], v[72:75]
ds_read_b128 v[64:67], v2 offset:6144
v_cvt_pk_bf16_f32 v236, v225, v225
v_lshlrev_b32 v226, 16, v236
v_mfma_f32_16x16x32_bf16 v[76:79], v[40:43], a[100:103], v[76:79]
v_sub_f32 v226, v225, v226
buffer_load_dwordx4 v1, s[4:7], s47 offen offset:2048 sc1 lds
v_mfma_f32_16x16x32_bf16 v[80:83], v[44:47], a[96:99], v[80:83]
ds_read_b128 v[68:71], v2 offset:7168
v_cvt_pk_bf16_f32 v237, v226, 0
v_mfma_f32_16x16x32_bf16 v[84:87], v[44:47], a[100:103], v[84:87]
v_mov_b32 v226, 0
v_mfma_f32_16x16x32_bf16 v[88:91], v[48:51], a[96:99], v[88:91]
ds_read_b128 v[40:43], v2 offset:8192
v_mov_b32 v227, 0
v_mfma_f32_16x16x32_bf16 v[92:95], v[48:51], a[100:103], v[92:95]
v_mov_b32 v230, 0
v_mov_b32 v231, 0
v_mfma_f32_16x16x32_bf16 v[96:99], v[52:55], a[96:99], v[96:99]
ds_read_b128 v[44:47], v2 offset:9216
v_mov_b32 v234, 0
v_mov_b32 v235, 0
v_mfma_f32_16x16x32_bf16 v[100:103], v[52:55], a[100:103], v[100:103]
v_mov_b32 v238, 0
buffer_load_dwordx4 v1, s[4:7], s47 offen offset:3072 sc1 lds
s_waitcnt vmcnt(9) lgkmcnt(2)
v_mfma_f32_16x16x32_bf16 v[72:75], v[56:59], a[104:107], v[72:75]
ds_read_b128 v[48:51], v2 offset:10240
v_mov_b32 v239, 0
v_mfma_f32_16x16x32_bf16 v[76:79], v[56:59], a[108:111], v[76:79]
s_add_u32 s76, s33, 0
v_mfma_f32_16x16x32_bf16 v[80:83], v[60:63], a[104:107], v[80:83]
ds_read_b128 v[52:55], v2 offset:11264
s_add_u32 s77, s33, 7168
v_mfma_f32_16x16x32_bf16 v[84:87], v[60:63], a[108:111], v[84:87]
s_add_u32 s78, s33, 14336
s_add_u32 s79, s33, 21504
v_mfma_f32_16x16x32_bf16 v[88:91], v[64:67], a[104:107], v[88:91]
ds_read_b128 v[56:59], v2 offset:12288
s_add_u32 s80, s33, 57344
v_mfma_f32_16x16x32_bf16 v[92:95], v[64:67], a[108:111], v[92:95]
s_add_u32 s81, s33, 64512
v_mfma_f32_16x16x32_bf16 v[96:99], v[68:71], a[104:107], v[96:99]
ds_read_b128 v[60:63], v2 offset:13312
s_add_u32 s82, s33, 71680
v_mfma_f32_16x16x32_bf16 v[100:103], v[68:71], a[108:111], v[100:103]
s_add_u32 s83, s33, 78848
s_add_u32 s58, s32, 57344
s_waitcnt vmcnt(7) lgkmcnt(2)
v_mfma_f32_16x16x32_bf16 v[72:75], v[40:43], a[112:115], v[72:75]
ds_read_b128 v[64:67], v2 offset:14336
v_mfma_f32_16x16x32_bf16 v[76:79], v[40:43], a[116:119], v[76:79]
s_waitcnt vmcnt(5)
v_cmp_ne_u64 vcc, s[66:67], v[38:39]
s_nop 0
s_cbranch_vccnz LS0_sp8
LS0_ok7:
v_mfma_f32_16x16x32_bf16 v[80:83], v[44:47], a[112:115], v[80:83]
s_barrier
v_mfma_f32_16x16x32_bf16 v[84:87], v[44:47], a[116:119], v[84:87]
ds_read_b128 v[68:71], v2 offset:15360
v_mfma_f32_16x16x32_bf16 v[88:91], v[48:51], a[112:115], v[88:91]
ds_read_b128 v[40:43], v2 offset:16384
s_add_u32 m0, s21, 98304
s_add_u32 s47, s19, 98304
v_mfma_f32_16x16x32_bf16 v[92:95], v[48:51], a[116:119], v[92:95]
buffer_load_dwordx4 v1, s[4:7], s47 offen offset:0 sc1 lds
v_mfma_f32_16x16x32_bf16 v[96:99], v[52:55], a[112:115], v[96:99]
ds_read_b128 v[44:47], v2 offset:17408
v_mfma_f32_16x16x32_bf16 v[100:103], v[52:55], a[116:119], v[100:103]
s_waitcnt vmcnt(5) lgkmcnt(2)
v_mfma_f32_16x16x32_bf16 v[72:75], v[56:59], a[120:123], v[72:75]
ds_read_b128 v[48:51], v2 offset:18432
ds_read_b64 v[224:225], v25 offset:0
ds_read_b64 v[228:229], v25 offset:128
v_mfma_f32_16x16x32_bf16 v[76:79], v[56:59], a[124:127], v[76:79]
buffer_load_dwordx4 v1, s[4:7], s47 offen offset:1024 sc1 lds
v_mfma_f32_16x16x32_bf16 v[80:83], v[60:63], a[120:123], v[80:83]
ds_read_b128 v[52:55], v2 offset:19456
v_mfma_f32_16x16x32_bf16 v[84:87], v[60:63], a[124:127], v[84:87]
v_mfma_f32_16x16x32_bf16 v[88:91], v[64:67], a[120:123], v[88:91]
ds_read_b128 v[56:59], v2 offset:20480
v_mfma_f32_16x16x32_bf16 v[92:95], v[64:67], a[124:127], v[92:95]
buffer_load_dwordx4 v1, s[4:7], s47 offen offset:2048 sc1 lds
v_mfma_f32_16x16x32_bf16 v[96:99], v[68:71], a[120:123], v[96:99]
ds_read_b128 v[60:63], v2 offset:21504
v_mfma_f32_16x16x32_bf16 v[100:103], v[68:71], a[124:127], v[100:103]
s_waitcnt lgkmcnt(4)
v_mfma_f32_16x16x32_bf16 v[72:75], v[224:227], v[232:235], v[72:75]
v_mfma_f32_16x16x32_bf16 v[76:79], v[224:227], v[236:239], v[76:79]
s_waitcnt lgkmcnt(3)
v_mfma_f32_16x16x32_bf16 v[80:83], v[228:231], v[232:235], v[80:83]
v_mfma_f32_16x16x32_bf16 v[84:87], v[228:231], v[236:239], v[84:87]
s_waitcnt lgkmcnt(2)
v_mfma_f32_16x16x32_bf16 v[104:107], v[40:43], a[0:3], 0
ds_read_b128 v[64:67], v2 offset:22528
ds_read_b64 v[224:225], v25 offset:256
v_mfma_f32_16x16x32_bf16 v[108:111], v[40:43], a[4:7], 0
ds_read_b64 v[228:229], v25 offset:384
v_mfma_f32_16x16x32_bf16 v[112:115], v[44:47], a[0:3], 0
ds_read_b128 v[68:71], v2 offset:23552
v_mfma_f32_16x16x32_bf16 v[116:119], v[44:47], a[4:7], 0
buffer_load_dwordx4 v1, s[4:7], s47 offen offset:3072 sc1 lds
v_mfma_f32_16x16x32_bf16 v[104:107], v[48:51], a[8:11], v[104:107]
ds_read_b128 v[40:43], v2 offset:24576
v_mul_f32 v240, v200, v72
v_mul_f32 v241, v200, v73
v_mfma_f32_16x16x32_bf16 v[108:111], v[48:51], a[12:15], v[108:111]
v_mul_f32 v242, v200, v74
v_mul_f32 v243, v200, v75
v_mfma_f32_16x16x32_bf16 v[112:115], v[52:55], a[8:11], v[112:115]
ds_read_b128 v[44:47], v2 offset:25600
s_add_u32 m0, s21, 16384
s_add_u32 s47, s20, 0
v_mfma_f32_16x16x32_bf16 v[116:119], v[52:55], a[12:15], v[116:119]
buffer_load_dwordx4 v1, s[4:7], s47 offen offset:0 sc1 lds
s_waitcnt lgkmcnt(4)
v_mfma_f32_16x16x32_bf16 v[88:91], v[224:227], v[232:235], v[88:91]
v_mfma_f32_16x16x32_bf16 v[92:95], v[224:227], v[236:239], v[92:95]
s_waitcnt lgkmcnt(3)
v_mfma_f32_16x16x32_bf16 v[96:99], v[228:231], v[232:235], v[96:99]
v_mfma_f32_16x16x32_bf16 v[100:103], v[228:231], v[236:239], v[100:103]
s_waitcnt lgkmcnt(2)
v_mfma_f32_16x16x32_bf16 v[104:107], v[56:59], a[16:19], v[104:107]
ds_read_b128 v[48:51], v2 offset:26624
v_mul_f32 v244, v201, v76
v_mul_f32 v245, v201, v77
v_mfma_f32_16x16x32_bf16 v[108:111], v[56:59], a[20:23], v[108:111]
v_mul_f32 v246, v201, v78
v_mul_f32 v247, v201, v79
v_mfma_f32_16x16x32_bf16 v[112:115], v[60:63], a[16:19], v[112:115]
ds_read_b128 v[52:55], v2 offset:27648
buffer_load_dwordx4 v1, s[4:7], s47 offen offset:1024 sc1 lds
v_mfma_f32_16x16x32_bf16 v[116:119], v[60:63], a[20:23], v[116:119]
v_exp_f32 v240, v240
v_mfma_f32_16x16x32_bf16 v[104:107], v[64:67], a[24:27], v[104:107]
ds_read_b128 v[56:59], v2 offset:28672
v_mul_f32 v72, v72, v80
v_mfma_f32_16x16x32_bf16 v[108:111], v[64:67], a[28:31], v[108:111]
v_exp_f32 v241, v241
v_mul_f32 v73, v73, v81
v_mfma_f32_16x16x32_bf16 v[112:115], v[68:71], a[24:27], v[112:115]
ds_read_b128 v[60:63], v2 offset:29696
v_exp_f32 v242, v242
v_mfma_f32_16x16x32_bf16 v[116:119], v[68:71], a[28:31], v[116:119]
v_mul_f32 v74, v74, v82
s_waitcnt lgkmcnt(2)
v_mfma_f32_16x16x32_bf16 v[104:107], v[40:43], a[32:35], v[104:107]
ds_read_b128 v[64:67], v2 offset:30720
buffer_load_dwordx4 v1, s[4:7], s47 offen offset:2048 sc1 lds
v_mfma_f32_16x16x32_bf16 v[108:111], v[40:43], a[36:39], v[108:111]
v_exp_f32 v243, v243
v_mul_f32 v75, v75, v83
v_mfma_f32_16x16x32_bf16 v[112:115], v[44:47], a[32:35], v[112:115]
s_waitcnt vmcnt(7)
s_barrier
ds_read_b128 v[68:71], v2 offset:31744
v_mfma_f32_16x16x32_bf16 v[116:119], v[44:47], a[36:39], v[116:119]
v_exp_f32 v244, v244
v_mfma_f32_16x16x32_bf16 v[104:107], v[48:51], a[40:43], v[104:107]
ds_read_b128 v[40:43], v1 offset:0
buffer_load_dwordx4 v1, s[4:7], s47 offen offset:3072 sc1 lds
v_mfma_f32_16x16x32_bf16 v[108:111], v[48:51], a[44:47], v[108:111]
v_mul_f32 v76, v76, v84
v_mfma_f32_16x16x32_bf16 v[112:115], v[52:55], a[40:43], v[112:115]
ds_read_b128 v[44:47], v1 offset:1024
v_exp_f32 v245, v245
v_mfma_f32_16x16x32_bf16 v[116:119], v[52:55], a[44:47], v[116:119]
v_mul_f32 v77, v77, v85
v_exp_f32 v246, v246
s_waitcnt lgkmcnt(2)
v_mfma_f32_16x16x32_bf16 v[104:107], v[56:59], a[48:51], v[104:107]
ds_read_b128 v[48:51], v1 offset:2048
s_add_u32 m0, s21, 65536
s_add_u32 s47, s19, 114688
v_mfma_f32_16x16x32_bf16 v[108:111], v[56:59], a[52:55], v[108:111]
buffer_load_dwordx4 v1, s[4:7], s47 offen offset:0 sc1 lds
v_mfma_f32_16x16x32_bf16 v[112:115], v[60:63], a[48:51], v[112:115]
ds_read_b128 v[52:55], v1 offset:3072
v_mul_f32 v78, v78, v86
v_mfma_f32_16x16x32_bf16 v[116:119], v[60:63], a[52:55], v[116:119]
v_exp_f32 v247, v247
v_mul_f32 v79, v79, v87
v_mfma_f32_16x16x32_bf16 v[104:107], v[64:67], a[56:59], v[104:107]
ds_read_b128 v[56:59], v1 offset:4096
v_fma_f32 v240, v240, v202, v202
v_fma_f32 v241, v241, v202, v202
v_mfma_f32_16x16x32_bf16 v[108:111], v[64:67], a[60:63], v[108:111]
v_fma_f32 v242, v242, v202, v202
v_fma_f32 v243, v243, v202, v202
v_mfma_f32_16x16x32_bf16 v[112:115], v[68:71], a[56:59], v[112:115]
ds_read_b128 v[60:63], v1 offset:5120
buffer_load_dwordx4 v1, s[4:7], s47 offen offset:1024 sc1 lds
v_mfma_f32_16x16x32_bf16 v[116:119], v[68:71], a[60:63], v[116:119]
v_fma_f32 v244, v244, v203, v203
s_waitcnt lgkmcnt(2)
v_mfma_f32_16x16x32_bf16 v[104:107], v[40:43], a[64:67], v[104:107]
ds_read_b128 v[64:67], v1 offset:6144
v_fma_f32 v245, v245, v203, v203
v_fma_f32 v246, v246, v203, v203
v_mfma_f32_16x16x32_bf16 v[108:111], v[40:43], a[68:71], v[108:111]
v_fma_f32 v247, v247, v203, v203
v_rcp_f32 v240, v240
v_mfma_f32_16x16x32_bf16 v[112:115], v[44:47], a[64:67], v[112:115]
ds_read_b128 v[68:71], v1 offset:7168
buffer_load_dwordx4 v1, s[4:7], s47 offen offset:2048 sc1 lds
v_mfma_f32_16x16x32_bf16 v[116:119], v[44:47], a[68:71], v[116:119]
v_rcp_f32 v241, v241
v_mfma_f32_16x16x32_bf16 v[104:107], v[48:51], a[72:75], v[104:107]
ds_read_b128 v[40:43], v1 offset:8192
v_rcp_f32 v242, v242
v_mfma_f32_16x16x32_bf16 v[108:111], v[48:51], a[76:79], v[108:111]
v_rcp_f32 v243, v243
v_mfma_f32_16x16x32_bf16 v[112:115], v[52:55], a[72:75], v[112:115]
ds_read_b128 v[44:47], v1 offset:9216
buffer_load_dwordx4 v1, s[4:7], s47 offen offset:3072 sc1 lds
v_mfma_f32_16x16x32_bf16 v[116:119], v[52:55], a[76:79], v[116:119]
v_rcp_f32 v244, v244
s_waitcnt lgkmcnt(2)
v_mfma_f32_16x16x32_bf16 v[104:107], v[56:59], a[80:83], v[104:107]
ds_read_b128 v[48:51], v1 offset:10240
v_rcp_f32 v245, v245
v_mfma_f32_16x16x32_bf16 v[108:111], v[56:59], a[84:87], v[108:111]
v_rcp_f32 v246, v246
v_mfma_f32_16x16x32_bf16 v[112:115], v[60:63], a[80:83], v[112:115]
ds_read_b128 v[52:55], v1 offset:11264
v_rcp_f32 v247, v247
v_mfma_f32_16x16x32_bf16 v[116:119], v[60:63], a[84:87], v[116:119]
v_mul_f32 v72, v72, v240
v_mfma_f32_16x16x32_bf16 v[104:107], v[64:67], a[88:91], v[104:107]
ds_read_b128 v[56:59], v1 offset:12288
s_add_u32 s57, s20, 98304
v_mfma_f32_16x16x32_bf16 v[108:111], v[64:67], a[92:95], v[108:111]
buffer_load_dwordx4 a[224:227], v1, s[4:7], s57 offen offset:0 sc1
v_mul_f32 v73, v73, v241
v_mfma_f32_16x16x32_bf16 v[112:115], v[68:71], a[88:91], v[112:115]
ds_read_b128 v[60:63], v1 offset:13312
v_mul_f32 v74, v74, v242
v_mul_f32 v75, v75, v243
v_mfma_f32_16x16x32_bf16 v[116:119], v[68:71], a[92:95], v[116:119]
v_mul_f32 v76, v76, v244
v_mul_f32 v77, v77, v245
s_waitcnt lgkmcnt(2)
v_mfma_f32_16x16x32_bf16 v[104:107], v[40:43], a[96:99], v[104:107]
ds_read_b128 v[64:67], v1 offset:14336
buffer_load_dwordx4 a[228:231], v1, s[4:7], s57 offen offset:1024 sc1
v_mfma_f32_16x16x32_bf16 v[108:111], v[40:43], a[100:103], v[108:111]
v_mul_f32 v78, v78, v246
v_mul_f32 v79, v79, v247
v_mfma_f32_16x16x32_bf16 v[112:115], v[44:47], a[96:99], v[112:115]
s_waitcnt vmcnt(10)
s_barrier
ds_read_b128 v[68:71], v1 offset:15360
v_mfma_f32_16x16x32_bf16 v[116:119], v[44:47], a[100:103], v[116:119]
v_cvt_pk_bf16_f32 v248, v72, v73
v_cvt_pk_bf16_f32 v249, v74, v75
v_mfma_f32_16x16x32_bf16 v[104:107], v[48:51], a[104:107], v[104:107]
ds_read_b128 v[40:43], v2 offset:32768
s_add_u32 m0, s21, 81920
s_add_u32 s47, s19, 131072
v_mfma_f32_16x16x32_bf16 v[108:111], v[48:51], a[108:111], v[108:111]
buffer_load_dwordx4 v1, s[4:7], s47 offen offset:0 sc1 lds
v_mfma_f32_16x16x32_bf16 v[112:115], v[52:55], a[104:107], v[112:115]
ds_read_b128 v[44:47], v2 offset:33792
ds_read_b64 v[224:225], v25 offset:512
ds_read_b64 v[228:229], v25 offset:640
v_mfma_f32_16x16x32_bf16 v[116:119], v[52:55], a[108:111], v[116:119]
v_cvt_pk_bf16_f32 v252, v76, v77
v_cvt_pk_bf16_f32 v253, v78, v79
s_waitcnt lgkmcnt(4)
v_mfma_f32_16x16x32_bf16 v[104:107], v[56:59], a[112:115], v[104:107]
ds_read_b128 v[48:51], v2 offset:34816
v_mul_f32 v240, v200, v88
v_mul_f32 v241, v200, v89
v_mfma_f32_16x16x32_bf16 v[108:111], v[56:59], a[116:119], v[108:111]
v_mul_f32 v242, v200, v90
v_mul_f32 v243, v200, v91
v_mfma_f32_16x16x32_bf16 v[112:115], v[60:63], a[112:115], v[112:115]
ds_read_b128 v[52:55], v2 offset:35840
buffer_load_dwordx4 v1, s[4:7], s47 offen offset:1024 sc1 lds
v_mfma_f32_16x16x32_bf16 v[116:119], v[60:63], a[116:119], v[116:119]
v_mul_f32 v244, v201, v92
v_mul_f32 v245, v201, v93
v_mfma_f32_16x16x32_bf16 v[104:107], v[64:67], a[120:123], v[104:107]
ds_read_b128 v[56:59], v2 offset:36864
v_mul_f32 v246, v201, v94
v_mul_f32 v247, v201, v95
v_mfma_f32_16x16x32_bf16 v[108:111], v[64:67], a[124:127], v[108:111]
v_exp_f32 v240, v240
v_mfma_f32_16x16x32_bf16 v[112:115], v[68:71], a[120:123], v[112:115]
ds_read_b128 v[60:63], v2 offset:37888
buffer_load_dwordx4 v1, s[4:7], s47 offen offset:2048 sc1 lds
v_mfma_f32_16x16x32_bf16 v[116:119], v[68:71], a[124:127], v[116:119]
v_mul_f32 v88, v88, v96
s_waitcnt lgkmcnt(5)
v_mfma_f32_16x16x32_bf16 v[104:107], v[224:227], v[232:235], v[104:107]
v_mfma_f32_16x16x32_bf16 v[108:111], v[224:227], v[236:239], v[108:111]
s_waitcnt lgkmcnt(4)
v_mfma_f32_16x16x32_bf16 v[112:115], v[228:231], v[232:235], v[112:115]
v_mfma_f32_16x16x32_bf16 v[116:119], v[228:231], v[236:239], v[116:119]
s_waitcnt lgkmcnt(2)
v_mfma_f32_16x16x32_bf16 v[72:75], v[40:43], a[0:3], 0
ds_read_b128 v[64:67], v2 offset:38912
v_exp_f32 v241, v241
v_mfma_f32_16x16x32_bf16 v[76:79], v[40:43], a[4:7], 0
v_mul_f32 v89, v89, v97
v_exp_f32 v242, v242
v_mfma_f32_16x16x32_bf16 v[80:83], v[44:47], a[0:3], 0
ds_read_b128 v[68:71], v2 offset:39936
buffer_load_dwordx4 v1, s[4:7], s47 offen offset:3072 sc1 lds
v_mfma_f32_16x16x32_bf16 v[84:87], v[44:47], a[4:7], 0
v_mul_f32 v90, v90, v98
v_mfma_f32_16x16x32_bf16 v[72:75], v[48:51], a[8:11], v[72:75]
ds_read_b128 v[40:43], v2 offset:40960
v_exp_f32 v243, v243
v_mfma_f32_16x16x32_bf16 v[76:79], v[48:51], a[12:15], v[76:79]
v_mul_f32 v91, v91, v99
v_mfma_f32_16x16x32_bf16 v[80:83], v[52:55], a[8:11], v[80:83]
ds_read_b128 v[44:47], v2 offset:41984
v_exp_f32 v244, v244
v_mfma_f32_16x16x32_bf16 v[84:87], v[52:55], a[12:15], v[84:87]
v_mul_f32 v92, v92, v100
v_exp_f32 v245, v245
s_waitcnt lgkmcnt(2)
v_mfma_f32_16x16x32_bf16 v[72:75], v[56:59], a[16:19], v[72:75]
ds_read_b128 v[48:51], v2 offset:43008
s_add_u32 m0, s21, 32768
s_add_u32 s47, s20, 16384
v_mfma_f32_16x16x32_bf16 v[76:79], v[56:59], a[20:23], v[76:79]
buffer_load_dwordx4 v1, s[4:7], s47 offen offset:0 sc1 lds
v_mfma_f32_16x16x32_bf16 v[80:83], v[60:63], a[16:19], v[80:83]
ds_read_b128 v[52:55], v2 offset:44032
v_mul_f32 v93, v93, v101
v_mfma_f32_16x16x32_bf16 v[84:87], v[60:63], a[20:23], v[84:87]
v_exp_f32 v246, v246
v_mfma_f32_16x16x32_bf16 v[72:75], v[64:67], a[24:27], v[72:75]
ds_read_b128 v[56:59], v2 offset:45056
buffer_load_dwordx4 v1, s[4:7], s47 offen offset:1024 sc1 lds
v_mfma_f32_16x16x32_bf16 v[76:79], v[64:67], a[28:31], v[76:79]
v_mul_f32 v94, v94, v102
v_exp_f32 v247, v247
v_mfma_f32_16x16x32_bf16 v[80:83], v[68:71], a[24:27], v[80:83]
ds_read_b128 v[60:63], v2 offset:46080
v_mul_f32 v95, v95, v103
v_mfma_f32_16x16x32_bf16 v[84:87], v[68:71], a[28:31], v[84:87]
v_fma_f32 v240, v240, v202, v202
v_fma_f32 v241, v241, v202, v202
s_waitcnt lgkmcnt(2)
v_mfma_f32_16x16x32_bf16 v[72:75], v[40:43], a[32:35], v[72:75]
ds_read_b128 v[64:67], v2 offset:47104
buffer_load_dwordx4 v1, s[4:7], s47 offen offset:2048 sc1 lds
v_mfma_f32_16x16x32_bf16 v[76:79], v[40:43], a[36:39], v[76:79]
v_fma_f32 v242, v242, v202, v202
v_fma_f32 v243, v243, v202, v202
v_mfma_f32_16x16x32_bf16 v[80:83], v[44:47], a[32:35], v[80:83]
s_waitcnt vmcnt(9)
s_barrier
ds_read_b128 v[68:71], v2 offset:48128
v_mfma_f32_16x16x32_bf16 v[84:87], v[44:47], a[36:39], v[84:87]
v_fma_f32 v244, v244, v203, v203
v_fma_f32 v245, v245, v203, v203
v_mfma_f32_16x16x32_bf16 v[72:75], v[48:51], a[40:43], v[72:75]
ds_read_b128 v[40:43], v2 offset:0
v_fma_f32 v246, v246, v203, v203
v_fma_f32 v247, v247, v203, v203
v_mfma_f32_16x16x32_bf16 v[76:79], v[48:51], a[44:47], v[76:79]
v_rcp_f32 v240, v240
v_mfma_f32_16x16x32_bf16 v[80:83], v[52:55], a[40:43], v[80:83]
ds_read_b128 v[44:47], v2 offset:1024
buffer_load_dwordx4 v1, s[4:7], s47 offen offset:3072 sc1 lds
v_mfma_f32_16x16x32_bf16 v[84:87], v[52:55], a[44:47], v[84:87]
v_rcp_f32 v241, v241
s_waitcnt lgkmcnt(2)
v_mfma_f32_16x16x32_bf16 v[72:75], v[56:59], a[48:51], v[72:75]
ds_read_b128 v[48:51], v2 offset:2048
v_rcp_f32 v242, v242
v_mfma_f32_16x16x32_bf16 v[76:79], v[56:59], a[52:55], v[76:79]
v_rcp_f32 v243, v243
v_mfma_f32_16x16x32_bf16 v[80:83], v[60:63], a[48:51], v[80:83]
ds_read_b128 v[52:55], v2 offset:3072
s_add_u32 m0, s21, 0
s_add_u32 s47, s19, 147456
v_mfma_f32_16x16x32_bf16 v[84:87], v[60:63], a[52:55], v[84:87]
buffer_load_dwordx4 v1, s[4:7], s47 offen offset:0 sc1 lds
v_mfma_f32_16x16x32_bf16 v[72:75], v[64:67], a[56:59], v[72:75]
ds_read_b128 v[56:59], v2 offset:4096
v_rcp_f32 v244, v244
v_mfma_f32_16x16x32_bf16 v[76:79], v[64:67], a[60:63], v[76:79]
v_rcp_f32 v245, v245
v_mfma_f32_16x16x32_bf16 v[80:83], v[68:71], a[56:59], v[80:83]
ds_read_b128 v[60:63], v2 offset:5120
v_mfma_f32_16x16x32_bf16 v[84:87], v[68:71], a[60:63], v[84:87]
buffer_load_dwordx4 v1, s[4:7], s47 offen offset:1024 sc1 lds
s_waitcnt lgkmcnt(2)
v_mfma_f32_16x16x32_bf16 v[72:75], v[40:43], a[64:67], v[72:75]
ds_read_b128 v[64:67], v2 offset:6144
v_rcp_f32 v246, v246
v_mfma_f32_16x16x32_bf16 v[76:79], v[40:43], a[68:71], v[76:79]
v_rcp_f32 v247, v247
v_mul_f32 v88, v88, v240
v_mfma_f32_16x16x32_bf16 v[80:83], v[44:47], a[64:67], v[80:83]
ds_read_b128 v[68:71], v2 offset:7168
v_mul_f32 v89, v89, v241
v_mul_f32 v90, v90, v242
v_mfma_f32_16x16x32_bf16 v[84:87], v[44:47], a[68:71], v[84:87]
v_mul_f32 v91, v91, v243
v_mul_f32 v92, v92, v244
v_mfma_f32_16x16x32_bf16 v[72:75], v[48:51], a[72:75], v[72:75]
ds_read_b128 v[40:43], v2 offset:8192
buffer_load_dwordx4 v1, s[4:7], s47 offen offset:2048 sc1 lds
v_mfma_f32_16x16x32_bf16 v[76:79], v[48:51], a[76:79], v[76:79]
v_mul_f32 v93, v93, v245
v_mfma_f32_16x16x32_bf16 v[80:83], v[52:55], a[72:75], v[80:83]
ds_read_b128 v[44:47], v2 offset:9216
v_mul_f32 v94, v94, v246
v_mul_f32 v95, v95, v247
v_mfma_f32_16x16x32_bf16 v[84:87], v[52:55], a[76:79], v[84:87]
v_cvt_pk_bf16_f32 v250, v88, v89
v_cvt_pk_bf16_f32 v251, v90, v91
s_waitcnt lgkmcnt(2)
v_mfma_f32_16x16x32_bf16 v[72:75], v[56:59], a[80:83], v[72:75]
ds_read_b128 v[48:51], v2 offset:10240
buffer_load_dwordx4 v1, s[4:7], s47 offen offset:3072 sc1 lds
v_mfma_f32_16x16x32_bf16 v[76:79], v[56:59], a[84:87], v[76:79]
v_cvt_pk_bf16_f32 v254, v92, v93
v_cvt_pk_bf16_f32 v255, v94, v95
v_mfma_f32_16x16x32_bf16 v[80:83], v[60:63], a[80:83], v[80:83]
ds_read_b128 v[52:55], v2 offset:11264
buffer_store_dwordx4 v[248:251], v1, s[4:7], s32 offen offset:0 sc1
v_mfma_f32_16x16x32_bf16 v[84:87], v[60:63], a[84:87], v[84:87]
buffer_store_dwordx4 v[252:255], v1, s[4:7], s58 offen offset:0 sc1
v_mfma_f32_16x16x32_bf16 v[72:75], v[64:67], a[88:91], v[72:75]
ds_read_b128 v[56:59], v2 offset:12288
buffer_load_dwordx4 a[232:235], v1, s[4:7], s57 offen offset:2048 sc1
v_mfma_f32_16x16x32_bf16 v[76:79], v[64:67], a[92:95], v[76:79]
v_mul_f32 v240, v200, v104
v_mul_f32 v241, v200, v105
v_mfma_f32_16x16x32_bf16 v[80:83], v[68:71], a[88:91], v[80:83]
ds_read_b128 v[60:63], v2 offset:13312
v_mul_f32 v242, v200, v106
v_mul_f32 v243, v200, v107
v_mfma_f32_16x16x32_bf16 v[84:87], v[68:71], a[92:95], v[84:87]
v_mul_f32 v244, v201, v108
v_mul_f32 v245, v201, v109
s_waitcnt lgkmcnt(2)
v_mfma_f32_16x16x32_bf16 v[72:75], v[40:43], a[96:99], v[72:75]
ds_read_b128 v[64:67], v2 offset:14336
v_mul_f32 v246, v201, v110
v_mul_f32 v247, v201, v111
v_mfma_f32_16x16x32_bf16 v[76:79], v[40:43], a[100:103], v[76:79]
v_exp_f32 v240, v240
v_mfma_f32_16x16x32_bf16 v[80:83], v[44:47], a[96:99], v[80:83]
s_waitcnt vmcnt(11)
s_barrier
ds_read_b128 v[68:71], v2 offset:15360
v_mfma_f32_16x16x32_bf16 v[84:87], v[44:47], a[100:103], v[84:87]
buffer_load_dwordx4 a[236:239], v1, s[4:7], s57 offen offset:3072 sc1
v_mfma_f32_16x16x32_bf16 v[72:75], v[48:51], a[104:107], v[72:75]
ds_read_b128 v[40:43], v2 offset:16384
v_mul_f32 v104, v104, v112
v_mfma_f32_16x16x32_bf16 v[76:79], v[48:51], a[108:111], v[76:79]
v_exp_f32 v241, v241
v_mul_f32 v105, v105, v113
v_mfma_f32_16x16x32_bf16 v[80:83], v[52:55], a[104:107], v[80:83]
ds_read_b128 v[44:47], v2 offset:17408
ds_read_b64 v[224:225], v25 offset:768
ds_read_b64 v[228:229], v25 offset:896
s_add_u32 m0, s21, 98304
v_mfma_f32_16x16x32_bf16 v[84:87], v[52:55], a[108:111], v[84:87]
s_add_u32 s47, s19, 163840
buffer_load_dwordx4 v1, s[4:7], s47 offen offset:0 sc1 lds
s_waitcnt lgkmcnt(4)
v_mfma_f32_16x16x32_bf16 v[72:75], v[56:59], a[112:115], v[72:75]
ds_read_b128 v[48:51], v2 offset:18432
v_mfma_f32_16x16x32_bf16 v[76:79], v[56:59], a[116:119], v[76:79]
v_exp_f32 v242, v242
v_mfma_f32_16x16x32_bf16 v[80:83], v[60:63], a[112:115], v[80:83]
ds_read_b128 v[52:55], v2 offset:19456
buffer_load_dwordx4 v1, s[4:7], s47 offen offset:1024 sc1 lds
v_mfma_f32_16x16x32_bf16 v[84:87], v[60:63], a[116:119], v[84:87]
v_mul_f32 v106, v106, v114
v_exp_f32 v243, v243
v_mfma_f32_16x16x32_bf16 v[72:75], v[64:67], a[120:123], v[72:75]
ds_read_b128 v[56:59], v2 offset:20480
v_mul_f32 v107, v107, v115
v_mfma_f32_16x16x32_bf16 v[76:79], v[64:67], a[124:127], v[76:79]
v_exp_f32 v244, v244
v_mfma_f32_16x16x32_bf16 v[80:83], v[68:71], a[120:123], v[80:83]
ds_read_b128 v[60:63], v2 offset:21504
v_mul_f32 v108, v108, v116
v_mfma_f32_16x16x32_bf16 v[84:87], v[68:71], a[124:127], v[84:87]
v_exp_f32 v245, v245
v_mul_f32 v109, v109, v117
s_waitcnt lgkmcnt(5)
v_mfma_f32_16x16x32_bf16 v[72:75], v[224:227], v[232:235], v[72:75]
v_mfma_f32_16x16x32_bf16 v[76:79], v[224:227], v[236:239], v[76:79]
s_waitcnt lgkmcnt(4)
v_mfma_f32_16x16x32_bf16 v[80:83], v[228:231], v[232:235], v[80:83]
v_mfma_f32_16x16x32_bf16 v[84:87], v[228:231], v[236:239], v[84:87]
s_waitcnt lgkmcnt(2)
v_mfma_f32_16x16x32_bf16 v[88:91], v[40:43], a[0:3], 0
ds_read_b128 v[64:67], v2 offset:22528
buffer_load_dwordx4 v1, s[4:7], s47 offen offset:2048 sc1 lds
v_mfma_f32_16x16x32_bf16 v[92:95], v[40:43], a[4:7], 0
v_exp_f32 v246, v246
v_mfma_f32_16x16x32_bf16 v[96:99], v[44:47], a[0:3], 0
ds_read_b128 v[68:71], v2 offset:23552
v_mul_f32 v110, v110, v118
v_mfma_f32_16x16x32_bf16 v[100:103], v[44:47], a[4:7], 0
v_exp_f32 v247, v247
v_mul_f32 v111, v111, v119
v_mfma_f32_16x16x32_bf16 v[88:91], v[48:51], a[8:11], v[88:91]
ds_read_b128 v[40:43], v2 offset:24576
buffer_load_dwordx4 v1, s[4:7], s47 offen offset:3072 sc1 lds
v_mfma_f32_16x16x32_bf16 v[92:95], v[48:51], a[12:15], v[92:95]
v_fma_f32 v240, v240, v202, v202
v_fma_f32 v241, v241, v202, v202
v_fma_f32 v242, v242, v202, v202
v_mfma_f32_16x16x32_bf16 v[96:99], v[52:55], a[8:11], v[96:99]
ds_read_b128 v[44:47], v2 offset:25600
v_fma_f32 v243, v243, v202, v202
v_fma_f32 v244, v244, v203, v203
v_mfma_f32_16x16x32_bf16 v[100:103], v[52:55], a[12:15], v[100:103]
v_fma_f32 v245, v245, v203, v203
v_fma_f32 v246, v246, v203, v203
s_waitcnt lgkmcnt(2)
v_mfma_f32_16x16x32_bf16 v[88:91], v[56:59], a[16:19], v[88:91]
ds_read_b128 v[48:51], v2 offset:26624
s_add_u32 m0, s21, 49152
s_add_u32 s47, s20, 32768
v_mfma_f32_16x16x32_bf16 v[92:95], v[56:59], a[20:23], v[92:95]
buffer_load_dwordx4 v1, s[4:7], s47 offen offset:0 sc1 lds
v_mfma_f32_16x16x32_bf16 v[96:99], v[60:63], a[16:19], v[96:99]
ds_read_b128 v[52:55], v2 offset:27648
v_fma_f32 v247, v247, v203, v203
v_mfma_f32_16x16x32_bf16 v[100:103], v[60:63], a[20:23], v[100:103]
v_rcp_f32 v240, v240
v_mfma_f32_16x16x32_bf16 v[88:91], v[64:67], a[24:27], v[88:91]
ds_read_b128 v[56:59], v2 offset:28672
v_rcp_f32 v241, v241
v_mfma_f32_16x16x32_bf16 v[92:95], v[64:67], a[28:31], v[92:95]
v_rcp_f32 v242, v242
v_mfma_f32_16x16x32_bf16 v[96:99], v[68:71], a[24:27], v[96:99]
ds_read_b128 v[60:63], v2 offset:29696
buffer_load_dwordx4 v1, s[4:7], s47 offen offset:1024 sc1 lds
v_mfma_f32_16x16x32_bf16 v[100:103], v[68:71], a[28:31], v[100:103]
v_rcp_f32 v243, v243
s_waitcnt lgkmcnt(2)
v_mfma_f32_16x16x32_bf16 v[88:91], v[40:43], a[32:35], v[88:91]
ds_read_b128 v[64:67], v2 offset:30720
v_rcp_f32 v244, v244
v_mfma_f32_16x16x32_bf16 v[92:95], v[40:43], a[36:39], v[92:95]
v_rcp_f32 v245, v245
v_mfma_f32_16x16x32_bf16 v[96:99], v[44:47], a[32:35], v[96:99]
s_waitcnt vmcnt(10)
s_barrier
ds_read_b128 v[68:71], v2 offset:31744
v_mfma_f32_16x16x32_bf16 v[100:103], v[44:47], a[36:39], v[100:103]
buffer_load_dwordx4 v1, s[4:7], s47 offen offset:2048 sc1 lds
v_mfma_f32_16x16x32_bf16 v[88:91], v[48:51], a[40:43], v[88:91]
ds_read_b128 v[40:43], v1 offset:0
v_rcp_f32 v246, v246
v_mfma_f32_16x16x32_bf16 v[92:95], v[48:51], a[44:47], v[92:95]
v_rcp_f32 v247, v247
v_mul_f32 v104, v104, v240
v_mfma_f32_16x16x32_bf16 v[96:99], v[52:55], a[40:43], v[96:99]
ds_read_b128 v[44:47], v1 offset:1024
buffer_load_dwordx4 v1, s[4:7], s47 offen offset:3072 sc1 lds
v_mfma_f32_16x16x32_bf16 v[100:103], v[52:55], a[44:47], v[100:103]
s_waitcnt vmcnt(10)
buffer_store_dwordx2 v[36:37], v26, s[4:7], s40 offen offset:0 sc1
s_waitcnt lgkmcnt(2)
v_mfma_f32_16x16x32_bf16 v[88:91], v[56:59], a[48:51], v[88:91]
ds_read_b128 v[48:51], v1 offset:2048
v_mul_f32 v105, v105, v241
v_mfma_f32_16x16x32_bf16 v[92:95], v[56:59], a[52:55], v[92:95]
v_mul_f32 v106, v106, v242
v_mul_f32 v107, v107, v243
v_mfma_f32_16x16x32_bf16 v[96:99], v[60:63], a[48:51], v[96:99]
ds_read_b128 v[52:55], v1 offset:3072
v_mul_f32 v108, v108, v244
v_mul_f32 v109, v109, v245
v_mfma_f32_16x16x32_bf16 v[100:103], v[60:63], a[52:55], v[100:103]
v_mul_f32 v110, v110, v246
v_mul_f32 v111, v111, v247
v_mfma_f32_16x16x32_bf16 v[88:91], v[64:67], a[56:59], v[88:91]
ds_read_b128 v[56:59], v1 offset:4096
s_add_u32 m0, s21, 65536
s_add_u32 s47, s19, 180224
v_mfma_f32_16x16x32_bf16 v[92:95], v[64:67], a[60:63], v[92:95]
buffer_load_dwordx4 v1, s[4:7], s47 offen offset:0 sc1 lds
v_mfma_f32_16x16x32_bf16 v[96:99], v[68:71], a[56:59], v[96:99]
ds_read_b128 v[60:63], v1 offset:5120
v_cvt_pk_bf16_f32 v248, v104, v105
v_cvt_pk_bf16_f32 v249, v106, v107
v_mfma_f32_16x16x32_bf16 v[100:103], v[68:71], a[60:63], v[100:103]
v_cvt_pk_bf16_f32 v252, v108, v109
v_cvt_pk_bf16_f32 v253, v110, v111
s_waitcnt lgkmcnt(2)
v_mfma_f32_16x16x32_bf16 v[88:91], v[40:43], a[64:67], v[88:91]
ds_read_b128 v[64:67], v1 offset:6144
buffer_load_dwordx4 v1, s[4:7], s47 offen offset:1024 sc1 lds
v_mfma_f32_16x16x32_bf16 v[92:95], v[40:43], a[68:71], v[92:95]
v_mul_f32 v240, v200, v72
v_mul_f32 v241, v200, v73
v_mfma_f32_16x16x32_bf16 v[96:99], v[44:47], a[64:67], v[96:99]
ds_read_b128 v[68:71], v1 offset:7168
v_mul_f32 v242, v200, v74
v_mul_f32 v243, v200, v75
v_mfma_f32_16x16x32_bf16 v[100:103], v[44:47], a[68:71], v[100:103]
v_mul_f32 v244, v201, v76
v_mul_f32 v245, v201, v77
v_mfma_f32_16x16x32_bf16 v[88:91], v[48:51], a[72:75], v[88:91]
ds_read_b128 v[40:43], v1 offset:8192
buffer_load_dwordx4 v1, s[4:7], s47 offen offset:2048 sc1 lds
v_mfma_f32_16x16x32_bf16 v[92:95], v[48:51], a[76:79], v[92:95]
v_mul_f32 v246, v201, v78
v_mul_f32 v247, v201, v79
v_mfma_f32_16x16x32_bf16 v[96:99], v[52:55], a[72:75], v[96:99]
ds_read_b128 v[44:47], v1 offset:9216
v_exp_f32 v240, v240
v_mfma_f32_16x16x32_bf16 v[100:103], v[52:55], a[76:79], v[100:103]
v_mul_f32 v72, v72, v80
v_exp_f32 v241, v241
s_waitcnt lgkmcnt(2)
v_mfma_f32_16x16x32_bf16 v[88:91], v[56:59], a[80:83], v[88:91]
ds_read_b128 v[48:51], v1 offset:10240
v_mul_f32 v73, v73, v81
v_mfma_f32_16x16x32_bf16 v[92:95], v[56:59], a[84:87], v[92:95]
v_exp_f32 v242, v242
v_mfma_f32_16x16x32_bf16 v[96:99], v[60:63], a[80:83], v[96:99]
ds_read_b128 v[52:55], v1 offset:11264
buffer_load_dwordx4 v1, s[4:7], s47 offen offset:3072 sc1 lds
v_mfma_f32_16x16x32_bf16 v[100:103], v[60:63], a[84:87], v[100:103]
v_mul_f32 v74, v74, v82
v_exp_f32 v243, v243
v_mfma_f32_16x16x32_bf16 v[88:91], v[64:67], a[88:91], v[88:91]
ds_read_b128 v[56:59], v1 offset:12288
v_mul_f32 v75, v75, v83
v_mfma_f32_16x16x32_bf16 v[92:95], v[64:67], a[92:95], v[92:95]
v_exp_f32 v244, v244
v_mfma_f32_16x16x32_bf16 v[96:99], v[68:71], a[88:91], v[96:99]
ds_read_b128 v[60:63], v1 offset:13312
s_add_u32 s57, s20, 114688
v_mfma_f32_16x16x32_bf16 v[100:103], v[68:71], a[92:95], v[100:103]
buffer_load_dwordx4 a[240:243], v1, s[4:7], s57 offen offset:0 sc1
v_mul_f32 v76, v76, v84
s_waitcnt lgkmcnt(2)
v_mfma_f32_16x16x32_bf16 v[88:91], v[40:43], a[96:99], v[88:91]
ds_read_b128 v[64:67], v1 offset:14336
v_exp_f32 v245, v245
v_mfma_f32_16x16x32_bf16 v[92:95], v[40:43], a[100:103], v[92:95]
v_mul_f32 v77, v77, v85
v_exp_f32 v246, v246
v_mfma_f32_16x16x32_bf16 v[96:99], v[44:47], a[96:99], v[96:99]
s_waitcnt vmcnt(10)
s_barrier
ds_read_b128 v[68:71], v1 offset:15360
v_mfma_f32_16x16x32_bf16 v[100:103], v[44:47], a[100:103], v[100:103]
buffer_load_dwordx4 a[244:247], v1, s[4:7], s57 offen offset:1024 sc1
v_mfma_f32_16x16x32_bf16 v[88:91], v[48:51], a[104:107], v[88:91]
ds_read_b128 v[40:43], v2 offset:32768
v_mul_f32 v78, v78, v86
v_mfma_f32_16x16x32_bf16 v[92:95], v[48:51], a[108:111], v[92:95]
v_exp_f32 v247, v247
v_mfma_f32_16x16x32_bf16 v[96:99], v[52:55], a[104:107], v[96:99]
ds_read_b128 v[44:47], v2 offset:33792
ds_read_b64 v[224:225], v25 offset:1024
ds_read_b64 v[228:229], v25 offset:1152
v_mfma_f32_16x16x32_bf16 v[100:103], v[52:55], a[108:111], v[100:103]
v_mul_f32 v79, v79, v87
v_fma_f32 v240, v240, v202, v202
s_waitcnt lgkmcnt(4)
v_mfma_f32_16x16x32_bf16 v[88:91], v[56:59], a[112:115], v[88:91]
ds_read_b128 v[48:51], v2 offset:34816
s_add_u32 m0, s21, 81920
s_add_u32 s47, s19, 196608
v_mfma_f32_16x16x32_bf16 v[92:95], v[56:59], a[116:119], v[92:95]
buffer_load_dwordx4 v1, s[4:7], s47 offen offset:0 sc1 lds
v_fma_f32 v241, v241, v202, v202
v_mfma_f32_16x16x32_bf16 v[96:99], v[60:63], a[112:115], v[96:99]
ds_read_b128 v[52:55], v2 offset:35840
v_fma_f32 v242, v242, v202, v202
v_fma_f32 v243, v243, v202, v202
v_mfma_f32_16x16x32_bf16 v[100:103], v[60:63], a[116:119], v[100:103]
v_fma_f32 v244, v244, v203, v203
v_fma_f32 v245, v245, v203, v203
v_mfma_f32_16x16x32_bf16 v[88:91], v[64:67], a[120:123], v[88:91]
ds_read_b128 v[56:59], v2 offset:36864
buffer_load_dwordx4 v1, s[4:7], s47 offen offset:1024 sc1 lds
v_mfma_f32_16x16x32_bf16 v[92:95], v[64:67], a[124:127], v[92:95]
v_fma_f32 v246, v246, v203, v203
v_fma_f32 v247, v247, v203, v203
v_mfma_f32_16x16x32_bf16 v[96:99], v[68:71], a[120:123], v[96:99]
ds_read_b128 v[60:63], v2 offset:37888
v_rcp_f32 v240, v240
v_mfma_f32_16x16x32_bf16 v[100:103], v[68:71], a[124:127], v[100:103]
v_rcp_f32 v241, v241
s_waitcnt lgkmcnt(5)
v_mfma_f32_16x16x32_bf16 v[88:91], v[224:227], v[232:235], v[88:91]
v_mfma_f32_16x16x32_bf16 v[92:95], v[224:227], v[236:239], v[92:95]
s_waitcnt lgkmcnt(4)
v_mfma_f32_16x16x32_bf16 v[96:99], v[228:231], v[232:235], v[96:99]
v_mfma_f32_16x16x32_bf16 v[100:103], v[228:231], v[236:239], v[100:103]
s_waitcnt lgkmcnt(2)
v_mfma_f32_16x16x32_bf16 v[104:107], v[40:43], a[0:3], 0
ds_read_b128 v[64:67], v2 offset:38912
v_rcp_f32 v242, v242
v_mfma_f32_16x16x32_bf16 v[108:111], v[40:43], a[4:7], 0
v_rcp_f32 v243, v243
v_mfma_f32_16x16x32_bf16 v[112:115], v[44:47], a[0:3], 0
ds_read_b128 v[68:71], v2 offset:39936
buffer_load_dwordx4 v1, s[4:7], s47 offen offset:2048 sc1 lds
v_mfma_f32_16x16x32_bf16 v[116:119], v[44:47], a[4:7], 0
v_rcp_f32 v244, v244
v_mfma_f32_16x16x32_bf16 v[104:107], v[48:51], a[8:11], v[104:107]
ds_read_b128 v[40:43], v2 offset:40960
v_rcp_f32 v245, v245
v_mfma_f32_16x16x32_bf16 v[108:111], v[48:51], a[12:15], v[108:111]
v_rcp_f32 v246, v246
v_mfma_f32_16x16x32_bf16 v[112:115], v[52:55], a[8:11], v[112:115]
ds_read_b128 v[44:47], v2 offset:41984
buffer_load_dwordx4 v1, s[4:7], s47 offen offset:3072 sc1 lds
v_mfma_f32_16x16x32_bf16 v[116:119], v[52:55], a[12:15], v[116:119]
v_rcp_f32 v247, v247
s_waitcnt lgkmcnt(2)
v_mfma_f32_16x16x32_bf16 v[104:107], v[56:59], a[16:19], v[104:107]
ds_read_b128 v[48:51], v2 offset:43008
v_mul_f32 v72, v72, v240
v_mul_f32 v73, v73, v241
v_mfma_f32_16x16x32_bf16 v[108:111], v[56:59], a[20:23], v[108:111]
v_mul_f32 v74, v74, v242
v_mul_f32 v75, v75, v243
v_mfma_f32_16x16x32_bf16 v[112:115], v[60:63], a[16:19], v[112:115]
ds_read_b128 v[52:55], v2 offset:44032
s_add_u32 m0, s21, 114688
s_add_u32 s47, s20, 49152
v_mfma_f32_16x16x32_bf16 v[116:119], v[60:63], a[20:23], v[116:119]
buffer_load_dwordx4 v1, s[4:7], s47 offen offset:0 sc1 lds
v_mfma_f32_16x16x32_bf16 v[104:107], v[64:67], a[24:27], v[104:107]
ds_read_b128 v[56:59], v2 offset:45056
v_mul_f32 v76, v76, v244
v_mul_f32 v77, v77, v245
v_mfma_f32_16x16x32_bf16 v[108:111], v[64:67], a[28:31], v[108:111]
v_mul_f32 v78, v78, v246
v_mul_f32 v79, v79, v247
v_mfma_f32_16x16x32_bf16 v[112:115], v[68:71], a[24:27], v[112:115]
ds_read_b128 v[60:63], v2 offset:46080
v_cvt_pk_bf16_f32 v250, v72, v73
v_cvt_pk_bf16_f32 v251, v74, v75
v_mfma_f32_16x16x32_bf16 v[116:119], v[68:71], a[28:31], v[116:119]
v_cvt_pk_bf16_f32 v254, v76, v77
v_cvt_pk_bf16_f32 v255, v78, v79
s_waitcnt lgkmcnt(2)
v_mfma_f32_16x16x32_bf16 v[104:107], v[40:43], a[32:35], v[104:107]
ds_read_b128 v[64:67], v2 offset:47104
buffer_load_dwordx4 v1, s[4:7], s47 offen offset:1024 sc1 lds
v_mfma_f32_16x16x32_bf16 v[108:111], v[40:43], a[36:39], v[108:111]
buffer_store_dwordx4 v[248:251], v1, s[4:7], s32 offen offset:1024 sc1
v_mfma_f32_16x16x32_bf16 v[112:115], v[44:47], a[32:35], v[112:115]
s_waitcnt vmcnt(9)
s_barrier
ds_read_b128 v[68:71], v2 offset:48128
v_mfma_f32_16x16x32_bf16 v[116:119], v[44:47], a[36:39], v[116:119]
buffer_store_dwordx4 v[252:255], v1, s[4:7], s58 offen offset:1024 sc1
v_mfma_f32_16x16x32_bf16 v[104:107], v[48:51], a[40:43], v[104:107]
ds_read_b128 v[40:43], v2 offset:0
buffer_load_dwordx4 v1, s[4:7], s47 offen offset:2048 sc1 lds
v_mfma_f32_16x16x32_bf16 v[108:111], v[48:51], a[44:47], v[108:111]
v_mul_f32 v240, v200, v88
v_mul_f32 v241, v200, v89
v_mfma_f32_16x16x32_bf16 v[112:115], v[52:55], a[40:43], v[112:115]
ds_read_b128 v[44:47], v2 offset:1024
v_mul_f32 v242, v200, v90
v_mul_f32 v243, v200, v91
v_mfma_f32_16x16x32_bf16 v[116:119], v[52:55], a[44:47], v[116:119]
v_mul_f32 v244, v201, v92
v_mul_f32 v245, v201, v93
s_waitcnt lgkmcnt(2)
v_mfma_f32_16x16x32_bf16 v[104:107], v[56:59], a[48:51], v[104:107]
ds_read_b128 v[48:51], v2 offset:2048
buffer_load_dwordx4 v1, s[4:7], s47 offen offset:3072 sc1 lds
v_mfma_f32_16x16x32_bf16 v[108:111], v[56:59], a[52:55], v[108:111]
v_mul_f32 v246, v201, v94
v_mul_f32 v247, v201, v95
v_mfma_f32_16x16x32_bf16 v[112:115], v[60:63], a[48:51], v[112:115]
ds_read_b128 v[52:55], v2 offset:3072
v_exp_f32 v240, v240
v_mfma_f32_16x16x32_bf16 v[116:119], v[60:63], a[52:55], v[116:119]
v_mul_f32 v88, v88, v96
v_mfma_f32_16x16x32_bf16 v[104:107], v[64:67], a[56:59], v[104:107]
ds_read_b128 v[56:59], v2 offset:4096
v_exp_f32 v241, v241
v_mfma_f32_16x16x32_bf16 v[108:111], v[64:67], a[60:63], v[108:111]
v_mul_f32 v89, v89, v97
v_exp_f32 v242, v242
v_mfma_f32_16x16x32_bf16 v[112:115], v[68:71], a[56:59], v[112:115]
ds_read_b128 v[60:63], v2 offset:5120
s_add_u32 m0, s21, 0
s_add_u32 s47, s19, 212992
v_mfma_f32_16x16x32_bf16 v[116:119], v[68:71], a[60:63], v[116:119]
buffer_load_dwordx4 v1, s[4:7], s47 offen offset:0 sc1 lds
s_waitcnt lgkmcnt(2)
v_mfma_f32_16x16x32_bf16 v[104:107], v[40:43], a[64:67], v[104:107]
ds_read_b128 v[64:67], v2 offset:6144
v_mul_f32 v90, v90, v98
v_mfma_f32_16x16x32_bf16 v[108:111], v[40:43], a[68:71], v[108:111]
v_exp_f32 v243, v243
v_mfma_f32_16x16x32_bf16 v[112:115], v[44:47], a[64:67], v[112:115]
ds_read_b128 v[68:71], v2 offset:7168
buffer_load_dwordx4 v1, s[4:7], s47 offen offset:1024 sc1 lds
v_mfma_f32_16x16x32_bf16 v[116:119], v[44:47], a[68:71], v[116:119]
v_mul_f32 v91, v91, v99
v_exp_f32 v244, v244
v_mfma_f32_16x16x32_bf16 v[104:107], v[48:51], a[72:75], v[104:107]
ds_read_b128 v[40:43], v2 offset:8192
v_mul_f32 v92, v92, v100
v_mfma_f32_16x16x32_bf16 v[108:111], v[48:51], a[76:79], v[108:111]
v_exp_f32 v245, v245
v_mfma_f32_16x16x32_bf16 v[112:115], v[52:55], a[72:75], v[112:115]
ds_read_b128 v[44:47], v2 offset:9216
buffer_load_dwordx4 v1, s[4:7], s47 offen offset:2048 sc1 lds
v_mfma_f32_16x16x32_bf16 v[116:119], v[52:55], a[76:79], v[116:119]
v_mul_f32 v93, v93, v101
s_waitcnt lgkmcnt(2)
v_mfma_f32_16x16x32_bf16 v[104:107], v[56:59], a[80:83], v[104:107]
ds_read_b128 v[48:51], v2 offset:10240
v_exp_f32 v246, v246
v_mfma_f32_16x16x32_bf16 v[108:111], v[56:59], a[84:87], v[108:111]
v_mul_f32 v94, v94, v102
v_exp_f32 v247, v247
v_mfma_f32_16x16x32_bf16 v[112:115], v[60:63], a[80:83], v[112:115]
ds_read_b128 v[52:55], v2 offset:11264
v_mul_f32 v95, v95, v103
v_fma_f32 v240, v240, v202, v202
v_mfma_f32_16x16x32_bf16 v[116:119], v[60:63], a[84:87], v[116:119]
v_fma_f32 v241, v241, v202, v202
v_fma_f32 v242, v242, v202, v202
v_mfma_f32_16x16x32_bf16 v[104:107], v[64:67], a[88:91], v[104:107]
ds_read_b128 v[56:59], v2 offset:12288
buffer_load_dwordx4 v1, s[4:7], s47 offen offset:3072 sc1 lds
v_mfma_f32_16x16x32_bf16 v[108:111], v[64:67], a[92:95], v[108:111]
v_fma_f32 v243, v243, v202, v202
v_fma_f32 v244, v244, v203, v203
v_mfma_f32_16x16x32_bf16 v[112:115], v[68:71], a[88:91], v[112:115]
ds_read_b128 v[60:63], v2 offset:13312
v_fma_f32 v245, v245, v203, v203
v_mfma_f32_16x16x32_bf16 v[116:119], v[68:71], a[92:95], v[116:119]
v_fma_f32 v246, v246, v203, v203
v_fma_f32 v247, v247, v203, v203
s_waitcnt lgkmcnt(2)
v_mfma_f32_16x16x32_bf16 v[104:107], v[40:43], a[96:99], v[104:107]
ds_read_b128 v[64:67], v2 offset:14336
buffer_load_dwordx4 a[248:251], v1, s[4:7], s57 offen offset:2048 sc1
v_mfma_f32_16x16x32_bf16 v[108:111], v[40:43], a[100:103], v[108:111]
v_rcp_f32 v240, v240
v_mfma_f32_16x16x32_bf16 v[112:115], v[44:47], a[96:99], v[112:115]
s_waitcnt vmcnt(11)
s_barrier
ds_read_b128 v[68:71], v2 offset:15360
v_mfma_f32_16x16x32_bf16 v[116:119], v[44:47], a[100:103], v[116:119]
v_rcp_f32 v241, v241
v_mfma_f32_16x16x32_bf16 v[104:107], v[48:51], a[104:107], v[104:107]
ds_read_b128 v[40:43], v2 offset:16384
buffer_load_dwordx4 a[252:255], v1, s[4:7], s57 offen offset:3072 sc1
v_mfma_f32_16x16x32_bf16 v[108:111], v[48:51], a[108:111], v[108:111]
v_rcp_f32 v242, v242
v_mfma_f32_16x16x32_bf16 v[112:115], v[52:55], a[104:107], v[112:115]
ds_read_b128 v[44:47], v2 offset:17408
ds_read_b64 v[224:225], v25 offset:1280
ds_read_b64 v[228:229], v25 offset:1408
v_mfma_f32_16x16x32_bf16 v[116:119], v[52:55], a[108:111], v[116:119]
v_rcp_f32 v243, v243
s_waitcnt lgkmcnt(4)
v_mfma_f32_16x16x32_bf16 v[104:107], v[56:59], a[112:115], v[104:107]
ds_read_b128 v[48:51], v2 offset:18432
v_rcp_f32 v244, v244
v_mfma_f32_16x16x32_bf16 v[108:111], v[56:59], a[116:119], v[108:111]
v_rcp_f32 v245, v245
v_mfma_f32_16x16x32_bf16 v[112:115], v[60:63], a[112:115], v[112:115]
ds_read_b128 v[52:55], v2 offset:19456
s_add_u32 m0, s21, 131072
s_add_u32 s47, s20, 65536
v_mfma_f32_16x16x32_bf16 v[116:119], v[60:63], a[116:119], v[116:119]
buffer_load_dwordx4 v1, s[4:7], s47 offen offset:0 sc1 lds
v_mfma_f32_16x16x32_bf16 v[104:107], v[64:67], a[120:123], v[104:107]
ds_read_b128 v[56:59], v2 offset:20480
v_rcp_f32 v246, v246
v_mfma_f32_16x16x32_bf16 v[108:111], v[64:67], a[124:127], v[108:111]
v_rcp_f32 v247, v247
v_mfma_f32_16x16x32_bf16 v[112:115], v[68:71], a[120:123], v[112:115]
ds_read_b128 v[60:63], v2 offset:21504
buffer_load_dwordx4 v1, s[4:7], s47 offen offset:1024 sc1 lds
v_mfma_f32_16x16x32_bf16 v[116:119], v[68:71], a[124:127], v[116:119]
v_mul_f32 v88, v88, v240
s_waitcnt lgkmcnt(5)
v_mfma_f32_16x16x32_bf16 v[104:107], v[224:227], v[232:235], v[104:107]
v_mfma_f32_16x16x32_bf16 v[108:111], v[224:227], v[236:239], v[108:111]
s_waitcnt lgkmcnt(4)
v_mfma_f32_16x16x32_bf16 v[112:115], v[228:231], v[232:235], v[112:115]
v_mfma_f32_16x16x32_bf16 v[116:119], v[228:231], v[236:239], v[116:119]
s_waitcnt lgkmcnt(2)
v_mfma_f32_16x16x32_bf16 v[72:75], v[40:43], a[0:3], 0
ds_read_b128 v[64:67], v2 offset:22528
s_waitcnt vmcnt(10)
v_mfma_f32_16x16x32_bf16 v[76:79], v[40:43], a[4:7], 0
buffer_store_dwordx2 v[36:37], v26, s[4:7], s40 offen offset:512 sc1
v_mul_f32 v89, v89, v241
v_mfma_f32_16x16x32_bf16 v[80:83], v[44:47], a[0:3], 0
ds_read_b128 v[68:71], v2 offset:23552
buffer_load_dwordx4 v1, s[4:7], s47 offen offset:2048 sc1 lds
v_mfma_f32_16x16x32_bf16 v[84:87], v[44:47], a[4:7], 0
v_mul_f32 v90, v90, v242
v_mul_f32 v91, v91, v243
v_mfma_f32_16x16x32_bf16 v[72:75], v[48:51], a[8:11], v[72:75]
ds_read_b128 v[40:43], v2 offset:24576
v_mul_f32 v92, v92, v244
v_mul_f32 v93, v93, v245
v_mfma_f32_16x16x32_bf16 v[76:79], v[48:51], a[12:15], v[76:79]
v_mul_f32 v94, v94, v246
v_mul_f32 v95, v95, v247
v_mfma_f32_16x16x32_bf16 v[80:83], v[52:55], a[8:11], v[80:83]
ds_read_b128 v[44:47], v2 offset:25600
v_cvt_pk_bf16_f32 v248, v88, v89
v_cvt_pk_bf16_f32 v249, v90, v91
v_mfma_f32_16x16x32_bf16 v[84:87], v[52:55], a[12:15], v[84:87]
v_cvt_pk_bf16_f32 v252, v92, v93
v_cvt_pk_bf16_f32 v253, v94, v95
s_waitcnt lgkmcnt(2)
v_mfma_f32_16x16x32_bf16 v[72:75], v[56:59], a[16:19], v[72:75]
ds_read_b128 v[48:51], v2 offset:26624
buffer_load_dwordx2 v[38:39], v17, s[4:7], s41 offen offset:0 sc1
v_mfma_f32_16x16x32_bf16 v[76:79], v[56:59], a[20:23], v[76:79]
buffer_load_dwordx4 v1, s[4:7], s47 offen offset:3072 sc1 lds
v_mul_f32 v240, v200, v104
v_mfma_f32_16x16x32_bf16 v[80:83], v[60:63], a[16:19], v[80:83]
ds_read_b128 v[52:55], v2 offset:27648
v_mul_f32 v241, v200, v105
v_mul_f32 v242, v200, v106
v_mfma_f32_16x16x32_bf16 v[84:87], v[60:63], a[20:23], v[84:87]
v_mul_f32 v243, v200, v107
v_mul_f32 v244, v201, v108
v_mul_f32 v245, v201, v109
v_mfma_f32_16x16x32_bf16 v[72:75], v[64:67], a[24:27], v[72:75]
ds_read_b128 v[56:59], v2 offset:28672
s_add_u32 m0, s21, 98304
s_add_u32 s47, s20, 81920
v_mfma_f32_16x16x32_bf16 v[76:79], v[64:67], a[28:31], v[76:79]
buffer_load_dwordx4 v1, s[4:7], s47 offen offset:0 sc1 lds
v_mul_f32 v246, v201, v110
v_mul_f32 v247, v201, v111
v_mfma_f32_16x16x32_bf16 v[80:83], v[68:71], a[24:27], v[80:83]
ds_read_b128 v[60:63], v2 offset:29696
v_exp_f32 v240, v240
v_mfma_f32_16x16x32_bf16 v[84:87], v[68:71], a[28:31], v[84:87]
v_mul_f32 v104, v104, v112
v_exp_f32 v241, v241
s_waitcnt lgkmcnt(2)
v_mfma_f32_16x16x32_bf16 v[72:75], v[40:43], a[32:35], v[72:75]
ds_read_b128 v[64:67], v2 offset:30720
buffer_load_dwordx4 v1, s[4:7], s47 offen offset:1024 sc1 lds
v_mfma_f32_16x16x32_bf16 v[76:79], v[40:43], a[36:39], v[76:79]
v_mul_f32 v105, v105, v113
v_exp_f32 v242, v242
v_mfma_f32_16x16x32_bf16 v[80:83], v[44:47], a[32:35], v[80:83]
s_waitcnt vmcnt(10)
s_barrier
ds_read_b128 v[68:71], v2 offset:31744
v_mfma_f32_16x16x32_bf16 v[84:87], v[44:47], a[36:39], v[84:87]
v_mul_f32 v106, v106, v114
v_exp_f32 v243, v243
v_mfma_f32_16x16x32_bf16 v[72:75], v[48:51], a[40:43], v[72:75]
ds_read_b128 v[40:43], v1 offset:0
v_mul_f32 v107, v107, v115
v_exp_f32 v244, v244
v_mfma_f32_16x16x32_bf16 v[76:79], v[48:51], a[44:47], v[76:79]
v_mul_f32 v108, v108, v116
v_exp_f32 v245, v245
v_mfma_f32_16x16x32_bf16 v[80:83], v[52:55], a[40:43], v[80:83]
ds_read_b128 v[44:47], v1 offset:1024
buffer_load_dwordx4 v1, s[4:7], s47 offen offset:2048 sc1 lds
v_mfma_f32_16x16x32_bf16 v[84:87], v[52:55], a[44:47], v[84:87]
v_mul_f32 v109, v109, v117
v_exp_f32 v246, v246
s_waitcnt lgkmcnt(2)
v_mfma_f32_16x16x32_bf16 v[72:75], v[56:59], a[48:51], v[72:75]
ds_read_b128 v[48:51], v1 offset:2048
v_mul_f32 v110, v110, v118
v_exp_f32 v247, v247
v_mfma_f32_16x16x32_bf16 v[76:79], v[56:59], a[52:55], v[76:79]
v_mul_f32 v111, v111, v119
v_fma_f32 v240, v240, v202, v202
v_mfma_f32_16x16x32_bf16 v[80:83], v[60:63], a[48:51], v[80:83]
ds_read_b128 v[52:55], v1 offset:3072
buffer_load_dwordx4 v1, s[4:7], s47 offen offset:3072 sc1 lds
v_mfma_f32_16x16x32_bf16 v[84:87], v[60:63], a[52:55], v[84:87]
v_fma_f32 v241, v241, v202, v202
v_fma_f32 v242, v242, v202, v202
v_fma_f32 v243, v243, v202, v202
v_mfma_f32_16x16x32_bf16 v[72:75], v[64:67], a[56:59], v[72:75]
ds_read_b128 v[56:59], v1 offset:4096
v_fma_f32 v244, v244, v203, v203
v_fma_f32 v245, v245, v203, v203
v_fma_f32 v246, v246, v203, v203
v_mfma_f32_16x16x32_bf16 v[76:79], v[64:67], a[60:63], v[76:79]
v_fma_f32 v247, v247, v203, v203
v_rcp_f32 v240, v240
v_mfma_f32_16x16x32_bf16 v[80:83], v[68:71], a[56:59], v[80:83]
ds_read_b128 v[60:63], v1 offset:5120
s_waitcnt vmcnt(5)
v_cmp_ne_u64 vcc, s[66:67], v[38:39]
s_nop 0
s_cbranch_vccnz LS0_sp10
LS0_ok9:
v_mfma_f32_16x16x32_bf16 v[84:87], v[68:71], a[60:63], v[84:87]
v_rcp_f32 v241, v241
s_waitcnt lgkmcnt(2)
v_mfma_f32_16x16x32_bf16 v[72:75], v[40:43], a[64:67], v[72:75]
ds_read_b128 v[64:67], v1 offset:6144
buffer_load_dwordx4 a[0:3], v1, s[4:7], s76 offen offset:0 sc1
v_mfma_f32_16x16x32_bf16 v[76:79], v[40:43], a[68:71], v[76:79]
v_rcp_f32 v242, v242
v_rcp_f32 v243, v243
v_mfma_f32_16x16x32_bf16 v[80:83], v[44:47], a[64:67], v[80:83]
ds_read_b128 v[68:71], v1 offset:7168
v_mfma_f32_16x16x32_bf16 v[84:87], v[44:47], a[68:71], v[84:87]
ds_write_b128 v12, a[224:227] offset:0
v_mfma_f32_16x16x32_bf16 v[72:75], v[48:51], a[72:75], v[72:75]
ds_read_b128 v[40:43], v1 offset:8192
buffer_load_dwordx4 a[4:7], v1, s[4:7], s80 offen offset:0 sc1
v_mfma_f32_16x16x32_bf16 v[76:79], v[48:51], a[76:79], v[76:79]
v_rcp_f32 v244, v244
v_mfma_f32_16x16x32_bf16 v[80:83], v[52:55], a[72:75], v[80:83]
ds_read_b128 v[44:47], v1 offset:9216
v_mfma_f32_16x16x32_bf16 v[84:87], v[52:55], a[76:79], v[84:87]
ds_write_b128 v12, a[228:231] offset:1024
s_waitcnt lgkmcnt(4)
v_mfma_f32_16x16x32_bf16 v[72:75], v[56:59], a[80:83], v[72:75]
ds_read_b128 v[48:51], v1 offset:10240
buffer_load_dwordx4 a[8:11], v5, s[4:7], s76 offen offset:0 sc1
v_mfma_f32_16x16x32_bf16 v[76:79], v[56:59], a[84:87], v[76:79]
v_rcp_f32 v245, v245
v_rcp_f32 v246, v246
v_mfma_f32_16x16x32_bf16 v[80:83], v[60:63], a[80:83], v[80:83]
ds_read_b128 v[52:55], v1 offset:11264
v_mfma_f32_16x16x32_bf16 v[84:87], v[60:63], a[84:87], v[84:87]
ds_write_b128 v12, a[232:235] offset:2048
v_mfma_f32_16x16x32_bf16 v[72:75], v[64:67], a[88:91], v[72:75]
ds_read_b128 v[56:59], v1 offset:12288
buffer_load_dwordx4 a[12:15], v5, s[4:7], s80 offen offset:0 sc1
v_mfma_f32_16x16x32_bf16 v[76:79], v[64:67], a[92:95], v[76:79]
v_rcp_f32 v247, v247
v_mul_f32 v104, v104, v240
v_mul_f32 v105, v105, v241
v_mfma_f32_16x16x32_bf16 v[80:83], v[68:71], a[88:91], v[80:83]
ds_read_b128 v[60:63], v1 offset:13312
v_mfma_f32_16x16x32_bf16 v[84:87], v[68:71], a[92:95], v[84:87]
ds_write_b128 v12, a[236:239] offset:3072
s_waitcnt lgkmcnt(4)
v_mfma_f32_16x16x32_bf16 v[72:75], v[40:43], a[96:99], v[72:75]
ds_read_b128 v[64:67], v1 offset:14336
buffer_load_dwordx4 a[16:19], v1, s[4:7], s77 offen offset:0 sc1
v_mfma_f32_16x16x32_bf16 v[76:79], v[40:43], a[100:103], v[76:79]
v_mul_f32 v106, v106, v242
v_mul_f32 v107, v107, v243
v_mul_f32 v108, v108, v244
v_mfma_f32_16x16x32_bf16 v[80:83], v[44:47], a[96:99], v[80:83]
s_barrier
ds_read_b128 v[68:71], v1 offset:15360
v_mfma_f32_16x16x32_bf16 v[84:87], v[44:47], a[100:103], v[84:87]
v_mul_f32 v109, v109, v245
v_mul_f32 v110, v110, v246
v_mul_f32 v111, v111, v247
v_mfma_f32_16x16x32_bf16 v[72:75], v[48:51], a[104:107], v[72:75]
ds_read_b128 v[40:43], v8 offset:16384
buffer_load_dwordx4 a[20:23], v1, s[4:7], s81 offen offset:0 sc1
v_mfma_f32_16x16x32_bf16 v[76:79], v[48:51], a[108:111], v[76:79]
v_cvt_pk_bf16_f32 v250, v104, v105
v_cvt_pk_bf16_f32 v251, v106, v107
v_cvt_pk_bf16_f32 v254, v108, v109
v_mfma_f32_16x16x32_bf16 v[80:83], v[52:55], a[104:107], v[80:83]
ds_read_b128 v[44:47], v8 offset:17408
ds_read_b64 v[224:225], v25 offset:1536
ds_read_b64 v[228:229], v25 offset:1664
v_mfma_f32_16x16x32_bf16 v[84:87], v[52:55], a[108:111], v[84:87]
ds_write_b128 v12, a[240:243] offset:16384
s_waitcnt lgkmcnt(5)
v_mfma_f32_16x16x32_bf16 v[72:75], v[56:59], a[112:115], v[72:75]
ds_read_b128 v[48:51], v8 offset:18432
buffer_load_dwordx4 a[24:27], v5, s[4:7], s77 offen offset:0 sc1
v_mfma_f32_16x16x32_bf16 v[76:79], v[56:59], a[116:119], v[76:79]
v_cvt_pk_bf16_f32 v255, v110, v111
v_mfma_f32_16x16x32_bf16 v[80:83], v[60:63], a[112:115], v[80:83]
ds_read_b128 v[52:55], v8 offset:19456
v_mfma_f32_16x16x32_bf16 v[84:87], v[60:63], a[116:119], v[84:87]
ds_write_b128 v12, a[244:247] offset:17408
v_mfma_f32_16x16x32_bf16 v[72:75], v[64:67], a[120:123], v[72:75]
ds_read_b128 v[56:59], v8 offset:20480
buffer_load_dwordx4 a[28:31], v5, s[4:7], s81 offen offset:0 sc1
v_mfma_f32_16x16x32_bf16 v[76:79], v[64:67], a[124:127], v[76:79]
buffer_store_dwordx4 v[248:251], v1, s[4:7], s32 offen offset:2048 sc1
buffer_store_dwordx4 v[252:255], v1, s[4:7], s58 offen offset:2048 sc1
v_mfma_f32_16x16x32_bf16 v[80:83], v[68:71], a[120:123], v[80:83]
ds_read_b128 v[60:63], v8 offset:21504
v_mfma_f32_16x16x32_bf16 v[84:87], v[68:71], a[124:127], v[84:87]
s_waitcnt lgkmcnt(7)
v_mfma_f32_16x16x32_bf16 v[72:75], v[224:227], v[232:235], v[72:75]
v_mfma_f32_16x16x32_bf16 v[76:79], v[224:227], v[236:239], v[76:79]
s_waitcnt lgkmcnt(6)
v_mfma_f32_16x16x32_bf16 v[80:83], v[228:231], v[232:235], v[80:83]
v_mfma_f32_16x16x32_bf16 v[84:87], v[228:231], v[236:239], v[84:87]
s_waitcnt vmcnt(8) lgkmcnt(3)
v_mfma_f32_16x16x32_bf16 v[168:171], v[40:43], a[0:3], v[168:171]
ds_read_b128 v[64:67], v8 offset:22528
v_mfma_f32_16x16x32_bf16 v[176:179], v[40:43], a[4:7], v[176:179]
buffer_load_dwordx4 a[32:35], v1, s[4:7], s78 offen offset:0 sc1
v_mfma_f32_16x16x32_bf16 v[172:175], v[44:47], a[0:3], v[172:175]
ds_read_b128 v[68:71], v8 offset:23552
ds_write_b128 v12, a[248:251] offset:18432
v_mfma_f32_16x16x32_bf16 v[180:183], v[44:47], a[4:7], v[180:183]
v_mul_f32 v240, v200, v72
v_mfma_f32_16x16x32_bf16 v[184:187], v[48:51], a[0:3], 0
ds_read_b128 v[40:43], v8 offset:32768
buffer_load_dwordx4 a[36:39], v1, s[4:7], s82 offen offset:0 sc1
v_mul_f32 v241, v200, v73
v_mfma_f32_16x16x32_bf16 v[192:195], v[48:51], a[4:7], 0
v_mul_f32 v242, v200, v74
v_mul_f32 v243, v200, v75
v_mul_f32 v244, v201, v76
v_mfma_f32_16x16x32_bf16 v[188:191], v[52:55], a[0:3], 0
ds_read_b128 v[44:47], v8 offset:33792
v_mul_f32 v245, v201, v77
v_mul_f32 v246, v201, v78
v_mul_f32 v247, v201, v79
v_mfma_f32_16x16x32_bf16 v[196:199], v[52:55], a[4:7], 0
v_exp_f32 v240, v240
v_mul_f32 v72, v72, v80
s_waitcnt vmcnt(8) lgkmcnt(3)
v_mfma_f32_16x16x32_bf16 v[168:171], v[56:59], a[8:11], v[168:171]
ds_read_b128 v[48:51], v8 offset:34816
buffer_load_dwordx4 a[40:43], v5, s[4:7], s78 offen offset:0 sc1
v_mfma_f32_16x16x32_bf16 v[176:179], v[56:59], a[12:15], v[176:179]
buffer_load_dwordx2 v[38:39], v17, s[4:7], s41 offen offset:512 sc1
v_exp_f32 v241, v241
v_mfma_f32_16x16x32_bf16 v[172:175], v[60:63], a[8:11], v[172:175]
ds_read_b128 v[52:55], v8 offset:35840
ds_write_b128 v12, a[252:255] offset:19456
v_mfma_f32_16x16x32_bf16 v[180:183], v[60:63], a[12:15], v[180:183]
v_mul_f32 v73, v73, v81
v_mfma_f32_16x16x32_bf16 v[184:187], v[64:67], a[8:11], v[184:187]
ds_read_b128 v[56:59], v8 offset:36864
buffer_load_dwordx4 a[44:47], v5, s[4:7], s82 offen offset:0 sc1
v_mfma_f32_16x16x32_bf16 v[192:195], v[64:67], a[12:15], v[192:195]
v_exp_f32 v242, v242
v_mul_f32 v74, v74, v82
v_mfma_f32_16x16x32_bf16 v[188:191], v[68:71], a[8:11], v[188:191]
ds_read_b128 v[60:63], v8 offset:37888
v_exp_f32 v243, v243
v_mul_f32 v75, v75, v83
v_mfma_f32_16x16x32_bf16 v[196:199], v[68:71], a[12:15], v[196:199]
v_exp_f32 v244, v244
v_mul_f32 v76, v76, v84
s_waitcnt vmcnt(9) lgkmcnt(3)
v_mfma_f32_16x16x32_bf16 v[168:171], v[40:43], a[16:19], v[168:171]
ds_read_b128 v[64:67], v8 offset:38912
buffer_load_dwordx4 a[48:51], v1, s[4:7], s79 offen offset:0 sc1
v_exp_f32 v245, v245
v_mfma_f32_16x16x32_bf16 v[176:179], v[40:43], a[20:23], v[176:179]
v_mul_f32 v77, v77, v85
v_exp_f32 v246, v246
v_mfma_f32_16x16x32_bf16 v[172:175], v[44:47], a[16:19], v[172:175]
s_barrier
ds_read_b128 v[68:71], v8 offset:39936
v_mfma_f32_16x16x32_bf16 v[180:183], v[44:47], a[20:23], v[180:183]
v_mul_f32 v78, v78, v86
v_exp_f32 v247, v247
v_mfma_f32_16x16x32_bf16 v[184:187], v[48:51], a[16:19], v[184:187]
ds_read_b128 v[40:43], v8 offset:49152
buffer_load_dwordx4 a[52:55], v1, s[4:7], s83 offen offset:0 sc1
v_mul_f32 v79, v79, v87
v_mfma_f32_16x16x32_bf16 v[192:195], v[48:51], a[20:23], v[192:195]
v_fma_f32 v240, v240, v202, v202
v_fma_f32 v241, v241, v202, v202
v_fma_f32 v242, v242, v202, v202
v_mfma_f32_16x16x32_bf16 v[188:191], v[52:55], a[16:19], v[188:191]
ds_read_b128 v[44:47], v8 offset:50176
s_add_u32 m0, s21, 0
s_add_u32 s47, s20, 131072
v_mfma_f32_16x16x32_bf16 v[196:199], v[52:55], a[20:23], v[196:199]
buffer_load_dwordx4 v1, s[4:7], s47 offen offset:0 sc1 lds
buffer_load_dwordx4 v1, s[4:7], s47 offen offset:1024 sc1 lds
s_waitcnt vmcnt(11) lgkmcnt(2)
v_mfma_f32_16x16x32_bf16 v[168:171], v[56:59], a[24:27], v[168:171]
ds_read_b128 v[48:51], v8 offset:51200
buffer_load_dwordx4 a[56:59], v5, s[4:7], s79 offen offset:0 sc1
v_fma_f32 v243, v243, v202, v202
v_mfma_f32_16x16x32_bf16 v[176:179], v[56:59], a[28:31], v[176:179]
v_fma_f32 v244, v244, v203, v203
v_fma_f32 v245, v245, v203, v203
v_fma_f32 v246, v246, v203, v203
v_mfma_f32_16x16x32_bf16 v[172:175], v[60:63], a[24:27], v[172:175]
ds_read_b128 v[52:55], v8 offset:52224
buffer_load_dwordx4 v1, s[4:7], s47 offen offset:2048 sc1 lds
v_mfma_f32_16x16x32_bf16 v[180:183], v[60:63], a[28:31], v[180:183]
v_fma_f32 v247, v247, v203, v203
v_rcp_f32 v240, v240
v_mfma_f32_16x16x32_bf16 v[184:187], v[64:67], a[24:27], v[184:187]
ds_read_b128 v[56:59], v8 offset:53248
buffer_load_dwordx4 a[60:63], v5, s[4:7], s83 offen offset:0 sc1
v_mfma_f32_16x16x32_bf16 v[192:195], v[64:67], a[28:31], v[192:195]
v_rcp_f32 v241, v241
v_rcp_f32 v242, v242
v_mfma_f32_16x16x32_bf16 v[188:191], v[68:71], a[24:27], v[188:191]
ds_read_b128 v[60:63], v8 offset:54272
s_waitcnt vmcnt(8)
v_cmp_ne_u64 vcc, s[66:67], v[38:39]
s_nop 0
s_cbranch_vccnz LS0_sp12
LS0_ok11:
v_mfma_f32_16x16x32_bf16 v[196:199], v[68:71], a[28:31], v[196:199]
buffer_load_dwordx4 v1, s[4:7], s47 offen offset:3072 sc1 lds
v_rcp_f32 v243, v243
s_waitcnt lgkmcnt(2)
v_mfma_f32_16x16x32_bf16 v[168:171], v[40:43], a[32:35], v[168:171]
ds_read_b128 v[64:67], v8 offset:55296
buffer_load_dwordx4 a[64:67], v1, s[4:7], s76 offen offset:1024 sc1
v_mfma_f32_16x16x32_bf16 v[176:179], v[40:43], a[36:39], v[176:179]
v_rcp_f32 v244, v244
v_rcp_f32 v245, v245
v_mfma_f32_16x16x32_bf16 v[172:175], v[44:47], a[32:35], v[172:175]
ds_read_b128 v[68:71], v8 offset:56320
s_add_u32 m0, s21, 16384
s_add_u32 s47, s20, 147456
buffer_load_dwordx4 v1, s[4:7], s47 offen offset:0 sc1 lds
v_mfma_f32_16x16x32_bf16 v[180:183], v[44:47], a[36:39], v[180:183]
buffer_store_dwordx2 v[36:37], v26, s[4:7], s40 offen offset:1024 sc1
v_mfma_f32_16x16x32_bf16 v[184:187], v[48:51], a[32:35], v[184:187]
ds_read_b128 v[40:43], v9 offset:49152
buffer_load_dwordx4 a[68:71], v1, s[4:7], s80 offen offset:1024 sc1
v_mfma_f32_16x16x32_bf16 v[192:195], v[48:51], a[36:39], v[192:195]
v_rcp_f32 v246, v246
v_rcp_f32 v247, v247
v_mfma_f32_16x16x32_bf16 v[188:191], v[52:55], a[32:35], v[188:191]
ds_read_b128 v[44:47], v9 offset:50176
buffer_load_dwordx4 v1, s[4:7], s47 offen offset:1024 sc1 lds
v_mfma_f32_16x16x32_bf16 v[196:199], v[52:55], a[36:39], v[196:199]
v_mul_f32 v72, v72, v240
v_mul_f32 v73, v73, v241
v_mul_f32 v74, v74, v242
s_waitcnt vmcnt(13) lgkmcnt(2)
v_mfma_f32_16x16x32_bf16 v[168:171], v[56:59], a[40:43], v[168:171]
ds_read_b128 v[48:51], v9 offset:51200
buffer_load_dwordx4 a[72:75], v5, s[4:7], s76 offen offset:1024 sc1
v_mul_f32 v75, v75, v243
v_mfma_f32_16x16x32_bf16 v[176:179], v[56:59], a[44:47], v[176:179]
v_mul_f32 v76, v76, v244
v_mul_f32 v77, v77, v245
v_mul_f32 v78, v78, v246
v_mfma_f32_16x16x32_bf16 v[172:175], v[60:63], a[40:43], v[172:175]
ds_read_b128 v[52:55], v9 offset:52224
buffer_load_dwordx4 v1, s[4:7], s47 offen offset:2048 sc1 lds
v_mul_f32 v79, v79, v247
v_mfma_f32_16x16x32_bf16 v[180:183], v[60:63], a[44:47], v[180:183]
v_bfe_u32 v240, v0, 4, 1
v_mul_u32_u24 v240, 57088, v240
v_bfe_u32 v241, v0, 5, 1
v_mfma_f32_16x16x32_bf16 v[184:187], v[64:67], a[40:43], v[184:187]
ds_read_b128 v[56:59], v9 offset:53248
buffer_load_dwordx4 a[76:79], v5, s[4:7], s80 offen offset:1024 sc1
v_mfma_f32_16x16x32_bf16 v[192:195], v[64:67], a[44:47], v[192:195]
v_mul_u32_u24 v241, 256, v241
v_sub_u32 v240, v240, v241
v_add_u32 v240, v240, v1
v_mfma_f32_16x16x32_bf16 v[188:191], v[68:71], a[40:43], v[188:191]
ds_read_b128 v[60:63], v9 offset:54272
buffer_load_dwordx4 v1, s[4:7], s47 offen offset:3072 sc1 lds
v_mfma_f32_16x16x32_bf16 v[196:199], v[68:71], a[44:47], v[196:199]
s_bitcmp1_b32 s13, 0
s_cselect_b32 s48, -512, 0
s_cselect_b32 s49, 0, 3072
s_add_u32 s48, s48, s49
s_add_u32 s48, s48, s32
s_waitcnt vmcnt(15) lgkmcnt(2)
v_mfma_f32_16x16x32_bf16 v[168:171], v[40:43], a[48:51], v[168:171]
ds_read_b128 v[64:67], v9 offset:55296
buffer_load_dwordx4 a[80:83], v1, s[4:7], s77 offen offset:1024 sc1
v_cvt_pk_bf16_f32 v248, v72, v73
v_mfma_f32_16x16x32_bf16 v[176:179], v[40:43], a[52:55], v[176:179]
v_cvt_pk_bf16_f32 v249, v74, v75
v_cvt_pk_bf16_f32 v250, v76, v77
v_cvt_pk_bf16_f32 v251, v78, v79
v_mfma_f32_16x16x32_bf16 v[172:175], v[44:47], a[48:51], v[172:175]
s_barrier
ds_read_b128 v[68:71], v9 offset:56320
v_permlane16_swap_b32 v248, v250
v_mfma_f32_16x16x32_bf16 v[180:183], v[44:47], a[52:55], v[180:183]
v_permlane16_swap_b32 v249, v251
buffer_store_dwordx4 v[248:251], v240, s[4:7], s48 offen sc1
v_mfma_f32_16x16x32_bf16 v[184:187], v[48:51], a[48:51], v[184:187]
ds_read_b128 v[40:43], v10 offset:0
v_mfma_f32_16x16x32_bf16 v[192:195], v[48:51], a[52:55], v[192:195]
buffer_load_dwordx4 a[84:87], v1, s[4:7], s81 offen offset:1024 sc1
v_mfma_f32_16x16x32_bf16 v[188:191], v[52:55], a[48:51], v[188:191]
ds_read_b128 v[44:47], v10 offset:1024
s_add_u32 m0, s21, 32768
s_add_u32 s47, s20, 163840
v_mfma_f32_16x16x32_bf16 v[196:199], v[52:55], a[52:55], v[196:199]
buffer_load_dwordx4 v1, s[4:7], s47 offen offset:0 sc1 lds
buffer_load_dwordx4 v1, s[4:7], s47 offen offset:1024 sc1 lds
s_waitcnt vmcnt(15) lgkmcnt(2)
v_mfma_f32_16x16x32_bf16 v[168:171], v[56:59], a[56:59], v[168:171]
ds_read_b128 v[48:51], v10 offset:2048
v_mfma_f32_16x16x32_bf16 v[176:179], v[56:59], a[60:63], v[176:179]
buffer_load_dwordx4 a[88:91], v5, s[4:7], s77 offen offset:1024 sc1
v_mfma_f32_16x16x32_bf16 v[172:175], v[60:63], a[56:59], v[172:175]
ds_read_b128 v[52:55], v10 offset:3072
v_mfma_f32_16x16x32_bf16 v[180:183], v[60:63], a[60:63], v[180:183]
buffer_load_dwordx4 v1, s[4:7], s47 offen offset:2048 sc1 lds
v_mfma_f32_16x16x32_bf16 v[184:187], v[64:67], a[56:59], v[184:187]
ds_read_b128 v[56:59], v10 offset:4096
v_mfma_f32_16x16x32_bf16 v[192:195], v[64:67], a[60:63], v[192:195]
buffer_load_dwordx4 a[92:95], v5, s[4:7], s81 offen offset:1024 sc1
v_mfma_f32_16x16x32_bf16 v[188:191], v[68:71], a[56:59], v[188:191]
ds_read_b128 v[60:63], v10 offset:5120
v_mfma_f32_16x16x32_bf16 v[196:199], v[68:71], a[60:63], v[196:199]
buffer_load_dwordx4 v1, s[4:7], s47 offen offset:3072 sc1 lds
s_waitcnt vmcnt(14) lgkmcnt(2)
v_mfma_f32_16x16x32_bf16 v[168:171], v[40:43], a[64:67], v[168:171]
ds_read_b128 v[64:67], v10 offset:6144
v_mfma_f32_16x16x32_bf16 v[176:179], v[40:43], a[68:71], v[176:179]
buffer_load_dwordx4 a[96:99], v1, s[4:7], s78 offen offset:1024 sc1
v_mfma_f32_16x16x32_bf16 v[172:175], v[44:47], a[64:67], v[172:175]
ds_read_b128 v[68:71], v10 offset:7168
s_add_u32 m0, s21, 49152
s_add_u32 s47, s20, 180224
v_mfma_f32_16x16x32_bf16 v[180:183], v[44:47], a[68:71], v[180:183]
buffer_load_dwordx4 v1, s[4:7], s47 offen offset:0 sc1 lds
v_mfma_f32_16x16x32_bf16 v[184:187], v[48:51], a[64:67], v[184:187]
ds_read_b128 v[40:43], v9 offset:32768
v_mfma_f32_16x16x32_bf16 v[192:195], v[48:51], a[68:71], v[192:195]
buffer_load_dwordx4 a[100:103], v1, s[4:7], s82 offen offset:1024 sc1
v_mfma_f32_16x16x32_bf16 v[188:191], v[52:55], a[64:67], v[188:191]
ds_read_b128 v[44:47], v9 offset:33792
v_mfma_f32_16x16x32_bf16 v[196:199], v[52:55], a[68:71], v[196:199]
buffer_load_dwordx4 v1, s[4:7], s47 offen offset:1024 sc1 lds
s_waitcnt vmcnt(14) lgkmcnt(2)
v_mfma_f32_16x16x32_bf16 v[168:171], v[56:59], a[72:75], v[168:171]
ds_read_b128 v[48:51], v9 offset:34816
buffer_load_dwordx4 a[104:107], v5, s[4:7], s78 offen offset:1024 sc1
v_mfma_f32_16x16x32_bf16 v[176:179], v[56:59], a[76:79], v[176:179]
buffer_load_dwordx2 v[38:39], v17, s[4:7], s41 offen offset:1024 sc1
v_mfma_f32_16x16x32_bf16 v[172:175], v[60:63], a[72:75], v[172:175]
ds_read_b128 v[52:55], v9 offset:35840
v_mfma_f32_16x16x32_bf16 v[180:183], v[60:63], a[76:79], v[180:183]
buffer_load_dwordx4 v1, s[4:7], s47 offen offset:2048 sc1 lds
v_mfma_f32_16x16x32_bf16 v[184:187], v[64:67], a[72:75], v[184:187]
ds_read_b128 v[56:59], v9 offset:36864
v_mfma_f32_16x16x32_bf16 v[192:195], v[64:67], a[76:79], v[192:195]
buffer_load_dwordx4 a[108:111], v5, s[4:7], s82 offen offset:1024 sc1
v_mfma_f32_16x16x32_bf16 v[188:191], v[68:71], a[72:75], v[188:191]
ds_read_b128 v[60:63], v9 offset:37888
v_mfma_f32_16x16x32_bf16 v[196:199], v[68:71], a[76:79], v[196:199]
buffer_load_dwordx4 v1, s[4:7], s47 offen offset:3072 sc1 lds
s_waitcnt vmcnt(15) lgkmcnt(2)
v_mfma_f32_16x16x32_bf16 v[168:171], v[40:43], a[80:83], v[168:171]
ds_read_b128 v[64:67], v9 offset:38912
v_mfma_f32_16x16x32_bf16 v[176:179], v[40:43], a[84:87], v[176:179]
buffer_load_dwordx4 a[112:115], v1, s[4:7], s79 offen offset:1024 sc1
v_mfma_f32_16x16x32_bf16 v[172:175], v[44:47], a[80:83], v[172:175]
s_barrier
v_mfma_f32_16x16x32_bf16 v[180:183], v[44:47], a[84:87], v[180:183]
ds_read_b128 v[68:71], v9 offset:39936
v_mfma_f32_16x16x32_bf16 v[184:187], v[48:51], a[80:83], v[184:187]
ds_read_b128 v[40:43], v9 offset:0
v_mfma_f32_16x16x32_bf16 v[192:195], v[48:51], a[84:87], v[192:195]
buffer_load_dwordx4 a[116:119], v1, s[4:7], s83 offen offset:1024 sc1
v_mfma_f32_16x16x32_bf16 v[188:191], v[52:55], a[80:83], v[188:191]
ds_read_b128 v[44:47], v9 offset:1024
s_add_u32 m0, s21, 114688
s_add_u32 s47, s20, 196608
v_mfma_f32_16x16x32_bf16 v[196:199], v[52:55], a[84:87], v[196:199]
buffer_load_dwordx4 v1, s[4:7], s47 offen offset:0 sc1 lds
buffer_load_dwordx4 v1, s[4:7], s47 offen offset:1024 sc1 lds
s_waitcnt vmcnt(14) lgkmcnt(2)
v_mfma_f32_16x16x32_bf16 v[168:171], v[56:59], a[88:91], v[168:171]
ds_read_b128 v[48:51], v9 offset:2048
v_mfma_f32_16x16x32_bf16 v[176:179], v[56:59], a[92:95], v[176:179]
buffer_load_dwordx4 a[120:123], v5, s[4:7], s79 offen offset:1024 sc1
v_mfma_f32_16x16x32_bf16 v[172:175], v[60:63], a[88:91], v[172:175]
ds_read_b128 v[52:55], v9 offset:3072
v_mfma_f32_16x16x32_bf16 v[180:183], v[60:63], a[92:95], v[180:183]
buffer_load_dwordx4 v1, s[4:7], s47 offen offset:2048 sc1 lds
v_mfma_f32_16x16x32_bf16 v[184:187], v[64:67], a[88:91], v[184:187]
ds_read_b128 v[56:59], v9 offset:4096
v_mfma_f32_16x16x32_bf16 v[192:195], v[64:67], a[92:95], v[192:195]
buffer_load_dwordx4 a[124:127], v5, s[4:7], s83 offen offset:1024 sc1
v_mfma_f32_16x16x32_bf16 v[188:191], v[68:71], a[88:91], v[188:191]
ds_read_b128 v[60:63], v9 offset:5120
s_waitcnt vmcnt(10)
v_cmp_ne_u64 vcc, s[66:67], v[38:39]
s_nop 0
s_cbranch_vccnz LS0_sp14
LS0_ok13:
v_mfma_f32_16x16x32_bf16 v[196:199], v[68:71], a[92:95], v[196:199]
buffer_load_dwordx4 v1, s[4:7], s47 offen offset:3072 sc1 lds
s_waitcnt lgkmcnt(2)
v_mfma_f32_16x16x32_bf16 v[168:171], v[40:43], a[96:99], v[168:171]
ds_read_b128 v[64:67], v9 offset:6144
buffer_load_dwordx4 a[0:3], v1, s[4:7], s76 offen offset:2048 sc1
v_mfma_f32_16x16x32_bf16 v[176:179], v[40:43], a[100:103], v[176:179]
buffer_store_dwordx2 v[36:37], v26, s[4:7], s40 offen offset:1536 sc1
v_mfma_f32_16x16x32_bf16 v[172:175], v[44:47], a[96:99], v[172:175]
ds_read_b128 v[68:71], v9 offset:7168
s_add_u32 m0, s21, 131072
s_add_u32 s47, s20, 212992
v_mfma_f32_16x16x32_bf16 v[180:183], v[44:47], a[100:103], v[180:183]
buffer_load_dwordx4 v1, s[4:7], s47 offen offset:0 sc1 lds
v_mfma_f32_16x16x32_bf16 v[184:187], v[48:51], a[96:99], v[184:187]
ds_read_b128 v[40:43], v9 offset:16384
v_mfma_f32_16x16x32_bf16 v[192:195], v[48:51], a[100:103], v[192:195]
buffer_load_dwordx4 a[4:7], v1, s[4:7], s80 offen offset:2048 sc1
v_mfma_f32_16x16x32_bf16 v[188:191], v[52:55], a[96:99], v[188:191]
ds_read_b128 v[44:47], v9 offset:17408
v_mfma_f32_16x16x32_bf16 v[196:199], v[52:55], a[100:103], v[196:199]
buffer_load_dwordx4 v1, s[4:7], s47 offen offset:1024 sc1 lds
s_waitcnt vmcnt(14) lgkmcnt(2)
v_mfma_f32_16x16x32_bf16 v[168:171], v[56:59], a[104:107], v[168:171]
ds_read_b128 v[48:51], v9 offset:18432
buffer_load_dwordx4 a[8:11], v5, s[4:7], s76 offen offset:2048 sc1
s_lshl_b32 s51, s14, 10
v_mfma_f32_16x16x32_bf16 v[176:179], v[56:59], a[108:111], v[176:179]
v_add_u32 v208, s51, v1
v_add_u32 v209, s51, v2
v_add_u32 v210, s51, v3
v_mfma_f32_16x16x32_bf16 v[172:175], v[60:63], a[104:107], v[172:175]
ds_read_b128 v[52:55], v9 offset:19456
v_mfma_f32_16x16x32_bf16 v[180:183], v[60:63], a[108:111], v[180:183]
buffer_load_dwordx4 v1, s[4:7], s47 offen offset:2048 sc1 lds
v_mfma_f32_16x16x32_bf16 v[184:187], v[64:67], a[104:107], v[184:187]
ds_read_b128 v[56:59], v9 offset:20480
v_mfma_f32_16x16x32_bf16 v[192:195], v[64:67], a[108:111], v[192:195]
buffer_load_dwordx4 a[12:15], v5, s[4:7], s80 offen offset:2048 sc1
v_mfma_f32_16x16x32_bf16 v[188:191], v[68:71], a[104:107], v[188:191]
ds_read_b128 v[60:63], v9 offset:21504
v_mfma_f32_16x16x32_bf16 v[196:199], v[68:71], a[108:111], v[196:199]
buffer_load_dwordx4 v1, s[4:7], s47 offen offset:3072 sc1 lds
s_waitcnt vmcnt(15) lgkmcnt(2)
v_mfma_f32_16x16x32_bf16 v[168:171], v[40:43], a[112:115], v[168:171]
ds_read_b128 v[64:67], v9 offset:22528
v_mfma_f32_16x16x32_bf16 v[176:179], v[40:43], a[116:119], v[176:179]
buffer_load_dwordx4 a[16:19], v1, s[4:7], s77 offen offset:2048 sc1
v_mfma_f32_16x16x32_bf16 v[172:175], v[44:47], a[112:115], v[172:175]
s_barrier
v_mfma_f32_16x16x32_bf16 v[180:183], v[44:47], a[116:119], v[180:183]
ds_read_b128 v[68:71], v9 offset:23552
v_mfma_f32_16x16x32_bf16 v[184:187], v[48:51], a[112:115], v[184:187]
ds_read_b128 v[40:43], v8 offset:0
v_mfma_f32_16x16x32_bf16 v[192:195], v[48:51], a[116:119], v[192:195]
buffer_load_dwordx4 a[20:23], v1, s[4:7], s81 offen offset:2048 sc1
v_mfma_f32_16x16x32_bf16 v[188:191], v[52:55], a[112:115], v[188:191]
ds_read_b128 v[44:47], v8 offset:1024
ds_write_b128 v209, a[128:131] offset:32768
v_mfma_f32_16x16x32_bf16 v[196:199], v[52:55], a[116:119], v[196:199]
ds_write_b128 v209, a[132:135] offset:36864
s_waitcnt vmcnt(12) lgkmcnt(4)
v_mfma_f32_16x16x32_bf16 v[168:171], v[56:59], a[120:123], v[168:171]
ds_read_b128 v[48:51], v8 offset:2048
v_mfma_f32_16x16x32_bf16 v[176:179], v[56:59], a[124:127], v[176:179]
buffer_load_dwordx4 a[24:27], v5, s[4:7], s77 offen offset:2048 sc1
v_mfma_f32_16x16x32_bf16 v[172:175], v[60:63], a[120:123], v[172:175]
ds_read_b128 v[52:55], v8 offset:3072
ds_write_b128 v209, a[136:139] offset:40960
v_mfma_f32_16x16x32_bf16 v[180:183], v[60:63], a[124:127], v[180:183]
v_lshrrev_b32 v25, 4, v0
v_and_b32 v25, 3, v25
s_lshl_b32 s51, s14, 9
v_mfma_f32_16x16x32_bf16 v[184:187], v[64:67], a[120:123], v[184:187]
ds_read_b128 v[56:59], v8 offset:4096
v_mfma_f32_16x16x32_bf16 v[192:195], v[64:67], a[124:127], v[192:195]
buffer_load_dwordx4 a[28:31], v5, s[4:7], s81 offen offset:2048 sc1
v_mfma_f32_16x16x32_bf16 v[188:191], v[68:71], a[120:123], v[188:191]
ds_read_b128 v[60:63], v8 offset:5120
ds_write_b128 v209, a[140:143] offset:45056
v_mfma_f32_16x16x32_bf16 v[196:199], v[68:71], a[124:127], v[196:199]
s_add_u32 s51, s51, 157696
v_lshl_add_u32 v25, v25, 4, s51
s_waitcnt vmcnt(9) lgkmcnt(4)
v_mfma_f32_16x16x32_bf16 v[168:171], v[40:43], a[0:3], v[168:171]
ds_read_b128 v[64:67], v8 offset:6144
v_mfma_f32_16x16x32_bf16 v[176:179], v[40:43], a[4:7], v[176:179]
buffer_load_dwordx4 a[32:35], v1, s[4:7], s78 offen offset:2048 sc1
v_mfma_f32_16x16x32_bf16 v[172:175], v[44:47], a[0:3], v[172:175]
ds_read_b128 v[68:71], v8 offset:7168
v_mfma_f32_16x16x32_bf16 v[180:183], v[44:47], a[4:7], v[180:183]
ds_write_b128 v209, a[144:147] offset:0
v_mfma_f32_16x16x32_bf16 v[184:187], v[48:51], a[0:3], v[184:187]
ds_read_b128 v[40:43], v8 offset:16384
v_mfma_f32_16x16x32_bf16 v[192:195], v[48:51], a[4:7], v[192:195]
buffer_load_dwordx4 a[36:39], v1, s[4:7], s82 offen offset:2048 sc1
v_mfma_f32_16x16x32_bf16 v[188:191], v[52:55], a[0:3], v[188:191]
ds_read_b128 v[44:47], v8 offset:17408
v_mfma_f32_16x16x32_bf16 v[196:199], v[52:55], a[4:7], v[196:199]
ds_write_b128 v209, a[148:151] offset:4096
s_waitcnt vmcnt(7) lgkmcnt(4)
v_mfma_f32_16x16x32_bf16 v[168:171], v[56:59], a[8:11], v[168:171]
ds_read_b128 v[48:51], v8 offset:18432
buffer_load_dwordx4 a[40:43], v5, s[4:7], s78 offen offset:2048 sc1
v_mfma_f32_16x16x32_bf16 v[176:179], v[56:59], a[12:15], v[176:179]
buffer_load_dwordx2 v[38:39], v17, s[4:7], s41 offen offset:1536 sc1
v_mfma_f32_16x16x32_bf16 v[172:175], v[60:63], a[8:11], v[172:175]
ds_read_b128 v[52:55], v8 offset:19456
v_mfma_f32_16x16x32_bf16 v[180:183], v[60:63], a[12:15], v[180:183]
ds_write_b128 v209, a[152:155] offset:8192
v_mfma_f32_16x16x32_bf16 v[184:187], v[64:67], a[8:11], v[184:187]
ds_read_b128 v[56:59], v8 offset:20480
v_mfma_f32_16x16x32_bf16 v[192:195], v[64:67], a[12:15], v[192:195]
buffer_load_dwordx4 a[44:47], v5, s[4:7], s82 offen offset:2048 sc1
v_mfma_f32_16x16x32_bf16 v[188:191], v[68:71], a[8:11], v[188:191]
ds_read_b128 v[60:63], v8 offset:21504
v_mfma_f32_16x16x32_bf16 v[196:199], v[68:71], a[12:15], v[196:199]
ds_write_b128 v209, a[156:159] offset:12288
s_waitcnt vmcnt(7) lgkmcnt(4)
v_mfma_f32_16x16x32_bf16 v[168:171], v[40:43], a[16:19], v[168:171]
ds_read_b128 v[64:67], v8 offset:22528
v_mfma_f32_16x16x32_bf16 v[176:179], v[40:43], a[20:23], v[176:179]
buffer_load_dwordx4 a[48:51], v1, s[4:7], s79 offen offset:2048 sc1
v_mfma_f32_16x16x32_bf16 v[172:175], v[44:47], a[16:19], v[172:175]
s_barrier
v_mfma_f32_16x16x32_bf16 v[180:183], v[44:47], a[20:23], v[180:183]
ds_read_b128 v[68:71], v8 offset:23552
v_mfma_f32_16x16x32_bf16 v[184:187], v[48:51], a[16:19], v[184:187]
ds_read_b128 v[40:43], v8 offset:32768
v_mfma_f32_16x16x32_bf16 v[192:195], v[48:51], a[20:23], v[192:195]
buffer_load_dwordx4 a[52:55], v1, s[4:7], s83 offen offset:2048 sc1
v_mfma_f32_16x16x32_bf16 v[188:191], v[52:55], a[16:19], v[188:191]
ds_read_b128 v[44:47], v8 offset:33792
ds_write_b128 v209, a[160:163] offset:16384
v_mfma_f32_16x16x32_bf16 v[196:199], v[52:55], a[20:23], v[196:199]
ds_write_b128 v209, a[164:167] offset:20480
s_waitcnt vmcnt(7) lgkmcnt(4)
v_mfma_f32_16x16x32_bf16 v[168:171], v[56:59], a[24:27], v[168:171]
ds_read_b128 v[48:51], v8 offset:34816
v_mfma_f32_16x16x32_bf16 v[176:179], v[56:59], a[28:31], v[176:179]
buffer_load_dwordx4 a[56:59], v5, s[4:7], s79 offen offset:2048 sc1
v_mfma_f32_16x16x32_bf16 v[172:175], v[60:63], a[24:27], v[172:175]
ds_read_b128 v[52:55], v8 offset:35840
v_mfma_f32_16x16x32_bf16 v[180:183], v[60:63], a[28:31], v[180:183]
ds_write_b128 v209, a[168:171] offset:24576
v_mfma_f32_16x16x32_bf16 v[184:187], v[64:67], a[24:27], v[184:187]
ds_read_b128 v[56:59], v8 offset:36864
v_mfma_f32_16x16x32_bf16 v[192:195], v[64:67], a[28:31], v[192:195]
buffer_load_dwordx4 a[60:63], v5, s[4:7], s83 offen offset:2048 sc1
v_mfma_f32_16x16x32_bf16 v[188:191], v[68:71], a[24:27], v[188:191]
ds_read_b128 v[60:63], v8 offset:37888
s_waitcnt vmcnt(5)
v_cmp_ne_u64 vcc, s[66:67], v[38:39]
s_nop 0
s_cbranch_vccnz LS0_sp16
LS0_ok15:
v_mfma_f32_16x16x32_bf16 v[196:199], v[68:71], a[28:31], v[196:199]
ds_write_b128 v209, a[172:175] offset:28672
s_waitcnt lgkmcnt(4)
v_mfma_f32_16x16x32_bf16 v[168:171], v[40:43], a[32:35], v[168:171]
ds_read_b128 v[64:67], v8 offset:38912
v_mfma_f32_16x16x32_bf16 v[176:179], v[40:43], a[36:39], v[176:179]
buffer_load_dwordx4 a[64:67], v1, s[4:7], s76 offen offset:3072 sc1
v_mfma_f32_16x16x32_bf16 v[172:175], v[44:47], a[32:35], v[172:175]
ds_read_b128 v[68:71], v8 offset:39936
v_mfma_f32_16x16x32_bf16 v[180:183], v[44:47], a[36:39], v[180:183]
ds_write_b128 v208, a[176:179] offset:0
v_mfma_f32_16x16x32_bf16 v[184:187], v[48:51], a[32:35], v[184:187]
ds_read_b128 v[40:43], v8 offset:49152
v_mfma_f32_16x16x32_bf16 v[192:195], v[48:51], a[36:39], v[192:195]
buffer_load_dwordx4 a[68:71], v1, s[4:7], s80 offen offset:3072 sc1
v_mfma_f32_16x16x32_bf16 v[188:191], v[52:55], a[32:35], v[188:191]
ds_read_b128 v[44:47], v8 offset:50176
v_mfma_f32_16x16x32_bf16 v[196:199], v[52:55], a[36:39], v[196:199]
ds_write_b128 v208, a[180:183] offset:4096
s_waitcnt vmcnt(6) lgkmcnt(4)
v_mfma_f32_16x16x32_bf16 v[168:171], v[56:59], a[40:43], v[168:171]
ds_read_b128 v[48:51], v8 offset:51200
v_mfma_f32_16x16x32_bf16 v[176:179], v[56:59], a[44:47], v[176:179]
buffer_load_dwordx4 a[72:75], v1, s[4:7], s77 offen offset:3072 sc1
v_mfma_f32_16x16x32_bf16 v[172:175], v[60:63], a[40:43], v[172:175]
ds_read_b128 v[52:55], v8 offset:52224
v_mfma_f32_16x16x32_bf16 v[180:183], v[60:63], a[44:47], v[180:183]
ds_write_b128 v208, a[184:187] offset:8192
v_mfma_f32_16x16x32_bf16 v[184:187], v[64:67], a[40:43], v[184:187]
ds_read_b128 v[56:59], v8 offset:53248
v_mfma_f32_16x16x32_bf16 v[192:195], v[64:67], a[44:47], v[192:195]
buffer_load_dwordx4 a[76:79], v1, s[4:7], s81 offen offset:3072 sc1
v_mfma_f32_16x16x32_bf16 v[188:191], v[68:71], a[40:43], v[188:191]
ds_read_b128 v[60:63], v8 offset:54272
v_mfma_f32_16x16x32_bf16 v[196:199], v[68:71], a[44:47], v[196:199]
ds_write_b128 v208, a[188:191] offset:12288
s_waitcnt vmcnt(6) lgkmcnt(4)
v_mfma_f32_16x16x32_bf16 v[168:171], v[40:43], a[48:51], v[168:171]
ds_read_b128 v[64:67], v8 offset:55296
v_mfma_f32_16x16x32_bf16 v[176:179], v[40:43], a[52:55], v[176:179]
buffer_load_dwordx4 a[80:83], v1, s[4:7], s78 offen offset:3072 sc1
v_mfma_f32_16x16x32_bf16 v[172:175], v[44:47], a[48:51], v[172:175]
s_barrier
v_mfma_f32_16x16x32_bf16 v[180:183], v[44:47], a[52:55], v[180:183]
ds_read_b128 v[68:71], v8 offset:56320
v_mfma_f32_16x16x32_bf16 v[184:187], v[48:51], a[48:51], v[184:187]
ds_read_b128 v[40:43], v9 offset:49152
v_mfma_f32_16x16x32_bf16 v[192:195], v[48:51], a[52:55], v[192:195]
buffer_load_dwordx4 a[84:87], v1, s[4:7], s82 offen offset:3072 sc1
v_mfma_f32_16x16x32_bf16 v[188:191], v[52:55], a[48:51], v[188:191]
ds_read_b128 v[44:47], v9 offset:50176
ds_write_b128 v208, a[192:195] offset:16384
v_mfma_f32_16x16x32_bf16 v[196:199], v[52:55], a[52:55], v[196:199]
ds_write_b128 v208, a[196:199] offset:20480
s_waitcnt vmcnt(6) lgkmcnt(4)
v_mfma_f32_16x16x32_bf16 v[168:171], v[56:59], a[56:59], v[168:171]
ds_read_b128 v[48:51], v9 offset:51200
v_mfma_f32_16x16x32_bf16 v[176:179], v[56:59], a[60:63], v[176:179]
buffer_load_dwordx4 a[88:91], v1, s[4:7], s79 offen offset:3072 sc1
v_mfma_f32_16x16x32_bf16 v[172:175], v[60:63], a[56:59], v[172:175]
ds_read_b128 v[52:55], v9 offset:52224
v_mfma_f32_16x16x32_bf16 v[180:183], v[60:63], a[60:63], v[180:183]
ds_write_b128 v208, a[200:203] offset:24576
v_mfma_f32_16x16x32_bf16 v[184:187], v[64:67], a[56:59], v[184:187]
ds_read_b128 v[56:59], v9 offset:53248
v_mfma_f32_16x16x32_bf16 v[192:195], v[64:67], a[60:63], v[192:195]
buffer_load_dwordx4 a[92:95], v1, s[4:7], s83 offen offset:3072 sc1
v_mfma_f32_16x16x32_bf16 v[188:191], v[68:71], a[56:59], v[188:191]
ds_read_b128 v[60:63], v9 offset:54272
v_mfma_f32_16x16x32_bf16 v[196:199], v[68:71], a[60:63], v[196:199]
ds_write_b128 v208, a[204:207] offset:28672
s_waitcnt vmcnt(6) lgkmcnt(4)
v_mfma_f32_16x16x32_bf16 v[168:171], v[40:43], a[64:67], v[168:171]
ds_read_b128 v[64:67], v9 offset:55296
v_mfma_f32_16x16x32_bf16 v[176:179], v[40:43], a[68:71], v[176:179]
v_mfma_f32_16x16x32_bf16 v[172:175], v[44:47], a[64:67], v[172:175]
ds_read_b128 v[68:71], v9 offset:56320
v_mfma_f32_16x16x32_bf16 v[180:183], v[44:47], a[68:71], v[180:183]
ds_write_b128 v208, a[208:211] offset:32768
v_mfma_f32_16x16x32_bf16 v[184:187], v[48:51], a[64:67], v[184:187]
ds_read_b128 v[40:43], v10 offset:0
v_mfma_f32_16x16x32_bf16 v[192:195], v[48:51], a[68:71], v[192:195]
v_mfma_f32_16x16x32_bf16 v[188:191], v[52:55], a[64:67], v[188:191]
ds_read_b128 v[44:47], v10 offset:1024
v_mfma_f32_16x16x32_bf16 v[196:199], v[52:55], a[68:71], v[196:199]
ds_write_b128 v208, a[212:215] offset:36864
s_waitcnt vmcnt(4) lgkmcnt(4)
v_mfma_f32_16x16x32_bf16 v[168:171], v[56:59], a[72:75], v[168:171]
ds_read_b128 v[48:51], v10 offset:2048
v_mfma_f32_16x16x32_bf16 v[176:179], v[56:59], a[76:79], v[176:179]
v_mfma_f32_16x16x32_bf16 v[172:175], v[60:63], a[72:75], v[172:175]
ds_read_b128 v[52:55], v10 offset:3072
v_mfma_f32_16x16x32_bf16 v[180:183], v[60:63], a[76:79], v[180:183]
ds_write_b128 v208, a[216:219] offset:40960
v_mfma_f32_16x16x32_bf16 v[184:187], v[64:67], a[72:75], v[184:187]
ds_read_b128 v[56:59], v10 offset:4096
v_mfma_f32_16x16x32_bf16 v[192:195], v[64:67], a[76:79], v[192:195]
v_mfma_f32_16x16x32_bf16 v[188:191], v[68:71], a[72:75], v[188:191]
ds_read_b128 v[60:63], v10 offset:5120
v_mfma_f32_16x16x32_bf16 v[196:199], v[68:71], a[76:79], v[196:199]
ds_write_b128 v208, a[220:223] offset:45056
s_waitcnt vmcnt(2) lgkmcnt(4)
ds_read_b128 v[64:67], v10 offset:6144
ds_read_b128 v[68:71], v10 offset:7168
v_mfma_f32_16x16x32_bf16 v[184:187], v[48:51], a[80:83], v[184:187]
v_mfma_f32_16x16x32_bf16 v[192:195], v[48:51], a[84:87], v[192:195]
v_mfma_f32_16x16x32_bf16 v[188:191], v[52:55], a[80:83], v[188:191]
v_mfma_f32_16x16x32_bf16 v[196:199], v[52:55], a[84:87], v[196:199]
s_waitcnt vmcnt(1) lgkmcnt(1)
v_mfma_f32_16x16x32_bf16 v[184:187], v[64:67], a[88:91], v[184:187]
s_waitcnt vmcnt(0)
v_mfma_f32_16x16x32_bf16 v[192:195], v[64:67], a[92:95], v[192:195]
s_waitcnt lgkmcnt(0)
v_mfma_f32_16x16x32_bf16 v[188:191], v[68:71], a[88:91], v[188:191]
v_mfma_f32_16x16x32_bf16 v[196:199], v[68:71], a[92:95], v[196:199]
v_mfma_f32_16x16x32_bf16 v[168:171], v[40:43], a[80:83], v[168:171]
v_mfma_f32_16x16x32_bf16 v[176:179], v[40:43], a[84:87], v[176:179]
v_mfma_f32_16x16x32_bf16 v[172:175], v[44:47], a[80:83], v[172:175]
v_mfma_f32_16x16x32_bf16 v[180:183], v[44:47], a[84:87], v[180:183]
ds_write_b128 v18, v[184:187] offset:0
v_mfma_f32_16x16x32_bf16 v[168:171], v[56:59], a[88:91], v[168:171]
s_nop 0
ds_write_b128 v18, v[188:191] offset:1024
v_mfma_f32_16x16x32_bf16 v[176:179], v[56:59], a[92:95], v[176:179]
ds_write_b128 v18, v[192:195] offset:2048
v_mfma_f32_16x16x32_bf16 v[172:175], v[60:63], a[88:91], v[172:175]
ds_write_b128 v18, v[196:199] offset:3072
v_mfma_f32_16x16x32_bf16 v[180:183], v[60:63], a[92:95], v[180:183]
s_waitcnt lgkmcnt(0)
s_barrier
ds_read_b128 v[224:227], v19 offset:0
ds_read_b128 v[228:231], v19 offset:1024
ds_read_b128 v[232:235], v19 offset:2048
ds_read_b128 v[236:239], v19 offset:3072
s_waitcnt lgkmcnt(3)
v_pk_add_f32 v[168:169], v[168:169], v[224:225]
v_pk_add_f32 v[170:171], v[170:171], v[226:227]
s_waitcnt lgkmcnt(2)
v_pk_add_f32 v[172:173], v[172:173], v[228:229]
v_pk_add_f32 v[174:175], v[174:175], v[230:231]
s_waitcnt lgkmcnt(1)
v_pk_add_f32 v[176:177], v[176:177], v[232:233]
v_pk_add_f32 v[178:179], v[178:179], v[234:235]
s_waitcnt lgkmcnt(0)
v_pk_add_f32 v[180:181], v[180:181], v[236:237]
v_pk_add_f32 v[182:183], v[182:183], v[238:239]
v_cvt_pk_bf16_f32 v124, v168, v169
v_cvt_pk_bf16_f32 v125, v170, v171
v_cvt_pk_bf16_f32 v126, v172, v173
v_cvt_pk_bf16_f32 v127, v174, v175
v_cvt_pk_bf16_f32 v128, v176, v177
v_cvt_pk_bf16_f32 v129, v178, v179
v_cvt_pk_bf16_f32 v130, v180, v181
v_cvt_pk_bf16_f32 v131, v182, v183
s_add_u32 s49, s35, 524288
buffer_store_dwordx4 v[124:127], v1, s[4:7], s34 offen sc1
buffer_store_dwordx4 v[128:131], v4, s[4:7], s34 offen sc1
v_pk_mul_f32 v[226:227], v[168:169], v[168:169]
v_pk_add_f32 v[224:225], v[168:169], v[170:171]
v_pk_mul_f32 v[230:231], v[176:177], v[176:177]
v_pk_add_f32 v[228:229], v[176:177], v[178:179]
v_pk_fma_f32 v[226:227], v[170:171], v[170:171], v[226:227]
v_pk_fma_f32 v[230:231], v[178:179], v[178:179], v[230:231]
v_pk_fma_f32 v[226:227], v[172:173], v[172:173], v[226:227]
v_pk_add_f32 v[224:225], v[224:225], v[172:173]
v_pk_fma_f32 v[230:231], v[180:181], v[180:181], v[230:231]
v_pk_add_f32 v[228:229], v[228:229], v[180:181]
v_pk_fma_f32 v[226:227], v[174:175], v[174:175], v[226:227]
v_pk_add_f32 v[224:225], v[224:225], v[174:175]
v_pk_fma_f32 v[230:231], v[182:183], v[182:183], v[230:231]
v_pk_add_f32 v[228:229], v[228:229], v[182:183]
v_add_f32 v224, v224, v225
v_add_f32 v226, v226, v227
v_add_f32 v228, v228, v229
v_add_f32 v230, v230, v231
v_permlane32_swap_b32 v224, v226
s_nop 0
v_permlane32_swap_b32 v228, v230
v_add_f32 v224, v224, v226
v_add_f32 v228, v228, v230
s_nop 1
v_permlane16_swap_b32 v224, v228
v_add_f32 v224, v224, v228
buffer_store_dword v224, v7, s[4:7], s35 offen sc1
s_waitcnt vmcnt(0)
buffer_store_dwordx2 v[36:37], v26, s[4:7], s42 offen offset:0 sc1
s_cmp_eq_u32 s53, 0
s_cbranch_scc1 LS0_c17
buffer_store_dword v224, v7, s[4:7], s49 offen sc1
s_waitcnt vmcnt(0)
buffer_store_dwordx2 v[36:37], v26, s[4:7], s44 offen sc1
LS0_c17:
s_add_u32 s23, s31, -262144
s_lshl_b32 s48, s13, 10
s_add_u32 s26, s30, s48
s_add_u32 s26, s26, -2097152
s_add_u32 s36, s40, -4096
s_add_u32 s48, s12, 15
s_and_b32 s48, s48, 15
s_lshl_b32 s48, s48, 14
s_add_u32 s25, s48, 15216640
v_add_u32 v20, 2048, v22
s_lshl_b32 s48, s16, 10
s_lshl_b32 s49, s15, 3
s_add_u32 s48, s48, s49
s_add_u32 s48, s48, 147456
v_add_u32 v21, s48, v1
s_and_b32 s48, s12, 7
s_or_b32 s48, s48, s14
s_cmp_eq_u32 s48, 0
s_cselect_b64 vcc, -1, 0
v_mov_b32 v232, 0xf149f2ca
v_cndmask_b32 v140, v136, v232, vcc
v_cndmask_b32 v141, v137, v232, vcc
v_cndmask_b32 v142, v138, v232, vcc
v_cndmask_b32 v143, v139, v232, vcc
s_cmp_lg_u32 s16, 0
s_cselect_b64 vcc, -1, 0
v_cndmask_b32 v232, v34, v35, vcc
v_cndmask_b32 v160, v152, v156, vcc
v_cndmask_b32 v161, v153, v157, vcc
v_cndmask_b32 v162, v154, v158, vcc
v_cndmask_b32 v163, v155, v159, vcc
s_cmp_lg_u32 s15, 0
s_cselect_b64 vcc, -1, 0
v_cndmask_b32 v160, v160, v232, vcc
v_cndmask_b32 v161, v161, v232, vcc
v_cndmask_b32 v162, v162, v232, vcc
v_cndmask_b32 v163, v163, v232, vcc
s_add_u32 s22, s22, 16777216
s_add_u32 s23, s23, 16777216
s_add_u32 s24, s24, 16777216
s_add_u32 s25, s25, 16777216
s_add_u32 s26, s26, 16777216
s_add_u32 s27, s27, 16777216
s_add_u32 s28, s28, 16777216
s_add_u32 s29, s29, 16777216
s_add_u32 s30, s30, 16777216
s_add_u32 s31, s31, 16777216
s_add_u32 s32, s32, 16777216
s_add_u32 s33, s33, 16777216
s_add_u32 s40, s40, 2560
s_add_u32 s41, s41, 2560
LS1_top:
s_cmp_eq_u32 s15, 0
s_mov_b32 s48, 81920
s_cselect_b32 s48, s48, 0
s_mov_b32 s49, 16384
s_cselect_b32 s49, s49, 32768
s_cmp_eq_u32 s16, 0
s_cselect_b32 s48, s48, s49
s_cmp_eq_u32 s15, 0
s_cselect_b32 s49, s48, 131072
s_cselect_b32 s48, 131072, s48
v_add_u32 v14, s49, v1
v_add_u32 v15, s48, v1
buffer_load_dwordx2 v[38:39], v16, s[4:7], s43 offen offset:0 sc1
buffer_load_dwordx2 v[252:253], v16, s[4:7], s43 offen offset:0 sc1
s_waitcnt vmcnt(1)
v_cmp_ne_u64 vcc, s[66:67], v[38:39]
s_nop 0
s_cbranch_vccnz LS1_sp2
LS1_ok1:
s_add_u32 s48, s22, 0
buffer_load_dwordx4 a[0:3], v1, s[4:7], s48 offen offset:0 sc1
s_add_u32 s49, s22, 16384
buffer_load_dwordx4 a[4:7], v1, s[4:7], s49 offen offset:0 sc1
buffer_load_dwordx4 a[8:11], v1, s[4:7], s48 offen offset:1024 sc1
buffer_load_dwordx4 a[12:15], v1, s[4:7], s49 offen offset:1024 sc1
buffer_load_dwordx4 a[16:19], v1, s[4:7], s48 offen offset:2048 sc1
buffer_load_dwordx4 a[20:23], v1, s[4:7], s49 offen offset:2048 sc1
buffer_load_dwordx4 a[24:27], v1, s[4:7], s48 offen offset:3072 sc1
buffer_load_dwordx4 a[28:31], v1, s[4:7], s49 offen offset:3072 sc1
s_barrier
ds_read_b128 v[40:43], v2 offset:32768
ds_read_b128 v[44:47], v2 offset:0
ds_read_b128 v[48:51], v2 offset:16384
ds_read_b128 v[52:55], v1 offset:0
ds_read_b128 v[56:59], v1 offset:16384
ds_read_b128 v[60:63], v1 offset:32768
s_add_u32 s50, s26, 16384
s_waitcnt vmcnt(6) lgkmcnt(3)
v_mfma_f32_16x16x32_bf16 v[72:75], v[40:43], a[0:3], 0
ds_read_b128 v[64:67], v2 offset:33792
v_mfma_f32_16x16x32_bf16 v[76:79], v[40:43], a[4:7], 0
s_add_u32 s48, s22, 4096
buffer_load_dwordx4 a[32:35], v1, s[4:7], s48 offen offset:0 sc1
v_mfma_f32_16x16x32_bf16 v[80:83], v[44:47], a[0:3], 0
ds_read_b128 v[68:71], v2 offset:1024
buffer_load_dwordx4 v[224:227], v6, s[4:7], s23 offen offset:0 sc1
v_mfma_f32_16x16x32_bf16 v[84:87], v[44:47], a[4:7], 0
buffer_load_dwordx4 v[228:231], v6, s[4:7], s23 offen offset:1024 sc1
v_mfma_f32_16x16x32_bf16 v[88:91], v[48:51], a[0:3], 0
ds_read_b128 v[240:243], v2 offset:17408
v_mfma_f32_16x16x32_bf16 v[92:95], v[48:51], a[4:7], 0
s_waitcnt lgkmcnt(3)
v_mfma_f32_16x16x32_bf16 v[96:99], a[0:3], v[52:55], 0
ds_read_b128 v[244:247], v1 offset:1024
buffer_load_dwordx4 v[232:235], v6, s[4:7], s23 offen offset:2048 sc1
v_mfma_f32_16x16x32_bf16 v[100:103], a[4:7], v[52:55], 0
s_add_u32 s49, s22, 20480
buffer_load_dwordx4 a[36:39], v1, s[4:7], s49 offen offset:0 sc1
v_mfma_f32_16x16x32_bf16 v[104:107], v[56:59], a[0:3], 0
ds_read_b128 v[248:251], v1 offset:17408
v_mfma_f32_16x16x32_bf16 v[108:111], v[56:59], a[4:7], 0
buffer_load_dwordx4 v[236:239], v6, s[4:7], s23 offen offset:3072 sc1
v_mfma_f32_16x16x32_bf16 v[112:115], a[0:3], v[60:63], 0
ds_read_b128 v[252:255], v1 offset:33792
v_mfma_f32_16x16x32_bf16 v[116:119], a[4:7], v[60:63], 0
s_waitcnt vmcnt(10) lgkmcnt(3)
v_mfma_f32_16x16x32_bf16 v[72:75], v[64:67], a[8:11], v[72:75]
ds_read_b128 v[40:43], v2 offset:34816
v_mfma_f32_16x16x32_bf16 v[76:79], v[64:67], a[12:15], v[76:79]
buffer_load_dwordx4 a[40:43], v1, s[4:7], s48 offen offset:1024 sc1
v_mfma_f32_16x16x32_bf16 v[80:83], v[68:71], a[8:11], v[80:83]
ds_read_b128 v[44:47], v2 offset:2048
v_mfma_f32_16x16x32_bf16 v[84:87], v[68:71], a[12:15], v[84:87]
v_mfma_f32_16x16x32_bf16 v[88:91], v[240:243], a[8:11], v[88:91]
ds_read_b128 v[48:51], v2 offset:18432
v_mfma_f32_16x16x32_bf16 v[92:95], v[240:243], a[12:15], v[92:95]
s_waitcnt lgkmcnt(3)
v_mfma_f32_16x16x32_bf16 v[96:99], a[8:11], v[244:247], v[96:99]
ds_read_b128 v[52:55], v1 offset:2048
v_mfma_f32_16x16x32_bf16 v[100:103], a[12:15], v[244:247], v[100:103]
buffer_load_dwordx4 a[44:47], v1, s[4:7], s49 offen offset:1024 sc1
v_mfma_f32_16x16x32_bf16 v[104:107], v[248:251], a[8:11], v[104:107]
ds_read_b128 v[56:59], v1 offset:18432
v_mfma_f32_16x16x32_bf16 v[108:111], v[248:251], a[12:15], v[108:111]
v_mfma_f32_16x16x32_bf16 v[112:115], a[8:11], v[252:255], v[112:115]
ds_read_b128 v[60:63], v1 offset:34816
v_mfma_f32_16x16x32_bf16 v[116:119], a[12:15], v[252:255], v[116:119]
s_waitcnt vmcnt(10) lgkmcnt(3)
v_mfma_f32_16x16x32_bf16 v[72:75], v[40:43], a[16:19], v[72:75]
ds_read_b128 v[64:67], v2 offset:35840
v_mfma_f32_16x16x32_bf16 v[76:79], v[40:43], a[20:23], v[76:79]
buffer_load_dwordx4 a[48:51], v1, s[4:7], s48 offen offset:2048 sc1
v_mfma_f32_16x16x32_bf16 v[80:83], v[44:47], a[16:19], v[80:83]
ds_read_b128 v[68:71], v2 offset:3072
v_mfma_f32_16x16x32_bf16 v[84:87], v[44:47], a[20:23], v[84:87]
v_mfma_f32_16x16x32_bf16 v[88:91], v[48:51], a[16:19], v[88:91]
ds_read_b128 v[240:243], v2 offset:19456
v_mfma_f32_16x16x32_bf16 v[92:95], v[48:51], a[20:23], v[92:95]
s_waitcnt lgkmcnt(3)
v_mfma_f32_16x16x32_bf16 v[96:99], a[16:19], v[52:55], v[96:99]
ds_read_b128 v[244:247], v1 offset:3072
v_mfma_f32_16x16x32_bf16 v[100:103], a[20:23], v[52:55], v[100:103]
buffer_load_dwordx4 a[52:55], v1, s[4:7], s49 offen offset:2048 sc1
v_mfma_f32_16x16x32_bf16 v[104:107], v[56:59], a[16:19], v[104:107]
ds_read_b128 v[248:251], v1 offset:19456
v_mfma_f32_16x16x32_bf16 v[108:111], v[56:59], a[20:23], v[108:111]
v_mfma_f32_16x16x32_bf16 v[112:115], a[16:19], v[60:63], v[112:115]
ds_read_b128 v[252:255], v1 offset:35840
v_mfma_f32_16x16x32_bf16 v[116:119], a[20:23], v[60:63], v[116:119]
s_waitcnt vmcnt(10) lgkmcnt(3)
v_mfma_f32_16x16x32_bf16 v[72:75], v[64:67], a[24:27], v[72:75]
ds_read_b128 v[40:43], v2 offset:36864
s_waitcnt vmcnt(8)
v_add_f32 v224, v224, v226
v_mfma_f32_16x16x32_bf16 v[76:79], v[64:67], a[28:31], v[76:79]
buffer_load_dwordx4 a[56:59], v1, s[4:7], s48 offen offset:3072 sc1
v_mfma_f32_16x16x32_bf16 v[80:83], v[68:71], a[24:27], v[80:83]
ds_read_b128 v[44:47], v2 offset:4096
v_mfma_f32_16x16x32_bf16 v[84:87], v[68:71], a[28:31], v[84:87]
v_add_f32 v225, v225, v227
s_waitcnt vmcnt(8)
v_add_f32 v228, v228, v230
v_mfma_f32_16x16x32_bf16 v[88:91], v[240:243], a[24:27], v[88:91]
ds_read_b128 v[48:51], v2 offset:20480
v_mfma_f32_16x16x32_bf16 v[92:95], v[240:243], a[28:31], v[92:95]
v_add_f32 v229, v229, v231
s_waitcnt vmcnt(7)
v_add_f32 v232, v232, v234
s_waitcnt lgkmcnt(3)
v_mfma_f32_16x16x32_bf16 v[96:99], a[24:27], v[244:247], v[96:99]
ds_read_b128 v[52:55], v1 offset:4096
v_add_f32 v233, v233, v235
v_mfma_f32_16x16x32_bf16 v[100:103], a[28:31], v[244:247], v[100:103]
buffer_load_dwordx4 a[60:63], v1, s[4:7], s49 offen offset:3072 sc1
v_mfma_f32_16x16x32_bf16 v[104:107], v[248:251], a[24:27], v[104:107]
ds_read_b128 v[56:59], v1 offset:20480
v_mfma_f32_16x16x32_bf16 v[108:111], v[248:251], a[28:31], v[108:111]
s_waitcnt vmcnt(6)
v_add_f32 v236, v236, v238
buffer_load_dwordx2 v[38:39], v16, s[4:7], s45 offen offset:0 sc1
v_mfma_f32_16x16x32_bf16 v[112:115], a[24:27], v[252:255], v[112:115]
ds_read_b128 v[60:63], v1 offset:36864
v_add_f32 v237, v237, v239
v_mfma_f32_16x16x32_bf16 v[116:119], a[28:31], v[252:255], v[116:119]
v_add_f32 v224, v224, v228
v_add_f32 v225, v225, v229
s_waitcnt lgkmcnt(3)
v_mfma_f32_16x16x32_bf16 v[72:75], v[40:43], a[32:35], v[72:75]
ds_read_b128 v[64:67], v2 offset:37888
v_mfma_f32_16x16x32_bf16 v[76:79], v[40:43], a[36:39], v[76:79]
s_add_u32 s48, s22, 8192
buffer_load_dwordx4 a[64:67], v1, s[4:7], s48 offen offset:0 sc1
v_mfma_f32_16x16x32_bf16 v[80:83], v[44:47], a[32:35], v[80:83]
ds_read_b128 v[68:71], v2 offset:5120
v_mfma_f32_16x16x32_bf16 v[84:87], v[44:47], a[36:39], v[84:87]
v_add_f32 v232, v232, v236
v_mfma_f32_16x16x32_bf16 v[88:91], v[48:51], a[32:35], v[88:91]
ds_read_b128 v[240:243], v2 offset:21504
v_add_f32 v233, v233, v237
v_mfma_f32_16x16x32_bf16 v[92:95], v[48:51], a[36:39], v[92:95]
v_add_f32 v224, v224, v232
v_add_f32 v225, v225, v233
s_waitcnt lgkmcnt(3)
v_mfma_f32_16x16x32_bf16 v[96:99], a[32:35], v[52:55], v[96:99]
ds_read_b128 v[244:247], v1 offset:5120
v_mfma_f32_16x16x32_bf16 v[100:103], a[36:39], v[52:55], v[100:103]
s_add_u32 s49, s22, 24576
buffer_load_dwordx4 a[68:71], v1, s[4:7], s49 offen offset:0 sc1
v_mfma_f32_16x16x32_bf16 v[104:107], v[56:59], a[32:35], v[104:107]
ds_read_b128 v[248:251], v1 offset:21504
v_mfma_f32_16x16x32_bf16 v[108:111], v[56:59], a[36:39], v[108:111]
v_mov_b32 v226, v224
v_mfma_f32_16x16x32_bf16 v[112:115], a[32:35], v[60:63], v[112:115]
ds_read_b128 v[252:255], v1 offset:37888
v_mov_b32 v227, v225
v_mfma_f32_16x16x32_bf16 v[116:119], a[36:39], v[60:63], v[116:119]
v_permlane32_swap_b32 v224, v226
v_permlane32_swap_b32 v225, v227
s_waitcnt vmcnt(7) lgkmcnt(3)
v_mfma_f32_16x16x32_bf16 v[72:75], v[64:67], a[40:43], v[72:75]
ds_read_b128 v[40:43], v2 offset:38912
v_mfma_f32_16x16x32_bf16 v[76:79], v[64:67], a[44:47], v[76:79]
buffer_load_dwordx4 a[72:75], v1, s[4:7], s48 offen offset:1024 sc1
v_mfma_f32_16x16x32_bf16 v[80:83], v[68:71], a[40:43], v[80:83]
ds_read_b128 v[44:47], v2 offset:6144
v_mfma_f32_16x16x32_bf16 v[84:87], v[68:71], a[44:47], v[84:87]
v_add_f32 v224, v224, v226
v_add_f32 v225, v225, v227
v_mfma_f32_16x16x32_bf16 v[88:91], v[240:243], a[40:43], v[88:91]
ds_read_b128 v[48:51], v2 offset:22528
v_mul_f32 v224, 0xbb000000, v224
v_mfma_f32_16x16x32_bf16 v[92:95], v[240:243], a[44:47], v[92:95]
v_mul_f32 v225, 0x3b000000, v225
s_waitcnt lgkmcnt(3)
v_mfma_f32_16x16x32_bf16 v[96:99], a[40:43], v[244:247], v[96:99]
ds_read_b128 v[52:55], v1 offset:6144
v_fma_f32 v225, -v224, v224, v225
v_mfma_f32_16x16x32_bf16 v[100:103], a[44:47], v[244:247], v[100:103]
buffer_load_dwordx4 a[76:79], v1, s[4:7], s49 offen offset:1024 sc1
v_mfma_f32_16x16x32_bf16 v[104:107], v[248:251], a[40:43], v[104:107]
ds_read_b128 v[56:59], v1 offset:22528
v_mfma_f32_16x16x32_bf16 v[108:111], v[248:251], a[44:47], v[108:111]
v_max_f32 v225, 0, v225
v_add_f32 v225, 0x3727c5ac, v225
v_mfma_f32_16x16x32_bf16 v[112:115], a[40:43], v[252:255], v[112:115]
ds_read_b128 v[60:63], v1 offset:38912
v_mfma_f32_16x16x32_bf16 v[116:119], a[44:47], v[252:255], v[116:119]
v_rsq_f32 v226, v225
s_waitcnt vmcnt(7) lgkmcnt(3)
v_mfma_f32_16x16x32_bf16 v[72:75], v[40:43], a[48:51], v[72:75]
ds_read_b128 v[64:67], v2 offset:39936
v_cndmask_b32 v227, v224, v226, s[62:63]
s_waitcnt vmcnt(4)
v_cmp_ne_u64 vcc, s[66:67], v[38:39]
s_nop 0
s_cbranch_vccnz LS1_sp4
LS1_ok3:
v_mfma_f32_16x16x32_bf16 v[76:79], v[40:43], a[52:55], v[76:79]
buffer_load_dwordx4 a[80:83], v1, s[4:7], s48 offen offset:2048 sc1
v_mfma_f32_16x16x32_bf16 v[80:83], v[44:47], a[48:51], v[80:83]
ds_read_b128 v[68:71], v2 offset:7168
v_mfma_f32_16x16x32_bf16 v[84:87], v[44:47], a[52:55], v[84:87]
ds_write_b32 v23, v227
ds_read2_b32 v[200:201], v24 offset0:0 offset1:32
v_mfma_f32_16x16x32_bf16 v[88:91], v[48:51], a[48:51], v[88:91]
ds_read_b128 v[240:243], v2 offset:23552
s_add_u32 m0, s21, 131072
s_add_u32 s47, s24, 0
buffer_load_dwordx4 v1, s[4:7], s47 offen offset:0 sc1 lds
v_mfma_f32_16x16x32_bf16 v[92:95], v[48:51], a[52:55], v[92:95]
ds_read2_b32 v[202:203], v24 offset0:16 offset1:48
ds_read_b128 v[208:211], v25 offset:0
s_waitcnt lgkmcnt(7)
v_mfma_f32_16x16x32_bf16 v[96:99], a[48:51], v[52:55], v[96:99]
ds_read_b128 v[244:247], v1 offset:7168
ds_read_b128 v[212:215], v25 offset:128
v_mfma_f32_16x16x32_bf16 v[100:103], a[52:55], v[52:55], v[100:103]
buffer_load_dwordx4 a[84:87], v1, s[4:7], s49 offen offset:2048 sc1
v_mfma_f32_16x16x32_bf16 v[104:107], v[56:59], a[48:51], v[104:107]
ds_read_b128 v[248:251], v1 offset:23552
v_mfma_f32_16x16x32_bf16 v[108:111], v[56:59], a[52:55], v[108:111]
ds_read_b128 v[216:219], v25 offset:64
ds_read_b128 v[220:223], v25 offset:192
v_mfma_f32_16x16x32_bf16 v[112:115], a[48:51], v[60:63], v[112:115]
ds_read_b128 v[252:255], v1 offset:39936
buffer_load_dwordx4 v1, s[4:7], s47 offen offset:1024 sc1 lds
v_mfma_f32_16x16x32_bf16 v[116:119], a[52:55], v[60:63], v[116:119]
s_waitcnt lgkmcnt(9)
v_mul_f32 v204, 0x3eb8aa3b, v201
s_waitcnt lgkmcnt(7)
v_mul_f32 v205, 0x3eb8aa3b, v203
v_mfma_f32_16x16x32_bf16 v[72:75], v[64:67], a[56:59], v[72:75]
ds_read_b128 v[40:43], v2 offset:40960
v_mfma_f32_16x16x32_bf16 v[76:79], v[64:67], a[60:63], v[76:79]
buffer_load_dwordx4 a[88:91], v1, s[4:7], s48 offen offset:3072 sc1
v_mfma_f32_16x16x32_bf16 v[80:83], v[68:71], a[56:59], v[80:83]
ds_read_b128 v[44:47], v2 offset:8192
v_mfma_f32_16x16x32_bf16 v[84:87], v[68:71], a[60:63], v[84:87]
buffer_load_dwordx4 v1, s[4:7], s47 offen offset:2048 sc1 lds
v_mfma_f32_16x16x32_bf16 v[88:91], v[240:243], a[56:59], v[88:91]
ds_read_b128 v[48:51], v2 offset:24576
v_mfma_f32_16x16x32_bf16 v[92:95], v[240:243], a[60:63], v[92:95]
s_waitcnt lgkmcnt(3)
v_mfma_f32_16x16x32_bf16 v[96:99], a[56:59], v[244:247], v[96:99]
ds_read_b128 v[52:55], v1 offset:8192
v_mfma_f32_16x16x32_bf16 v[100:103], a[60:63], v[244:247], v[100:103]
buffer_load_dwordx4 a[92:95], v1, s[4:7], s49 offen offset:3072 sc1
v_mfma_f32_16x16x32_bf16 v[104:107], v[248:251], a[56:59], v[104:107]
ds_read_b128 v[56:59], v1 offset:24576
buffer_load_dwordx4 v1, s[4:7], s47 offen offset:3072 sc1 lds
v_mfma_f32_16x16x32_bf16 v[108:111], v[248:251], a[60:63], v[108:111]
v_mfma_f32_16x16x32_bf16 v[112:115], a[56:59], v[252:255], v[112:115]
ds_read_b128 v[60:63], v1 offset:40960
v_mfma_f32_16x16x32_bf16 v[116:119], a[60:63], v[252:255], v[116:119]
s_waitcnt vmcnt(10) lgkmcnt(3)
v_mfma_f32_16x16x32_bf16 v[72:75], v[40:43], a[64:67], v[72:75]
ds_read_b128 v[64:67], v2 offset:41984
buffer_load_dwordx4 v[224:227], v6, s[4:7], s25 offen offset:0 sc1
v_mfma_f32_16x16x32_bf16 v[76:79], v[40:43], a[68:71], v[76:79]
s_add_u32 s48, s22, 12288
buffer_load_dwordx4 a[96:99], v1, s[4:7], s48 offen offset:0 sc1
v_mfma_f32_16x16x32_bf16 v[80:83], v[44:47], a[64:67], v[80:83]
ds_read_b128 v[68:71], v2 offset:9216
v_mfma_f32_16x16x32_bf16 v[84:87], v[44:47], a[68:71], v[84:87]
v_mfma_f32_16x16x32_bf16 v[88:91], v[48:51], a[64:67], v[88:91]
ds_read_b128 v[240:243], v2 offset:25600
v_mfma_f32_16x16x32_bf16 v[92:95], v[48:51], a[68:71], v[92:95]
s_waitcnt lgkmcnt(3)
v_mfma_f32_16x16x32_bf16 v[96:99], a[64:67], v[52:55], v[96:99]
ds_read_b128 v[244:247], v1 offset:9216
buffer_load_dwordx4 v[228:231], v6, s[4:7], s25 offen offset:1024 sc1
v_mfma_f32_16x16x32_bf16 v[100:103], a[68:71], v[52:55], v[100:103]
s_add_u32 s49, s22, 28672
buffer_load_dwordx4 a[100:103], v1, s[4:7], s49 offen offset:0 sc1
v_mfma_f32_16x16x32_bf16 v[104:107], v[56:59], a[64:67], v[104:107]
ds_read_b128 v[248:251], v1 offset:25600
v_mfma_f32_16x16x32_bf16 v[108:111], v[56:59], a[68:71], v[108:111]
v_mfma_f32_16x16x32_bf16 v[112:115], a[64:67], v[60:63], v[112:115]
ds_read_b128 v[252:255], v1 offset:41984
v_mfma_f32_16x16x32_bf16 v[116:119], a[68:71], v[60:63], v[116:119]
s_waitcnt vmcnt(12) lgkmcnt(3)
v_mfma_f32_16x16x32_bf16 v[72:75], v[64:67], a[72:75], v[72:75]
ds_read_b128 v[40:43], v2 offset:43008
buffer_load_dwordx4 v[232:235], v6, s[4:7], s25 offen offset:2048 sc1
v_mfma_f32_16x16x32_bf16 v[76:79], v[64:67], a[76:79], v[76:79]
buffer_load_dwordx4 a[104:107], v1, s[4:7], s48 offen offset:1024 sc1
v_mfma_f32_16x16x32_bf16 v[80:83], v[68:71], a[72:75], v[80:83]
ds_read_b128 v[44:47], v2 offset:10240
v_mfma_f32_16x16x32_bf16 v[84:87], v[68:71], a[76:79], v[84:87]
v_mfma_f32_16x16x32_bf16 v[88:91], v[240:243], a[72:75], v[88:91]
ds_read_b128 v[48:51], v2 offset:26624
v_mfma_f32_16x16x32_bf16 v[92:95], v[240:243], a[76:79], v[92:95]
s_waitcnt lgkmcnt(3)
v_mfma_f32_16x16x32_bf16 v[96:99], a[72:75], v[244:247], v[96:99]
ds_read_b128 v[52:55], v1 offset:10240
buffer_load_dwordx4 v[236:239], v6, s[4:7], s25 offen offset:3072 sc1
v_mfma_f32_16x16x32_bf16 v[100:103], a[76:79], v[244:247], v[100:103]
buffer_load_dwordx4 a[108:111], v1, s[4:7], s49 offen offset:1024 sc1
v_mfma_f32_16x16x32_bf16 v[104:107], v[248:251], a[72:75], v[104:107]
ds_read_b128 v[56:59], v1 offset:26624
v_mfma_f32_16x16x32_bf16 v[108:111], v[248:251], a[76:79], v[108:111]
v_mfma_f32_16x16x32_bf16 v[112:115], a[72:75], v[252:255], v[112:115]
ds_read_b128 v[60:63], v1 offset:43008
v_mfma_f32_16x16x32_bf16 v[116:119], a[76:79], v[252:255], v[116:119]
s_waitcnt vmcnt(13) lgkmcnt(3)
v_mfma_f32_16x16x32_bf16 v[72:75], v[40:43], a[80:83], v[72:75]
ds_read_b128 v[64:67], v2 offset:44032
v_mfma_f32_16x16x32_bf16 v[76:79], v[40:43], a[84:87], v[76:79]
buffer_load_dwordx4 a[112:115], v1, s[4:7], s48 offen offset:2048 sc1
v_mfma_f32_16x16x32_bf16 v[80:83], v[44:47], a[80:83], v[80:83]
ds_read_b128 v[68:71], v2 offset:11264
v_mfma_f32_16x16x32_bf16 v[84:87], v[44:47], a[84:87], v[84:87]
v_mfma_f32_16x16x32_bf16 v[88:91], v[48:51], a[80:83], v[88:91]
ds_read_b128 v[240:243], v2 offset:27648
v_mfma_f32_16x16x32_bf16 v[92:95], v[48:51], a[84:87], v[92:95]
s_waitcnt lgkmcnt(3)
v_mfma_f32_16x16x32_bf16 v[96:99], a[80:83], v[52:55], v[96:99]
ds_read_b128 v[244:247], v1 offset:11264
v_mfma_f32_16x16x32_bf16 v[100:103], a[84:87], v[52:55], v[100:103]
buffer_load_dwordx4 a[116:119], v1, s[4:7], s49 offen offset:2048 sc1
v_mfma_f32_16x16x32_bf16 v[104:107], v[56:59], a[80:83], v[104:107]
ds_read_b128 v[248:251], v1 offset:27648
v_mfma_f32_16x16x32_bf16 v[108:111], v[56:59], a[84:87], v[108:111]
v_mfma_f32_16x16x32_bf16 v[112:115], a[80:83], v[60:63], v[112:115]
ds_read_b128 v[252:255], v1 offset:44032
v_mfma_f32_16x16x32_bf16 v[116:119], a[84:87], v[60:63], v[116:119]
s_waitcnt vmcnt(11) lgkmcnt(3)
v_mfma_f32_16x16x32_bf16 v[72:75], v[64:67], a[88:91], v[72:75]
ds_read_b128 v[40:43], v2 offset:45056
s_add_u32 m0, s21, 49152
s_add_u32 s47, s19, 0
buffer_load_dwordx4 v1, s[4:7], s47 offen offset:0 sc1 lds
v_mfma_f32_16x16x32_bf16 v[76:79], v[64:67], a[92:95], v[76:79]
buffer_load_dwordx4 a[120:123], v1, s[4:7], s48 offen offset:3072 sc1
v_mfma_f32_16x16x32_bf16 v[80:83], v[68:71], a[88:91], v[80:83]
ds_read_b128 v[44:47], v2 offset:12288
v_mfma_f32_16x16x32_bf16 v[84:87], v[68:71], a[92:95], v[84:87]
v_mfma_f32_16x16x32_bf16 v[88:91], v[240:243], a[88:91], v[88:91]
ds_read_b128 v[48:51], v2 offset:28672
v_mfma_f32_16x16x32_bf16 v[92:95], v[240:243], a[92:95], v[92:95]
s_waitcnt lgkmcnt(3)
v_mfma_f32_16x16x32_bf16 v[96:99], a[88:91], v[244:247], v[96:99]
ds_read_b128 v[52:55], v1 offset:12288
v_mfma_f32_16x16x32_bf16 v[100:103], a[92:95], v[244:247], v[100:103]
buffer_load_dwordx4 a[124:127], v1, s[4:7], s49 offen offset:3072 sc1
v_mfma_f32_16x16x32_bf16 v[104:107], v[248:251], a[88:91], v[104:107]
ds_read_b128 v[56:59], v1 offset:28672
v_mfma_f32_16x16x32_bf16 v[108:111], v[248:251], a[92:95], v[108:111]
s_waitcnt vmcnt(13)
s_barrier
ds_read_b128 v[168:171], v14 offset:0
ds_read_b128 v[172:175], v15 offset:0
ds_read_b128 v[176:179], v14 offset:1024
ds_read_b128 v[180:183], v15 offset:1024
v_mfma_f32_16x16x32_bf16 v[112:115], a[88:91], v[252:255], v[112:115]
ds_read_b128 v[60:63], v1 offset:45056
buffer_load_dwordx4 v1, s[4:7], s47 offen offset:1024 sc1 lds
v_mfma_f32_16x16x32_bf16 v[116:119], a[92:95], v[252:255], v[116:119]
s_waitcnt vmcnt(10) lgkmcnt(7)
v_mfma_f32_16x16x32_bf16 v[72:75], v[40:43], a[96:99], v[72:75]
ds_read_b128 v[64:67], v2 offset:46080
v_mfma_f32_16x16x32_bf16 v[76:79], v[40:43], a[100:103], v[76:79]
v_mfma_f32_16x16x32_bf16 v[80:83], v[44:47], a[96:99], v[80:83]
ds_read_b128 v[68:71], v2 offset:13312
v_mfma_f32_16x16x32_bf16 v[84:87], v[44:47], a[100:103], v[84:87]
v_mfma_f32_16x16x32_bf16 v[88:91], v[48:51], a[96:99], v[88:91]
ds_read_b128 v[240:243], v2 offset:29696
v_mfma_f32_16x16x32_bf16 v[92:95], v[48:51], a[100:103], v[92:95]
s_waitcnt lgkmcnt(6)
v_mfma_f32_16x16x32_bf16 v[120:123], v[168:171], v[172:175], 0
ds_read_b128 v[168:171], v14 offset:2048
ds_read_b128 v[172:175], v15 offset:2048
s_waitcnt lgkmcnt(5)
v_mfma_f32_16x16x32_bf16 v[96:99], a[96:99], v[52:55], v[96:99]
ds_read_b128 v[244:247], v1 offset:13312
buffer_load_dwordx4 v1, s[4:7], s47 offen offset:2048 sc1 lds
v_mfma_f32_16x16x32_bf16 v[100:103], a[100:103], v[52:55], v[100:103]
v_mfma_f32_16x16x32_bf16 v[120:123], v[176:179], v[180:183], v[120:123]
ds_read_b128 v[176:179], v14 offset:3072
ds_read_b128 v[180:183], v15 offset:3072
v_mfma_f32_16x16x32_bf16 v[104:107], v[56:59], a[96:99], v[104:107]
ds_read_b128 v[248:251], v1 offset:29696
v_mfma_f32_16x16x32_bf16 v[108:111], v[56:59], a[100:103], v[108:111]
s_waitcnt lgkmcnt(4)
v_mfma_f32_16x16x32_bf16 v[120:123], v[168:171], v[172:175], v[120:123]
ds_read_b128 v[168:171], v14 offset:4096
ds_read_b128 v[172:175], v15 offset:4096
v_mfma_f32_16x16x32_bf16 v[112:115], a[96:99], v[60:63], v[112:115]
ds_read_b128 v[252:255], v1 offset:46080
v_mfma_f32_16x16x32_bf16 v[116:119], a[100:103], v[60:63], v[116:119]
s_waitcnt lgkmcnt(4)
v_mfma_f32_16x16x32_bf16 v[120:123], v[176:179], v[180:183], v[120:123]
ds_read_b128 v[176:179], v14 offset:5120
ds_read_b128 v[180:183], v15 offset:5120
s_waitcnt vmcnt(7)
v_mfma_f32_16x16x32_bf16 v[72:75], v[64:67], a[104:107], v[72:75]
ds_read_b128 v[40:43], v2 offset:47104
buffer_load_dwordx4 v1, s[4:7], s47 offen offset:3072 sc1 lds
v_mfma_f32_16x16x32_bf16 v[76:79], v[64:67], a[108:111], v[76:79]
v_mfma_f32_16x16x32_bf16 v[80:83], v[68:71], a[104:107], v[80:83]
ds_read_b128 v[44:47], v2 offset:14336
v_mfma_f32_16x16x32_bf16 v[84:87], v[68:71], a[108:111], v[84:87]
v_mfma_f32_16x16x32_bf16 v[88:91], v[240:243], a[104:107], v[88:91]
ds_read_b128 v[48:51], v2 offset:30720
v_mfma_f32_16x16x32_bf16 v[92:95], v[240:243], a[108:111], v[92:95]
s_waitcnt lgkmcnt(6)
v_mfma_f32_16x16x32_bf16 v[120:123], v[168:171], v[172:175], v[120:123]
ds_read_b128 v[168:171], v14 offset:6144
ds_read_b128 v[172:175], v15 offset:6144
s_waitcnt lgkmcnt(7)
v_mfma_f32_16x16x32_bf16 v[96:99], a[104:107], v[244:247], v[96:99]
ds_read_b128 v[52:55], v1 offset:14336
v_mfma_f32_16x16x32_bf16 v[100:103], a[108:111], v[244:247], v[100:103]
s_waitcnt lgkmcnt(6)
v_mfma_f32_16x16x32_bf16 v[120:123], v[176:179], v[180:183], v[120:123]
ds_read_b128 v[176:179], v14 offset:7168
ds_read_b128 v[180:183], v15 offset:7168
v_mfma_f32_16x16x32_bf16 v[104:107], v[248:251], a[104:107], v[104:107]
ds_read_b128 v[56:59], v1 offset:30720
s_add_u32 m0, s21, 114688
s_add_u32 s47, s19, 16384
buffer_load_dwordx4 v1, s[4:7], s47 offen offset:0 sc1 lds
v_mfma_f32_16x16x32_bf16 v[108:111], v[248:251], a[108:111], v[108:111]
s_waitcnt lgkmcnt(4)
v_mfma_f32_16x16x32_bf16 v[120:123], v[168:171], v[172:175], v[120:123]
ds_read_b128 v[168:171], v14 offset:8192
ds_read_b128 v[172:175], v15 offset:8192
v_mfma_f32_16x16x32_bf16 v[112:115], a[104:107], v[252:255], v[112:115]
ds_read_b128 v[60:63], v1 offset:47104
v_mfma_f32_16x16x32_bf16 v[116:119], a[108:111], v[252:255], v[116:119]
s_waitcnt lgkmcnt(4)
v_mfma_f32_16x16x32_bf16 v[120:123], v[176:179], v[180:183], v[120:123]
ds_read_b128 v[176:179], v14 offset:9216
ds_read_b128 v[180:183], v15 offset:9216
s_waitcnt vmcnt(7)
v_mfma_f32_16x16x32_bf16 v[72:75], v[40:43], a[112:115], v[72:75]
ds_read_b128 v[64:67], v2 offset:48128
v_mfma_f32_16x16x32_bf16 v[76:79], v[40:43], a[116:119], v[76:79]
v_mfma_f32_16x16x32_bf16 v[80:83], v[44:47], a[112:115], v[80:83]
ds_read_b128 v[68:71], v2 offset:15360
v_mfma_f32_16x16x32_bf16 v[84:87], v[44:47], a[116:119], v[84:87]
buffer_load_dwordx4 v1, s[4:7], s47 offen offset:1024 sc1 lds
v_mfma_f32_16x16x32_bf16 v[88:91], v[48:51], a[112:115], v[88:91]
ds_read_b128 v[240:243], v2 offset:31744
v_mfma_f32_16x16x32_bf16 v[92:95], v[48:51], a[116:119], v[92:95]
s_waitcnt lgkmcnt(6)
v_mfma_f32_16x16x32_bf16 v[120:123], v[168:171], v[172:175], v[120:123]
ds_read_b128 v[168:171], v14 offset:10240
ds_read_b128 v[172:175], v15 offset:10240
s_waitcnt lgkmcnt(7)
v_mfma_f32_16x16x32_bf16 v[96:99], a[112:115], v[52:55], v[96:99]
ds_read_b128 v[244:247], v1 offset:15360
v_mfma_f32_16x16x32_bf16 v[100:103], a[116:119], v[52:55], v[100:103]
s_waitcnt lgkmcnt(6)
v_mfma_f32_16x16x32_bf16 v[120:123], v[176:179], v[180:183], v[120:123]
ds_read_b128 v[176:179], v14 offset:11264
ds_read_b128 v[180:183], v15 offset:11264
v_mfma_f32_16x16x32_bf16 v[104:107], v[56:59], a[112:115], v[104:107]
ds_read_b128 v[248:251], v1 offset:31744
v_mfma_f32_16x16x32_bf16 v[108:111], v[56:59], a[116:119], v[108:111]
buffer_load_dwordx4 v1, s[4:7], s47 offen offset:2048 sc1 lds
s_waitcnt lgkmcnt(4)
v_mfma_f32_16x16x32_bf16 v[120:123], v[168:171], v[172:175], v[120:123]
ds_read_b128 v[168:171], v14 offset:12288
ds_read_b128 v[172:175], v15 offset:12288
v_mfma_f32_16x16x32_bf16 v[112:115], a[112:115], v[60:63], v[112:115]
ds_read_b128 v[252:255], v1 offset:48128
v_mfma_f32_16x16x32_bf16 v[116:119], a[116:119], v[60:63], v[116:119]
s_waitcnt lgkmcnt(4)
v_mfma_f32_16x16x32_bf16 v[120:123], v[176:179], v[180:183], v[120:123]
ds_read_b128 v[176:179], v14 offset:13312
ds_read_b128 v[180:183], v15 offset:13312
s_waitcnt vmcnt(6)
v_mfma_f32_16x16x32_bf16 v[72:75], v[64:67], a[120:123], v[72:75]
v_mfma_f32_16x16x32_bf16 v[76:79], v[64:67], a[124:127], v[76:79]
v_mfma_f32_16x16x32_bf16 v[80:83], v[68:71], a[120:123], v[80:83]
v_mfma_f32_16x16x32_bf16 v[84:87], v[68:71], a[124:127], v[84:87]
v_mfma_f32_16x16x32_bf16 v[88:91], v[240:243], a[120:123], v[88:91]
buffer_load_dwordx4 v1, s[4:7], s47 offen offset:3072 sc1 lds
v_mfma_f32_16x16x32_bf16 v[92:95], v[240:243], a[124:127], v[92:95]
s_waitcnt lgkmcnt(3)
v_mfma_f32_16x16x32_bf16 v[120:123], v[168:171], v[172:175], v[120:123]
ds_read_b128 v[168:171], v14 offset:14336
ds_read_b128 v[172:175], v15 offset:14336
s_waitcnt lgkmcnt(4)
v_mfma_f32_16x16x32_bf16 v[96:99], a[120:123], v[244:247], v[96:99]
v_mfma_f32_16x16x32_bf16 v[100:103], a[124:127], v[244:247], v[100:103]
s_waitcnt lgkmcnt(2)
v_mfma_f32_16x16x32_bf16 v[120:123], v[176:179], v[180:183], v[120:123]
ds_read_b128 v[176:179], v14 offset:15360
ds_read_b128 v[180:183], v15 offset:15360
v_mfma_f32_16x16x32_bf16 v[104:107], v[248:251], a[120:123], v[104:107]
v_mfma_f32_16x16x32_bf16 v[108:111], v[248:251], a[124:127], v[108:111]
s_waitcnt lgkmcnt(2)
v_mfma_f32_16x16x32_bf16 v[120:123], v[168:171], v[172:175], v[120:123]
v_mfma_f32_16x16x32_bf16 v[112:115], a[120:123], v[252:255], v[112:115]
v_mfma_f32_16x16x32_bf16 v[116:119], a[124:127], v[252:255], v[116:119]
s_waitcnt lgkmcnt(0)
v_mfma_f32_16x16x32_bf16 v[120:123], v[176:179], v[180:183], v[120:123]
LS1_tail:
v_pk_add_f32 v[224:225], v[224:225], v[226:227]
v_pk_add_f32 v[228:229], v[228:229], v[230:231]
v_pk_add_f32 v[232:233], v[232:233], v[234:235]
v_pk_add_f32 v[236:237], v[236:237], v[238:239]
v_pk_add_f32 v[224:225], v[224:225], v[228:229]
v_pk_add_f32 v[232:233], v[232:233], v[236:237]
v_pk_add_f32 v[224:225], v[224:225], v[232:233]
v_mov_b32 v226, v224
v_mov_b32 v227, v225
s_nop 0
v_permlane32_swap_b32 v224, v226
v_permlane32_swap_b32 v225, v227
v_add_f32 v224, v224, v226
v_add_f32 v225, v225, v227
v_mul_f32 v224, 0xbb000000, v224
v_mul_f32 v225, 0x3b000000, v225
v_fma_f32 v225, -v224, v224, v225
v_max_f32 v225, 0, v225
v_add_f32 v225, 0x3727c5ac, v225
v_rsq_f32 v226, v225
s_nop 0
v_cndmask_b32 v227, v224, v226, s[62:63]
ds_write_b32 v23, v227 offset:256
v_add_u32 v226, s56, v30
v_add_u32 v228, s56, v226
v_add_u32 v230, s56, v228
ds_read2_b32 v[224:225], v30 offset0:0 offset1:32
ds_read2_b32 v[226:227], v226 offset0:0 offset1:32
ds_read2_b32 v[228:229], v228 offset0:0 offset1:32
ds_read2_b32 v[230:231], v230 offset0:0 offset1:32
v_pk_fma_f32 v[92:93], v[202:203], v[152:153], v[92:93] op_sel:[0,0,0] op_sel_hi:[0,1,1]
v_pk_fma_f32 v[94:95], v[202:203], v[154:155], v[94:95] op_sel:[0,0,0] op_sel_hi:[0,1,1]
v_pk_mul_f32 v[92:93], v[202:203], v[92:93] op_sel:[1,0] op_sel_hi:[1,1]
v_pk_mul_f32 v[94:95], v[202:203], v[94:95] op_sel:[1,0] op_sel_hi:[1,1]
v_cvt_pk_bf16_f32 v172, v92, v93
v_cvt_pk_bf16_f32 v173, v94, v95
v_pk_fma_f32 v[100:101], v[216:217], v[34:35], v[100:101] op_sel:[0,0,0] op_sel_hi:[1,0,1]
v_pk_fma_f32 v[102:103], v[218:219], v[34:35], v[102:103] op_sel:[0,0,0] op_sel_hi:[1,0,1]
v_pk_mul_f32 v[100:101], v[220:221], v[100:101] op_sel:[0,0] op_sel_hi:[1,1]
v_pk_mul_f32 v[102:103], v[222:223], v[102:103] op_sel:[0,0] op_sel_hi:[1,1]
v_cvt_pk_bf16_f32 v184, v100, v101
v_cvt_pk_bf16_f32 v185, v102, v103
ds_write_b64 v20, v[172:173] offset:0
ds_write_b64 v20, v[184:185] offset:8
v_pk_fma_f32 v[108:109], v[202:203], v[156:157], v[108:109] op_sel:[0,0,0] op_sel_hi:[0,1,1]
v_pk_fma_f32 v[110:111], v[202:203], v[158:159], v[110:111] op_sel:[0,0,0] op_sel_hi:[0,1,1]
v_pk_mul_f32 v[108:109], v[202:203], v[108:109] op_sel:[1,0] op_sel_hi:[1,1]
v_pk_mul_f32 v[110:111], v[202:203], v[110:111] op_sel:[1,0] op_sel_hi:[1,1]
v_cvt_pk_bf16_f32 v178, v108, v109
v_cvt_pk_bf16_f32 v179, v110, v111
v_pk_fma_f32 v[116:117], v[216:217], v[34:35], v[116:117] op_sel:[0,1,0] op_sel_hi:[1,1,1]
v_pk_fma_f32 v[118:119], v[218:219], v[34:35], v[118:119] op_sel:[0,1,0] op_sel_hi:[1,1,1]
v_pk_mul_f32 v[116:117], v[220:221], v[116:117] op_sel:[0,0] op_sel_hi:[1,1]
v_pk_mul_f32 v[118:119], v[222:223], v[118:119] op_sel:[0,0] op_sel_hi:[1,1]
v_cvt_pk_bf16_f32 v190, v116, v117
v_cvt_pk_bf16_f32 v191, v118, v119
ds_write_b64 v20, v[178:179] offset:1024
ds_write_b64 v20, v[190:191] offset:1032
s_waitcnt lgkmcnt(7)
v_fmac_f32 v120, v224, v160
s_waitcnt lgkmcnt(6)
v_fmac_f32 v121, v226, v161
s_waitcnt lgkmcnt(5)
v_fmac_f32 v122, v228, v162
s_waitcnt lgkmcnt(4)
v_fmac_f32 v123, v230, v163
v_mul_f32 v120, v225, v120
v_mul_f32 v121, v227, v121
v_mul_f32 v122, v229, v122
v_mul_f32 v123, v231, v123
v_cvt_pk_bf16_f32 v120, v120, v121
v_cvt_pk_bf16_f32 v121, v122, v123
ds_write_b64 v21, v[120:121]
v_pk_fma_f32 v[88:89], v[200:201], v[152:153], v[88:89] op_sel:[0,0,0] op_sel_hi:[0,1,1]
v_pk_fma_f32 v[90:91], v[200:201], v[154:155], v[90:91] op_sel:[0,0,0] op_sel_hi:[0,1,1]
v_pk_mul_f32 v[88:89], v[200:201], v[88:89] op_sel:[1,0] op_sel_hi:[1,1]
v_pk_mul_f32 v[90:91], v[200:201], v[90:91] op_sel:[1,0] op_sel_hi:[1,1]
v_cvt_pk_bf16_f32 v170, v88, v89
v_cvt_pk_bf16_f32 v171, v90, v91
v_pk_fma_f32 v[96:97], v[208:209], v[34:35], v[96:97] op_sel:[0,0,0] op_sel_hi:[1,0,1]
v_pk_fma_f32 v[98:99], v[210:211], v[34:35], v[98:99] op_sel:[0,0,0] op_sel_hi:[1,0,1]
v_pk_mul_f32 v[96:97], v[212:213], v[96:97] op_sel:[0,0] op_sel_hi:[1,1]
v_pk_mul_f32 v[98:99], v[214:215], v[98:99] op_sel:[0,0] op_sel_hi:[1,1]
v_cvt_pk_bf16_f32 v182, v96, v97
v_cvt_pk_bf16_f32 v183, v98, v99
v_pk_fma_f32 v[76:77], v[202:203], v[144:145], v[76:77] op_sel:[0,0,0] op_sel_hi:[0,1,1]
v_pk_fma_f32 v[78:79], v[202:203], v[146:147], v[78:79] op_sel:[0,0,0] op_sel_hi:[0,1,1]
v_cvt_pk_bf16_f32 v76, v76, v77
v_cvt_pk_bf16_f32 v77, v78, v79
v_pk_fma_f32 v[72:73], v[200:201], v[144:145], v[72:73] op_sel:[0,0,0] op_sel_hi:[0,1,1]
v_pk_fma_f32 v[74:75], v[200:201], v[146:147], v[74:75] op_sel:[0,0,0] op_sel_hi:[0,1,1]
v_cvt_pk_bf16_f32 v72, v72, v73
v_cvt_pk_bf16_f32 v73, v74, v75
v_pk_fma_f32 v[104:105], v[200:201], v[156:157], v[104:105] op_sel:[0,0,0] op_sel_hi:[0,1,1]
v_pk_fma_f32 v[106:107], v[200:201], v[158:159], v[106:107] op_sel:[0,0,0] op_sel_hi:[0,1,1]
v_pk_mul_f32 v[104:105], v[200:201], v[104:105] op_sel:[1,0] op_sel_hi:[1,1]
v_pk_mul_f32 v[106:107], v[200:201], v[106:107] op_sel:[1,0] op_sel_hi:[1,1]
v_cvt_pk_bf16_f32 v176, v104, v105
v_cvt_pk_bf16_f32 v177, v106, v107
v_pk_fma_f32 v[112:113], v[208:209], v[34:35], v[112:113] op_sel:[0,1,0] op_sel_hi:[1,1,1]
v_pk_fma_f32 v[114:115], v[210:211], v[34:35], v[114:115] op_sel:[0,1,0] op_sel_hi:[1,1,1]
v_pk_mul_f32 v[112:113], v[212:213], v[112:113] op_sel:[0,0] op_sel_hi:[1,1]
v_pk_mul_f32 v[114:115], v[214:215], v[114:115] op_sel:[0,0] op_sel_hi:[1,1]
v_cvt_pk_bf16_f32 v188, v112, v113
v_cvt_pk_bf16_f32 v189, v114, v115
v_pk_fma_f32 v[84:85], v[202:203], v[148:149], v[84:85] op_sel:[0,0,0] op_sel_hi:[0,1,1]
v_pk_fma_f32 v[86:87], v[202:203], v[150:151], v[86:87] op_sel:[0,0,0] op_sel_hi:[0,1,1]
v_cvt_pk_bf16_f32 v84, v84, v85
v_cvt_pk_bf16_f32 v85, v86, v87
v_pk_fma_f32 v[80:81], v[200:201], v[148:149], v[80:81] op_sel:[0,0,0] op_sel_hi:[0,1,1]
v_pk_fma_f32 v[82:83], v[200:201], v[150:151], v[82:83] op_sel:[0,0,0] op_sel_hi:[0,1,1]
v_cvt_pk_bf16_f32 v80, v80, v81
v_cvt_pk_bf16_f32 v81, v82, v83
s_waitcnt lgkmcnt(0)
s_barrier
ds_read_b64 v[168:169], v22 offset:0
ds_read_b64 v[180:181], v22 offset:8
ds_read_b64 v[174:175], v22 offset:1024
ds_read_b64 v[186:187], v22 offset:1032
v_mfma_f32_16x16x16_bf16 v[224:227], v[170:171], v[76:77], v[136:139]
s_add_u32 m0, s21, 98304
s_add_u32 s47, s18, 0
buffer_load_dwordx4 v1, s[4:7], s47 offen offset:0 sc1 lds
v_mfma_f32_16x16x16_bf16 v[228:231], v[172:173], v[76:77], v[132:135]
v_mfma_f32_16x16x16_bf16 v[240:243], v[176:177], v[84:85], v[136:139]
v_mfma_f32_16x16x16_bf16 v[244:247], v[178:179], v[84:85], v[132:135]
s_waitcnt lgkmcnt(3)
v_mfma_f32_16x16x16_bf16 v[40:43], v[168:169], v[72:73], v[140:143]
v_mfma_f32_16x16x16_bf16 v[44:47], v[170:171], v[72:73], v[132:135]
s_waitcnt lgkmcnt(1)
v_mfma_f32_16x16x16_bf16 v[56:59], v[174:175], v[80:81], v[140:143]
buffer_load_dwordx4 v1, s[4:7], s47 offen offset:1024 sc1 lds
v_mfma_f32_16x16x16_bf16 v[60:63], v[176:177], v[80:81], v[132:135]
v_max3_f32 v232, v224, v225, v226
v_max3_f32 v233, v227, v228, v229
v_max3_f32 v232, v232, v230, v231
v_max_f32 v232, v232, v233
v_mov_b32 v233, v232
buffer_load_dwordx4 v1, s[4:7], s47 offen offset:2048 sc1 lds
v_max3_f32 v248, v240, v241, v242
v_max3_f32 v249, v243, v244, v245
v_max3_f32 v248, v248, v246, v247
v_max_f32 v248, v248, v249
v_mov_b32 v249, v248
v_max3_f32 v48, v40, v41, v42
buffer_load_dwordx4 v1, s[4:7], s47 offen offset:3072 sc1 lds
v_max3_f32 v49, v43, v44, v45
v_max3_f32 v48, v48, v46, v47
v_max_f32 v48, v48, v49
v_mov_b32 v49, v48
v_max3_f32 v64, v56, v57, v58
v_max3_f32 v65, v59, v60, v61
v_max3_f32 v64, v64, v62, v63
s_add_u32 m0, s21, 65536
s_add_u32 s47, s18, 16384
buffer_load_dwordx4 v1, s[4:7], s47 offen offset:0 sc1 lds
v_max_f32 v64, v64, v65
v_mov_b32 v65, v64
v_permlane32_swap_b32 v232, v233
v_max_f32 v232, v232, v233
v_mov_b32 v233, v232
v_permlane32_swap_b32 v248, v249
buffer_load_dwordx4 v1, s[4:7], s47 offen offset:1024 sc1 lds
v_max_f32 v248, v248, v249
v_mov_b32 v249, v248
v_permlane32_swap_b32 v48, v49
v_max_f32 v48, v48, v49
v_mov_b32 v49, v48
v_permlane32_swap_b32 v64, v65
buffer_load_dwordx4 v1, s[4:7], s47 offen offset:2048 sc1 lds
v_max_f32 v64, v64, v65
v_mov_b32 v65, v64
v_permlane16_swap_b32 v232, v233
v_max_f32 v232, v232, v233
v_mul_f32 v232, v205, v232
v_permlane16_swap_b32 v248, v249
buffer_load_dwordx4 v1, s[4:7], s47 offen offset:3072 sc1 lds
v_max_f32 v248, v248, v249
v_mul_f32 v248, v205, v248
v_permlane16_swap_b32 v48, v49
v_max_f32 v48, v48, v49
v_mul_f32 v48, v204, v48
v_permlane16_swap_b32 v64, v65
v_max_f32 v64, v64, v65
s_add_u32 m0, s21, 81920
s_add_u32 s47, s18, 32768
buffer_load_dwordx4 v1, s[4:7], s47 offen offset:0 sc1 lds
v_mul_f32 v64, v204, v64
v_pk_fma_f32 v[224:225], v[224:225], v[204:205], v[232:233] op_sel:[0,1,0] op_sel_hi:[1,1,0] neg_lo:[0,0,1] neg_hi:[0,0,1]
v_pk_fma_f32 v[226:227], v[226:227], v[204:205], v[232:233] op_sel:[0,1,0] op_sel_hi:[1,1,0] neg_lo:[0,0,1] neg_hi:[0,0,1]
v_pk_fma_f32 v[228:229], v[228:229], v[204:205], v[232:233] op_sel:[0,1,0] op_sel_hi:[1,1,0] neg_lo:[0,0,1] neg_hi:[0,0,1]
v_pk_fma_f32 v[230:231], v[230:231], v[204:205], v[232:233] op_sel:[0,1,0] op_sel_hi:[1,1,0] neg_lo:[0,0,1] neg_hi:[0,0,1]
v_pk_fma_f32 v[240:241], v[240:241], v[204:205], v[248:249] op_sel:[0,1,0] op_sel_hi:[1,1,0] neg_lo:[0,0,1] neg_hi:[0,0,1]
buffer_load_dwordx4 v1, s[4:7], s47 offen offset:1024 sc1 lds
v_pk_fma_f32 v[242:243], v[242:243], v[204:205], v[248:249] op_sel:[0,1,0] op_sel_hi:[1,1,0] neg_lo:[0,0,1] neg_hi:[0,0,1]
v_pk_fma_f32 v[244:245], v[244:245], v[204:205], v[248:249] op_sel:[0,1,0] op_sel_hi:[1,1,0] neg_lo:[0,0,1] neg_hi:[0,0,1]
v_pk_fma_f32 v[246:247], v[246:247], v[204:205], v[248:249] op_sel:[0,1,0] op_sel_hi:[1,1,0] neg_lo:[0,0,1] neg_hi:[0,0,1]
v_pk_fma_f32 v[40:41], v[40:41], v[204:205], v[48:49] op_sel:[0,0,0] op_sel_hi:[1,0,0] neg_lo:[0,0,1] neg_hi:[0,0,1]
v_pk_fma_f32 v[42:43], v[42:43], v[204:205], v[48:49] op_sel:[0,0,0] op_sel_hi:[1,0,0] neg_lo:[0,0,1] neg_hi:[0,0,1]
v_pk_fma_f32 v[44:45], v[44:45], v[204:205], v[48:49] op_sel:[0,0,0] op_sel_hi:[1,0,0] neg_lo:[0,0,1] neg_hi:[0,0,1]
buffer_load_dwordx4 v1, s[4:7], s47 offen offset:2048 sc1 lds
v_pk_fma_f32 v[46:47], v[46:47], v[204:205], v[48:49] op_sel:[0,0,0] op_sel_hi:[1,0,0] neg_lo:[0,0,1] neg_hi:[0,0,1]
v_pk_fma_f32 v[56:57], v[56:57], v[204:205], v[64:65] op_sel:[0,0,0] op_sel_hi:[1,0,0] neg_lo:[0,0,1] neg_hi:[0,0,1]
v_pk_fma_f32 v[58:59], v[58:59], v[204:205], v[64:65] op_sel:[0,0,0] op_sel_hi:[1,0,0] neg_lo:[0,0,1] neg_hi:[0,0,1]
v_pk_fma_f32 v[60:61], v[60:61], v[204:205], v[64:65] op_sel:[0,0,0] op_sel_hi:[1,0,0] neg_lo:[0,0,1] neg_hi:[0,0,1]
v_pk_fma_f32 v[62:63], v[62:63], v[204:205], v[64:65] op_sel:[0,0,0] op_sel_hi:[1,0,0] neg_lo:[0,0,1] neg_hi:[0,0,1]
v_exp_f32 v224, v224
buffer_load_dwordx4 v1, s[4:7], s47 offen offset:3072 sc1 lds
v_exp_f32 v225, v225
v_exp_f32 v226, v226
v_exp_f32 v227, v227
v_exp_f32 v228, v228
v_exp_f32 v229, v229
v_exp_f32 v230, v230
v_exp_f32 v231, v231
s_add_u32 m0, s21, 0
s_add_u32 s47, s18, 49152
buffer_load_dwordx4 v1, s[4:7], s47 offen offset:0 sc1 lds
v_exp_f32 v240, v240
v_exp_f32 v241, v241
v_exp_f32 v242, v242
v_exp_f32 v243, v243
v_exp_f32 v244, v244
v_exp_f32 v245, v245
buffer_load_dwordx4 v1, s[4:7], s47 offen offset:1024 sc1 lds
v_exp_f32 v246, v246
v_exp_f32 v247, v247
v_exp_f32 v40, v40
v_exp_f32 v41, v41
v_exp_f32 v42, v42
v_exp_f32 v43, v43
buffer_load_dwordx4 v1, s[4:7], s47 offen offset:2048 sc1 lds
v_exp_f32 v44, v44
v_exp_f32 v45, v45
v_exp_f32 v46, v46
v_exp_f32 v47, v47
v_exp_f32 v56, v56
v_exp_f32 v57, v57
buffer_load_dwordx4 v1, s[4:7], s47 offen offset:3072 sc1 lds
v_exp_f32 v58, v58
v_exp_f32 v59, v59
v_exp_f32 v60, v60
v_exp_f32 v61, v61
v_exp_f32 v62, v62
v_exp_f32 v63, v63
v_cvt_pk_bf16_f32 v234, v224, v225
v_cvt_pk_bf16_f32 v235, v226, v227
v_cvt_pk_bf16_f32 v236, v228, v229
v_cvt_pk_bf16_f32 v237, v230, v231
v_cvt_pk_bf16_f32 v250, v240, v241
v_cvt_pk_bf16_f32 v251, v242, v243
v_cvt_pk_bf16_f32 v252, v244, v245
v_cvt_pk_bf16_f32 v253, v246, v247
v_cvt_pk_bf16_f32 v50, v40, v41
v_cvt_pk_bf16_f32 v51, v42, v43
v_cvt_pk_bf16_f32 v52, v44, v45
v_cvt_pk_bf16_f32 v53, v46, v47
v_cvt_pk_bf16_f32 v66, v56, v57
v_cvt_pk_bf16_f32 v67, v58, v59
v_cvt_pk_bf16_f32 v68, v60, v61
v_cvt_pk_bf16_f32 v69, v62, v63
v_mfma_f32_16x16x32_bf16 v[228:231], v[164:167], v[234:237], 0
v_mfma_f32_16x16x32_bf16 v[224:227], v[182:185], v[234:237], 0
v_mfma_f32_16x16x32_bf16 v[244:247], v[164:167], v[250:253], 0
v_mfma_f32_16x16x32_bf16 v[240:243], v[188:191], v[250:253], 0
v_mfma_f32_16x16x32_bf16 v[44:47], v[164:167], v[50:53], 0
v_mfma_f32_16x16x32_bf16 v[40:43], v[180:183], v[50:53], 0
v_mfma_f32_16x16x32_bf16 v[60:63], v[164:167], v[66:69], 0
s_waitcnt lgkmcnt(0)
v_mfma_f32_16x16x32_bf16 v[56:59], v[186:189], v[66:69], 0
v_rcp_f32 v228, v228
s_nop 0
v_rcp_f32 v244, v244
s_nop 0
v_rcp_f32 v44, v44
s_nop 0
v_rcp_f32 v60, v60
v_pk_mul_f32 v[224:225], v[228:229], v[224:225] op_sel_hi:[0,1]
v_pk_mul_f32 v[226:227], v[228:229], v[226:227] op_sel_hi:[0,1]
v_pk_mul_f32 v[240:241], v[244:245], v[240:241] op_sel_hi:[0,1]
v_pk_mul_f32 v[242:243], v[244:245], v[242:243] op_sel_hi:[0,1]
v_pk_mul_f32 v[40:41], v[44:45], v[40:41] op_sel_hi:[0,1]
v_pk_mul_f32 v[42:43], v[44:45], v[42:43] op_sel_hi:[0,1]
v_pk_mul_f32 v[56:57], v[60:61], v[56:57] op_sel_hi:[0,1]
v_pk_mul_f32 v[58:59], v[60:61], v[58:59] op_sel_hi:[0,1]
v_cvt_pk_bf16_f32 v196, v224, v225
v_cvt_pk_bf16_f32 v197, v226, v227
v_cvt_pk_bf16_f32 v198, v240, v241
v_cvt_pk_bf16_f32 v199, v242, v243
v_cvt_pk_bf16_f32 v192, v40, v41
v_cvt_pk_bf16_f32 v193, v42, v43
v_cvt_pk_bf16_f32 v194, v56, v57
v_cvt_pk_bf16_f32 v195, v58, v59
s_add_u32 s48, s26, 16384
buffer_store_dwordx4 v[192:195], v1, s[4:7], s26 offen sc1
buffer_store_dwordx4 v[196:199], v1, s[4:7], s48 offen sc1
s_waitcnt vmcnt(0)
buffer_store_dwordx2 v[36:37], v26, s[4:7], s36 offen offset:512 sc1
v_lshlrev_b32 v168, 16, v124
v_and_b32 v169, 0xffff0000, v124
v_lshlrev_b32 v170, 16, v125
v_and_b32 v171, 0xffff0000, v125
v_lshlrev_b32 v172, 16, v126
v_and_b32 v173, 0xffff0000, v126
v_lshlrev_b32 v174, 16, v127
v_and_b32 v175, 0xffff0000, v127
v_lshlrev_b32 v176, 16, v128
v_and_b32 v177, 0xffff0000, v128
v_lshlrev_b32 v178, 16, v129
v_and_b32 v179, 0xffff0000, v129
v_lshlrev_b32 v180, 16, v130
v_and_b32 v181, 0xffff0000, v130
v_lshlrev_b32 v182, 16, v131
v_and_b32 v183, 0xffff0000, v131
buffer_load_dwordx2 v[38:39], v17, s[4:7], s37 offen offset:512 sc1
buffer_load_dwordx2 v[252:253], v17, s[4:7], s37 offen offset:512 sc1
s_waitcnt vmcnt(1)
v_cmp_ne_u64 vcc, s[66:67], v[38:39]
s_nop 0
s_cbranch_vccnz LS1_sp6
LS1_ok5:
s_add_u32 s48, s27, 0
buffer_load_dwordx4 a[0:3], v1, s[4:7], s48 offen offset:0 sc1
buffer_load_dwordx4 a[4:7], v4, s[4:7], s48 offen offset:0 sc1
buffer_load_dwordx4 a[8:11], v1, s[4:7], s48 offen offset:1024 sc1
buffer_load_dwordx4 a[12:15], v4, s[4:7], s48 offen offset:1024 sc1
buffer_load_dwordx4 a[16:19], v1, s[4:7], s48 offen offset:2048 sc1
buffer_load_dwordx4 a[20:23], v4, s[4:7], s48 offen offset:2048 sc1
buffer_load_dwordx4 a[24:27], v1, s[4:7], s48 offen offset:3072 sc1
buffer_load_dwordx4 a[28:31], v4, s[4:7], s48 offen offset:3072 sc1
s_add_u32 s48, s27, 4096
buffer_load_dwordx4 a[32:35], v1, s[4:7], s48 offen offset:0 sc1
buffer_load_dwordx4 a[36:39], v4, s[4:7], s48 offen offset:0 sc1
s_barrier
ds_read_b128 v[40:43], v9 offset:32768
ds_read_b128 v[44:47], v9 offset:33792
ds_read_b128 v[48:51], v9 offset:34816
ds_read_b128 v[52:55], v9 offset:35840
s_waitcnt vmcnt(8) lgkmcnt(2)
v_mfma_f32_16x16x32_bf16 v[168:171], v[40:43], a[0:3], v[168:171]
ds_read_b128 v[56:59], v9 offset:36864
v_mfma_f32_16x16x32_bf16 v[176:179], v[40:43], a[4:7], v[176:179]
buffer_load_dwordx4 a[40:43], v1, s[4:7], s48 offen offset:1024 sc1
v_mfma_f32_16x16x32_bf16 v[172:175], v[44:47], a[0:3], v[172:175]
ds_read_b128 v[60:63], v9 offset:37888
v_mfma_f32_16x16x32_bf16 v[180:183], v[44:47], a[4:7], v[180:183]
s_waitcnt lgkmcnt(2)
v_mfma_f32_16x16x32_bf16 v[184:187], v[48:51], a[0:3], 0
ds_read_b128 v[64:67], v9 offset:38912
v_mfma_f32_16x16x32_bf16 v[192:195], v[48:51], a[4:7], 0
buffer_load_dwordx4 a[44:47], v4, s[4:7], s48 offen offset:1024 sc1
v_mfma_f32_16x16x32_bf16 v[188:191], v[52:55], a[0:3], 0
ds_read_b128 v[68:71], v9 offset:39936
v_mfma_f32_16x16x32_bf16 v[196:199], v[52:55], a[4:7], 0
s_waitcnt vmcnt(8) lgkmcnt(2)
v_mfma_f32_16x16x32_bf16 v[168:171], v[56:59], a[8:11], v[168:171]
ds_read_b128 v[40:43], v9 offset:0
v_mfma_f32_16x16x32_bf16 v[176:179], v[56:59], a[12:15], v[176:179]
buffer_load_dwordx4 a[48:51], v1, s[4:7], s48 offen offset:2048 sc1
v_mfma_f32_16x16x32_bf16 v[172:175], v[60:63], a[8:11], v[172:175]
ds_read_b128 v[44:47], v9 offset:1024
v_mfma_f32_16x16x32_bf16 v[180:183], v[60:63], a[12:15], v[180:183]
s_waitcnt lgkmcnt(2)
v_mfma_f32_16x16x32_bf16 v[184:187], v[64:67], a[8:11], v[184:187]
ds_read_b128 v[48:51], v9 offset:2048
v_mfma_f32_16x16x32_bf16 v[192:195], v[64:67], a[12:15], v[192:195]
buffer_load_dwordx4 a[52:55], v4, s[4:7], s48 offen offset:2048 sc1
v_mfma_f32_16x16x32_bf16 v[188:191], v[68:71], a[8:11], v[188:191]
ds_read_b128 v[52:55], v9 offset:3072
v_mfma_f32_16x16x32_bf16 v[196:199], v[68:71], a[12:15], v[196:199]
s_waitcnt vmcnt(8) lgkmcnt(2)
v_mfma_f32_16x16x32_bf16 v[168:171], v[40:43], a[16:19], v[168:171]
ds_read_b128 v[56:59], v9 offset:4096
v_mfma_f32_16x16x32_bf16 v[176:179], v[40:43], a[20:23], v[176:179]
buffer_load_dwordx4 a[56:59], v1, s[4:7], s48 offen offset:3072 sc1
v_mfma_f32_16x16x32_bf16 v[172:175], v[44:47], a[16:19], v[172:175]
ds_read_b128 v[60:63], v9 offset:5120
v_mfma_f32_16x16x32_bf16 v[180:183], v[44:47], a[20:23], v[180:183]
s_waitcnt lgkmcnt(2)
v_mfma_f32_16x16x32_bf16 v[184:187], v[48:51], a[16:19], v[184:187]
ds_read_b128 v[64:67], v9 offset:6144
v_mfma_f32_16x16x32_bf16 v[192:195], v[48:51], a[20:23], v[192:195]
buffer_load_dwordx4 a[60:63], v4, s[4:7], s48 offen offset:3072 sc1
v_mfma_f32_16x16x32_bf16 v[188:191], v[52:55], a[16:19], v[188:191]
ds_read_b128 v[68:71], v9 offset:7168
v_mfma_f32_16x16x32_bf16 v[196:199], v[52:55], a[20:23], v[196:199]
s_waitcnt vmcnt(8) lgkmcnt(2)
v_mfma_f32_16x16x32_bf16 v[168:171], v[56:59], a[24:27], v[168:171]
ds_read_b128 v[40:43], v9 offset:16384
s_add_u32 m0, s21, 131072
s_add_u32 s47, s19, 32768
v_mfma_f32_16x16x32_bf16 v[176:179], v[56:59], a[28:31], v[176:179]
buffer_load_dwordx4 v1, s[4:7], s47 offen offset:0 sc1 lds
v_mfma_f32_16x16x32_bf16 v[172:175], v[60:63], a[24:27], v[172:175]
ds_read_b128 v[44:47], v9 offset:17408
v_mfma_f32_16x16x32_bf16 v[180:183], v[60:63], a[28:31], v[180:183]
s_waitcnt lgkmcnt(2)
v_mfma_f32_16x16x32_bf16 v[184:187], v[64:67], a[24:27], v[184:187]
ds_read_b128 v[48:51], v9 offset:18432
v_mfma_f32_16x16x32_bf16 v[192:195], v[64:67], a[28:31], v[192:195]
buffer_load_dwordx4 v1, s[4:7], s47 offen offset:1024 sc1 lds
v_mfma_f32_16x16x32_bf16 v[188:191], v[68:71], a[24:27], v[188:191]
ds_read_b128 v[52:55], v9 offset:19456
v_mfma_f32_16x16x32_bf16 v[196:199], v[68:71], a[28:31], v[196:199]
s_waitcnt vmcnt(8) lgkmcnt(2)
v_mfma_f32_16x16x32_bf16 v[168:171], v[40:43], a[32:35], v[168:171]
ds_read_b128 v[56:59], v9 offset:20480
v_mfma_f32_16x16x32_bf16 v[176:179], v[40:43], a[36:39], v[176:179]
v_mfma_f32_16x16x32_bf16 v[172:175], v[44:47], a[32:35], v[172:175]
ds_read_b128 v[60:63], v9 offset:21504
v_mfma_f32_16x16x32_bf16 v[180:183], v[44:47], a[36:39], v[180:183]
buffer_load_dwordx4 v1, s[4:7], s47 offen offset:2048 sc1 lds
s_waitcnt lgkmcnt(2)
v_mfma_f32_16x16x32_bf16 v[184:187], v[48:51], a[32:35], v[184:187]
ds_read_b128 v[64:67], v9 offset:22528
v_mfma_f32_16x16x32_bf16 v[192:195], v[48:51], a[36:39], v[192:195]
v_mfma_f32_16x16x32_bf16 v[188:191], v[52:55], a[32:35], v[188:191]
ds_read_b128 v[68:71], v9 offset:23552
v_mfma_f32_16x16x32_bf16 v[196:199], v[52:55], a[36:39], v[196:199]
buffer_load_dwordx4 v1, s[4:7], s47 offen offset:3072 sc1 lds
s_waitcnt vmcnt(8) lgkmcnt(2)
v_mfma_f32_16x16x32_bf16 v[168:171], v[56:59], a[40:43], v[168:171]
ds_read_b128 v[40:43], v8 offset:0
v_mfma_f32_16x16x32_bf16 v[176:179], v[56:59], a[44:47], v[176:179]
v_mfma_f32_16x16x32_bf16 v[172:175], v[60:63], a[40:43], v[172:175]
ds_read_b128 v[44:47], v8 offset:1024
v_mfma_f32_16x16x32_bf16 v[180:183], v[60:63], a[44:47], v[180:183]
s_waitcnt lgkmcnt(2)
v_mfma_f32_16x16x32_bf16 v[184:187], v[64:67], a[40:43], v[184:187]
ds_read_b128 v[48:51], v8 offset:2048
s_add_u32 m0, s21, 16384
s_add_u32 s47, s19, 49152
v_mfma_f32_16x16x32_bf16 v[192:195], v[64:67], a[44:47], v[192:195]
buffer_load_dwordx4 v1, s[4:7], s47 offen offset:0 sc1 lds
v_mfma_f32_16x16x32_bf16 v[188:191], v[68:71], a[40:43], v[188:191]
ds_read_b128 v[52:55], v8 offset:3072
v_mfma_f32_16x16x32_bf16 v[196:199], v[68:71], a[44:47], v[196:199]
s_waitcnt vmcnt(7) lgkmcnt(2)
ds_read_b128 v[56:59], v8 offset:4096
buffer_load_dwordx4 v1, s[4:7], s47 offen offset:1024 sc1 lds
ds_read_b128 v[60:63], v8 offset:5120
ds_read_b128 v[64:67], v8 offset:6144
ds_read_b128 v[68:71], v8 offset:7168
buffer_load_dwordx4 v1, s[4:7], s47 offen offset:2048 sc1 lds
buffer_load_dwordx4 v1, s[4:7], s47 offen offset:3072 sc1 lds
s_waitcnt lgkmcnt(5)
v_mfma_f32_16x16x32_bf16 v[184:187], v[48:51], a[48:51], v[184:187]
v_mfma_f32_16x16x32_bf16 v[192:195], v[48:51], a[52:55], v[192:195]
s_waitcnt lgkmcnt(4)
v_mfma_f32_16x16x32_bf16 v[188:191], v[52:55], a[48:51], v[188:191]
v_mfma_f32_16x16x32_bf16 v[196:199], v[52:55], a[52:55], v[196:199]
s_waitcnt vmcnt(9) lgkmcnt(1)
v_mfma_f32_16x16x32_bf16 v[184:187], v[64:67], a[56:59], v[184:187]
s_waitcnt vmcnt(8)
v_mfma_f32_16x16x32_bf16 v[192:195], v[64:67], a[60:63], v[192:195]
s_waitcnt lgkmcnt(0)
v_mfma_f32_16x16x32_bf16 v[188:191], v[68:71], a[56:59], v[188:191]
v_mfma_f32_16x16x32_bf16 v[196:199], v[68:71], a[60:63], v[196:199]
v_mfma_f32_16x16x32_bf16 v[168:171], v[40:43], a[48:51], v[168:171]
v_mfma_f32_16x16x32_bf16 v[176:179], v[40:43], a[52:55], v[176:179]
v_mfma_f32_16x16x32_bf16 v[172:175], v[44:47], a[48:51], v[172:175]
v_mfma_f32_16x16x32_bf16 v[180:183], v[44:47], a[52:55], v[180:183]
ds_write_b128 v18, v[184:187] offset:0
v_mfma_f32_16x16x32_bf16 v[168:171], v[56:59], a[56:59], v[168:171]
s_nop 0
ds_write_b128 v18, v[188:191] offset:1024
v_mfma_f32_16x16x32_bf16 v[176:179], v[56:59], a[60:63], v[176:179]
ds_write_b128 v18, v[192:195] offset:2048
v_mfma_f32_16x16x32_bf16 v[172:175], v[60:63], a[56:59], v[172:175]
ds_write_b128 v18, v[196:199] offset:3072
v_mfma_f32_16x16x32_bf16 v[180:183], v[60:63], a[60:63], v[180:183]
s_waitcnt lgkmcnt(0)
s_barrier
ds_read_b128 v[224:227], v19 offset:0
ds_read_b128 v[228:231], v19 offset:1024
ds_read_b128 v[232:235], v19 offset:2048
ds_read_b128 v[236:239], v19 offset:3072
s_waitcnt lgkmcnt(3)
v_pk_add_f32 v[168:169], v[168:169], v[224:225]
v_pk_add_f32 v[170:171], v[170:171], v[226:227]
s_waitcnt lgkmcnt(2)
v_pk_add_f32 v[172:173], v[172:173], v[228:229]
v_pk_add_f32 v[174:175], v[174:175], v[230:231]
s_waitcnt lgkmcnt(1)
v_pk_add_f32 v[176:177], v[176:177], v[232:233]
v_pk_add_f32 v[178:179], v[178:179], v[234:235]
s_waitcnt lgkmcnt(0)
v_pk_add_f32 v[180:181], v[180:181], v[236:237]
v_pk_add_f32 v[182:183], v[182:183], v[238:239]
v_cvt_pk_bf16_f32 v124, v168, v169
v_cvt_pk_bf16_f32 v125, v170, v171
v_cvt_pk_bf16_f32 v126, v172, v173
v_cvt_pk_bf16_f32 v127, v174, v175
v_cvt_pk_bf16_f32 v128, v176, v177
v_cvt_pk_bf16_f32 v129, v178, v179
v_cvt_pk_bf16_f32 v130, v180, v181
v_cvt_pk_bf16_f32 v131, v182, v183
buffer_store_dwordx4 v[124:127], v1, s[4:7], s28 offen sc1
buffer_store_dwordx4 v[128:131], v4, s[4:7], s28 offen sc1
v_pk_mul_f32 v[226:227], v[168:169], v[168:169]
v_pk_add_f32 v[224:225], v[168:169], v[170:171]
v_pk_mul_f32 v[230:231], v[176:177], v[176:177]
v_pk_add_f32 v[228:229], v[176:177], v[178:179]
v_pk_fma_f32 v[226:227], v[170:171], v[170:171], v[226:227]
v_pk_fma_f32 v[230:231], v[178:179], v[178:179], v[230:231]
v_pk_fma_f32 v[226:227], v[172:173], v[172:173], v[226:227]
v_pk_add_f32 v[224:225], v[224:225], v[172:173]
v_pk_fma_f32 v[230:231], v[180:181], v[180:181], v[230:231]
v_pk_add_f32 v[228:229], v[228:229], v[180:181]
v_pk_fma_f32 v[226:227], v[174:175], v[174:175], v[226:227]
v_pk_add_f32 v[224:225], v[224:225], v[174:175]
v_pk_fma_f32 v[230:231], v[182:183], v[182:183], v[230:231]
v_pk_add_f32 v[228:229], v[228:229], v[182:183]
v_add_f32 v224, v224, v225
v_add_f32 v226, v226, v227
v_add_f32 v228, v228, v229
v_add_f32 v230, v230, v231
v_permlane32_swap_b32 v224, v226
s_nop 0
v_permlane32_swap_b32 v228, v230
v_add_f32 v224, v224, v226
v_add_f32 v228, v228, v230
s_nop 1
v_permlane16_swap_b32 v224, v228
v_add_f32 v224, v224, v228
buffer_store_dword v224, v7, s[4:7], s29 offen sc1
s_waitcnt vmcnt(0)
buffer_store_dwordx2 v[36:37], v26, s[4:7], s38 offen offset:512 sc1
s_add_u32 m0, s21, 32768
s_add_u32 s47, s19, 65536
buffer_load_dwordx4 v1, s[4:7], s47 offen offset:0 sc1 lds
buffer_load_dwordx4 v1, s[4:7], s47 offen offset:1024 sc1 lds
buffer_load_dwordx4 v1, s[4:7], s47 offen offset:2048 sc1 lds
buffer_load_dwordx4 v1, s[4:7], s47 offen offset:3072 sc1 lds
buffer_load_dwordx2 v[38:39], v16, s[4:7], s39 offen offset:512 sc1
buffer_load_dwordx2 v[252:253], v16, s[4:7], s39 offen offset:512 sc1
s_waitcnt vmcnt(1)
v_cmp_ne_u64 vcc, s[66:67], v[38:39]
s_nop 0
s_cbranch_vccnz LS1_sp8
LS1_ok7:
s_add_u32 s48, s30, 0
buffer_load_dwordx4 a[0:3], v1, s[4:7], s48 offen offset:0 sc1
buffer_load_dwordx4 a[4:7], v4, s[4:7], s48 offen offset:0 sc1
buffer_load_dwordx4 a[8:11], v1, s[4:7], s48 offen offset:1024 sc1
buffer_load_dwordx4 a[12:15], v4, s[4:7], s48 offen offset:1024 sc1
buffer_load_dwordx4 a[16:19], v1, s[4:7], s48 offen offset:2048 sc1
buffer_load_dwordx4 a[20:23], v4, s[4:7], s48 offen offset:2048 sc1
buffer_load_dwordx4 a[24:27], v1, s[4:7], s48 offen offset:3072 sc1
buffer_load_dwordx4 a[28:31], v4, s[4:7], s48 offen offset:3072 sc1
s_add_u32 s48, s30, 4096
buffer_load_dwordx4 a[32:35], v1, s[4:7], s48 offen offset:0 sc1
buffer_load_dwordx4 a[36:39], v4, s[4:7], s48 offen offset:0 sc1
s_barrier
v_lshlrev_b32 v240, 3, v0
v_add_u32 v240, 147456, v240
ds_write_b64 v240, v[32:33]
v_and_b32 v25, 15, v0
v_lshlrev_b32 v25, 3, v25
v_add_u32 v25, 147456, v25
ds_read_b128 v[40:43], v1 offset:49152
ds_read_b128 v[44:47], v1 offset:50176
ds_read_b128 v[48:51], v1 offset:51200
ds_read_b128 v[52:55], v1 offset:52224
ds_read_b128 v[56:59], v1 offset:53248
ds_read_b128 v[60:63], v1 offset:54272
s_waitcnt vmcnt(8) lgkmcnt(2)
v_mfma_f32_16x16x32_bf16 v[72:75], v[40:43], a[0:3], 0
ds_read_b128 v[64:67], v1 offset:55296
v_mfma_f32_16x16x32_bf16 v[76:79], v[40:43], a[4:7], 0
buffer_load_dwordx4 a[40:43], v1, s[4:7], s48 offen offset:1024 sc1
v_mfma_f32_16x16x32_bf16 v[80:83], v[44:47], a[0:3], 0
ds_read_b128 v[68:71], v1 offset:56320
v_mfma_f32_16x16x32_bf16 v[84:87], v[44:47], a[4:7], 0
buffer_load_dwordx4 v[224:227], v6, s[4:7], s31 offen offset:0 sc1
v_mfma_f32_16x16x32_bf16 v[88:91], v[48:51], a[0:3], 0
ds_read_b128 v[40:43], v1 offset:57344
v_mfma_f32_16x16x32_bf16 v[92:95], v[48:51], a[4:7], 0
buffer_load_dwordx4 a[44:47], v4, s[4:7], s48 offen offset:1024 sc1
v_mfma_f32_16x16x32_bf16 v[96:99], v[52:55], a[0:3], 0
ds_read_b128 v[44:47], v1 offset:58368
v_mfma_f32_16x16x32_bf16 v[100:103], v[52:55], a[4:7], 0
buffer_load_dwordx4 v[228:231], v6, s[4:7], s31 offen offset:1024 sc1
s_waitcnt vmcnt(10) lgkmcnt(2)
v_mfma_f32_16x16x32_bf16 v[72:75], v[56:59], a[8:11], v[72:75]
ds_read_b128 v[48:51], v1 offset:59392
v_mfma_f32_16x16x32_bf16 v[76:79], v[56:59], a[12:15], v[76:79]
buffer_load_dwordx4 a[48:51], v1, s[4:7], s48 offen offset:2048 sc1
v_mfma_f32_16x16x32_bf16 v[80:83], v[60:63], a[8:11], v[80:83]
ds_read_b128 v[52:55], v1 offset:60416
v_mfma_f32_16x16x32_bf16 v[84:87], v[60:63], a[12:15], v[84:87]
buffer_load_dwordx4 v[232:235], v6, s[4:7], s31 offen offset:2048 sc1
v_mfma_f32_16x16x32_bf16 v[88:91], v[64:67], a[8:11], v[88:91]
ds_read_b128 v[56:59], v1 offset:61440
v_mfma_f32_16x16x32_bf16 v[92:95], v[64:67], a[12:15], v[92:95]
buffer_load_dwordx4 a[52:55], v4, s[4:7], s48 offen offset:2048 sc1
v_mfma_f32_16x16x32_bf16 v[96:99], v[68:71], a[8:11], v[96:99]
ds_read_b128 v[60:63], v1 offset:62464
v_mfma_f32_16x16x32_bf16 v[100:103], v[68:71], a[12:15], v[100:103]
buffer_load_dwordx4 v[236:239], v6, s[4:7], s31 offen offset:3072 sc1
s_waitcnt vmcnt(12) lgkmcnt(2)
v_mfma_f32_16x16x32_bf16 v[72:75], v[40:43], a[16:19], v[72:75]
ds_read_b128 v[64:67], v1 offset:63488
v_mfma_f32_16x16x32_bf16 v[76:79], v[40:43], a[20:23], v[76:79]
buffer_load_dwordx4 a[56:59], v1, s[4:7], s48 offen offset:3072 sc1
v_mfma_f32_16x16x32_bf16 v[80:83], v[44:47], a[16:19], v[80:83]
ds_read_b128 v[68:71], v1 offset:64512
v_mfma_f32_16x16x32_bf16 v[84:87], v[44:47], a[20:23], v[84:87]
v_mfma_f32_16x16x32_bf16 v[88:91], v[48:51], a[16:19], v[88:91]
ds_read_b128 v[40:43], v2 offset:49152
v_mfma_f32_16x16x32_bf16 v[92:95], v[48:51], a[20:23], v[92:95]
buffer_load_dwordx4 a[60:63], v4, s[4:7], s48 offen offset:3072 sc1
v_mfma_f32_16x16x32_bf16 v[96:99], v[52:55], a[16:19], v[96:99]
ds_read_b128 v[44:47], v2 offset:50176
v_mfma_f32_16x16x32_bf16 v[100:103], v[52:55], a[20:23], v[100:103]
s_waitcnt vmcnt(12) lgkmcnt(2)
v_mfma_f32_16x16x32_bf16 v[72:75], v[56:59], a[24:27], v[72:75]
ds_read_b128 v[48:51], v2 offset:51200
s_add_u32 s48, s30, 8192
v_mfma_f32_16x16x32_bf16 v[76:79], v[56:59], a[28:31], v[76:79]
buffer_load_dwordx4 a[64:67], v1, s[4:7], s48 offen offset:0 sc1
v_mfma_f32_16x16x32_bf16 v[80:83], v[60:63], a[24:27], v[80:83]
ds_read_b128 v[52:55], v2 offset:52224
v_mfma_f32_16x16x32_bf16 v[84:87], v[60:63], a[28:31], v[84:87]
v_mfma_f32_16x16x32_bf16 v[88:91], v[64:67], a[24:27], v[88:91]
ds_read_b128 v[56:59], v2 offset:53248
v_mfma_f32_16x16x32_bf16 v[92:95], v[64:67], a[28:31], v[92:95]
buffer_load_dwordx4 a[68:71], v4, s[4:7], s48 offen offset:0 sc1
v_mfma_f32_16x16x32_bf16 v[96:99], v[68:71], a[24:27], v[96:99]
ds_read_b128 v[60:63], v2 offset:54272
v_mfma_f32_16x16x32_bf16 v[100:103], v[68:71], a[28:31], v[100:103]
s_waitcnt vmcnt(12) lgkmcnt(2)
v_mfma_f32_16x16x32_bf16 v[72:75], v[40:43], a[32:35], v[72:75]
ds_read_b128 v[64:67], v2 offset:55296
v_mfma_f32_16x16x32_bf16 v[76:79], v[40:43], a[36:39], v[76:79]
buffer_load_dwordx4 a[72:75], v1, s[4:7], s48 offen offset:1024 sc1
v_mfma_f32_16x16x32_bf16 v[80:83], v[44:47], a[32:35], v[80:83]
ds_read_b128 v[68:71], v2 offset:56320
v_mfma_f32_16x16x32_bf16 v[84:87], v[44:47], a[36:39], v[84:87]
v_mfma_f32_16x16x32_bf16 v[88:91], v[48:51], a[32:35], v[88:91]
ds_read_b128 v[40:43], v2 offset:57344
v_mfma_f32_16x16x32_bf16 v[92:95], v[48:51], a[36:39], v[92:95]
buffer_load_dwordx4 a[76:79], v4, s[4:7], s48 offen offset:1024 sc1
v_mfma_f32_16x16x32_bf16 v[96:99], v[52:55], a[32:35], v[96:99]
ds_read_b128 v[44:47], v2 offset:58368
v_mfma_f32_16x16x32_bf16 v[100:103], v[52:55], a[36:39], v[100:103]
s_waitcnt vmcnt(11) lgkmcnt(2)
v_mfma_f32_16x16x32_bf16 v[72:75], v[56:59], a[40:43], v[72:75]
ds_read_b128 v[48:51], v2 offset:59392
v_mfma_f32_16x16x32_bf16 v[76:79], v[56:59], a[44:47], v[76:79]
buffer_load_dwordx4 a[80:83], v1, s[4:7], s48 offen offset:2048 sc1
v_mfma_f32_16x16x32_bf16 v[80:83], v[60:63], a[40:43], v[80:83]
ds_read_b128 v[52:55], v2 offset:60416
v_mfma_f32_16x16x32_bf16 v[84:87], v[60:63], a[44:47], v[84:87]
v_mfma_f32_16x16x32_bf16 v[88:91], v[64:67], a[40:43], v[88:91]
ds_read_b128 v[56:59], v2 offset:61440
v_mfma_f32_16x16x32_bf16 v[92:95], v[64:67], a[44:47], v[92:95]
buffer_load_dwordx4 a[84:87], v4, s[4:7], s48 offen offset:2048 sc1
v_mfma_f32_16x16x32_bf16 v[96:99], v[68:71], a[40:43], v[96:99]
ds_read_b128 v[60:63], v2 offset:62464
v_mfma_f32_16x16x32_bf16 v[100:103], v[68:71], a[44:47], v[100:103]
s_waitcnt vmcnt(9) lgkmcnt(2)
v_mfma_f32_16x16x32_bf16 v[72:75], v[40:43], a[48:51], v[72:75]
ds_read_b128 v[64:67], v2 offset:63488
buffer_load_dwordx4 a[88:91], v1, s[4:7], s48 offen offset:3072 sc1
v_mfma_f32_16x16x32_bf16 v[76:79], v[40:43], a[52:55], v[76:79]
v_add_f32 v224, v224, v226
v_mfma_f32_16x16x32_bf16 v[80:83], v[44:47], a[48:51], v[80:83]
ds_read_b128 v[68:71], v2 offset:64512
v_add_f32 v225, v225, v227
v_mfma_f32_16x16x32_bf16 v[84:87], v[44:47], a[52:55], v[84:87]
v_add_f32 v228, v228, v230
v_mfma_f32_16x16x32_bf16 v[88:91], v[48:51], a[48:51], v[88:91]
ds_read_b128 v[40:43], v3 offset:0
buffer_load_dwordx4 a[92:95], v4, s[4:7], s48 offen offset:3072 sc1
v_mfma_f32_16x16x32_bf16 v[92:95], v[48:51], a[52:55], v[92:95]
v_add_f32 v229, v229, v231
v_mfma_f32_16x16x32_bf16 v[96:99], v[52:55], a[48:51], v[96:99]
ds_read_b128 v[44:47], v3 offset:1024
v_add_f32 v232, v232, v234
v_mfma_f32_16x16x32_bf16 v[100:103], v[52:55], a[52:55], v[100:103]
v_add_f32 v233, v233, v235
s_waitcnt vmcnt(10)
v_add_f32 v236, v236, v238
s_waitcnt vmcnt(8) lgkmcnt(2)
v_mfma_f32_16x16x32_bf16 v[72:75], v[56:59], a[56:59], v[72:75]
ds_read_b128 v[48:51], v3 offset:2048
s_add_u32 s48, s30, 12288
v_mfma_f32_16x16x32_bf16 v[76:79], v[56:59], a[60:63], v[76:79]
buffer_load_dwordx4 a[96:99], v1, s[4:7], s48 offen offset:0 sc1
v_mfma_f32_16x16x32_bf16 v[80:83], v[60:63], a[56:59], v[80:83]
ds_read_b128 v[52:55], v3 offset:3072
v_add_f32 v237, v237, v239
v_mfma_f32_16x16x32_bf16 v[84:87], v[60:63], a[60:63], v[84:87]
v_add_f32 v224, v224, v228
v_mfma_f32_16x16x32_bf16 v[88:91], v[64:67], a[56:59], v[88:91]
ds_read_b128 v[56:59], v3 offset:4096
v_mfma_f32_16x16x32_bf16 v[92:95], v[64:67], a[60:63], v[92:95]
buffer_load_dwordx4 a[100:103], v4, s[4:7], s48 offen offset:0 sc1
v_mfma_f32_16x16x32_bf16 v[96:99], v[68:71], a[56:59], v[96:99]
ds_read_b128 v[60:63], v3 offset:5120
v_add_f32 v225, v225, v229
v_mfma_f32_16x16x32_bf16 v[100:103], v[68:71], a[60:63], v[100:103]
v_add_f32 v232, v232, v236
v_add_f32 v233, v233, v237
s_waitcnt vmcnt(8) lgkmcnt(2)
v_mfma_f32_16x16x32_bf16 v[72:75], v[40:43], a[64:67], v[72:75]
ds_read_b128 v[64:67], v3 offset:6144
buffer_load_dwordx4 a[104:107], v1, s[4:7], s48 offen offset:1024 sc1
v_mfma_f32_16x16x32_bf16 v[76:79], v[40:43], a[68:71], v[76:79]
v_add_f32 v224, v224, v232
v_mfma_f32_16x16x32_bf16 v[80:83], v[44:47], a[64:67], v[80:83]
ds_read_b128 v[68:71], v3 offset:7168
v_add_f32 v225, v225, v233
v_mfma_f32_16x16x32_bf16 v[84:87], v[44:47], a[68:71], v[84:87]
v_mov_b32 v226, v224
v_mfma_f32_16x16x32_bf16 v[88:91], v[48:51], a[64:67], v[88:91]
ds_read_b128 v[40:43], v3 offset:8192
buffer_load_dwordx4 a[108:111], v4, s[4:7], s48 offen offset:1024 sc1
v_mfma_f32_16x16x32_bf16 v[92:95], v[48:51], a[68:71], v[92:95]
v_mov_b32 v227, v225
v_mfma_f32_16x16x32_bf16 v[96:99], v[52:55], a[64:67], v[96:99]
ds_read_b128 v[44:47], v3 offset:9216
v_permlane32_swap_b32 v224, v226
v_mfma_f32_16x16x32_bf16 v[100:103], v[52:55], a[68:71], v[100:103]
v_permlane32_swap_b32 v225, v227
v_add_f32 v224, v224, v226
s_waitcnt vmcnt(8) lgkmcnt(2)
v_mfma_f32_16x16x32_bf16 v[72:75], v[56:59], a[72:75], v[72:75]
ds_read_b128 v[48:51], v3 offset:10240
v_mfma_f32_16x16x32_bf16 v[76:79], v[56:59], a[76:79], v[76:79]
buffer_load_dwordx4 a[112:115], v1, s[4:7], s48 offen offset:2048 sc1
v_mfma_f32_16x16x32_bf16 v[80:83], v[60:63], a[72:75], v[80:83]
ds_read_b128 v[52:55], v3 offset:11264
v_add_f32 v225, v225, v227
v_mfma_f32_16x16x32_bf16 v[84:87], v[60:63], a[76:79], v[84:87]
v_mul_f32 v224, 0xbb000000, v224
v_mul_f32 v225, 0x3b000000, v225
v_mfma_f32_16x16x32_bf16 v[88:91], v[64:67], a[72:75], v[88:91]
ds_read_b128 v[56:59], v3 offset:12288
v_mfma_f32_16x16x32_bf16 v[92:95], v[64:67], a[76:79], v[92:95]
buffer_load_dwordx4 a[116:119], v4, s[4:7], s48 offen offset:2048 sc1
v_mfma_f32_16x16x32_bf16 v[96:99], v[68:71], a[72:75], v[96:99]
ds_read_b128 v[60:63], v3 offset:13312
v_fma_f32 v225, -v224, v224, v225
v_mfma_f32_16x16x32_bf16 v[100:103], v[68:71], a[76:79], v[100:103]
v_max_f32 v225, 0, v225
v_add_f32 v225, 0x3727c5ac, v225
s_waitcnt vmcnt(8) lgkmcnt(2)
v_mfma_f32_16x16x32_bf16 v[72:75], v[40:43], a[80:83], v[72:75]
ds_read_b128 v[64:67], v3 offset:14336
v_mfma_f32_16x16x32_bf16 v[76:79], v[40:43], a[84:87], v[76:79]
buffer_load_dwordx4 a[120:123], v1, s[4:7], s48 offen offset:3072 sc1
v_mfma_f32_16x16x32_bf16 v[80:83], v[44:47], a[80:83], v[80:83]
ds_read_b128 v[68:71], v3 offset:15360
v_rsq_f32 v226, v225
v_mfma_f32_16x16x32_bf16 v[84:87], v[44:47], a[84:87], v[84:87]
v_mul_f32 v200, 0xbfb8aa3b, v226
v_mfma_f32_16x16x32_bf16 v[88:91], v[48:51], a[80:83], v[88:91]
ds_read_b128 v[40:43], v1 offset:16384
buffer_load_dwordx4 a[124:127], v4, s[4:7], s48 offen offset:3072 sc1
v_mfma_f32_16x16x32_bf16 v[92:95], v[48:51], a[84:87], v[92:95]
v_mov_b32 v202, v225
v_mfma_f32_16x16x32_bf16 v[96:99], v[52:55], a[80:83], v[96:99]
ds_read_b128 v[44:47], v1 offset:17408
v_mov_b32 v203, v225
v_mfma_f32_16x16x32_bf16 v[100:103], v[52:55], a[84:87], v[100:103]
v_mov_b32 v201, v200
v_mov_b32 v225, v224
s_waitcnt vmcnt(8) lgkmcnt(2)
v_mfma_f32_16x16x32_bf16 v[72:75], v[56:59], a[88:91], v[72:75]
ds_read_b128 v[48:51], v1 offset:18432
v_permlane16_swap_b32 v202, v203
v_permlane16_swap_b32 v200, v201
s_add_u32 m0, s21, 98304
v_mfma_f32_16x16x32_bf16 v[76:79], v[56:59], a[92:95], v[76:79]
s_add_u32 s47, s19, 81920
buffer_load_dwordx4 v1, s[4:7], s47 offen offset:0 sc1 lds
v_mfma_f32_16x16x32_bf16 v[80:83], v[60:63], a[88:91], v[80:83]
ds_read_b128 v[52:55], v1 offset:19456
v_permlane16_swap_b32 v224, v225
s_mov_b64 vcc, 0xffff
v_cndmask_b32 v224, 0, v224, vcc
v_cndmask_b32 v225, 0, v225, vcc
v_mfma_f32_16x16x32_bf16 v[84:87], v[60:63], a[92:95], v[84:87]
buffer_load_dwordx4 v1, s[4:7], s47 offen offset:1024 sc1 lds
v_mfma_f32_16x16x32_bf16 v[88:91], v[64:67], a[88:91], v[88:91]
ds_read_b128 v[56:59], v1 offset:20480
v_mfma_f32_16x16x32_bf16 v[92:95], v[64:67], a[92:95], v[92:95]
v_cvt_pk_bf16_f32 v232, v224, v224
v_mfma_f32_16x16x32_bf16 v[96:99], v[68:71], a[88:91], v[96:99]
ds_read_b128 v[60:63], v1 offset:21504
v_lshlrev_b32 v226, 16, v232
v_sub_f32 v226, v224, v226
v_mfma_f32_16x16x32_bf16 v[100:103], v[68:71], a[92:95], v[100:103]
v_cvt_pk_bf16_f32 v233, v226, 0
buffer_load_dwordx4 v1, s[4:7], s47 offen offset:2048 sc1 lds
s_waitcnt vmcnt(9) lgkmcnt(2)
v_mfma_f32_16x16x32_bf16 v[72:75], v[40:43], a[96:99], v[72:75]
ds_read_b128 v[64:67], v1 offset:22528
v_cvt_pk_bf16_f32 v236, v225, v225
v_mfma_f32_16x16x32_bf16 v[76:79], v[40:43], a[100:103], v[76:79]
v_lshlrev_b32 v226, 16, v236
v_sub_f32 v226, v225, v226
v_mfma_f32_16x16x32_bf16 v[80:83], v[44:47], a[96:99], v[80:83]
ds_read_b128 v[68:71], v1 offset:23552
v_cvt_pk_bf16_f32 v237, v226, 0
v_mov_b32 v226, 0
v_mfma_f32_16x16x32_bf16 v[84:87], v[44:47], a[100:103], v[84:87]
buffer_load_dwordx4 v1, s[4:7], s47 offen offset:3072 sc1 lds
v_mfma_f32_16x16x32_bf16 v[88:91], v[48:51], a[96:99], v[88:91]
ds_read_b128 v[40:43], v1 offset:24576
v_mov_b32 v227, 0
v_mfma_f32_16x16x32_bf16 v[92:95], v[48:51], a[100:103], v[92:95]
v_mov_b32 v230, 0
v_mov_b32 v231, 0
v_mfma_f32_16x16x32_bf16 v[96:99], v[52:55], a[96:99], v[96:99]
ds_read_b128 v[44:47], v1 offset:25600
v_mov_b32 v234, 0
v_mov_b32 v235, 0
v_mov_b32 v238, 0
v_mfma_f32_16x16x32_bf16 v[100:103], v[52:55], a[100:103], v[100:103]
s_add_u32 s57, s20, 131072
buffer_load_dwordx4 a[128:131], v1, s[4:7], s57 offen offset:0 sc1
s_waitcnt vmcnt(9) lgkmcnt(2)
v_mfma_f32_16x16x32_bf16 v[72:75], v[56:59], a[104:107], v[72:75]
ds_read_b128 v[48:51], v1 offset:26624
v_mov_b32 v239, 0
v_mfma_f32_16x16x32_bf16 v[76:79], v[56:59], a[108:111], v[76:79]
s_add_u32 s76, s33, 0
v_mfma_f32_16x16x32_bf16 v[80:83], v[60:63], a[104:107], v[80:83]
ds_read_b128 v[52:55], v1 offset:27648
s_add_u32 s77, s33, 7168
s_add_u32 s78, s33, 14336
v_mfma_f32_16x16x32_bf16 v[84:87], v[60:63], a[108:111], v[84:87]
s_add_u32 s79, s33, 21504
buffer_load_dwordx4 a[132:135], v1, s[4:7], s57 offen offset:1024 sc1
v_mfma_f32_16x16x32_bf16 v[88:91], v[64:67], a[104:107], v[88:91]
ds_read_b128 v[56:59], v1 offset:28672
s_add_u32 s80, s33, 57344
v_mfma_f32_16x16x32_bf16 v[92:95], v[64:67], a[108:111], v[92:95]
s_add_u32 s81, s33, 64512
v_mfma_f32_16x16x32_bf16 v[96:99], v[68:71], a[104:107], v[96:99]
ds_read_b128 v[60:63], v1 offset:29696
s_add_u32 s82, s33, 71680
s_add_u32 s83, s33, 78848
v_mfma_f32_16x16x32_bf16 v[100:103], v[68:71], a[108:111], v[100:103]
s_add_u32 s58, s32, 57344
buffer_load_dwordx4 a[136:139], v1, s[4:7], s57 offen offset:2048 sc1
s_waitcnt vmcnt(9) lgkmcnt(2)
v_mfma_f32_16x16x32_bf16 v[72:75], v[40:43], a[112:115], v[72:75]
ds_read_b128 v[64:67], v1 offset:30720
v_mfma_f32_16x16x32_bf16 v[76:79], v[40:43], a[116:119], v[76:79]
v_mfma_f32_16x16x32_bf16 v[80:83], v[44:47], a[112:115], v[80:83]
s_barrier
ds_read_b128 v[68:71], v1 offset:31744
v_mfma_f32_16x16x32_bf16 v[84:87], v[44:47], a[116:119], v[84:87]
buffer_load_dwordx4 a[140:143], v1, s[4:7], s57 offen offset:3072 sc1
v_mfma_f32_16x16x32_bf16 v[88:91], v[48:51], a[112:115], v[88:91]
ds_read_b128 v[40:43], v1 offset:32768
v_mfma_f32_16x16x32_bf16 v[92:95], v[48:51], a[116:119], v[92:95]
v_mfma_f32_16x16x32_bf16 v[96:99], v[52:55], a[112:115], v[96:99]
ds_read_b128 v[44:47], v1 offset:33792
s_add_u32 m0, s21, 49152
s_add_u32 s47, s19, 98304
v_mfma_f32_16x16x32_bf16 v[100:103], v[52:55], a[116:119], v[100:103]
buffer_load_dwordx4 v1, s[4:7], s47 offen offset:0 sc1 lds
s_waitcnt vmcnt(9) lgkmcnt(2)
v_mfma_f32_16x16x32_bf16 v[72:75], v[56:59], a[120:123], v[72:75]
ds_read_b128 v[48:51], v1 offset:34816
ds_read_b64 v[224:225], v25 offset:0
v_mfma_f32_16x16x32_bf16 v[76:79], v[56:59], a[124:127], v[76:79]
ds_read_b64 v[228:229], v25 offset:128
v_mfma_f32_16x16x32_bf16 v[80:83], v[60:63], a[120:123], v[80:83]
ds_read_b128 v[52:55], v1 offset:35840
v_mfma_f32_16x16x32_bf16 v[84:87], v[60:63], a[124:127], v[84:87]
buffer_load_dwordx4 v1, s[4:7], s47 offen offset:1024 sc1 lds
v_mfma_f32_16x16x32_bf16 v[88:91], v[64:67], a[120:123], v[88:91]
ds_read_b128 v[56:59], v1 offset:36864
v_mfma_f32_16x16x32_bf16 v[92:95], v[64:67], a[124:127], v[92:95]
v_mfma_f32_16x16x32_bf16 v[96:99], v[68:71], a[120:123], v[96:99]
ds_read_b128 v[60:63], v1 offset:37888
v_mfma_f32_16x16x32_bf16 v[100:103], v[68:71], a[124:127], v[100:103]
buffer_load_dwordx4 v1, s[4:7], s47 offen offset:2048 sc1 lds
s_waitcnt lgkmcnt(4)
v_mfma_f32_16x16x32_bf16 v[72:75], v[224:227], v[232:235], v[72:75]
v_mfma_f32_16x16x32_bf16 v[76:79], v[224:227], v[236:239], v[76:79]
s_waitcnt lgkmcnt(3)
v_mfma_f32_16x16x32_bf16 v[80:83], v[228:231], v[232:235], v[80:83]
v_mfma_f32_16x16x32_bf16 v[84:87], v[228:231], v[236:239], v[84:87]
s_waitcnt lgkmcnt(2)
v_mfma_f32_16x16x32_bf16 v[104:107], v[40:43], a[0:3], 0
ds_read_b128 v[64:67], v1 offset:38912
ds_read_b64 v[224:225], v25 offset:256
v_mfma_f32_16x16x32_bf16 v[108:111], v[40:43], a[4:7], 0
ds_read_b64 v[228:229], v25 offset:384
v_mfma_f32_16x16x32_bf16 v[112:115], v[44:47], a[0:3], 0
ds_read_b128 v[68:71], v1 offset:39936
v_mfma_f32_16x16x32_bf16 v[116:119], v[44:47], a[4:7], 0
buffer_load_dwordx4 v1, s[4:7], s47 offen offset:3072 sc1 lds
v_mfma_f32_16x16x32_bf16 v[104:107], v[48:51], a[8:11], v[104:107]
ds_read_b128 v[40:43], v1 offset:40960
v_mul_f32 v240, v200, v72
v_mul_f32 v241, v200, v73
v_mfma_f32_16x16x32_bf16 v[108:111], v[48:51], a[12:15], v[108:111]
v_mul_f32 v242, v200, v74
v_mul_f32 v243, v200, v75
v_mfma_f32_16x16x32_bf16 v[112:115], v[52:55], a[8:11], v[112:115]
ds_read_b128 v[44:47], v1 offset:41984
s_add_u32 m0, s21, 65536
s_add_u32 s47, s20, 0
v_mfma_f32_16x16x32_bf16 v[116:119], v[52:55], a[12:15], v[116:119]
buffer_load_dwordx4 v1, s[4:7], s47 offen offset:0 sc1 lds
s_waitcnt lgkmcnt(4)
v_mfma_f32_16x16x32_bf16 v[88:91], v[224:227], v[232:235], v[88:91]
v_mfma_f32_16x16x32_bf16 v[92:95], v[224:227], v[236:239], v[92:95]
s_waitcnt lgkmcnt(3)
v_mfma_f32_16x16x32_bf16 v[96:99], v[228:231], v[232:235], v[96:99]
v_mfma_f32_16x16x32_bf16 v[100:103], v[228:231], v[236:239], v[100:103]
s_waitcnt lgkmcnt(2)
v_mfma_f32_16x16x32_bf16 v[104:107], v[56:59], a[16:19], v[104:107]
ds_read_b128 v[48:51], v1 offset:43008
v_mul_f32 v244, v201, v76
v_mul_f32 v245, v201, v77
v_mfma_f32_16x16x32_bf16 v[108:111], v[56:59], a[20:23], v[108:111]
v_mul_f32 v246, v201, v78
v_mul_f32 v247, v201, v79
v_mfma_f32_16x16x32_bf16 v[112:115], v[60:63], a[16:19], v[112:115]
ds_read_b128 v[52:55], v1 offset:44032
buffer_load_dwordx4 v1, s[4:7], s47 offen offset:1024 sc1 lds
v_mfma_f32_16x16x32_bf16 v[116:119], v[60:63], a[20:23], v[116:119]
v_exp_f32 v240, v240
v_mfma_f32_16x16x32_bf16 v[104:107], v[64:67], a[24:27], v[104:107]
ds_read_b128 v[56:59], v1 offset:45056
v_mul_f32 v72, v72, v80
v_mfma_f32_16x16x32_bf16 v[108:111], v[64:67], a[28:31], v[108:111]
v_exp_f32 v241, v241
v_mul_f32 v73, v73, v81
v_mfma_f32_16x16x32_bf16 v[112:115], v[68:71], a[24:27], v[112:115]
ds_read_b128 v[60:63], v1 offset:46080
buffer_load_dwordx4 v1, s[4:7], s47 offen offset:2048 sc1 lds
v_mfma_f32_16x16x32_bf16 v[116:119], v[68:71], a[28:31], v[116:119]
v_exp_f32 v242, v242
v_mul_f32 v74, v74, v82
s_waitcnt lgkmcnt(2)
v_mfma_f32_16x16x32_bf16 v[104:107], v[40:43], a[32:35], v[104:107]
ds_read_b128 v[64:67], v1 offset:47104
v_exp_f32 v243, v243
v_mfma_f32_16x16x32_bf16 v[108:111], v[40:43], a[36:39], v[108:111]
v_mul_f32 v75, v75, v83
v_mfma_f32_16x16x32_bf16 v[112:115], v[44:47], a[32:35], v[112:115]
s_waitcnt vmcnt(11)
s_barrier
ds_read_b128 v[68:71], v1 offset:48128
v_mfma_f32_16x16x32_bf16 v[116:119], v[44:47], a[36:39], v[116:119]
buffer_load_dwordx4 v1, s[4:7], s47 offen offset:3072 sc1 lds
v_mfma_f32_16x16x32_bf16 v[104:107], v[48:51], a[40:43], v[104:107]
ds_read_b128 v[40:43], v2 offset:32768
v_exp_f32 v244, v244
v_mfma_f32_16x16x32_bf16 v[108:111], v[48:51], a[44:47], v[108:111]
v_mul_f32 v76, v76, v84
v_exp_f32 v245, v245
v_mfma_f32_16x16x32_bf16 v[112:115], v[52:55], a[40:43], v[112:115]
ds_read_b128 v[44:47], v2 offset:33792
s_add_u32 m0, s21, 16384
s_add_u32 s47, s19, 114688
v_mfma_f32_16x16x32_bf16 v[116:119], v[52:55], a[44:47], v[116:119]
buffer_load_dwordx4 v1, s[4:7], s47 offen offset:0 sc1 lds
s_waitcnt lgkmcnt(2)
v_mfma_f32_16x16x32_bf16 v[104:107], v[56:59], a[48:51], v[104:107]
ds_read_b128 v[48:51], v2 offset:34816
v_mul_f32 v77, v77, v85
v_mfma_f32_16x16x32_bf16 v[108:111], v[56:59], a[52:55], v[108:111]
v_exp_f32 v246, v246
v_mul_f32 v78, v78, v86
v_mfma_f32_16x16x32_bf16 v[112:115], v[60:63], a[48:51], v[112:115]
ds_read_b128 v[52:55], v2 offset:35840
buffer_load_dwordx4 v1, s[4:7], s47 offen offset:1024 sc1 lds
v_mfma_f32_16x16x32_bf16 v[116:119], v[60:63], a[52:55], v[116:119]
v_exp_f32 v247, v247
v_mfma_f32_16x16x32_bf16 v[104:107], v[64:67], a[56:59], v[104:107]
ds_read_b128 v[56:59], v2 offset:36864
v_mul_f32 v79, v79, v87
v_fma_f32 v240, v240, v202, v202
v_mfma_f32_16x16x32_bf16 v[108:111], v[64:67], a[60:63], v[108:111]
v_fma_f32 v241, v241, v202, v202
v_fma_f32 v242, v242, v202, v202
v_fma_f32 v243, v243, v202, v202
v_mfma_f32_16x16x32_bf16 v[112:115], v[68:71], a[56:59], v[112:115]
ds_read_b128 v[60:63], v2 offset:37888
buffer_load_dwordx4 v1, s[4:7], s47 offen offset:2048 sc1 lds
v_mfma_f32_16x16x32_bf16 v[116:119], v[68:71], a[60:63], v[116:119]
v_fma_f32 v244, v244, v203, v203
v_fma_f32 v245, v245, v203, v203
s_waitcnt lgkmcnt(2)
v_mfma_f32_16x16x32_bf16 v[104:107], v[40:43], a[64:67], v[104:107]
ds_read_b128 v[64:67], v2 offset:38912
v_fma_f32 v246, v246, v203, v203
v_fma_f32 v247, v247, v203, v203
v_mfma_f32_16x16x32_bf16 v[108:111], v[40:43], a[68:71], v[108:111]
v_rcp_f32 v240, v240
v_mfma_f32_16x16x32_bf16 v[112:115], v[44:47], a[64:67], v[112:115]
ds_read_b128 v[68:71], v2 offset:39936
buffer_load_dwordx4 v1, s[4:7], s47 offen offset:3072 sc1 lds
v_mfma_f32_16x16x32_bf16 v[116:119], v[44:47], a[68:71], v[116:119]
v_rcp_f32 v241, v241
v_mfma_f32_16x16x32_bf16 v[104:107], v[48:51], a[72:75], v[104:107]
ds_read_b128 v[40:43], v2 offset:40960
v_rcp_f32 v242, v242
v_mfma_f32_16x16x32_bf16 v[108:111], v[48:51], a[76:79], v[108:111]
v_rcp_f32 v243, v243
v_mfma_f32_16x16x32_bf16 v[112:115], v[52:55], a[72:75], v[112:115]
ds_read_b128 v[44:47], v2 offset:41984
s_add_u32 s57, s20, 147456
buffer_load_dwordx4 a[144:147], v1, s[4:7], s57 offen offset:0 sc1
v_mfma_f32_16x16x32_bf16 v[116:119], v[52:55], a[76:79], v[116:119]
v_rcp_f32 v244, v244
s_waitcnt lgkmcnt(2)
v_mfma_f32_16x16x32_bf16 v[104:107], v[56:59], a[80:83], v[104:107]
ds_read_b128 v[48:51], v2 offset:43008
v_rcp_f32 v245, v245
v_mfma_f32_16x16x32_bf16 v[108:111], v[56:59], a[84:87], v[108:111]
v_rcp_f32 v246, v246
v_mfma_f32_16x16x32_bf16 v[112:115], v[60:63], a[80:83], v[112:115]
ds_read_b128 v[52:55], v2 offset:44032
buffer_load_dwordx4 a[148:151], v1, s[4:7], s57 offen offset:1024 sc1
v_mfma_f32_16x16x32_bf16 v[116:119], v[60:63], a[84:87], v[116:119]
v_rcp_f32 v247, v247
v_mfma_f32_16x16x32_bf16 v[104:107], v[64:67], a[88:91], v[104:107]
ds_read_b128 v[56:59], v2 offset:45056
v_mul_f32 v72, v72, v240
v_mfma_f32_16x16x32_bf16 v[108:111], v[64:67], a[92:95], v[108:111]
v_mul_f32 v73, v73, v241
v_mul_f32 v74, v74, v242
v_mfma_f32_16x16x32_bf16 v[112:115], v[68:71], a[88:91], v[112:115]
ds_read_b128 v[60:63], v2 offset:46080
buffer_load_dwordx4 a[152:155], v1, s[4:7], s57 offen offset:2048 sc1
v_mfma_f32_16x16x32_bf16 v[116:119], v[68:71], a[92:95], v[116:119]
v_mul_f32 v75, v75, v243
v_mul_f32 v76, v76, v244
v_mul_f32 v77, v77, v245
s_waitcnt lgkmcnt(2)
v_mfma_f32_16x16x32_bf16 v[104:107], v[40:43], a[96:99], v[104:107]
ds_read_b128 v[64:67], v2 offset:47104
v_mul_f32 v78, v78, v246
v_mul_f32 v79, v79, v247
v_mfma_f32_16x16x32_bf16 v[108:111], v[40:43], a[100:103], v[108:111]
v_cvt_pk_bf16_f32 v248, v72, v73
v_cvt_pk_bf16_f32 v249, v74, v75
v_mfma_f32_16x16x32_bf16 v[112:115], v[44:47], a[96:99], v[112:115]
s_waitcnt vmcnt(11)
s_barrier
ds_read_b128 v[68:71], v2 offset:48128
v_mfma_f32_16x16x32_bf16 v[116:119], v[44:47], a[100:103], v[116:119]
buffer_load_dwordx4 a[156:159], v1, s[4:7], s57 offen offset:3072 sc1
v_mfma_f32_16x16x32_bf16 v[104:107], v[48:51], a[104:107], v[104:107]
ds_read_b128 v[40:43], v1 offset:49152
v_cvt_pk_bf16_f32 v252, v76, v77
v_mfma_f32_16x16x32_bf16 v[108:111], v[48:51], a[108:111], v[108:111]
v_cvt_pk_bf16_f32 v253, v78, v79
v_mfma_f32_16x16x32_bf16 v[112:115], v[52:55], a[104:107], v[112:115]
ds_read_b128 v[44:47], v1 offset:50176
ds_read_b64 v[224:225], v25 offset:512
ds_read_b64 v[228:229], v25 offset:640
s_add_u32 m0, s21, 32768
v_mfma_f32_16x16x32_bf16 v[116:119], v[52:55], a[108:111], v[116:119]
s_add_u32 s47, s19, 131072
buffer_load_dwordx4 v1, s[4:7], s47 offen offset:0 sc1 lds
s_waitcnt lgkmcnt(4)
v_mfma_f32_16x16x32_bf16 v[104:107], v[56:59], a[112:115], v[104:107]
ds_read_b128 v[48:51], v1 offset:51200
v_mul_f32 v240, v200, v88
v_mul_f32 v241, v200, v89
v_mfma_f32_16x16x32_bf16 v[108:111], v[56:59], a[116:119], v[108:111]
v_mul_f32 v242, v200, v90
v_mul_f32 v243, v200, v91
v_mfma_f32_16x16x32_bf16 v[112:115], v[60:63], a[112:115], v[112:115]
ds_read_b128 v[52:55], v1 offset:52224
buffer_load_dwordx4 v1, s[4:7], s47 offen offset:1024 sc1 lds
v_mfma_f32_16x16x32_bf16 v[116:119], v[60:63], a[116:119], v[116:119]
v_mul_f32 v244, v201, v92
v_mul_f32 v245, v201, v93
v_mfma_f32_16x16x32_bf16 v[104:107], v[64:67], a[120:123], v[104:107]
ds_read_b128 v[56:59], v1 offset:53248
v_mul_f32 v246, v201, v94
v_mul_f32 v247, v201, v95
v_mfma_f32_16x16x32_bf16 v[108:111], v[64:67], a[124:127], v[108:111]
v_exp_f32 v240, v240
v_mfma_f32_16x16x32_bf16 v[112:115], v[68:71], a[120:123], v[112:115]
ds_read_b128 v[60:63], v1 offset:54272
buffer_load_dwordx4 v1, s[4:7], s47 offen offset:2048 sc1 lds
v_mfma_f32_16x16x32_bf16 v[116:119], v[68:71], a[124:127], v[116:119]
v_mul_f32 v88, v88, v96
v_exp_f32 v241, v241
s_waitcnt lgkmcnt(5)
v_mfma_f32_16x16x32_bf16 v[104:107], v[224:227], v[232:235], v[104:107]
v_mfma_f32_16x16x32_bf16 v[108:111], v[224:227], v[236:239], v[108:111]
s_waitcnt lgkmcnt(4)
v_mfma_f32_16x16x32_bf16 v[112:115], v[228:231], v[232:235], v[112:115]
v_mfma_f32_16x16x32_bf16 v[116:119], v[228:231], v[236:239], v[116:119]
s_waitcnt lgkmcnt(2)
v_mfma_f32_16x16x32_bf16 v[72:75], v[40:43], a[0:3], 0
ds_read_b128 v[64:67], v1 offset:55296
v_mul_f32 v89, v89, v97
v_mfma_f32_16x16x32_bf16 v[76:79], v[40:43], a[4:7], 0
v_exp_f32 v242, v242
v_mfma_f32_16x16x32_bf16 v[80:83], v[44:47], a[0:3], 0
ds_read_b128 v[68:71], v1 offset:56320
buffer_load_dwordx4 v1, s[4:7], s47 offen offset:3072 sc1 lds
v_mfma_f32_16x16x32_bf16 v[84:87], v[44:47], a[4:7], 0
v_mul_f32 v90, v90, v98
v_exp_f32 v243, v243
v_mfma_f32_16x16x32_bf16 v[72:75], v[48:51], a[8:11], v[72:75]
ds_read_b128 v[40:43], v1 offset:57344
v_mul_f32 v91, v91, v99
v_mfma_f32_16x16x32_bf16 v[76:79], v[48:51], a[12:15], v[76:79]
v_exp_f32 v244, v244
v_mfma_f32_16x16x32_bf16 v[80:83], v[52:55], a[8:11], v[80:83]
ds_read_b128 v[44:47], v1 offset:58368
s_add_u32 m0, s21, 81920
s_add_u32 s47, s20, 16384
v_mfma_f32_16x16x32_bf16 v[84:87], v[52:55], a[12:15], v[84:87]
buffer_load_dwordx4 v1, s[4:7], s47 offen offset:0 sc1 lds
s_waitcnt lgkmcnt(2)
v_mfma_f32_16x16x32_bf16 v[72:75], v[56:59], a[16:19], v[72:75]
ds_read_b128 v[48:51], v1 offset:59392
buffer_load_dwordx4 v1, s[4:7], s47 offen offset:1024 sc1 lds
v_mfma_f32_16x16x32_bf16 v[76:79], v[56:59], a[20:23], v[76:79]
v_mul_f32 v92, v92, v100
v_exp_f32 v245, v245
v_mfma_f32_16x16x32_bf16 v[80:83], v[60:63], a[16:19], v[80:83]
ds_read_b128 v[52:55], v1 offset:60416
v_mul_f32 v93, v93, v101
v_mfma_f32_16x16x32_bf16 v[84:87], v[60:63], a[20:23], v[84:87]
v_exp_f32 v246, v246
v_mfma_f32_16x16x32_bf16 v[72:75], v[64:67], a[24:27], v[72:75]
ds_read_b128 v[56:59], v1 offset:61440
buffer_load_dwordx4 v1, s[4:7], s47 offen offset:2048 sc1 lds
v_mfma_f32_16x16x32_bf16 v[76:79], v[64:67], a[28:31], v[76:79]
v_mul_f32 v94, v94, v102
v_exp_f32 v247, v247
v_mfma_f32_16x16x32_bf16 v[80:83], v[68:71], a[24:27], v[80:83]
ds_read_b128 v[60:63], v1 offset:62464
v_mul_f32 v95, v95, v103
v_mfma_f32_16x16x32_bf16 v[84:87], v[68:71], a[28:31], v[84:87]
v_fma_f32 v240, v240, v202, v202
v_fma_f32 v241, v241, v202, v202
s_waitcnt lgkmcnt(2)
v_mfma_f32_16x16x32_bf16 v[72:75], v[40:43], a[32:35], v[72:75]
ds_read_b128 v[64:67], v1 offset:63488
buffer_load_dwordx4 v1, s[4:7], s47 offen offset:3072 sc1 lds
v_mfma_f32_16x16x32_bf16 v[76:79], v[40:43], a[36:39], v[76:79]
v_fma_f32 v242, v242, v202, v202
v_fma_f32 v243, v243, v202, v202
v_fma_f32 v244, v244, v203, v203
v_mfma_f32_16x16x32_bf16 v[80:83], v[44:47], a[32:35], v[80:83]
s_waitcnt vmcnt(12)
s_barrier
ds_read_b128 v[68:71], v1 offset:64512
v_mfma_f32_16x16x32_bf16 v[84:87], v[44:47], a[36:39], v[84:87]
v_fma_f32 v245, v245, v203, v203
v_fma_f32 v246, v246, v203, v203
v_mfma_f32_16x16x32_bf16 v[72:75], v[48:51], a[40:43], v[72:75]
ds_read_b128 v[40:43], v1 offset:16384
s_add_u32 m0, s21, 98304
s_add_u32 s47, s19, 147456
v_mfma_f32_16x16x32_bf16 v[76:79], v[48:51], a[44:47], v[76:79]
buffer_load_dwordx4 v1, s[4:7], s47 offen offset:0 sc1 lds
v_mfma_f32_16x16x32_bf16 v[80:83], v[52:55], a[40:43], v[80:83]
ds_read_b128 v[44:47], v1 offset:17408
v_fma_f32 v247, v247, v203, v203
v_mfma_f32_16x16x32_bf16 v[84:87], v[52:55], a[44:47], v[84:87]
v_rcp_f32 v240, v240
s_waitcnt lgkmcnt(2)
v_mfma_f32_16x16x32_bf16 v[72:75], v[56:59], a[48:51], v[72:75]
ds_read_b128 v[48:51], v1 offset:18432
buffer_load_dwordx4 v1, s[4:7], s47 offen offset:1024 sc1 lds
v_mfma_f32_16x16x32_bf16 v[76:79], v[56:59], a[52:55], v[76:79]
v_rcp_f32 v241, v241
v_mfma_f32_16x16x32_bf16 v[80:83], v[60:63], a[48:51], v[80:83]
ds_read_b128 v[52:55], v1 offset:19456
v_rcp_f32 v242, v242
v_mfma_f32_16x16x32_bf16 v[84:87], v[60:63], a[52:55], v[84:87]
v_rcp_f32 v243, v243
v_mfma_f32_16x16x32_bf16 v[72:75], v[64:67], a[56:59], v[72:75]
ds_read_b128 v[56:59], v1 offset:20480
buffer_load_dwordx4 v1, s[4:7], s47 offen offset:2048 sc1 lds
v_mfma_f32_16x16x32_bf16 v[76:79], v[64:67], a[60:63], v[76:79]
v_rcp_f32 v244, v244
v_mfma_f32_16x16x32_bf16 v[80:83], v[68:71], a[56:59], v[80:83]
ds_read_b128 v[60:63], v1 offset:21504
v_rcp_f32 v245, v245
v_mfma_f32_16x16x32_bf16 v[84:87], v[68:71], a[60:63], v[84:87]
v_rcp_f32 v246, v246
s_waitcnt lgkmcnt(2)
v_mfma_f32_16x16x32_bf16 v[72:75], v[40:43], a[64:67], v[72:75]
ds_read_b128 v[64:67], v1 offset:22528
buffer_load_dwordx4 v1, s[4:7], s47 offen offset:3072 sc1 lds
v_mfma_f32_16x16x32_bf16 v[76:79], v[40:43], a[68:71], v[76:79]
v_rcp_f32 v247, v247
v_mul_f32 v88, v88, v240
v_mfma_f32_16x16x32_bf16 v[80:83], v[44:47], a[64:67], v[80:83]
ds_read_b128 v[68:71], v1 offset:23552
v_mul_f32 v89, v89, v241
v_mul_f32 v90, v90, v242
v_mfma_f32_16x16x32_bf16 v[84:87], v[44:47], a[68:71], v[84:87]
v_mul_f32 v91, v91, v243
v_mul_f32 v92, v92, v244
v_mfma_f32_16x16x32_bf16 v[72:75], v[48:51], a[72:75], v[72:75]
ds_read_b128 v[40:43], v1 offset:24576
s_add_u32 s57, s20, 163840
v_mfma_f32_16x16x32_bf16 v[76:79], v[48:51], a[76:79], v[76:79]
buffer_load_dwordx4 a[160:163], v1, s[4:7], s57 offen offset:0 sc1
v_mul_f32 v93, v93, v245
v_mfma_f32_16x16x32_bf16 v[80:83], v[52:55], a[72:75], v[80:83]
ds_read_b128 v[44:47], v1 offset:25600
v_mul_f32 v94, v94, v246
v_mul_f32 v95, v95, v247
v_mfma_f32_16x16x32_bf16 v[84:87], v[52:55], a[76:79], v[84:87]
v_cvt_pk_bf16_f32 v250, v88, v89
v_cvt_pk_bf16_f32 v251, v90, v91
s_waitcnt lgkmcnt(2)
v_mfma_f32_16x16x32_bf16 v[72:75], v[56:59], a[80:83], v[72:75]
ds_read_b128 v[48:51], v1 offset:26624
buffer_load_dwordx4 a[164:167], v1, s[4:7], s57 offen offset:1024 sc1
v_mfma_f32_16x16x32_bf16 v[76:79], v[56:59], a[84:87], v[76:79]
v_cvt_pk_bf16_f32 v254, v92, v93
v_cvt_pk_bf16_f32 v255, v94, v95
v_mfma_f32_16x16x32_bf16 v[80:83], v[60:63], a[80:83], v[80:83]
ds_read_b128 v[52:55], v1 offset:27648
buffer_store_dwordx4 v[248:251], v1, s[4:7], s32 offen offset:0 sc1
v_mfma_f32_16x16x32_bf16 v[84:87], v[60:63], a[84:87], v[84:87]
buffer_store_dwordx4 v[252:255], v1, s[4:7], s58 offen offset:0 sc1
v_mfma_f32_16x16x32_bf16 v[72:75], v[64:67], a[88:91], v[72:75]
ds_read_b128 v[56:59], v1 offset:28672
buffer_load_dwordx4 a[168:171], v1, s[4:7], s57 offen offset:2048 sc1
v_mfma_f32_16x16x32_bf16 v[76:79], v[64:67], a[92:95], v[76:79]
v_mul_f32 v240, v200, v104
v_mul_f32 v241, v200, v105
v_mfma_f32_16x16x32_bf16 v[80:83], v[68:71], a[88:91], v[80:83]
ds_read_b128 v[60:63], v1 offset:29696
v_mul_f32 v242, v200, v106
v_mul_f32 v243, v200, v107
v_mfma_f32_16x16x32_bf16 v[84:87], v[68:71], a[92:95], v[84:87]
v_mul_f32 v244, v201, v108
v_mul_f32 v245, v201, v109
s_waitcnt lgkmcnt(2)
v_mfma_f32_16x16x32_bf16 v[72:75], v[40:43], a[96:99], v[72:75]
ds_read_b128 v[64:67], v1 offset:30720
buffer_load_dwordx4 a[172:175], v1, s[4:7], s57 offen offset:3072 sc1
v_mfma_f32_16x16x32_bf16 v[76:79], v[40:43], a[100:103], v[76:79]
v_mul_f32 v246, v201, v110
v_mul_f32 v247, v201, v111
v_mfma_f32_16x16x32_bf16 v[80:83], v[44:47], a[96:99], v[80:83]
s_waitcnt vmcnt(14)
s_barrier
ds_read_b128 v[68:71], v1 offset:31744
v_mfma_f32_16x16x32_bf16 v[84:87], v[44:47], a[100:103], v[84:87]
v_exp_f32 v240, v240
v_mul_f32 v104, v104, v112
v_mfma_f32_16x16x32_bf16 v[72:75], v[48:51], a[104:107], v[72:75]
ds_read_b128 v[40:43], v1 offset:32768
s_add_u32 m0, s21, 49152
s_add_u32 s47, s19, 163840
v_mfma_f32_16x16x32_bf16 v[76:79], v[48:51], a[108:111], v[76:79]
buffer_load_dwordx4 v1, s[4:7], s47 offen offset:0 sc1 lds
v_mfma_f32_16x16x32_bf16 v[80:83], v[52:55], a[104:107], v[80:83]
ds_read_b128 v[44:47], v1 offset:33792
ds_read_b64 v[224:225], v25 offset:768
ds_read_b64 v[228:229], v25 offset:896
v_mfma_f32_16x16x32_bf16 v[84:87], v[52:55], a[108:111], v[84:87]
v_exp_f32 v241, v241
s_waitcnt lgkmcnt(4)
v_mfma_f32_16x16x32_bf16 v[72:75], v[56:59], a[112:115], v[72:75]
ds_read_b128 v[48:51], v1 offset:34816
buffer_load_dwordx4 v1, s[4:7], s47 offen offset:1024 sc1 lds
v_mfma_f32_16x16x32_bf16 v[76:79], v[56:59], a[116:119], v[76:79]
v_mul_f32 v105, v105, v113
v_exp_f32 v242, v242
v_mfma_f32_16x16x32_bf16 v[80:83], v[60:63], a[112:115], v[80:83]
ds_read_b128 v[52:55], v1 offset:35840
v_mul_f32 v106, v106, v114
v_mfma_f32_16x16x32_bf16 v[84:87], v[60:63], a[116:119], v[84:87]
v_exp_f32 v243, v243
v_mul_f32 v107, v107, v115
v_mfma_f32_16x16x32_bf16 v[72:75], v[64:67], a[120:123], v[72:75]
ds_read_b128 v[56:59], v1 offset:36864
buffer_load_dwordx4 v1, s[4:7], s47 offen offset:2048 sc1 lds
v_mfma_f32_16x16x32_bf16 v[76:79], v[64:67], a[124:127], v[76:79]
v_exp_f32 v244, v244
v_mfma_f32_16x16x32_bf16 v[80:83], v[68:71], a[120:123], v[80:83]
ds_read_b128 v[60:63], v1 offset:37888
v_mul_f32 v108, v108, v116
v_mfma_f32_16x16x32_bf16 v[84:87], v[68:71], a[124:127], v[84:87]
v_exp_f32 v245, v245
v_mul_f32 v109, v109, v117
s_waitcnt lgkmcnt(5)
v_mfma_f32_16x16x32_bf16 v[72:75], v[224:227], v[232:235], v[72:75]
v_mfma_f32_16x16x32_bf16 v[76:79], v[224:227], v[236:239], v[76:79]
s_waitcnt lgkmcnt(4)
v_mfma_f32_16x16x32_bf16 v[80:83], v[228:231], v[232:235], v[80:83]
v_mfma_f32_16x16x32_bf16 v[84:87], v[228:231], v[236:239], v[84:87]
s_waitcnt lgkmcnt(2)
v_mfma_f32_16x16x32_bf16 v[88:91], v[40:43], a[0:3], 0
ds_read_b128 v[64:67], v1 offset:38912
buffer_load_dwordx4 v1, s[4:7], s47 offen offset:3072 sc1 lds
v_mfma_f32_16x16x32_bf16 v[92:95], v[40:43], a[4:7], 0
v_exp_f32 v246, v246
v_mfma_f32_16x16x32_bf16 v[96:99], v[44:47], a[0:3], 0
ds_read_b128 v[68:71], v1 offset:39936
v_mul_f32 v110, v110, v118
v_mfma_f32_16x16x32_bf16 v[100:103], v[44:47], a[4:7], 0
v_exp_f32 v247, v247
v_mul_f32 v111, v111, v119
v_mfma_f32_16x16x32_bf16 v[88:91], v[48:51], a[8:11], v[88:91]
ds_read_b128 v[40:43], v1 offset:40960
s_add_u32 m0, s21, 0
s_add_u32 s47, s20, 32768
v_mfma_f32_16x16x32_bf16 v[92:95], v[48:51], a[12:15], v[92:95]
buffer_load_dwordx4 v1, s[4:7], s47 offen offset:0 sc1 lds
v_fma_f32 v240, v240, v202, v202
v_mfma_f32_16x16x32_bf16 v[96:99], v[52:55], a[8:11], v[96:99]
ds_read_b128 v[44:47], v1 offset:41984
v_fma_f32 v241, v241, v202, v202
v_fma_f32 v242, v242, v202, v202
v_mfma_f32_16x16x32_bf16 v[100:103], v[52:55], a[12:15], v[100:103]
v_fma_f32 v243, v243, v202, v202
v_fma_f32 v244, v244, v203, v203
s_waitcnt lgkmcnt(2)
v_mfma_f32_16x16x32_bf16 v[88:91], v[56:59], a[16:19], v[88:91]
ds_read_b128 v[48:51], v1 offset:43008
buffer_load_dwordx4 v1, s[4:7], s47 offen offset:1024 sc1 lds
v_mfma_f32_16x16x32_bf16 v[92:95], v[56:59], a[20:23], v[92:95]
v_fma_f32 v245, v245, v203, v203
v_fma_f32 v246, v246, v203, v203
v_mfma_f32_16x16x32_bf16 v[96:99], v[60:63], a[16:19], v[96:99]
ds_read_b128 v[52:55], v1 offset:44032
v_fma_f32 v247, v247, v203, v203
v_rcp_f32 v240, v240
v_mfma_f32_16x16x32_bf16 v[100:103], v[60:63], a[20:23], v[100:103]
v_rcp_f32 v241, v241
v_mfma_f32_16x16x32_bf16 v[88:91], v[64:67], a[24:27], v[88:91]
ds_read_b128 v[56:59], v1 offset:45056
buffer_load_dwordx4 v1, s[4:7], s47 offen offset:2048 sc1 lds
v_mfma_f32_16x16x32_bf16 v[92:95], v[64:67], a[28:31], v[92:95]
v_rcp_f32 v242, v242
v_mfma_f32_16x16x32_bf16 v[96:99], v[68:71], a[24:27], v[96:99]
ds_read_b128 v[60:63], v1 offset:46080
v_rcp_f32 v243, v243
v_mfma_f32_16x16x32_bf16 v[100:103], v[68:71], a[28:31], v[100:103]
v_rcp_f32 v244, v244
s_waitcnt lgkmcnt(2)
v_mfma_f32_16x16x32_bf16 v[88:91], v[40:43], a[32:35], v[88:91]
ds_read_b128 v[64:67], v1 offset:47104
buffer_load_dwordx4 v1, s[4:7], s47 offen offset:3072 sc1 lds
v_mfma_f32_16x16x32_bf16 v[92:95], v[40:43], a[36:39], v[92:95]
v_rcp_f32 v245, v245
v_mfma_f32_16x16x32_bf16 v[96:99], v[44:47], a[32:35], v[96:99]
s_waitcnt vmcnt(14)
s_barrier
ds_read_b128 v[68:71], v1 offset:48128
v_mfma_f32_16x16x32_bf16 v[100:103], v[44:47], a[36:39], v[100:103]
v_rcp_f32 v246, v246
v_mfma_f32_16x16x32_bf16 v[88:91], v[48:51], a[40:43], v[88:91]
ds_read_b128 v[40:43], v2 offset:32768
s_add_u32 m0, s21, 16384
s_add_u32 s47, s19, 180224
v_mfma_f32_16x16x32_bf16 v[92:95], v[48:51], a[44:47], v[92:95]
buffer_load_dwordx4 v1, s[4:7], s47 offen offset:0 sc1 lds
v_mfma_f32_16x16x32_bf16 v[96:99], v[52:55], a[40:43], v[96:99]
ds_read_b128 v[44:47], v2 offset:33792
v_rcp_f32 v247, v247
v_mfma_f32_16x16x32_bf16 v[100:103], v[52:55], a[44:47], v[100:103]
v_mul_f32 v104, v104, v240
s_waitcnt lgkmcnt(2)
v_mfma_f32_16x16x32_bf16 v[88:91], v[56:59], a[48:51], v[88:91]
ds_read_b128 v[48:51], v2 offset:34816
buffer_load_dwordx4 v1, s[4:7], s47 offen offset:1024 sc1 lds
v_mfma_f32_16x16x32_bf16 v[92:95], v[56:59], a[52:55], v[92:95]
s_waitcnt vmcnt(12)
buffer_store_dwordx2 v[36:37], v26, s[4:7], s40 offen offset:0 sc1
v_mfma_f32_16x16x32_bf16 v[96:99], v[60:63], a[48:51], v[96:99]
ds_read_b128 v[52:55], v2 offset:35840
v_mul_f32 v105, v105, v241
v_mul_f32 v106, v106, v242
v_mfma_f32_16x16x32_bf16 v[100:103], v[60:63], a[52:55], v[100:103]
v_mul_f32 v107, v107, v243
v_mul_f32 v108, v108, v244
v_mul_f32 v109, v109, v245
v_mfma_f32_16x16x32_bf16 v[88:91], v[64:67], a[56:59], v[88:91]
ds_read_b128 v[56:59], v2 offset:36864
buffer_load_dwordx4 v1, s[4:7], s47 offen offset:2048 sc1 lds
v_mfma_f32_16x16x32_bf16 v[92:95], v[64:67], a[60:63], v[92:95]
v_mul_f32 v110, v110, v246
v_mul_f32 v111, v111, v247
v_mfma_f32_16x16x32_bf16 v[96:99], v[68:71], a[56:59], v[96:99]
ds_read_b128 v[60:63], v2 offset:37888
v_cvt_pk_bf16_f32 v248, v104, v105
v_cvt_pk_bf16_f32 v249, v106, v107
v_mfma_f32_16x16x32_bf16 v[100:103], v[68:71], a[60:63], v[100:103]
v_cvt_pk_bf16_f32 v252, v108, v109
v_cvt_pk_bf16_f32 v253, v110, v111
s_waitcnt lgkmcnt(2)
v_mfma_f32_16x16x32_bf16 v[88:91], v[40:43], a[64:67], v[88:91]
ds_read_b128 v[64:67], v2 offset:38912
buffer_load_dwordx4 v1, s[4:7], s47 offen offset:3072 sc1 lds
v_mfma_f32_16x16x32_bf16 v[92:95], v[40:43], a[68:71], v[92:95]
v_mul_f32 v240, v200, v72
v_mul_f32 v241, v200, v73
v_mfma_f32_16x16x32_bf16 v[96:99], v[44:47], a[64:67], v[96:99]
ds_read_b128 v[68:71], v2 offset:39936
v_mul_f32 v242, v200, v74
v_mul_f32 v243, v200, v75
v_mfma_f32_16x16x32_bf16 v[100:103], v[44:47], a[68:71], v[100:103]
v_mul_f32 v244, v201, v76
v_mul_f32 v245, v201, v77
v_mul_f32 v246, v201, v78
v_mfma_f32_16x16x32_bf16 v[88:91], v[48:51], a[72:75], v[88:91]
ds_read_b128 v[40:43], v2 offset:40960
s_add_u32 s57, s20, 180224
v_mfma_f32_16x16x32_bf16 v[92:95], v[48:51], a[76:79], v[92:95]
buffer_load_dwordx4 a[176:179], v1, s[4:7], s57 offen offset:0 sc1
v_mul_f32 v247, v201, v79
v_mfma_f32_16x16x32_bf16 v[96:99], v[52:55], a[72:75], v[96:99]
ds_read_b128 v[44:47], v2 offset:41984
v_exp_f32 v240, v240
v_mfma_f32_16x16x32_bf16 v[100:103], v[52:55], a[76:79], v[100:103]
v_mul_f32 v72, v72, v80
v_exp_f32 v241, v241
s_waitcnt lgkmcnt(2)
v_mfma_f32_16x16x32_bf16 v[88:91], v[56:59], a[80:83], v[88:91]
ds_read_b128 v[48:51], v2 offset:43008
buffer_load_dwordx4 a[180:183], v1, s[4:7], s57 offen offset:1024 sc1
v_mfma_f32_16x16x32_bf16 v[92:95], v[56:59], a[84:87], v[92:95]
v_mul_f32 v73, v73, v81
v_mfma_f32_16x16x32_bf16 v[96:99], v[60:63], a[80:83], v[96:99]
ds_read_b128 v[52:55], v2 offset:44032
v_exp_f32 v242, v242
v_mfma_f32_16x16x32_bf16 v[100:103], v[60:63], a[84:87], v[100:103]
v_mul_f32 v74, v74, v82
v_exp_f32 v243, v243
v_mfma_f32_16x16x32_bf16 v[88:91], v[64:67], a[88:91], v[88:91]
ds_read_b128 v[56:59], v2 offset:45056
buffer_load_dwordx4 a[184:187], v1, s[4:7], s57 offen offset:2048 sc1
v_mfma_f32_16x16x32_bf16 v[92:95], v[64:67], a[92:95], v[92:95]
v_mul_f32 v75, v75, v83
v_exp_f32 v244, v244
v_mfma_f32_16x16x32_bf16 v[96:99], v[68:71], a[88:91], v[96:99]
ds_read_b128 v[60:63], v2 offset:46080
v_mul_f32 v76, v76, v84
v_mfma_f32_16x16x32_bf16 v[100:103], v[68:71], a[92:95], v[100:103]
v_exp_f32 v245, v245
s_waitcnt lgkmcnt(2)
v_mfma_f32_16x16x32_bf16 v[88:91], v[40:43], a[96:99], v[88:91]
ds_read_b128 v[64:67], v2 offset:47104
buffer_load_dwordx4 a[188:191], v1, s[4:7], s57 offen offset:3072 sc1
v_mfma_f32_16x16x32_bf16 v[92:95], v[40:43], a[100:103], v[92:95]
v_mul_f32 v77, v77, v85
v_exp_f32 v246, v246
v_mfma_f32_16x16x32_bf16 v[96:99], v[44:47], a[96:99], v[96:99]
s_waitcnt vmcnt(13)
s_barrier
ds_read_b128 v[68:71], v2 offset:48128
v_mfma_f32_16x16x32_bf16 v[100:103], v[44:47], a[100:103], v[100:103]
v_mul_f32 v78, v78, v86
v_exp_f32 v247, v247
v_mfma_f32_16x16x32_bf16 v[88:91], v[48:51], a[104:107], v[88:91]
ds_read_b128 v[40:43], v1 offset:49152
s_add_u32 m0, s21, 32768
s_add_u32 s47, s19, 196608
v_mfma_f32_16x16x32_bf16 v[92:95], v[48:51], a[108:111], v[92:95]
buffer_load_dwordx4 v1, s[4:7], s47 offen offset:0 sc1 lds
v_mfma_f32_16x16x32_bf16 v[96:99], v[52:55], a[104:107], v[96:99]
ds_read_b128 v[44:47], v1 offset:50176
ds_read_b64 v[224:225], v25 offset:1024
ds_read_b64 v[228:229], v25 offset:1152
v_mfma_f32_16x16x32_bf16 v[100:103], v[52:55], a[108:111], v[100:103]
v_mul_f32 v79, v79, v87
v_fma_f32 v240, v240, v202, v202
s_waitcnt lgkmcnt(4)
v_mfma_f32_16x16x32_bf16 v[88:91], v[56:59], a[112:115], v[88:91]
ds_read_b128 v[48:51], v1 offset:51200
buffer_load_dwordx4 v1, s[4:7], s47 offen offset:1024 sc1 lds
v_mfma_f32_16x16x32_bf16 v[92:95], v[56:59], a[116:119], v[92:95]
v_fma_f32 v241, v241, v202, v202
v_fma_f32 v242, v242, v202, v202
v_mfma_f32_16x16x32_bf16 v[96:99], v[60:63], a[112:115], v[96:99]
ds_read_b128 v[52:55], v1 offset:52224
buffer_load_dwordx4 v1, s[4:7], s47 offen offset:2048 sc1 lds
v_mfma_f32_16x16x32_bf16 v[100:103], v[60:63], a[116:119], v[100:103]
v_fma_f32 v243, v243, v202, v202
v_fma_f32 v244, v244, v203, v203
v_mfma_f32_16x16x32_bf16 v[88:91], v[64:67], a[120:123], v[88:91]
ds_read_b128 v[56:59], v1 offset:53248
v_fma_f32 v245, v245, v203, v203
v_fma_f32 v246, v246, v203, v203
v_mfma_f32_16x16x32_bf16 v[92:95], v[64:67], a[124:127], v[92:95]
v_fma_f32 v247, v247, v203, v203
v_rcp_f32 v240, v240
v_mfma_f32_16x16x32_bf16 v[96:99], v[68:71], a[120:123], v[96:99]
ds_read_b128 v[60:63], v1 offset:54272
buffer_load_dwordx4 v1, s[4:7], s47 offen offset:3072 sc1 lds
v_mfma_f32_16x16x32_bf16 v[100:103], v[68:71], a[124:127], v[100:103]
v_rcp_f32 v241, v241
s_waitcnt lgkmcnt(5)
v_mfma_f32_16x16x32_bf16 v[88:91], v[224:227], v[232:235], v[88:91]
v_mfma_f32_16x16x32_bf16 v[92:95], v[224:227], v[236:239], v[92:95]
s_waitcnt lgkmcnt(4)
v_mfma_f32_16x16x32_bf16 v[96:99], v[228:231], v[232:235], v[96:99]
v_mfma_f32_16x16x32_bf16 v[100:103], v[228:231], v[236:239], v[100:103]
s_waitcnt lgkmcnt(2)
v_mfma_f32_16x16x32_bf16 v[104:107], v[40:43], a[0:3], 0
ds_read_b128 v[64:67], v1 offset:55296
v_rcp_f32 v242, v242
v_mfma_f32_16x16x32_bf16 v[108:111], v[40:43], a[4:7], 0
v_rcp_f32 v243, v243
v_mfma_f32_16x16x32_bf16 v[112:115], v[44:47], a[0:3], 0
ds_read_b128 v[68:71], v1 offset:56320
s_add_u32 m0, s21, 114688
s_add_u32 s47, s20, 49152
v_mfma_f32_16x16x32_bf16 v[116:119], v[44:47], a[4:7], 0
buffer_load_dwordx4 v1, s[4:7], s47 offen offset:0 sc1 lds
v_mfma_f32_16x16x32_bf16 v[104:107], v[48:51], a[8:11], v[104:107]
ds_read_b128 v[40:43], v1 offset:57344
v_rcp_f32 v244, v244
v_mfma_f32_16x16x32_bf16 v[108:111], v[48:51], a[12:15], v[108:111]
v_rcp_f32 v245, v245
v_mfma_f32_16x16x32_bf16 v[112:115], v[52:55], a[8:11], v[112:115]
ds_read_b128 v[44:47], v1 offset:58368
buffer_load_dwordx4 v1, s[4:7], s47 offen offset:1024 sc1 lds
v_mfma_f32_16x16x32_bf16 v[116:119], v[52:55], a[12:15], v[116:119]
v_rcp_f32 v246, v246
v_rcp_f32 v247, v247
s_waitcnt lgkmcnt(2)
v_mfma_f32_16x16x32_bf16 v[104:107], v[56:59], a[16:19], v[104:107]
ds_read_b128 v[48:51], v1 offset:59392
v_mul_f32 v72, v72, v240
v_mfma_f32_16x16x32_bf16 v[108:111], v[56:59], a[20:23], v[108:111]
v_mul_f32 v73, v73, v241
v_mul_f32 v74, v74, v242
v_mfma_f32_16x16x32_bf16 v[112:115], v[60:63], a[16:19], v[112:115]
ds_read_b128 v[52:55], v1 offset:60416
buffer_load_dwordx4 v1, s[4:7], s47 offen offset:2048 sc1 lds
v_mfma_f32_16x16x32_bf16 v[116:119], v[60:63], a[20:23], v[116:119]
v_mul_f32 v75, v75, v243
v_mul_f32 v76, v76, v244
v_mul_f32 v77, v77, v245
v_mfma_f32_16x16x32_bf16 v[104:107], v[64:67], a[24:27], v[104:107]
ds_read_b128 v[56:59], v1 offset:61440
v_mul_f32 v78, v78, v246
v_mul_f32 v79, v79, v247
v_mfma_f32_16x16x32_bf16 v[108:111], v[64:67], a[28:31], v[108:111]
v_cvt_pk_bf16_f32 v250, v72, v73
v_cvt_pk_bf16_f32 v251, v74, v75
v_mfma_f32_16x16x32_bf16 v[112:115], v[68:71], a[24:27], v[112:115]
ds_read_b128 v[60:63], v1 offset:62464
buffer_load_dwordx4 v1, s[4:7], s47 offen offset:3072 sc1 lds
v_mfma_f32_16x16x32_bf16 v[116:119], v[68:71], a[28:31], v[116:119]
v_cvt_pk_bf16_f32 v254, v76, v77
v_cvt_pk_bf16_f32 v255, v78, v79
s_waitcnt lgkmcnt(2)
v_mfma_f32_16x16x32_bf16 v[104:107], v[40:43], a[32:35], v[104:107]
ds_read_b128 v[64:67], v1 offset:63488
buffer_store_dwordx4 v[248:251], v1, s[4:7], s32 offen offset:1024 sc1
v_mfma_f32_16x16x32_bf16 v[108:111], v[40:43], a[36:39], v[108:111]
buffer_store_dwordx4 v[252:255], v1, s[4:7], s58 offen offset:1024 sc1
v_mfma_f32_16x16x32_bf16 v[112:115], v[44:47], a[32:35], v[112:115]
s_waitcnt vmcnt(14)
s_barrier
ds_read_b128 v[68:71], v1 offset:64512
v_mfma_f32_16x16x32_bf16 v[116:119], v[44:47], a[36:39], v[116:119]
s_add_u32 s57, s20, 196608
buffer_load_dwordx4 a[192:195], v1, s[4:7], s57 offen offset:0 sc1
v_mfma_f32_16x16x32_bf16 v[104:107], v[48:51], a[40:43], v[104:107]
ds_read_b128 v[40:43], v1 offset:16384
v_mul_f32 v240, v200, v88
v_mul_f32 v241, v200, v89
v_mfma_f32_16x16x32_bf16 v[108:111], v[48:51], a[44:47], v[108:111]
v_mul_f32 v242, v200, v90
v_mul_f32 v243, v200, v91
v_mfma_f32_16x16x32_bf16 v[112:115], v[52:55], a[40:43], v[112:115]
ds_read_b128 v[44:47], v1 offset:17408
s_add_u32 m0, s21, 98304
s_add_u32 s47, s19, 212992
v_mfma_f32_16x16x32_bf16 v[116:119], v[52:55], a[44:47], v[116:119]
buffer_load_dwordx4 v1, s[4:7], s47 offen offset:0 sc1 lds
s_waitcnt lgkmcnt(2)
v_mfma_f32_16x16x32_bf16 v[104:107], v[56:59], a[48:51], v[104:107]
ds_read_b128 v[48:51], v1 offset:18432
v_mul_f32 v244, v201, v92
v_mul_f32 v245, v201, v93
v_mfma_f32_16x16x32_bf16 v[108:111], v[56:59], a[52:55], v[108:111]
v_mul_f32 v246, v201, v94
v_mul_f32 v247, v201, v95
v_mfma_f32_16x16x32_bf16 v[112:115], v[60:63], a[48:51], v[112:115]
ds_read_b128 v[52:55], v1 offset:19456
buffer_load_dwordx4 v1, s[4:7], s47 offen offset:1024 sc1 lds
v_mfma_f32_16x16x32_bf16 v[116:119], v[60:63], a[52:55], v[116:119]
v_exp_f32 v240, v240
v_mfma_f32_16x16x32_bf16 v[104:107], v[64:67], a[56:59], v[104:107]
ds_read_b128 v[56:59], v1 offset:20480
v_mul_f32 v88, v88, v96
v_mfma_f32_16x16x32_bf16 v[108:111], v[64:67], a[60:63], v[108:111]
v_exp_f32 v241, v241
v_mul_f32 v89, v89, v97
v_mfma_f32_16x16x32_bf16 v[112:115], v[68:71], a[56:59], v[112:115]
ds_read_b128 v[60:63], v1 offset:21504
buffer_load_dwordx4 v1, s[4:7], s47 offen offset:2048 sc1 lds
v_mfma_f32_16x16x32_bf16 v[116:119], v[68:71], a[60:63], v[116:119]
v_exp_f32 v242, v242
v_mul_f32 v90, v90, v98
s_waitcnt lgkmcnt(2)
v_mfma_f32_16x16x32_bf16 v[104:107], v[40:43], a[64:67], v[104:107]
ds_read_b128 v[64:67], v1 offset:22528
v_exp_f32 v243, v243
v_mfma_f32_16x16x32_bf16 v[108:111], v[40:43], a[68:71], v[108:111]
v_mul_f32 v91, v91, v99
v_mfma_f32_16x16x32_bf16 v[112:115], v[44:47], a[64:67], v[112:115]
ds_read_b128 v[68:71], v1 offset:23552
buffer_load_dwordx4 v1, s[4:7], s47 offen offset:3072 sc1 lds
v_mfma_f32_16x16x32_bf16 v[116:119], v[44:47], a[68:71], v[116:119]
v_exp_f32 v244, v244
v_mul_f32 v92, v92, v100
v_mfma_f32_16x16x32_bf16 v[104:107], v[48:51], a[72:75], v[104:107]
ds_read_b128 v[40:43], v1 offset:24576
v_exp_f32 v245, v245
v_mfma_f32_16x16x32_bf16 v[108:111], v[48:51], a[76:79], v[108:111]
v_mul_f32 v93, v93, v101
v_exp_f32 v246, v246
v_mfma_f32_16x16x32_bf16 v[112:115], v[52:55], a[72:75], v[112:115]
ds_read_b128 v[44:47], v1 offset:25600
s_add_u32 m0, s21, 131072
s_add_u32 s47, s20, 65536
v_mfma_f32_16x16x32_bf16 v[116:119], v[52:55], a[76:79], v[116:119]
buffer_load_dwordx4 v1, s[4:7], s47 offen offset:0 sc1 lds
s_waitcnt lgkmcnt(2)
v_mfma_f32_16x16x32_bf16 v[104:107], v[56:59], a[80:83], v[104:107]
ds_read_b128 v[48:51], v1 offset:26624
v_mul_f32 v94, v94, v102
v_mfma_f32_16x16x32_bf16 v[108:111], v[56:59], a[84:87], v[108:111]
v_exp_f32 v247, v247
v_mfma_f32_16x16x32_bf16 v[112:115], v[60:63], a[80:83], v[112:115]
ds_read_b128 v[52:55], v1 offset:27648
buffer_load_dwordx4 v1, s[4:7], s47 offen offset:1024 sc1 lds
v_mfma_f32_16x16x32_bf16 v[116:119], v[60:63], a[84:87], v[116:119]
v_mul_f32 v95, v95, v103
v_fma_f32 v240, v240, v202, v202
v_mfma_f32_16x16x32_bf16 v[104:107], v[64:67], a[88:91], v[104:107]
ds_read_b128 v[56:59], v1 offset:28672
v_fma_f32 v241, v241, v202, v202
v_fma_f32 v242, v242, v202, v202
v_mfma_f32_16x16x32_bf16 v[108:111], v[64:67], a[92:95], v[108:111]
v_fma_f32 v243, v243, v202, v202
v_fma_f32 v244, v244, v203, v203
v_fma_f32 v245, v245, v203, v203
v_mfma_f32_16x16x32_bf16 v[112:115], v[68:71], a[88:91], v[112:115]
ds_read_b128 v[60:63], v1 offset:29696
buffer_load_dwordx4 v1, s[4:7], s47 offen offset:2048 sc1 lds
v_mfma_f32_16x16x32_bf16 v[116:119], v[68:71], a[92:95], v[116:119]
v_fma_f32 v246, v246, v203, v203
v_fma_f32 v247, v247, v203, v203
s_waitcnt lgkmcnt(2)
v_mfma_f32_16x16x32_bf16 v[104:107], v[40:43], a[96:99], v[104:107]
ds_read_b128 v[64:67], v1 offset:30720
v_rcp_f32 v240, v240
v_mfma_f32_16x16x32_bf16 v[108:111], v[40:43], a[100:103], v[108:111]
v_rcp_f32 v241, v241
v_mfma_f32_16x16x32_bf16 v[112:115], v[44:47], a[96:99], v[112:115]
s_waitcnt vmcnt(14)
s_barrier
ds_read_b128 v[68:71], v1 offset:31744
v_mfma_f32_16x16x32_bf16 v[116:119], v[44:47], a[100:103], v[116:119]
buffer_load_dwordx4 v1, s[4:7], s47 offen offset:3072 sc1 lds
v_mfma_f32_16x16x32_bf16 v[104:107], v[48:51], a[104:107], v[104:107]
ds_read_b128 v[40:43], v1 offset:32768
v_rcp_f32 v242, v242
v_mfma_f32_16x16x32_bf16 v[108:111], v[48:51], a[108:111], v[108:111]
v_rcp_f32 v243, v243
v_mfma_f32_16x16x32_bf16 v[112:115], v[52:55], a[104:107], v[112:115]
ds_read_b128 v[44:47], v1 offset:33792
ds_read_b64 v[224:225], v25 offset:1280
ds_read_b64 v[228:229], v25 offset:1408
s_add_u32 m0, s21, 49152
v_mfma_f32_16x16x32_bf16 v[116:119], v[52:55], a[108:111], v[116:119]
s_add_u32 s47, s20, 81920
buffer_load_dwordx4 v1, s[4:7], s47 offen offset:0 sc1 lds
s_waitcnt lgkmcnt(4)
v_mfma_f32_16x16x32_bf16 v[104:107], v[56:59], a[112:115], v[104:107]
ds_read_b128 v[48:51], v1 offset:34816
v_mfma_f32_16x16x32_bf16 v[108:111], v[56:59], a[116:119], v[108:111]
v_rcp_f32 v244, v244
v_mfma_f32_16x16x32_bf16 v[112:115], v[60:63], a[112:115], v[112:115]
ds_read_b128 v[52:55], v1 offset:35840
buffer_load_dwordx4 v1, s[4:7], s47 offen offset:1024 sc1 lds
v_mfma_f32_16x16x32_bf16 v[116:119], v[60:63], a[116:119], v[116:119]
v_rcp_f32 v245, v245
v_mfma_f32_16x16x32_bf16 v[104:107], v[64:67], a[120:123], v[104:107]
ds_read_b128 v[56:59], v1 offset:36864
v_rcp_f32 v246, v246
v_mfma_f32_16x16x32_bf16 v[108:111], v[64:67], a[124:127], v[108:111]
v_rcp_f32 v247, v247
v_mfma_f32_16x16x32_bf16 v[112:115], v[68:71], a[120:123], v[112:115]
ds_read_b128 v[60:63], v1 offset:37888
buffer_load_dwordx4 v1, s[4:7], s47 offen offset:2048 sc1 lds
v_mul_f32 v88, v88, v240
v_mfma_f32_16x16x32_bf16 v[116:119], v[68:71], a[124:127], v[116:119]
s_waitcnt vmcnt(12)
buffer_store_dwordx2 v[36:37], v26, s[4:7], s40 offen offset:512 sc1
s_waitcnt lgkmcnt(5)
v_mfma_f32_16x16x32_bf16 v[104:107], v[224:227], v[232:235], v[104:107]
v_mfma_f32_16x16x32_bf16 v[108:111], v[224:227], v[236:239], v[108:111]
s_waitcnt lgkmcnt(4)
v_mfma_f32_16x16x32_bf16 v[112:115], v[228:231], v[232:235], v[112:115]
v_mfma_f32_16x16x32_bf16 v[116:119], v[228:231], v[236:239], v[116:119]
s_waitcnt lgkmcnt(2)
v_mfma_f32_16x16x32_bf16 v[72:75], v[40:43], a[0:3], 0
ds_read_b128 v[64:67], v1 offset:38912
v_mul_f32 v89, v89, v241
v_mfma_f32_16x16x32_bf16 v[76:79], v[40:43], a[4:7], 0
v_mul_f32 v90, v90, v242
v_mul_f32 v91, v91, v243
v_mfma_f32_16x16x32_bf16 v[80:83], v[44:47], a[0:3], 0
ds_read_b128 v[68:71], v1 offset:39936
buffer_load_dwordx4 v1, s[4:7], s47 offen offset:3072 sc1 lds
v_mfma_f32_16x16x32_bf16 v[84:87], v[44:47], a[4:7], 0
v_mul_f32 v92, v92, v244
v_mul_f32 v93, v93, v245
v_mfma_f32_16x16x32_bf16 v[72:75], v[48:51], a[8:11], v[72:75]
ds_read_b128 v[40:43], v1 offset:40960
v_mul_f32 v94, v94, v246
v_mul_f32 v95, v95, v247
v_mfma_f32_16x16x32_bf16 v[76:79], v[48:51], a[12:15], v[76:79]
v_cvt_pk_bf16_f32 v248, v88, v89
v_cvt_pk_bf16_f32 v249, v90, v91
v_mfma_f32_16x16x32_bf16 v[80:83], v[52:55], a[8:11], v[80:83]
ds_read_b128 v[44:47], v1 offset:41984
buffer_load_dwordx4 a[196:199], v1, s[4:7], s57 offen offset:1024 sc1
v_mfma_f32_16x16x32_bf16 v[84:87], v[52:55], a[12:15], v[84:87]
v_cvt_pk_bf16_f32 v252, v92, v93
v_cvt_pk_bf16_f32 v253, v94, v95
s_waitcnt lgkmcnt(2)
v_mfma_f32_16x16x32_bf16 v[72:75], v[56:59], a[16:19], v[72:75]
ds_read_b128 v[48:51], v1 offset:43008
buffer_load_dwordx2 v[38:39], v17, s[4:7], s41 offen offset:0 sc1
v_mfma_f32_16x16x32_bf16 v[76:79], v[56:59], a[20:23], v[76:79]
v_mul_f32 v240, v200, v104
v_mul_f32 v241, v200, v105
v_mul_f32 v242, v200, v106
v_mfma_f32_16x16x32_bf16 v[80:83], v[60:63], a[16:19], v[80:83]
ds_read_b128 v[52:55], v1 offset:44032
buffer_load_dwordx4 a[200:203], v1, s[4:7], s57 offen offset:2048 sc1
v_mfma_f32_16x16x32_bf16 v[84:87], v[60:63], a[20:23], v[84:87]
v_mul_f32 v243, v200, v107
v_mul_f32 v244, v201, v108
v_mul_f32 v245, v201, v109
v_mfma_f32_16x16x32_bf16 v[72:75], v[64:67], a[24:27], v[72:75]
ds_read_b128 v[56:59], v1 offset:45056
v_mul_f32 v246, v201, v110
v_mul_f32 v247, v201, v111
v_mfma_f32_16x16x32_bf16 v[76:79], v[64:67], a[28:31], v[76:79]
v_exp_f32 v240, v240
v_mul_f32 v104, v104, v112
v_mfma_f32_16x16x32_bf16 v[80:83], v[68:71], a[24:27], v[80:83]
ds_read_b128 v[60:63], v1 offset:46080
buffer_load_dwordx4 a[204:207], v1, s[4:7], s57 offen offset:3072 sc1
v_mfma_f32_16x16x32_bf16 v[84:87], v[68:71], a[28:31], v[84:87]
v_exp_f32 v241, v241
v_mul_f32 v105, v105, v113
s_waitcnt lgkmcnt(2)
v_mfma_f32_16x16x32_bf16 v[72:75], v[40:43], a[32:35], v[72:75]
ds_read_b128 v[64:67], v1 offset:47104
v_exp_f32 v242, v242
v_mul_f32 v106, v106, v114
v_mfma_f32_16x16x32_bf16 v[76:79], v[40:43], a[36:39], v[76:79]
v_exp_f32 v243, v243
v_mul_f32 v107, v107, v115
v_mfma_f32_16x16x32_bf16 v[80:83], v[44:47], a[32:35], v[80:83]
s_waitcnt vmcnt(13)
s_barrier
ds_read_b128 v[68:71], v1 offset:48128
v_mfma_f32_16x16x32_bf16 v[84:87], v[44:47], a[36:39], v[84:87]
s_add_u32 s57, s20, 212992
buffer_load_dwordx4 a[208:211], v1, s[4:7], s57 offen offset:0 sc1
v_mfma_f32_16x16x32_bf16 v[72:75], v[48:51], a[40:43], v[72:75]
ds_read_b128 v[40:43], v2 offset:32768
v_exp_f32 v244, v244
v_mul_f32 v108, v108, v116
v_mfma_f32_16x16x32_bf16 v[76:79], v[48:51], a[44:47], v[76:79]
v_exp_f32 v245, v245
v_mul_f32 v109, v109, v117
v_mfma_f32_16x16x32_bf16 v[80:83], v[52:55], a[40:43], v[80:83]
ds_read_b128 v[44:47], v2 offset:33792
buffer_load_dwordx4 a[212:215], v1, s[4:7], s57 offen offset:1024 sc1
v_mfma_f32_16x16x32_bf16 v[84:87], v[52:55], a[44:47], v[84:87]
v_exp_f32 v246, v246
v_mul_f32 v110, v110, v118
s_waitcnt lgkmcnt(2)
v_mfma_f32_16x16x32_bf16 v[72:75], v[56:59], a[48:51], v[72:75]
ds_read_b128 v[48:51], v2 offset:34816
v_exp_f32 v247, v247
v_mfma_f32_16x16x32_bf16 v[76:79], v[56:59], a[52:55], v[76:79]
v_mul_f32 v111, v111, v119
v_fma_f32 v240, v240, v202, v202
v_fma_f32 v241, v241, v202, v202
v_mfma_f32_16x16x32_bf16 v[80:83], v[60:63], a[48:51], v[80:83]
ds_read_b128 v[52:55], v2 offset:35840
buffer_load_dwordx4 a[216:219], v1, s[4:7], s57 offen offset:2048 sc1
v_mfma_f32_16x16x32_bf16 v[84:87], v[60:63], a[52:55], v[84:87]
v_fma_f32 v242, v242, v202, v202
v_fma_f32 v243, v243, v202, v202
v_fma_f32 v244, v244, v203, v203
v_mfma_f32_16x16x32_bf16 v[72:75], v[64:67], a[56:59], v[72:75]
ds_read_b128 v[56:59], v2 offset:36864
v_fma_f32 v245, v245, v203, v203
v_fma_f32 v246, v246, v203, v203
v_mfma_f32_16x16x32_bf16 v[76:79], v[64:67], a[60:63], v[76:79]
v_fma_f32 v247, v247, v203, v203
v_rcp_f32 v240, v240
v_mfma_f32_16x16x32_bf16 v[80:83], v[68:71], a[56:59], v[80:83]
ds_read_b128 v[60:63], v2 offset:37888
s_waitcnt vmcnt(5)
v_cmp_ne_u64 vcc, s[66:67], v[38:39]
s_nop 0
s_cbranch_vccnz LS1_sp10
LS1_ok9:
v_mfma_f32_16x16x32_bf16 v[84:87], v[68:71], a[60:63], v[84:87]
buffer_load_dwordx4 a[220:223], v1, s[4:7], s57 offen offset:3072 sc1
v_rcp_f32 v241, v241
s_waitcnt lgkmcnt(2)
v_mfma_f32_16x16x32_bf16 v[72:75], v[40:43], a[64:67], v[72:75]
ds_read_b128 v[64:67], v2 offset:38912
buffer_load_dwordx4 a[0:3], v1, s[4:7], s76 offen offset:0 sc1
v_mfma_f32_16x16x32_bf16 v[76:79], v[40:43], a[68:71], v[76:79]
v_rcp_f32 v242, v242
v_mfma_f32_16x16x32_bf16 v[80:83], v[44:47], a[64:67], v[80:83]
ds_read_b128 v[68:71], v2 offset:39936
ds_write_b128 v11, a[224:227] offset:16384
v_mfma_f32_16x16x32_bf16 v[84:87], v[44:47], a[68:71], v[84:87]
v_rcp_f32 v243, v243
v_mfma_f32_16x16x32_bf16 v[72:75], v[48:51], a[72:75], v[72:75]
ds_read_b128 v[40:43], v2 offset:40960
buffer_load_dwordx4 a[4:7], v1, s[4:7], s80 offen offset:0 sc1
v_mfma_f32_16x16x32_bf16 v[76:79], v[48:51], a[76:79], v[76:79]
v_rcp_f32 v244, v244
v_mfma_f32_16x16x32_bf16 v[80:83], v[52:55], a[72:75], v[80:83]
ds_read_b128 v[44:47], v2 offset:41984
v_mfma_f32_16x16x32_bf16 v[84:87], v[52:55], a[76:79], v[84:87]
ds_write_b128 v11, a[228:231] offset:17408
s_waitcnt lgkmcnt(4)
v_mfma_f32_16x16x32_bf16 v[72:75], v[56:59], a[80:83], v[72:75]
ds_read_b128 v[48:51], v2 offset:43008
buffer_load_dwordx4 a[8:11], v5, s[4:7], s76 offen offset:0 sc1
v_mfma_f32_16x16x32_bf16 v[76:79], v[56:59], a[84:87], v[76:79]
v_rcp_f32 v245, v245
v_rcp_f32 v246, v246
v_mfma_f32_16x16x32_bf16 v[80:83], v[60:63], a[80:83], v[80:83]
ds_read_b128 v[52:55], v2 offset:44032
v_mfma_f32_16x16x32_bf16 v[84:87], v[60:63], a[84:87], v[84:87]
ds_write_b128 v11, a[232:235] offset:18432
v_mfma_f32_16x16x32_bf16 v[72:75], v[64:67], a[88:91], v[72:75]
ds_read_b128 v[56:59], v2 offset:45056
buffer_load_dwordx4 a[12:15], v5, s[4:7], s80 offen offset:0 sc1
v_mfma_f32_16x16x32_bf16 v[76:79], v[64:67], a[92:95], v[76:79]
v_rcp_f32 v247, v247
v_mul_f32 v104, v104, v240
v_mfma_f32_16x16x32_bf16 v[80:83], v[68:71], a[88:91], v[80:83]
ds_read_b128 v[60:63], v2 offset:46080
v_mfma_f32_16x16x32_bf16 v[84:87], v[68:71], a[92:95], v[84:87]
ds_write_b128 v11, a[236:239] offset:19456
s_waitcnt lgkmcnt(4)
v_mfma_f32_16x16x32_bf16 v[72:75], v[40:43], a[96:99], v[72:75]
ds_read_b128 v[64:67], v2 offset:47104
buffer_load_dwordx4 a[16:19], v1, s[4:7], s77 offen offset:0 sc1
v_mul_f32 v105, v105, v241
v_mfma_f32_16x16x32_bf16 v[76:79], v[40:43], a[100:103], v[76:79]
v_mul_f32 v106, v106, v242
v_mul_f32 v107, v107, v243
v_mul_f32 v108, v108, v244
v_mfma_f32_16x16x32_bf16 v[80:83], v[44:47], a[96:99], v[80:83]
s_barrier
ds_read_b128 v[68:71], v2 offset:48128
v_mfma_f32_16x16x32_bf16 v[84:87], v[44:47], a[100:103], v[84:87]
v_mul_f32 v109, v109, v245
v_mul_f32 v110, v110, v246
v_mul_f32 v111, v111, v247
v_mfma_f32_16x16x32_bf16 v[72:75], v[48:51], a[104:107], v[72:75]
ds_read_b128 v[40:43], v9 offset:0
buffer_load_dwordx4 a[20:23], v1, s[4:7], s81 offen offset:0 sc1
v_mfma_f32_16x16x32_bf16 v[76:79], v[48:51], a[108:111], v[76:79]
v_cvt_pk_bf16_f32 v250, v104, v105
v_cvt_pk_bf16_f32 v251, v106, v107
v_cvt_pk_bf16_f32 v254, v108, v109
v_mfma_f32_16x16x32_bf16 v[80:83], v[52:55], a[104:107], v[80:83]
ds_read_b128 v[44:47], v9 offset:1024
ds_read_b64 v[224:225], v25 offset:1536
ds_read_b64 v[228:229], v25 offset:1664
v_mfma_f32_16x16x32_bf16 v[84:87], v[52:55], a[108:111], v[84:87]
ds_write_b128 v11, a[240:243] offset:32768
s_waitcnt lgkmcnt(5)
v_mfma_f32_16x16x32_bf16 v[72:75], v[56:59], a[112:115], v[72:75]
ds_read_b128 v[48:51], v9 offset:2048
buffer_load_dwordx4 a[24:27], v5, s[4:7], s77 offen offset:0 sc1
v_mfma_f32_16x16x32_bf16 v[76:79], v[56:59], a[116:119], v[76:79]
v_cvt_pk_bf16_f32 v255, v110, v111
v_mfma_f32_16x16x32_bf16 v[80:83], v[60:63], a[112:115], v[80:83]
ds_read_b128 v[52:55], v9 offset:3072
v_mfma_f32_16x16x32_bf16 v[84:87], v[60:63], a[116:119], v[84:87]
ds_write_b128 v11, a[244:247] offset:33792
v_mfma_f32_16x16x32_bf16 v[72:75], v[64:67], a[120:123], v[72:75]
ds_read_b128 v[56:59], v9 offset:4096
buffer_load_dwordx4 a[28:31], v5, s[4:7], s81 offen offset:0 sc1
v_mfma_f32_16x16x32_bf16 v[76:79], v[64:67], a[124:127], v[76:79]
buffer_store_dwordx4 v[248:251], v1, s[4:7], s32 offen offset:2048 sc1
buffer_store_dwordx4 v[252:255], v1, s[4:7], s58 offen offset:2048 sc1
v_mfma_f32_16x16x32_bf16 v[80:83], v[68:71], a[120:123], v[80:83]
ds_read_b128 v[60:63], v9 offset:5120
v_mfma_f32_16x16x32_bf16 v[84:87], v[68:71], a[124:127], v[84:87]
s_waitcnt lgkmcnt(7)
v_mfma_f32_16x16x32_bf16 v[72:75], v[224:227], v[232:235], v[72:75]
v_mfma_f32_16x16x32_bf16 v[76:79], v[224:227], v[236:239], v[76:79]
s_waitcnt lgkmcnt(6)
v_mfma_f32_16x16x32_bf16 v[80:83], v[228:231], v[232:235], v[80:83]
v_mfma_f32_16x16x32_bf16 v[84:87], v[228:231], v[236:239], v[84:87]
s_waitcnt vmcnt(8) lgkmcnt(3)
v_mfma_f32_16x16x32_bf16 v[168:171], v[40:43], a[0:3], v[168:171]
ds_read_b128 v[64:67], v9 offset:6144
v_mfma_f32_16x16x32_bf16 v[176:179], v[40:43], a[4:7], v[176:179]
buffer_load_dwordx4 a[32:35], v1, s[4:7], s78 offen offset:0 sc1
v_mfma_f32_16x16x32_bf16 v[172:175], v[44:47], a[0:3], v[172:175]
ds_read_b128 v[68:71], v9 offset:7168
ds_write_b128 v11, a[248:251] offset:34816
v_mfma_f32_16x16x32_bf16 v[180:183], v[44:47], a[4:7], v[180:183]
v_mul_f32 v240, v200, v72
v_mul_f32 v241, v200, v73
v_mfma_f32_16x16x32_bf16 v[184:187], v[48:51], a[0:3], 0
ds_read_b128 v[40:43], v9 offset:16384
buffer_load_dwordx4 a[36:39], v1, s[4:7], s82 offen offset:0 sc1
v_mul_f32 v242, v200, v74
v_mfma_f32_16x16x32_bf16 v[192:195], v[48:51], a[4:7], 0
v_mul_f32 v243, v200, v75
v_mul_f32 v244, v201, v76
v_mul_f32 v245, v201, v77
v_mfma_f32_16x16x32_bf16 v[188:191], v[52:55], a[0:3], 0
ds_read_b128 v[44:47], v9 offset:17408
v_mul_f32 v246, v201, v78
v_mul_f32 v247, v201, v79
v_exp_f32 v240, v240
v_mfma_f32_16x16x32_bf16 v[196:199], v[52:55], a[4:7], 0
v_mul_f32 v72, v72, v80
v_exp_f32 v241, v241
s_waitcnt vmcnt(8) lgkmcnt(3)
v_mfma_f32_16x16x32_bf16 v[168:171], v[56:59], a[8:11], v[168:171]
ds_read_b128 v[48:51], v9 offset:18432
buffer_load_dwordx4 a[40:43], v5, s[4:7], s78 offen offset:0 sc1
buffer_load_dwordx2 v[38:39], v17, s[4:7], s41 offen offset:512 sc1
v_mfma_f32_16x16x32_bf16 v[176:179], v[56:59], a[12:15], v[176:179]
v_mul_f32 v73, v73, v81
v_exp_f32 v242, v242
v_mfma_f32_16x16x32_bf16 v[172:175], v[60:63], a[8:11], v[172:175]
ds_read_b128 v[52:55], v9 offset:19456
ds_write_b128 v11, a[252:255] offset:35840
v_mfma_f32_16x16x32_bf16 v[180:183], v[60:63], a[12:15], v[180:183]
v_mul_f32 v74, v74, v82
v_mfma_f32_16x16x32_bf16 v[184:187], v[64:67], a[8:11], v[184:187]
ds_read_b128 v[56:59], v9 offset:20480
buffer_load_dwordx4 a[44:47], v5, s[4:7], s82 offen offset:0 sc1
v_exp_f32 v243, v243
v_mfma_f32_16x16x32_bf16 v[192:195], v[64:67], a[12:15], v[192:195]
v_mul_f32 v75, v75, v83
v_exp_f32 v244, v244
v_mfma_f32_16x16x32_bf16 v[188:191], v[68:71], a[8:11], v[188:191]
ds_read_b128 v[60:63], v9 offset:21504
v_mul_f32 v76, v76, v84
v_exp_f32 v245, v245
v_mfma_f32_16x16x32_bf16 v[196:199], v[68:71], a[12:15], v[196:199]
v_mul_f32 v77, v77, v85
v_exp_f32 v246, v246
v_mul_f32 v78, v78, v86
s_waitcnt vmcnt(9) lgkmcnt(3)
v_mfma_f32_16x16x32_bf16 v[168:171], v[40:43], a[16:19], v[168:171]
ds_read_b128 v[64:67], v9 offset:22528
buffer_load_dwordx4 a[48:51], v1, s[4:7], s79 offen offset:0 sc1
v_exp_f32 v247, v247
v_mfma_f32_16x16x32_bf16 v[176:179], v[40:43], a[20:23], v[176:179]
v_mul_f32 v79, v79, v87
v_fma_f32 v240, v240, v202, v202
v_fma_f32 v241, v241, v202, v202
v_mfma_f32_16x16x32_bf16 v[172:175], v[44:47], a[16:19], v[172:175]
s_barrier
ds_read_b128 v[68:71], v9 offset:23552
v_fma_f32 v242, v242, v202, v202
v_mfma_f32_16x16x32_bf16 v[180:183], v[44:47], a[20:23], v[180:183]
v_fma_f32 v243, v243, v202, v202
v_fma_f32 v244, v244, v203, v203
v_fma_f32 v245, v245, v203, v203
v_mfma_f32_16x16x32_bf16 v[184:187], v[48:51], a[16:19], v[184:187]
ds_read_b128 v[40:43], v8 offset:0
buffer_load_dwordx4 a[52:55], v1, s[4:7], s83 offen offset:0 sc1
v_fma_f32 v246, v246, v203, v203
v_fma_f32 v247, v247, v203, v203
v_mfma_f32_16x16x32_bf16 v[192:195], v[48:51], a[20:23], v[192:195]
v_rcp_f32 v240, v240
v_rcp_f32 v241, v241
v_mfma_f32_16x16x32_bf16 v[188:191], v[52:55], a[16:19], v[188:191]
ds_read_b128 v[44:47], v8 offset:1024
ds_write_b128 v12, a[128:131] offset:32768
v_mfma_f32_16x16x32_bf16 v[196:199], v[52:55], a[20:23], v[196:199]
ds_write_b128 v12, a[132:135] offset:33792
s_waitcnt vmcnt(9) lgkmcnt(4)
v_mfma_f32_16x16x32_bf16 v[168:171], v[56:59], a[24:27], v[168:171]
ds_read_b128 v[48:51], v8 offset:2048
v_mfma_f32_16x16x32_bf16 v[176:179], v[56:59], a[28:31], v[176:179]
buffer_load_dwordx4 a[56:59], v5, s[4:7], s79 offen offset:0 sc1
v_mfma_f32_16x16x32_bf16 v[172:175], v[60:63], a[24:27], v[172:175]
ds_read_b128 v[52:55], v8 offset:3072
ds_write_b128 v12, a[136:139] offset:34816
v_mfma_f32_16x16x32_bf16 v[180:183], v[60:63], a[28:31], v[180:183]
v_rcp_f32 v242, v242
v_mfma_f32_16x16x32_bf16 v[184:187], v[64:67], a[24:27], v[184:187]
ds_read_b128 v[56:59], v8 offset:4096
buffer_load_dwordx4 a[60:63], v5, s[4:7], s83 offen offset:0 sc1
v_rcp_f32 v243, v243
v_mfma_f32_16x16x32_bf16 v[192:195], v[64:67], a[28:31], v[192:195]
v_rcp_f32 v244, v244
v_rcp_f32 v245, v245
v_mfma_f32_16x16x32_bf16 v[188:191], v[68:71], a[24:27], v[188:191]
ds_read_b128 v[60:63], v8 offset:5120
s_waitcnt vmcnt(5)
v_cmp_ne_u64 vcc, s[66:67], v[38:39]
s_nop 0
s_cbranch_vccnz LS1_sp12
LS1_ok11:
v_mfma_f32_16x16x32_bf16 v[196:199], v[68:71], a[28:31], v[196:199]
ds_write_b128 v12, a[140:143] offset:35840
s_waitcnt lgkmcnt(4)
v_mfma_f32_16x16x32_bf16 v[168:171], v[40:43], a[32:35], v[168:171]
ds_read_b128 v[64:67], v8 offset:6144
buffer_load_dwordx4 a[64:67], v1, s[4:7], s76 offen offset:1024 sc1
v_mfma_f32_16x16x32_bf16 v[176:179], v[40:43], a[36:39], v[176:179]
buffer_store_dwordx2 v[36:37], v26, s[4:7], s40 offen offset:1024 sc1
v_mfma_f32_16x16x32_bf16 v[172:175], v[44:47], a[32:35], v[172:175]
ds_read_b128 v[68:71], v8 offset:7168
ds_write_b128 v12, a[144:147] offset:0
v_mfma_f32_16x16x32_bf16 v[180:183], v[44:47], a[36:39], v[180:183]
v_rcp_f32 v246, v246
v_mfma_f32_16x16x32_bf16 v[184:187], v[48:51], a[32:35], v[184:187]
ds_read_b128 v[40:43], v9 offset:49152
buffer_load_dwordx4 a[68:71], v1, s[4:7], s80 offen offset:1024 sc1
v_rcp_f32 v247, v247
v_mfma_f32_16x16x32_bf16 v[192:195], v[48:51], a[36:39], v[192:195]
v_mul_f32 v72, v72, v240
v_mul_f32 v73, v73, v241
v_mul_f32 v74, v74, v242
v_mfma_f32_16x16x32_bf16 v[188:191], v[52:55], a[32:35], v[188:191]
ds_read_b128 v[44:47], v9 offset:50176
ds_write_b128 v12, a[148:151] offset:1024
v_mfma_f32_16x16x32_bf16 v[196:199], v[52:55], a[36:39], v[196:199]
v_mul_f32 v75, v75, v243
v_mul_f32 v76, v76, v244
s_waitcnt vmcnt(7) lgkmcnt(4)
v_mfma_f32_16x16x32_bf16 v[168:171], v[56:59], a[40:43], v[168:171]
ds_read_b128 v[48:51], v9 offset:51200
buffer_load_dwordx4 a[72:75], v5, s[4:7], s76 offen offset:1024 sc1
v_mul_f32 v77, v77, v245
v_mfma_f32_16x16x32_bf16 v[176:179], v[56:59], a[44:47], v[176:179]
v_mul_f32 v78, v78, v246
v_mul_f32 v79, v79, v247
v_bfe_u32 v240, v0, 4, 1
v_mfma_f32_16x16x32_bf16 v[172:175], v[60:63], a[40:43], v[172:175]
ds_read_b128 v[52:55], v9 offset:52224
ds_write_b128 v12, a[152:155] offset:2048
v_mfma_f32_16x16x32_bf16 v[180:183], v[60:63], a[44:47], v[180:183]
v_mul_u32_u24 v240, 57088, v240
v_bfe_u32 v241, v0, 5, 1
v_mfma_f32_16x16x32_bf16 v[184:187], v[64:67], a[40:43], v[184:187]
ds_read_b128 v[56:59], v9 offset:53248
buffer_load_dwordx4 a[76:79], v5, s[4:7], s80 offen offset:1024 sc1
v_mul_u32_u24 v241, 256, v241
v_sub_u32 v240, v240, v241
v_mfma_f32_16x16x32_bf16 v[192:195], v[64:67], a[44:47], v[192:195]
v_add_u32 v240, v240, v1
s_bitcmp1_b32 s13, 0
s_cselect_b32 s48, -512, 0
s_cselect_b32 s49, 0, 3072
v_mfma_f32_16x16x32_bf16 v[188:191], v[68:71], a[40:43], v[188:191]
ds_read_b128 v[60:63], v9 offset:54272
ds_write_b128 v12, a[156:159] offset:3072
v_mfma_f32_16x16x32_bf16 v[196:199], v[68:71], a[44:47], v[196:199]
s_add_u32 s48, s48, s49
s_waitcnt vmcnt(7) lgkmcnt(4)
v_mfma_f32_16x16x32_bf16 v[168:171], v[40:43], a[48:51], v[168:171]
ds_read_b128 v[64:67], v9 offset:55296
buffer_load_dwordx4 a[80:83], v1, s[4:7], s77 offen offset:1024 sc1
s_add_u32 s48, s48, s32
v_mfma_f32_16x16x32_bf16 v[176:179], v[40:43], a[52:55], v[176:179]
v_cvt_pk_bf16_f32 v248, v72, v73
v_cvt_pk_bf16_f32 v249, v74, v75
v_cvt_pk_bf16_f32 v250, v76, v77
v_mfma_f32_16x16x32_bf16 v[172:175], v[44:47], a[48:51], v[172:175]
s_barrier
ds_read_b128 v[68:71], v9 offset:56320
v_cvt_pk_bf16_f32 v251, v78, v79
v_mfma_f32_16x16x32_bf16 v[180:183], v[44:47], a[52:55], v[180:183]
v_permlane16_swap_b32 v248, v250
v_permlane16_swap_b32 v249, v251
buffer_store_dwordx4 v[248:251], v240, s[4:7], s48 offen sc1
v_mfma_f32_16x16x32_bf16 v[184:187], v[48:51], a[48:51], v[184:187]
ds_read_b128 v[40:43], v10 offset:0
v_mfma_f32_16x16x32_bf16 v[192:195], v[48:51], a[52:55], v[192:195]
buffer_load_dwordx4 a[84:87], v1, s[4:7], s81 offen offset:1024 sc1
v_mfma_f32_16x16x32_bf16 v[188:191], v[52:55], a[48:51], v[188:191]
ds_read_b128 v[44:47], v10 offset:1024
ds_write_b128 v12, a[160:163] offset:16384
v_mfma_f32_16x16x32_bf16 v[196:199], v[52:55], a[52:55], v[196:199]
ds_write_b128 v12, a[164:167] offset:17408
s_waitcnt vmcnt(8) lgkmcnt(4)
v_mfma_f32_16x16x32_bf16 v[168:171], v[56:59], a[56:59], v[168:171]
ds_read_b128 v[48:51], v10 offset:2048
v_mfma_f32_16x16x32_bf16 v[176:179], v[56:59], a[60:63], v[176:179]
buffer_load_dwordx4 a[88:91], v5, s[4:7], s77 offen offset:1024 sc1
v_mfma_f32_16x16x32_bf16 v[172:175], v[60:63], a[56:59], v[172:175]
ds_read_b128 v[52:55], v10 offset:3072
v_mfma_f32_16x16x32_bf16 v[180:183], v[60:63], a[60:63], v[180:183]
ds_write_b128 v12, a[168:171] offset:18432
v_mfma_f32_16x16x32_bf16 v[184:187], v[64:67], a[56:59], v[184:187]
ds_read_b128 v[56:59], v10 offset:4096
v_mfma_f32_16x16x32_bf16 v[192:195], v[64:67], a[60:63], v[192:195]
buffer_load_dwordx4 a[92:95], v5, s[4:7], s81 offen offset:1024 sc1
v_mfma_f32_16x16x32_bf16 v[188:191], v[68:71], a[56:59], v[188:191]
ds_read_b128 v[60:63], v10 offset:5120
v_mfma_f32_16x16x32_bf16 v[196:199], v[68:71], a[60:63], v[196:199]
ds_write_b128 v12, a[172:175] offset:19456
s_waitcnt vmcnt(7) lgkmcnt(4)
v_mfma_f32_16x16x32_bf16 v[168:171], v[40:43], a[64:67], v[168:171]
ds_read_b128 v[64:67], v10 offset:6144
v_mfma_f32_16x16x32_bf16 v[176:179], v[40:43], a[68:71], v[176:179]
buffer_load_dwordx4 a[96:99], v1, s[4:7], s78 offen offset:1024 sc1
v_mfma_f32_16x16x32_bf16 v[172:175], v[44:47], a[64:67], v[172:175]
ds_read_b128 v[68:71], v10 offset:7168
v_mfma_f32_16x16x32_bf16 v[180:183], v[44:47], a[68:71], v[180:183]
ds_write_b128 v11, a[176:179] offset:0
v_mfma_f32_16x16x32_bf16 v[184:187], v[48:51], a[64:67], v[184:187]
ds_read_b128 v[40:43], v8 offset:49152
v_mfma_f32_16x16x32_bf16 v[192:195], v[48:51], a[68:71], v[192:195]
buffer_load_dwordx4 a[100:103], v1, s[4:7], s82 offen offset:1024 sc1
v_mfma_f32_16x16x32_bf16 v[188:191], v[52:55], a[64:67], v[188:191]
ds_read_b128 v[44:47], v8 offset:50176
v_mfma_f32_16x16x32_bf16 v[196:199], v[52:55], a[68:71], v[196:199]
ds_write_b128 v11, a[180:183] offset:1024
s_waitcnt vmcnt(7) lgkmcnt(4)
v_mfma_f32_16x16x32_bf16 v[168:171], v[56:59], a[72:75], v[168:171]
ds_read_b128 v[48:51], v8 offset:51200
buffer_load_dwordx4 a[104:107], v5, s[4:7], s78 offen offset:1024 sc1
v_mfma_f32_16x16x32_bf16 v[176:179], v[56:59], a[76:79], v[176:179]
buffer_load_dwordx2 v[38:39], v17, s[4:7], s41 offen offset:1024 sc1
v_mfma_f32_16x16x32_bf16 v[172:175], v[60:63], a[72:75], v[172:175]
ds_read_b128 v[52:55], v8 offset:52224
v_mfma_f32_16x16x32_bf16 v[180:183], v[60:63], a[76:79], v[180:183]
ds_write_b128 v11, a[184:187] offset:2048
v_mfma_f32_16x16x32_bf16 v[184:187], v[64:67], a[72:75], v[184:187]
ds_read_b128 v[56:59], v8 offset:53248
v_mfma_f32_16x16x32_bf16 v[192:195], v[64:67], a[76:79], v[192:195]
buffer_load_dwordx4 a[108:111], v5, s[4:7], s82 offen offset:1024 sc1
v_mfma_f32_16x16x32_bf16 v[188:191], v[68:71], a[72:75], v[188:191]
ds_read_b128 v[60:63], v8 offset:54272
v_mfma_f32_16x16x32_bf16 v[196:199], v[68:71], a[76:79], v[196:199]
ds_write_b128 v11, a[188:191] offset:3072
s_waitcnt vmcnt(7) lgkmcnt(4)
v_mfma_f32_16x16x32_bf16 v[168:171], v[40:43], a[80:83], v[168:171]
ds_read_b128 v[64:67], v8 offset:55296
v_mfma_f32_16x16x32_bf16 v[176:179], v[40:43], a[84:87], v[176:179]
buffer_load_dwordx4 a[112:115], v1, s[4:7], s79 offen offset:1024 sc1
v_mfma_f32_16x16x32_bf16 v[172:175], v[44:47], a[80:83], v[172:175]
s_barrier
v_mfma_f32_16x16x32_bf16 v[180:183], v[44:47], a[84:87], v[180:183]
ds_read_b128 v[68:71], v8 offset:56320
v_mfma_f32_16x16x32_bf16 v[184:187], v[48:51], a[80:83], v[184:187]
ds_read_b128 v[40:43], v8 offset:16384
v_mfma_f32_16x16x32_bf16 v[192:195], v[48:51], a[84:87], v[192:195]
buffer_load_dwordx4 a[116:119], v1, s[4:7], s83 offen offset:1024 sc1
v_mfma_f32_16x16x32_bf16 v[188:191], v[52:55], a[80:83], v[188:191]
ds_read_b128 v[44:47], v8 offset:17408
ds_write_b128 v12, a[192:195] offset:49152
v_mfma_f32_16x16x32_bf16 v[196:199], v[52:55], a[84:87], v[196:199]
ds_write_b128 v12, a[196:199] offset:50176
s_waitcnt vmcnt(7) lgkmcnt(4)
v_mfma_f32_16x16x32_bf16 v[168:171], v[56:59], a[88:91], v[168:171]
ds_read_b128 v[48:51], v8 offset:18432
v_mfma_f32_16x16x32_bf16 v[176:179], v[56:59], a[92:95], v[176:179]
buffer_load_dwordx4 a[120:123], v5, s[4:7], s79 offen offset:1024 sc1
v_mfma_f32_16x16x32_bf16 v[172:175], v[60:63], a[88:91], v[172:175]
ds_read_b128 v[52:55], v8 offset:19456
v_mfma_f32_16x16x32_bf16 v[180:183], v[60:63], a[92:95], v[180:183]
ds_write_b128 v12, a[200:203] offset:51200
v_mfma_f32_16x16x32_bf16 v[184:187], v[64:67], a[88:91], v[184:187]
ds_read_b128 v[56:59], v8 offset:20480
v_mfma_f32_16x16x32_bf16 v[192:195], v[64:67], a[92:95], v[192:195]
buffer_load_dwordx4 a[124:127], v5, s[4:7], s83 offen offset:1024 sc1
v_mfma_f32_16x16x32_bf16 v[188:191], v[68:71], a[88:91], v[188:191]
ds_read_b128 v[60:63], v8 offset:21504
s_waitcnt vmcnt(5)
v_cmp_ne_u64 vcc, s[66:67], v[38:39]
s_nop 0
s_cbranch_vccnz LS1_sp14
LS1_ok13:
v_mfma_f32_16x16x32_bf16 v[196:199], v[68:71], a[92:95], v[196:199]
ds_write_b128 v12, a[204:207] offset:52224
s_waitcnt lgkmcnt(4)
v_mfma_f32_16x16x32_bf16 v[168:171], v[40:43], a[96:99], v[168:171]
ds_read_b128 v[64:67], v8 offset:22528
buffer_load_dwordx4 a[0:3], v1, s[4:7], s76 offen offset:2048 sc1
v_mfma_f32_16x16x32_bf16 v[176:179], v[40:43], a[100:103], v[176:179]
buffer_store_dwordx2 v[36:37], v26, s[4:7], s40 offen offset:1536 sc1
v_mfma_f32_16x16x32_bf16 v[172:175], v[44:47], a[96:99], v[172:175]
ds_read_b128 v[68:71], v8 offset:23552
v_mfma_f32_16x16x32_bf16 v[180:183], v[44:47], a[100:103], v[180:183]
ds_write_b128 v13, a[208:211] offset:0
v_mfma_f32_16x16x32_bf16 v[184:187], v[48:51], a[96:99], v[184:187]
ds_read_b128 v[40:43], v8 offset:32768
v_mfma_f32_16x16x32_bf16 v[192:195], v[48:51], a[100:103], v[192:195]
buffer_load_dwordx4 a[4:7], v1, s[4:7], s80 offen offset:2048 sc1
v_mfma_f32_16x16x32_bf16 v[188:191], v[52:55], a[96:99], v[188:191]
ds_read_b128 v[44:47], v8 offset:33792
v_mfma_f32_16x16x32_bf16 v[196:199], v[52:55], a[100:103], v[196:199]
ds_write_b128 v13, a[212:215] offset:1024
s_waitcnt vmcnt(7) lgkmcnt(4)
v_mfma_f32_16x16x32_bf16 v[168:171], v[56:59], a[104:107], v[168:171]
ds_read_b128 v[48:51], v8 offset:34816
v_mfma_f32_16x16x32_bf16 v[176:179], v[56:59], a[108:111], v[176:179]
buffer_load_dwordx4 a[8:11], v5, s[4:7], s76 offen offset:2048 sc1
v_mfma_f32_16x16x32_bf16 v[172:175], v[60:63], a[104:107], v[172:175]
ds_read_b128 v[52:55], v8 offset:35840
v_mfma_f32_16x16x32_bf16 v[180:183], v[60:63], a[108:111], v[180:183]
ds_write_b128 v13, a[216:219] offset:2048
v_mfma_f32_16x16x32_bf16 v[184:187], v[64:67], a[104:107], v[184:187]
ds_read_b128 v[56:59], v8 offset:36864
v_mfma_f32_16x16x32_bf16 v[192:195], v[64:67], a[108:111], v[192:195]
buffer_load_dwordx4 a[12:15], v5, s[4:7], s80 offen offset:2048 sc1
v_mfma_f32_16x16x32_bf16 v[188:191], v[68:71], a[104:107], v[188:191]
ds_read_b128 v[60:63], v8 offset:37888
v_mfma_f32_16x16x32_bf16 v[196:199], v[68:71], a[108:111], v[196:199]
ds_write_b128 v13, a[220:223] offset:3072
s_waitcnt vmcnt(7) lgkmcnt(4)
v_mfma_f32_16x16x32_bf16 v[168:171], v[40:43], a[112:115], v[168:171]
ds_read_b128 v[64:67], v8 offset:38912
v_mfma_f32_16x16x32_bf16 v[176:179], v[40:43], a[116:119], v[176:179]
buffer_load_dwordx4 a[16:19], v1, s[4:7], s77 offen offset:2048 sc1
v_mfma_f32_16x16x32_bf16 v[172:175], v[44:47], a[112:115], v[172:175]
s_barrier
v_mfma_f32_16x16x32_bf16 v[180:183], v[44:47], a[116:119], v[180:183]
ds_read_b128 v[68:71], v8 offset:39936
v_mfma_f32_16x16x32_bf16 v[184:187], v[48:51], a[112:115], v[184:187]
ds_read_b128 v[40:43], v9 offset:32768
v_mfma_f32_16x16x32_bf16 v[192:195], v[48:51], a[116:119], v[192:195]
buffer_load_dwordx4 a[20:23], v1, s[4:7], s81 offen offset:2048 sc1
v_mfma_f32_16x16x32_bf16 v[188:191], v[52:55], a[112:115], v[188:191]
ds_read_b128 v[44:47], v9 offset:33792
v_mfma_f32_16x16x32_bf16 v[196:199], v[52:55], a[116:119], v[196:199]
s_waitcnt vmcnt(7) lgkmcnt(2)
v_mfma_f32_16x16x32_bf16 v[168:171], v[56:59], a[120:123], v[168:171]
ds_read_b128 v[48:51], v9 offset:34816
v_mfma_f32_16x16x32_bf16 v[176:179], v[56:59], a[124:127], v[176:179]
buffer_load_dwordx4 a[24:27], v5, s[4:7], s77 offen offset:2048 sc1
v_mfma_f32_16x16x32_bf16 v[172:175], v[60:63], a[120:123], v[172:175]
ds_read_b128 v[52:55], v9 offset:35840
v_lshrrev_b32 v25, 4, v0
v_mfma_f32_16x16x32_bf16 v[180:183], v[60:63], a[124:127], v[180:183]
v_and_b32 v25, 3, v25
s_lshl_b32 s51, s14, 9
v_mfma_f32_16x16x32_bf16 v[184:187], v[64:67], a[120:123], v[184:187]
ds_read_b128 v[56:59], v9 offset:36864
v_mfma_f32_16x16x32_bf16 v[192:195], v[64:67], a[124:127], v[192:195]
buffer_load_dwordx4 a[28:31], v5, s[4:7], s81 offen offset:2048 sc1
v_mfma_f32_16x16x32_bf16 v[188:191], v[68:71], a[120:123], v[188:191]
ds_read_b128 v[60:63], v9 offset:37888
s_add_u32 s51, s51, 157696
v_mfma_f32_16x16x32_bf16 v[196:199], v[68:71], a[124:127], v[196:199]
v_lshl_add_u32 v25, v25, 4, s51
s_waitcnt vmcnt(6) lgkmcnt(2)
v_mfma_f32_16x16x32_bf16 v[168:171], v[40:43], a[0:3], v[168:171]
ds_read_b128 v[64:67], v9 offset:38912
v_mfma_f32_16x16x32_bf16 v[176:179], v[40:43], a[4:7], v[176:179]
buffer_load_dwordx4 a[32:35], v1, s[4:7], s78 offen offset:2048 sc1
v_mfma_f32_16x16x32_bf16 v[172:175], v[44:47], a[0:3], v[172:175]
ds_read_b128 v[68:71], v9 offset:39936
v_mfma_f32_16x16x32_bf16 v[180:183], v[44:47], a[4:7], v[180:183]
v_mfma_f32_16x16x32_bf16 v[184:187], v[48:51], a[0:3], v[184:187]
ds_read_b128 v[40:43], v9 offset:0
v_mfma_f32_16x16x32_bf16 v[192:195], v[48:51], a[4:7], v[192:195]
buffer_load_dwordx4 a[36:39], v1, s[4:7], s82 offen offset:2048 sc1
v_mfma_f32_16x16x32_bf16 v[188:191], v[52:55], a[0:3], v[188:191]
ds_read_b128 v[44:47], v9 offset:1024
v_mfma_f32_16x16x32_bf16 v[196:199], v[52:55], a[4:7], v[196:199]
s_waitcnt vmcnt(6) lgkmcnt(2)
v_mfma_f32_16x16x32_bf16 v[168:171], v[56:59], a[8:11], v[168:171]
ds_read_b128 v[48:51], v9 offset:2048
buffer_load_dwordx4 a[40:43], v5, s[4:7], s78 offen offset:2048 sc1
v_mfma_f32_16x16x32_bf16 v[176:179], v[56:59], a[12:15], v[176:179]
buffer_load_dwordx2 v[38:39], v17, s[4:7], s41 offen offset:1536 sc1
v_mfma_f32_16x16x32_bf16 v[172:175], v[60:63], a[8:11], v[172:175]
ds_read_b128 v[52:55], v9 offset:3072
v_mfma_f32_16x16x32_bf16 v[180:183], v[60:63], a[12:15], v[180:183]
v_mfma_f32_16x16x32_bf16 v[184:187], v[64:67], a[8:11], v[184:187]
ds_read_b128 v[56:59], v9 offset:4096
v_mfma_f32_16x16x32_bf16 v[192:195], v[64:67], a[12:15], v[192:195]
buffer_load_dwordx4 a[44:47], v5, s[4:7], s82 offen offset:2048 sc1
v_mfma_f32_16x16x32_bf16 v[188:191], v[68:71], a[8:11], v[188:191]
ds_read_b128 v[60:63], v9 offset:5120
v_mfma_f32_16x16x32_bf16 v[196:199], v[68:71], a[12:15], v[196:199]
s_waitcnt vmcnt(7) lgkmcnt(2)
v_mfma_f32_16x16x32_bf16 v[168:171], v[40:43], a[16:19], v[168:171]
ds_read_b128 v[64:67], v9 offset:6144
v_mfma_f32_16x16x32_bf16 v[176:179], v[40:43], a[20:23], v[176:179]
buffer_load_dwordx4 a[48:51], v1, s[4:7], s79 offen offset:2048 sc1
v_mfma_f32_16x16x32_bf16 v[172:175], v[44:47], a[16:19], v[172:175]
s_barrier
v_mfma_f32_16x16x32_bf16 v[180:183], v[44:47], a[20:23], v[180:183]
ds_read_b128 v[68:71], v9 offset:7168
v_mfma_f32_16x16x32_bf16 v[184:187], v[48:51], a[16:19], v[184:187]
ds_read_b128 v[40:43], v9 offset:16384
v_mfma_f32_16x16x32_bf16 v[192:195], v[48:51], a[20:23], v[192:195]
buffer_load_dwordx4 a[52:55], v1, s[4:7], s83 offen offset:2048 sc1
v_mfma_f32_16x16x32_bf16 v[188:191], v[52:55], a[16:19], v[188:191]
ds_read_b128 v[44:47], v9 offset:17408
v_mfma_f32_16x16x32_bf16 v[196:199], v[52:55], a[20:23], v[196:199]
s_waitcnt vmcnt(7) lgkmcnt(2)
v_mfma_f32_16x16x32_bf16 v[168:171], v[56:59], a[24:27], v[168:171]
ds_read_b128 v[48:51], v9 offset:18432
v_mfma_f32_16x16x32_bf16 v[176:179], v[56:59], a[28:31], v[176:179]
buffer_load_dwordx4 a[56:59], v5, s[4:7], s79 offen offset:2048 sc1
v_mfma_f32_16x16x32_bf16 v[172:175], v[60:63], a[24:27], v[172:175]
ds_read_b128 v[52:55], v9 offset:19456
v_mfma_f32_16x16x32_bf16 v[180:183], v[60:63], a[28:31], v[180:183]
v_mfma_f32_16x16x32_bf16 v[184:187], v[64:67], a[24:27], v[184:187]
ds_read_b128 v[56:59], v9 offset:20480
v_mfma_f32_16x16x32_bf16 v[192:195], v[64:67], a[28:31], v[192:195]
buffer_load_dwordx4 a[60:63], v5, s[4:7], s83 offen offset:2048 sc1
v_mfma_f32_16x16x32_bf16 v[188:191], v[68:71], a[24:27], v[188:191]
ds_read_b128 v[60:63], v9 offset:21504
v_mfma_f32_16x16x32_bf16 v[196:199], v[68:71], a[28:31], v[196:199]
s_waitcnt vmcnt(5)
v_cmp_ne_u64 vcc, s[66:67], v[38:39]
s_nop 0
s_cbranch_vccnz LS1_sp16
LS1_ok15:
s_waitcnt lgkmcnt(2)
v_mfma_f32_16x16x32_bf16 v[168:171], v[40:43], a[32:35], v[168:171]
ds_read_b128 v[64:67], v9 offset:22528
v_mfma_f32_16x16x32_bf16 v[176:179], v[40:43], a[36:39], v[176:179]
buffer_load_dwordx4 a[64:67], v1, s[4:7], s76 offen offset:3072 sc1
v_mfma_f32_16x16x32_bf16 v[172:175], v[44:47], a[32:35], v[172:175]
ds_read_b128 v[68:71], v9 offset:23552
v_mfma_f32_16x16x32_bf16 v[180:183], v[44:47], a[36:39], v[180:183]
v_mfma_f32_16x16x32_bf16 v[184:187], v[48:51], a[32:35], v[184:187]
ds_read_b128 v[40:43], v8 offset:0
v_mfma_f32_16x16x32_bf16 v[192:195], v[48:51], a[36:39], v[192:195]
buffer_load_dwordx4 a[68:71], v1, s[4:7], s80 offen offset:3072 sc1
v_mfma_f32_16x16x32_bf16 v[188:191], v[52:55], a[32:35], v[188:191]
ds_read_b128 v[44:47], v8 offset:1024
v_mfma_f32_16x16x32_bf16 v[196:199], v[52:55], a[36:39], v[196:199]
s_waitcnt vmcnt(6) lgkmcnt(2)
v_mfma_f32_16x16x32_bf16 v[168:171], v[56:59], a[40:43], v[168:171]
ds_read_b128 v[48:51], v8 offset:2048
v_mfma_f32_16x16x32_bf16 v[176:179], v[56:59], a[44:47], v[176:179]
buffer_load_dwordx4 a[72:75], v1, s[4:7], s77 offen offset:3072 sc1
v_mfma_f32_16x16x32_bf16 v[172:175], v[60:63], a[40:43], v[172:175]
ds_read_b128 v[52:55], v8 offset:3072
v_mfma_f32_16x16x32_bf16 v[180:183], v[60:63], a[44:47], v[180:183]
v_mfma_f32_16x16x32_bf16 v[184:187], v[64:67], a[40:43], v[184:187]
ds_read_b128 v[56:59], v8 offset:4096
v_mfma_f32_16x16x32_bf16 v[192:195], v[64:67], a[44:47], v[192:195]
buffer_load_dwordx4 a[76:79], v1, s[4:7], s81 offen offset:3072 sc1
v_mfma_f32_16x16x32_bf16 v[188:191], v[68:71], a[40:43], v[188:191]
ds_read_b128 v[60:63], v8 offset:5120
v_mfma_f32_16x16x32_bf16 v[196:199], v[68:71], a[44:47], v[196:199]
s_waitcnt vmcnt(6) lgkmcnt(2)
v_mfma_f32_16x16x32_bf16 v[168:171], v[40:43], a[48:51], v[168:171]
ds_read_b128 v[64:67], v8 offset:6144
v_mfma_f32_16x16x32_bf16 v[176:179], v[40:43], a[52:55], v[176:179]
buffer_load_dwordx4 a[80:83], v1, s[4:7], s78 offen offset:3072 sc1
v_mfma_f32_16x16x32_bf16 v[172:175], v[44:47], a[48:51], v[172:175]
s_barrier
v_mfma_f32_16x16x32_bf16 v[180:183], v[44:47], a[52:55], v[180:183]
ds_read_b128 v[68:71], v8 offset:7168
v_mfma_f32_16x16x32_bf16 v[184:187], v[48:51], a[48:51], v[184:187]
ds_read_b128 v[40:43], v9 offset:49152
v_mfma_f32_16x16x32_bf16 v[192:195], v[48:51], a[52:55], v[192:195]
buffer_load_dwordx4 a[84:87], v1, s[4:7], s82 offen offset:3072 sc1
v_mfma_f32_16x16x32_bf16 v[188:191], v[52:55], a[48:51], v[188:191]
ds_read_b128 v[44:47], v9 offset:50176
v_mfma_f32_16x16x32_bf16 v[196:199], v[52:55], a[52:55], v[196:199]
s_waitcnt vmcnt(6) lgkmcnt(2)
v_mfma_f32_16x16x32_bf16 v[168:171], v[56:59], a[56:59], v[168:171]
ds_read_b128 v[48:51], v9 offset:51200
v_mfma_f32_16x16x32_bf16 v[176:179], v[56:59], a[60:63], v[176:179]
buffer_load_dwordx4 a[88:91], v1, s[4:7], s79 offen offset:3072 sc1
v_mfma_f32_16x16x32_bf16 v[172:175], v[60:63], a[56:59], v[172:175]
ds_read_b128 v[52:55], v9 offset:52224
v_mfma_f32_16x16x32_bf16 v[180:183], v[60:63], a[60:63], v[180:183]
v_mfma_f32_16x16x32_bf16 v[184:187], v[64:67], a[56:59], v[184:187]
ds_read_b128 v[56:59], v9 offset:53248
v_mfma_f32_16x16x32_bf16 v[192:195], v[64:67], a[60:63], v[192:195]
buffer_load_dwordx4 a[92:95], v1, s[4:7], s83 offen offset:3072 sc1
v_mfma_f32_16x16x32_bf16 v[188:191], v[68:71], a[56:59], v[188:191]
ds_read_b128 v[60:63], v9 offset:54272
v_mfma_f32_16x16x32_bf16 v[196:199], v[68:71], a[60:63], v[196:199]
s_waitcnt vmcnt(6) lgkmcnt(2)
v_mfma_f32_16x16x32_bf16 v[168:171], v[40:43], a[64:67], v[168:171]
ds_read_b128 v[64:67], v9 offset:55296
v_mfma_f32_16x16x32_bf16 v[176:179], v[40:43], a[68:71], v[176:179]
v_mfma_f32_16x16x32_bf16 v[172:175], v[44:47], a[64:67], v[172:175]
ds_read_b128 v[68:71], v9 offset:56320
v_mfma_f32_16x16x32_bf16 v[180:183], v[44:47], a[68:71], v[180:183]
v_mfma_f32_16x16x32_bf16 v[184:187], v[48:51], a[64:67], v[184:187]
ds_read_b128 v[40:43], v10 offset:0
v_mfma_f32_16x16x32_bf16 v[192:195], v[48:51], a[68:71], v[192:195]
v_mfma_f32_16x16x32_bf16 v[188:191], v[52:55], a[64:67], v[188:191]
ds_read_b128 v[44:47], v10 offset:1024
v_mfma_f32_16x16x32_bf16 v[196:199], v[52:55], a[68:71], v[196:199]
s_waitcnt vmcnt(4) lgkmcnt(2)
v_mfma_f32_16x16x32_bf16 v[168:171], v[56:59], a[72:75], v[168:171]
ds_read_b128 v[48:51], v10 offset:2048
v_mfma_f32_16x16x32_bf16 v[176:179], v[56:59], a[76:79], v[176:179]
v_mfma_f32_16x16x32_bf16 v[172:175], v[60:63], a[72:75], v[172:175]
ds_read_b128 v[52:55], v10 offset:3072
v_mfma_f32_16x16x32_bf16 v[180:183], v[60:63], a[76:79], v[180:183]
v_mfma_f32_16x16x32_bf16 v[184:187], v[64:67], a[72:75], v[184:187]
ds_read_b128 v[56:59], v10 offset:4096
v_mfma_f32_16x16x32_bf16 v[192:195], v[64:67], a[76:79], v[192:195]
v_mfma_f32_16x16x32_bf16 v[188:191], v[68:71], a[72:75], v[188:191]
ds_read_b128 v[60:63], v10 offset:5120
v_mfma_f32_16x16x32_bf16 v[196:199], v[68:71], a[76:79], v[196:199]
s_waitcnt vmcnt(2) lgkmcnt(2)
ds_read_b128 v[64:67], v10 offset:6144
ds_read_b128 v[68:71], v10 offset:7168
v_mfma_f32_16x16x32_bf16 v[184:187], v[48:51], a[80:83], v[184:187]
v_mfma_f32_16x16x32_bf16 v[192:195], v[48:51], a[84:87], v[192:195]
v_mfma_f32_16x16x32_bf16 v[188:191], v[52:55], a[80:83], v[188:191]
v_mfma_f32_16x16x32_bf16 v[196:199], v[52:55], a[84:87], v[196:199]
s_waitcnt vmcnt(1) lgkmcnt(1)
v_mfma_f32_16x16x32_bf16 v[184:187], v[64:67], a[88:91], v[184:187]
s_waitcnt vmcnt(0)
v_mfma_f32_16x16x32_bf16 v[192:195], v[64:67], a[92:95], v[192:195]
s_waitcnt lgkmcnt(0)
v_mfma_f32_16x16x32_bf16 v[188:191], v[68:71], a[88:91], v[188:191]
v_mfma_f32_16x16x32_bf16 v[196:199], v[68:71], a[92:95], v[196:199]
v_mfma_f32_16x16x32_bf16 v[168:171], v[40:43], a[80:83], v[168:171]
v_mfma_f32_16x16x32_bf16 v[176:179], v[40:43], a[84:87], v[176:179]
v_mfma_f32_16x16x32_bf16 v[172:175], v[44:47], a[80:83], v[172:175]
v_mfma_f32_16x16x32_bf16 v[180:183], v[44:47], a[84:87], v[180:183]
ds_write_b128 v18, v[184:187] offset:0
v_mfma_f32_16x16x32_bf16 v[168:171], v[56:59], a[88:91], v[168:171]
s_nop 0
ds_write_b128 v18, v[188:191] offset:1024
v_mfma_f32_16x16x32_bf16 v[176:179], v[56:59], a[92:95], v[176:179]
ds_write_b128 v18, v[192:195] offset:2048
v_mfma_f32_16x16x32_bf16 v[172:175], v[60:63], a[88:91], v[172:175]
ds_write_b128 v18, v[196:199] offset:3072
v_mfma_f32_16x16x32_bf16 v[180:183], v[60:63], a[92:95], v[180:183]
s_waitcnt lgkmcnt(0)
s_barrier
ds_read_b128 v[224:227], v19 offset:0
ds_read_b128 v[228:231], v19 offset:1024
ds_read_b128 v[232:235], v19 offset:2048
ds_read_b128 v[236:239], v19 offset:3072
s_waitcnt lgkmcnt(3)
v_pk_add_f32 v[168:169], v[168:169], v[224:225]
v_pk_add_f32 v[170:171], v[170:171], v[226:227]
s_waitcnt lgkmcnt(2)
v_pk_add_f32 v[172:173], v[172:173], v[228:229]
v_pk_add_f32 v[174:175], v[174:175], v[230:231]
s_waitcnt lgkmcnt(1)
v_pk_add_f32 v[176:177], v[176:177], v[232:233]
v_pk_add_f32 v[178:179], v[178:179], v[234:235]
s_waitcnt lgkmcnt(0)
v_pk_add_f32 v[180:181], v[180:181], v[236:237]
v_pk_add_f32 v[182:183], v[182:183], v[238:239]
v_cvt_pk_bf16_f32 v124, v168, v169
v_cvt_pk_bf16_f32 v125, v170, v171
v_cvt_pk_bf16_f32 v126, v172, v173
v_cvt_pk_bf16_f32 v127, v174, v175
v_cvt_pk_bf16_f32 v128, v176, v177
v_cvt_pk_bf16_f32 v129, v178, v179
v_cvt_pk_bf16_f32 v130, v180, v181
v_cvt_pk_bf16_f32 v131, v182, v183
v_and_b32 v224, 15, v0
v_lshlrev_b32 v27, 11, v224
v_bfe_u32 v224, v0, 5, 1
v_lshl_add_u32 v27, v224, 4, v27
v_bfe_u32 v224, v0, 4, 1
v_lshl_add_u32 v27, v224, 5, v27
s_add_u32 s49, s54, 32768
v_permlane16_swap_b32 v124, v126
v_permlane16_swap_b32 v125, v127
v_permlane16_swap_b32 v128, v130
v_permlane16_swap_b32 v129, v131
buffer_store_dwordx4 v[124:127], v27, s[8:11], s54 offen
buffer_store_dwordx4 v[128:131], v27, s[8:11], s49 offen
s_or_b32 s48, s2, s14
s_cbranch_scc1 LS1_c17
s_mov_b32 s48, 8134656
buffer_store_dword v37, v26, s[4:7], s48 offen
LS1_c17:
s_endpgm
.fill 64, 4, 0xbf800000
.section .rodata,"a"
.p2align 6
.amdhsa_kernel interleave_layers__sliding_local_dilated__swiglu_ffn__prompt_kernel
  .amdhsa_next_free_vgpr 512
  .amdhsa_next_free_sgpr 102
  .amdhsa_accum_offset 256
  .amdhsa_group_segment_fixed_size 0
  .amdhsa_kernarg_size 80
  .amdhsa_user_sgpr_count 2
  .amdhsa_user_sgpr_kernarg_segment_ptr 1
  .amdhsa_system_sgpr_workgroup_id_x 1
  .amdhsa_float_denorm_mode_32 3
.end_amdhsa_kernel
```
